```python
import torch

def _softmax(x, axis=-1):
    return torch.softmax(x, dim=axis)

def _gelu(x):
    return torch.nn.functional.gelu(x, approximate='tanh')

def _silu(x):
    return torch.nn.functional.silu(x)

def _sigmoid(x):
    return torch.sigmoid(x)

def _layernorm(x, axis=-1, eps=1e-05):
    m = x.mean(dim=axis, keepdim=True)
    v = x.var(dim=axis, keepdim=True, unbiased=False)
    return (x - m) / torch.sqrt(v + eps)

def _scatter_add(tgt, idx, src, axis=0):
    return tgt.clone().index_add_(axis, idx, src)

def _segment_sum(src, seg, n):
    out = torch.zeros((n,) + src.shape[1:], dtype=src.dtype)
    return out.index_add_(0, seg, src)

def _pad(x, pw):
    flat = tuple((v for pair in reversed(pw) for v in pair))
    return torch.nn.functional.pad(x, flat)
kernel_name = 'interleave_layers__linear_attn_block__memory_aug_recurrent_mem_tr__prompt'

def setup_inputs():

    _w = lambda a: (lambda t: t.to(torch.bfloat16) if t.is_floating_point() else t)(torch.as_tensor(a))

    def _A_setup():
        B, S, D = (1, 2048, 512)
        return {'x': _w((lambda *s: torch.randn(*s, dtype=torch.bfloat16) * 0.05)(B, S, D)), 'wqkv': _w((lambda *s: torch.randn(*s, dtype=torch.bfloat16) * 0.05)(D, 3 * D)), 'wo': _w((lambda *s: torch.randn(*s, dtype=torch.bfloat16) * 0.05)(D, D))}
    _A_in = _A_setup()

    def _B_setup():
        B, S, Dm = (1, 2048, 512)
        H, Dh = (32, 128)
        M, seg = (8, 32)
        seg = min(seg, S)
        S = S // seg * seg
        return {'x': _w((lambda *s: torch.randn(*s, dtype=torch.bfloat16) * 0.05)(B, S, Dm)), 'mem0': _w((lambda *s: torch.randn(*s, dtype=torch.bfloat16) * 0.4)(B, M, Dm)), 'Wq': _w((lambda *s: torch.randn(*s, dtype=torch.bfloat16) * 3.2)(Dm, H, Dh) * Dm ** (-0.5)), 'Wk': _w((lambda *s: torch.randn(*s, dtype=torch.bfloat16) * 3.2)(Dm, H, Dh) * Dm ** (-0.5)), 'Wv': _w((lambda *s: torch.randn(*s, dtype=torch.bfloat16) * 0.4)(Dm, H, Dh) * Dm ** (-0.5)), 'Wo': _w((lambda *s: torch.randn(*s, dtype=torch.bfloat16) * 0.4)(H, Dh, Dm) * (H * Dh) ** (-0.5)), 'seg_len': seg}
    _B_in = _B_setup()
    return {'A_x': _A_in['x'], 'A_wqkv': _A_in['wqkv'], 'A_wo': _A_in['wo'], 'B_x': _B_in['x'], 'B_mem0': _B_in['mem0'], 'B_Wq': _B_in['Wq'], 'B_Wk': _B_in['Wk'], 'B_Wv': _B_in['Wv'], 'B_Wo': _B_in['Wo'], 'B_seg_len': _B_in['seg_len']}

def reference(A_x, A_wqkv, A_wo, B_x, B_mem0, B_Wq, B_Wk, B_Wv, B_Wo, B_seg_len):

    def _A_ref(x, wqkv, wo):
        B, S, D = x.shape
        H = 32
        Dh = D // H
        qkv = (lambda x, *d: x.permute(*d))((x @ wqkv).reshape(B, S, 3, H, Dh), 2, 0, 3, 1, 4)
        q, k, v = (qkv[0], qkv[1], qkv[2])
        phi = lambda t: torch.where(t > 0, t + 1, torch.exp(t)) + 1e-06
        pq, pk = (phi(q), phi(k))
        kv = torch.einsum('bhsd,bhse->bhde', pk, v)
        z = torch.einsum('bhsd->bhd', pk)
        num = torch.einsum('bhqd,bhde->bhqe', pq, kv)
        den = torch.einsum('bhqd,bhd->bhq', pq, z)[..., None] + 1e-06
        o = num / den
        return (lambda x, *d: x.permute(*d))(o, 0, 2, 1, 3).reshape(B, S, D) @ wo

    def _B_ref(x, mem0, Wq, Wk, Wv, Wo, seg_len):
        B, S, Dm = x.shape
        H, Dh = (Wq.shape[1], Wq.shape[2])
        M = mem0.shape[1]
        scale = Dh ** (-0.5)
        n_seg = S // seg_len
        L = M + seg_len
        idx = torch.arange(L)
        mask = (idx[:, None] < M) | (idx[:, None] >= idx[None, :])
        mem = mem0
        outs = []
        for s in range(n_seg):
            xs = x[:, s * seg_len:(s + 1) * seg_len, :].clone()
            h = torch.concatenate([mem, xs], axis=1)
            q = torch.einsum('btd,dhe->bhte', h, Wq)
            k = torch.einsum('btd,dhe->bhte', h, Wk)
            v = torch.einsum('btd,dhe->bhte', h, Wv)
            scores = torch.einsum('bhqe,bhke->bhqk', q, k) * scale
            scores = torch.where(mask[None, None], scores, -1000000000.0)
            p = _softmax(scores, axis=-1)
            o = torch.einsum('bhqk,bhke->bhqe', p, v)
            o = torch.einsum('bhte,hed->btd', o, Wo)
            mem = o[:, :M, :].clone()
            outs.append(o[:, M:, :])
        return torch.concatenate(outs, axis=1)
    x = A_x
    x = x + _A_ref(_layernorm(x, axis=-1), A_wqkv, A_wo)
    x = x + _B_ref(_layernorm(x, axis=-1), B_mem0, B_Wq, B_Wk, B_Wv, B_Wo, B_seg_len)
    x = x + _A_ref(_layernorm(x, axis=-1), A_wqkv, A_wo)
    x = x + _B_ref(_layernorm(x, axis=-1), B_mem0, B_Wq, B_Wk, B_Wv, B_Wo, B_seg_len)
    return x
```

```asm
; @launch grid=(256,1,1) block=(256,1,1) lds=163840
.amdgcn_target "amdgcn-amd-amdhsa--gfx950"
.text
.globl interleave_layers__linear_attn_block__memory_aug_recurrent_mem_tr__prompt_kernel
.p2align 8
.type interleave_layers__linear_attn_block__memory_aug_recurrent_mem_tr__prompt_kernel,@function
interleave_layers__linear_attn_block__memory_aug_recurrent_mem_tr__prompt_kernel:
  s_cmp_ge_u32 s2, 256
  s_cbranch_scc1 L_end
  v_lshrrev_b32 v1, 6, v0
  s_nop 0
  v_readfirstlane_b32 s21, v1
  v_and_b32 v0, 63, v0
  s_load_dwordx2 s[84:85], s[0:1], 8
  s_load_dwordx2 s[86:87], s[0:1], 0
  s_load_dwordx2 s[88:89], s[0:1], 48
  s_load_dwordx2 s[92:93], s[0:1], 88
  s_load_dwordx2 s[4:5], s[0:1], 96
  s_waitcnt lgkmcnt(0)
  s_and_b32 s5, s5, 0xffff
  s_mov_b32 s6, 268435456
  s_mov_b32 s7, 0x20000
  s_mov_b32 s12, s92
  s_and_b32 s13, s93, 0xffff
  s_mov_b32 s14, 256
  s_mov_b32 s15, 0x20000
  s_getreg_b32 s74, hwreg(HW_REG_XCC_ID)
  s_and_b32 s74, s74, 7
  s_lshl_b32 s29, s74, 5
  v_mov_b32 v1, 1
  v_mov_b32 v2, 1
  v_mov_b32 v3, 0
  s_cmp_lg_u32 s21, 0
  s_cbranch_scc1 L_tk
  s_mov_b64 exec, 1
  buffer_atomic_add v1, off, s[12:15], s29 sc0 sc1
  s_waitcnt vmcnt(0)
  ds_write_b32 v3, v1
  s_mov_b64 exec, -1
  s_waitcnt lgkmcnt(0)
L_tk:
  s_barrier
  ds_read_b32 v1, v3
  s_waitcnt lgkmcnt(0)
  v_readfirstlane_b32 s75, v1
  s_barrier
  s_cmp_lt_u32 s75, 32
  s_nop 1
  s_cbranch_scc1 L_slot
  s_mov_b32 s26, 0
  v_lshlrev_b32 v4, 5, v0
  s_nop 1
L_ov:
  buffer_load_dword v2, v4, s[12:15], 0 offen sc1
  s_waitcnt vmcnt(0)
  s_mov_b32 s53, 0
  v_readlane_b32 s29, v2, 0
  s_nop 0
  s_add_u32 s53, s53, s29
  v_readlane_b32 s29, v2, 1
  s_nop 0
  s_add_u32 s53, s53, s29
  v_readlane_b32 s29, v2, 2
  s_nop 0
  s_add_u32 s53, s53, s29
  v_readlane_b32 s29, v2, 3
  s_nop 0
  s_add_u32 s53, s53, s29
  v_readlane_b32 s29, v2, 4
  s_nop 0
  s_add_u32 s53, s53, s29
  v_readlane_b32 s29, v2, 5
  s_nop 0
  s_add_u32 s53, s53, s29
  v_readlane_b32 s29, v2, 6
  s_nop 0
  s_add_u32 s53, s53, s29
  v_readlane_b32 s29, v2, 7
  s_nop 0
  s_add_u32 s53, s53, s29
  s_cmp_ge_u32 s53, 256
  s_nop 0
  s_cbranch_scc1 L_ov2
  s_sleep 4
  s_add_u32 s26, s26, 1
  s_cmp_lt_u32 s26, 0x40000
  s_cbranch_scc1 L_ov
  s_branch L_end
L_ov2:
  v_mov_b32 v1, 1
  s_cmp_lg_u32 s21, 0
  s_cbranch_scc1 L_ov3
  s_mov_b64 exec, 1
  buffer_atomic_add v1, off, s[12:15], 0 offset:8 sc0 sc1
  s_waitcnt vmcnt(0)
  ds_write_b32 v3, v1
  s_mov_b64 exec, -1
  s_waitcnt lgkmcnt(0)
L_ov3:
  s_barrier
  ds_read_b32 v1, v3
  s_waitcnt lgkmcnt(0)
  v_readfirstlane_b32 s53, v1
  s_barrier
  v_readlane_b32 s29, v2, 0
  s_nop 0
  s_min_u32 s29, s29, 32
  s_add_u32 s75, s29, s53
  s_mov_b32 s74, 0
  s_cmp_lt_u32 s75, 32
  s_cbranch_scc1 L_slot
  s_sub_u32 s53, s75, 32
  v_readlane_b32 s29, v2, 1
  s_nop 0
  s_min_u32 s29, s29, 32
  s_add_u32 s75, s29, s53
  s_mov_b32 s74, 1
  s_cmp_lt_u32 s75, 32
  s_cbranch_scc1 L_slot
  s_sub_u32 s53, s75, 32
  v_readlane_b32 s29, v2, 2
  s_nop 0
  s_min_u32 s29, s29, 32
  s_add_u32 s75, s29, s53
  s_mov_b32 s74, 2
  s_cmp_lt_u32 s75, 32
  s_cbranch_scc1 L_slot
  s_sub_u32 s53, s75, 32
  v_readlane_b32 s29, v2, 3
  s_nop 0
  s_min_u32 s29, s29, 32
  s_add_u32 s75, s29, s53
  s_mov_b32 s74, 3
  s_cmp_lt_u32 s75, 32
  s_cbranch_scc1 L_slot
  s_sub_u32 s53, s75, 32
  v_readlane_b32 s29, v2, 4
  s_nop 0
  s_min_u32 s29, s29, 32
  s_add_u32 s75, s29, s53
  s_mov_b32 s74, 4
  s_cmp_lt_u32 s75, 32
  s_cbranch_scc1 L_slot
  s_sub_u32 s53, s75, 32
  v_readlane_b32 s29, v2, 5
  s_nop 0
  s_min_u32 s29, s29, 32
  s_add_u32 s75, s29, s53
  s_mov_b32 s74, 5
  s_cmp_lt_u32 s75, 32
  s_cbranch_scc1 L_slot
  s_sub_u32 s53, s75, 32
  v_readlane_b32 s29, v2, 6
  s_nop 0
  s_min_u32 s29, s29, 32
  s_add_u32 s75, s29, s53
  s_mov_b32 s74, 6
  s_cmp_lt_u32 s75, 32
  s_cbranch_scc1 L_slot
  s_sub_u32 s53, s75, 32
  v_readlane_b32 s29, v2, 7
  s_nop 0
  s_min_u32 s29, s29, 32
  s_add_u32 s75, s29, s53
  s_mov_b32 s74, 7
  s_cmp_lt_u32 s75, 32
  s_cbranch_scc1 L_slot
  s_sub_u32 s53, s75, 32
  s_branch L_end
L_slot:
  s_lshl_b32 s65, s74, 5
  s_add_u32 s65, s65, s75
  s_mov_b32 s20, s75
  s_mov_b32 s46, 0
  s_cmp_eq_u32 s74, 0
  s_cbranch_scc1 L_chain
  s_andn2_b32 s29, s74, 2
  s_cmp_lg_u32 s29, 4
  s_cbranch_scc1 L_p1
  s_cmp_lt_u32 s75, 16
  s_cbranch_scc1 L_p1
  s_cmp_eq_u32 s74, 6
  s_cbranch_scc1 L_g6
  s_add_u32 s64, s75, 2
  s_cmp_lt_u32 s75, 22
  s_cbranch_scc1 L_a1
  s_cmp_lt_u32 s75, 30
  s_cbranch_scc1 L_a2
  s_sub_u32 s64, s75, 26
  s_branch L_a1
L_g6:
  s_sub_u32 s64, s75, 4
  s_cmp_lt_u32 s75, 22
  s_cbranch_scc1 L_a1
  s_sub_u32 s64, s75, 16
  s_cmp_lt_u32 s75, 28
  s_cbranch_scc1 L_a1
  s_sub_u32 s64, s75, 28
  s_lshl_b32 s29, s64, 2
  s_add_u32 s29, s29, s21
  s_lshl_b32 s53, s29, 12
  s_mul_i32 s54, s29, 12288
  s_add_u32 s54, s54, 30408704
  v_lshlrev_b32 v1, 4, v0
  v_mov_b64 v[4:5], 0
  v_mov_b64 v[6:7], 0
  buffer_store_dwordx4 v[4:7], v1, s[4:7], s53 offen offset:0 sc1
  buffer_store_dwordx4 v[4:7], v1, s[4:7], s53 offen offset:1024 sc1
  buffer_store_dwordx4 v[4:7], v1, s[4:7], s53 offen offset:2048 sc1
  buffer_store_dwordx4 v[4:7], v1, s[4:7], s53 offen offset:3072 sc1
  buffer_store_dwordx4 v[4:7], v1, s[4:7], s54 offen offset:0 sc1
  buffer_store_dwordx4 v[4:7], v1, s[4:7], s54 offen offset:1024 sc1
  buffer_store_dwordx4 v[4:7], v1, s[4:7], s54 offen offset:2048 sc1
  buffer_store_dwordx4 v[4:7], v1, s[4:7], s54 offen offset:3072 sc1
  s_add_u32 s54, s54, 4096
  buffer_store_dwordx4 v[4:7], v1, s[4:7], s54 offen offset:0 sc1
  buffer_store_dwordx4 v[4:7], v1, s[4:7], s54 offen offset:1024 sc1
  buffer_store_dwordx4 v[4:7], v1, s[4:7], s54 offen offset:2048 sc1
  buffer_store_dwordx4 v[4:7], v1, s[4:7], s54 offen offset:3072 sc1
  s_add_u32 s54, s54, 4096
  buffer_store_dwordx4 v[4:7], v1, s[4:7], s54 offen offset:0 sc1
  buffer_store_dwordx4 v[4:7], v1, s[4:7], s54 offen offset:1024 sc1
  buffer_store_dwordx4 v[4:7], v1, s[4:7], s54 offen offset:2048 sc1
  buffer_store_dwordx4 v[4:7], v1, s[4:7], s54 offen offset:3072 sc1
  s_waitcnt vmcnt(0)
  s_barrier
  s_cmp_lg_u32 s21, 0
  s_cbranch_scc1 L_a1
  v_mov_b32 v1, 1
  s_mov_b64 exec, 1
  buffer_atomic_add v1, off, s[12:15], 0 offset:12 sc1
  s_mov_b64 exec, -1
  s_branch L_a1
L_p1:
  s_lshl_b32 s53, s74, 2
  s_lshr_b32 s29, 0x4b3a2100, s53
  s_and_b32 s29, s29, 15
  s_cmp_ge_u32 s29, 10
  s_cselect_b32 s53, 4, 5
  s_lshl_b32 s29, s29, s53
  s_add_u32 s64, s29, s75
  s_mov_b32 s82, 1
  s_branch L_a1x
L_a1:
  s_mov_b32 s82, 0
L_a1x:
  s_mul_hi_u32 s47, s64, 715827883
  s_mul_i32 s29, s47, 6
  s_sub_u32 s20, s64, s29
  s_mov_b32 s46, s47
  s_mov_b32 s50, s64
  s_cmp_eq_u32 s82, 0
  s_cbranch_scc1 L_a1b
  v_lshlrev_b32 v1, 4, v0
  v_and_b32 v2, 31, v0
  v_lshrrev_b32 v3, 5, v0
  v_bfe_u32 v4, v0, 2, 2
  s_mov_b32 s70, 0x358637bd
  s_mov_b32 s71, 0x358637bd
  s_mov_b32 s73, 0x3fb8aa3b
  s_mov_b32 s72, 0x3fb8aa3b
  s_mov_b32 s59, 0x3b000000
  s_mov_b32 s60, 0x3727c5ac
  v_mov_b32 v100, 0x3f803f80
  v_mov_b32 v101, 0x3f803f80
  v_mov_b32 v102, 0x3f803f80
  v_mov_b32 v103, 0x3f803f80
  v_mul_u32_u24 v5, 1040, v2
  v_lshl_add_u32 v5, v3, 4, v5
  s_lshl_b32 s29, s21, 13
  v_add_u32 v6, s29, v1
  s_lshl_b32 s29, s21, 8
  s_add_u32 s29, s29, 67584
  v_lshlrev_b32 v7, 2, v2
  v_add_u32 v7, s29, v7
  v_lshlrev_b32 v8, 4, v3
  v_add_u32 v8, s29, v8
  s_mov_b32 s8, s84
  s_and_b32 s9, s85, 0xffff
  s_mov_b32 s10, 1572864
  s_mov_b32 s11, 0x20000
  s_lshl_b32 s54, s75, 2
  s_add_u32 s54, s54, s21
  s_mul_i32 s54, s54, 12288
  v_lshlrev_b32 v17, 7, v0
  v_lshlrev_b32 v18, 7, v2
  buffer_load_dword v16, v17, s[8:11], s54 offen
  s_add_u32 s54, s54, 8192
  buffer_load_dword v16, v18, s[8:11], s54 offen
  s_lshl_b32 s57, s20, 9
  s_lshl_b32 s29, s21, 7
  s_add_u32 s57, s57, s29
  s_add_u32 s52, s57, 64
  s_lshl_b32 s53, s20, 8
  s_lshl_b32 s29, s21, 6
  s_add_u32 s53, s53, s29
  s_add_u32 s53, s53, 512
  s_add_u32 s54, s53, 1024
  s_cmp_lt_u32 s20, 2
  s_cselect_b32 s57, s57, s53
  s_cselect_b32 s52, s52, s54
  v_lshrrev_b32 v10, 3, v0
  v_and_b32 v11, 7, v0
  v_bfe_u32 v12, v0, 4, 1
  v_lshlrev_b32 v12, 2, v12
  v_xor_b32 v11, v11, v12
  s_mov_b32 s29, 3072
  v_mul_lo_u32 v10, v10, s29
  v_and_b32 v12, 3, v11
  v_lshl_add_u32 v10, v12, 4, v10
  s_sub_u32 s29, s52, s57
  v_lshrrev_b32 v12, 2, v11
  v_mul_lo_u32 v12, v12, s29
  v_add_u32 v10, v10, v12
  v_lshl_add_u32 v13, v3, 3, v4
  v_mul_u32_u24 v13, 128, v13
  v_bfe_u32 v12, v0, 4, 1
  v_lshl_add_u32 v13, v12, 5, v13
  v_and_b32 v12, 3, v0
  v_lshl_add_u32 v13, v12, 3, v13
  s_mul_i32 s83, s21, 24576
  s_add_u32 s83, s83, 33792
  v_add_u32 v13, s83, v13
  v_bfe_u32 v12, v0, 3, 1
  v_lshlrev_b32 v12, 6, v12
  v_xor_b32 v13, v13, v12
  v_xor_b32 v14, 64, v13
  s_mov_b32 s12, s86
  s_and_b32 s13, s87, 0xffff
  s_mov_b32 s14, 2097152
  s_mov_b32 s15, 0x20000
  s_mov_b32 s67, s57
  s_lshl_b32 s57, s46, 15
  s_mov_b32 s51, 0
  s_mul_i32 s53, s21, 8320
  s_add_u32 s53, s53, s51
  s_add_u32 m0, s53, 0
  s_add_u32 s54, s57, 0
  buffer_load_dwordx4 v6, s[12:15], s54 offen sc1 lds
  s_add_u32 m0, s53, 1040
  s_add_u32 s54, s57, 1024
  buffer_load_dwordx4 v6, s[12:15], s54 offen sc1 lds
  s_add_u32 m0, s53, 2080
  s_add_u32 s54, s57, 2048
  buffer_load_dwordx4 v6, s[12:15], s54 offen sc1 lds
  s_add_u32 m0, s53, 3120
  s_add_u32 s54, s57, 3072
  buffer_load_dwordx4 v6, s[12:15], s54 offen sc1 lds
  s_add_u32 m0, s53, 4160
  s_add_u32 s54, s57, 4096
  buffer_load_dwordx4 v6, s[12:15], s54 offen sc1 lds
  s_add_u32 m0, s53, 5200
  s_add_u32 s54, s57, 5120
  buffer_load_dwordx4 v6, s[12:15], s54 offen sc1 lds
  s_add_u32 m0, s53, 6240
  s_add_u32 s54, s57, 6144
  buffer_load_dwordx4 v6, s[12:15], s54 offen sc1 lds
  s_add_u32 m0, s53, 7280
  s_add_u32 s54, s57, 7168
  buffer_load_dwordx4 v6, s[12:15], s54 offen sc1 lds
  v_lshlrev_b32 v17, 7, v0
  s_lshl_b32 s29, s21, 13
  s_add_u32 s54, s57, s29
  s_add_u32 s54, s54, 1048576
  buffer_load_dword v16, v17, s[12:15], s54 offen
  s_mov_b32 s57, s67
  s_waitcnt lgkmcnt(0)
  s_add_u32 m0, s83, 0
  s_add_u32 s54, s57, 0
  buffer_load_dwordx4 v10, s[8:11], s54 offen lds
  s_add_u32 m0, s83, 1024
  s_add_u32 s54, s57, 24576
  buffer_load_dwordx4 v10, s[8:11], s54 offen lds
  s_add_u32 m0, s83, 2048
  s_add_u32 s54, s57, 49152
  buffer_load_dwordx4 v10, s[8:11], s54 offen lds
  s_add_u32 m0, s83, 3072
  s_add_u32 s54, s57, 73728
  buffer_load_dwordx4 v10, s[8:11], s54 offen lds
  s_add_u32 m0, s83, 4096
  s_add_u32 s54, s57, 98304
  buffer_load_dwordx4 v10, s[8:11], s54 offen lds
  s_add_u32 m0, s83, 5120
  s_add_u32 s54, s57, 122880
  buffer_load_dwordx4 v10, s[8:11], s54 offen lds
  s_add_u32 m0, s83, 6144
  s_add_u32 s54, s57, 147456
  buffer_load_dwordx4 v10, s[8:11], s54 offen lds
  s_add_u32 m0, s83, 7168
  s_add_u32 s54, s57, 172032
  buffer_load_dwordx4 v10, s[8:11], s54 offen lds
  s_add_u32 m0, s83, 8192
  s_add_u32 s54, s57, 196608
  buffer_load_dwordx4 v10, s[8:11], s54 offen lds
  s_add_u32 m0, s83, 9216
  s_add_u32 s54, s57, 221184
  buffer_load_dwordx4 v10, s[8:11], s54 offen lds
  s_add_u32 m0, s83, 10240
  s_add_u32 s54, s57, 245760
  buffer_load_dwordx4 v10, s[8:11], s54 offen lds
  s_add_u32 m0, s83, 11264
  s_add_u32 s54, s57, 270336
  buffer_load_dwordx4 v10, s[8:11], s54 offen lds
  s_add_u32 m0, s83, 12288
  s_add_u32 s54, s57, 294912
  buffer_load_dwordx4 v10, s[8:11], s54 offen lds
  s_add_u32 m0, s83, 13312
  s_add_u32 s54, s57, 319488
  buffer_load_dwordx4 v10, s[8:11], s54 offen lds
  s_add_u32 m0, s83, 14336
  s_add_u32 s54, s57, 344064
  buffer_load_dwordx4 v10, s[8:11], s54 offen lds
  s_add_u32 m0, s83, 15360
  s_add_u32 s54, s57, 368640
  buffer_load_dwordx4 v10, s[8:11], s54 offen lds
  s_add_u32 m0, s83, 16384
  s_add_u32 s54, s57, 393216
  buffer_load_dwordx4 v10, s[8:11], s54 offen lds
  s_add_u32 m0, s83, 17408
  s_add_u32 s54, s57, 417792
  buffer_load_dwordx4 v10, s[8:11], s54 offen lds
  s_add_u32 m0, s83, 18432
  s_add_u32 s54, s57, 442368
  buffer_load_dwordx4 v10, s[8:11], s54 offen lds
  s_add_u32 m0, s83, 19456
  s_add_u32 s54, s57, 466944
  buffer_load_dwordx4 v10, s[8:11], s54 offen lds
  s_add_u32 m0, s83, 20480
  s_add_u32 s54, s57, 491520
  buffer_load_dwordx4 v10, s[8:11], s54 offen lds
  s_add_u32 m0, s83, 21504
  s_add_u32 s54, s57, 516096
  buffer_load_dwordx4 v10, s[8:11], s54 offen lds
  s_add_u32 m0, s83, 22528
  s_add_u32 s54, s57, 540672
  buffer_load_dwordx4 v10, s[8:11], s54 offen lds
  s_add_u32 m0, s83, 23552
  s_add_u32 s54, s57, 565248
  buffer_load_dwordx4 v10, s[8:11], s54 offen lds
  s_waitcnt vmcnt(16)
  ds_read_b64_tr_b16 a[0:1], v13 offset:0
  ds_read_b64_tr_b16 a[2:3], v13 offset:512
  ds_read_b64_tr_b16 a[4:5], v14 offset:0
  ds_read_b64_tr_b16 a[6:7], v14 offset:512
  ds_read_b64_tr_b16 a[8:9], v13 offset:2048
  ds_read_b64_tr_b16 a[10:11], v13 offset:2560
  ds_read_b64_tr_b16 a[12:13], v14 offset:2048
  ds_read_b64_tr_b16 a[14:15], v14 offset:2560
  ds_read_b64_tr_b16 a[16:17], v13 offset:4096
  ds_read_b64_tr_b16 a[18:19], v13 offset:4608
  ds_read_b64_tr_b16 a[20:21], v14 offset:4096
  ds_read_b64_tr_b16 a[22:23], v14 offset:4608
  ds_read_b64_tr_b16 a[24:25], v13 offset:6144
  ds_read_b64_tr_b16 a[26:27], v13 offset:6656
  ds_read_b64_tr_b16 a[28:29], v14 offset:6144
  ds_read_b64_tr_b16 a[30:31], v14 offset:6656
  s_waitcnt lgkmcnt(0)
  s_add_u32 m0, s83, 0
  s_add_u32 s54, s57, 589824
  buffer_load_dwordx4 v10, s[8:11], s54 offen lds
  s_add_u32 m0, s83, 1024
  s_add_u32 s54, s57, 614400
  buffer_load_dwordx4 v10, s[8:11], s54 offen lds
  s_add_u32 m0, s83, 2048
  s_add_u32 s54, s57, 638976
  buffer_load_dwordx4 v10, s[8:11], s54 offen lds
  s_add_u32 m0, s83, 3072
  s_add_u32 s54, s57, 663552
  buffer_load_dwordx4 v10, s[8:11], s54 offen lds
  s_add_u32 m0, s83, 4096
  s_add_u32 s54, s57, 688128
  buffer_load_dwordx4 v10, s[8:11], s54 offen lds
  s_add_u32 m0, s83, 5120
  s_add_u32 s54, s57, 712704
  buffer_load_dwordx4 v10, s[8:11], s54 offen lds
  s_add_u32 m0, s83, 6144
  s_add_u32 s54, s57, 737280
  buffer_load_dwordx4 v10, s[8:11], s54 offen lds
  s_add_u32 m0, s83, 7168
  s_add_u32 s54, s57, 761856
  buffer_load_dwordx4 v10, s[8:11], s54 offen lds
  s_cmp_lt_u32 s20, 2
  s_cbranch_scc0 Lws_1
  v_mfma_f32_32x32x16_bf16 v[48:63], a[0:3], v[100:103], 0
  v_mfma_f32_32x32x16_bf16 v[64:79], a[4:7], v[100:103], 0
  v_mfma_f32_32x32x16_bf16 v[48:63], a[8:11], v[100:103], v[48:63]
  v_mfma_f32_32x32x16_bf16 v[64:79], a[12:15], v[100:103], v[64:79]
  v_mfma_f32_32x32x16_bf16 v[48:63], a[16:19], v[100:103], v[48:63]
  v_mfma_f32_32x32x16_bf16 v[64:79], a[20:23], v[100:103], v[64:79]
  v_mfma_f32_32x32x16_bf16 v[48:63], a[24:27], v[100:103], v[48:63]
  v_mfma_f32_32x32x16_bf16 v[64:79], a[28:31], v[100:103], v[64:79]
  s_nop 10
  s_branch Lws_2
Lws_1:
  v_mfma_f32_32x32x16_bf16 v[48:63], v[100:103], a[0:3], 0
  v_mfma_f32_32x32x16_bf16 v[64:79], v[100:103], a[4:7], 0
  v_mfma_f32_32x32x16_bf16 v[48:63], v[100:103], a[8:11], v[48:63]
  v_mfma_f32_32x32x16_bf16 v[64:79], v[100:103], a[12:15], v[64:79]
  v_mfma_f32_32x32x16_bf16 v[48:63], v[100:103], a[16:19], v[48:63]
  v_mfma_f32_32x32x16_bf16 v[64:79], v[100:103], a[20:23], v[64:79]
  v_mfma_f32_32x32x16_bf16 v[48:63], v[100:103], a[24:27], v[48:63]
  v_mfma_f32_32x32x16_bf16 v[64:79], v[100:103], a[28:31], v[64:79]
  s_nop 11
Lws_2:
  s_waitcnt vmcnt(16)
  ds_read_b64_tr_b16 a[32:33], v13 offset:8192
  ds_read_b64_tr_b16 a[34:35], v13 offset:8704
  ds_read_b64_tr_b16 a[36:37], v14 offset:8192
  ds_read_b64_tr_b16 a[38:39], v14 offset:8704
  ds_read_b64_tr_b16 a[40:41], v13 offset:10240
  ds_read_b64_tr_b16 a[42:43], v13 offset:10752
  ds_read_b64_tr_b16 a[44:45], v14 offset:10240
  ds_read_b64_tr_b16 a[46:47], v14 offset:10752
  ds_read_b64_tr_b16 a[48:49], v13 offset:12288
  ds_read_b64_tr_b16 a[50:51], v13 offset:12800
  ds_read_b64_tr_b16 a[52:53], v14 offset:12288
  ds_read_b64_tr_b16 a[54:55], v14 offset:12800
  ds_read_b64_tr_b16 a[56:57], v13 offset:14336
  ds_read_b64_tr_b16 a[58:59], v13 offset:14848
  ds_read_b64_tr_b16 a[60:61], v14 offset:14336
  ds_read_b64_tr_b16 a[62:63], v14 offset:14848
  s_waitcnt lgkmcnt(0)
  s_add_u32 m0, s83, 8192
  s_add_u32 s54, s57, 786432
  buffer_load_dwordx4 v10, s[8:11], s54 offen lds
  s_add_u32 m0, s83, 9216
  s_add_u32 s54, s57, 811008
  buffer_load_dwordx4 v10, s[8:11], s54 offen lds
  s_add_u32 m0, s83, 10240
  s_add_u32 s54, s57, 835584
  buffer_load_dwordx4 v10, s[8:11], s54 offen lds
  s_add_u32 m0, s83, 11264
  s_add_u32 s54, s57, 860160
  buffer_load_dwordx4 v10, s[8:11], s54 offen lds
  s_add_u32 m0, s83, 12288
  s_add_u32 s54, s57, 884736
  buffer_load_dwordx4 v10, s[8:11], s54 offen lds
  s_add_u32 m0, s83, 13312
  s_add_u32 s54, s57, 909312
  buffer_load_dwordx4 v10, s[8:11], s54 offen lds
  s_add_u32 m0, s83, 14336
  s_add_u32 s54, s57, 933888
  buffer_load_dwordx4 v10, s[8:11], s54 offen lds
  s_add_u32 m0, s83, 15360
  s_add_u32 s54, s57, 958464
  buffer_load_dwordx4 v10, s[8:11], s54 offen lds
  s_cmp_lt_u32 s20, 2
  s_cbranch_scc0 Lws_3
  v_mfma_f32_32x32x16_bf16 v[48:63], a[32:35], v[100:103], v[48:63]
  v_mfma_f32_32x32x16_bf16 v[64:79], a[36:39], v[100:103], v[64:79]
  v_mfma_f32_32x32x16_bf16 v[48:63], a[40:43], v[100:103], v[48:63]
  v_mfma_f32_32x32x16_bf16 v[64:79], a[44:47], v[100:103], v[64:79]
  v_mfma_f32_32x32x16_bf16 v[48:63], a[48:51], v[100:103], v[48:63]
  v_mfma_f32_32x32x16_bf16 v[64:79], a[52:55], v[100:103], v[64:79]
  v_mfma_f32_32x32x16_bf16 v[48:63], a[56:59], v[100:103], v[48:63]
  v_mfma_f32_32x32x16_bf16 v[64:79], a[60:63], v[100:103], v[64:79]
  s_nop 10
  s_branch Lws_4
Lws_3:
  v_mfma_f32_32x32x16_bf16 v[48:63], v[100:103], a[32:35], v[48:63]
  v_mfma_f32_32x32x16_bf16 v[64:79], v[100:103], a[36:39], v[64:79]
  v_mfma_f32_32x32x16_bf16 v[48:63], v[100:103], a[40:43], v[48:63]
  v_mfma_f32_32x32x16_bf16 v[64:79], v[100:103], a[44:47], v[64:79]
  v_mfma_f32_32x32x16_bf16 v[48:63], v[100:103], a[48:51], v[48:63]
  v_mfma_f32_32x32x16_bf16 v[64:79], v[100:103], a[52:55], v[64:79]
  v_mfma_f32_32x32x16_bf16 v[48:63], v[100:103], a[56:59], v[48:63]
  v_mfma_f32_32x32x16_bf16 v[64:79], v[100:103], a[60:63], v[64:79]
  s_nop 11
Lws_4:
  s_waitcnt vmcnt(16)
  ds_read_b64_tr_b16 a[64:65], v13 offset:16384
  ds_read_b64_tr_b16 a[66:67], v13 offset:16896
  ds_read_b64_tr_b16 a[68:69], v14 offset:16384
  ds_read_b64_tr_b16 a[70:71], v14 offset:16896
  ds_read_b64_tr_b16 a[72:73], v13 offset:18432
  ds_read_b64_tr_b16 a[74:75], v13 offset:18944
  ds_read_b64_tr_b16 a[76:77], v14 offset:18432
  ds_read_b64_tr_b16 a[78:79], v14 offset:18944
  ds_read_b64_tr_b16 a[80:81], v13 offset:20480
  ds_read_b64_tr_b16 a[82:83], v13 offset:20992
  ds_read_b64_tr_b16 a[84:85], v14 offset:20480
  ds_read_b64_tr_b16 a[86:87], v14 offset:20992
  ds_read_b64_tr_b16 a[88:89], v13 offset:22528
  ds_read_b64_tr_b16 a[90:91], v13 offset:23040
  ds_read_b64_tr_b16 a[92:93], v14 offset:22528
  ds_read_b64_tr_b16 a[94:95], v14 offset:23040
  s_waitcnt lgkmcnt(0)
  s_add_u32 m0, s83, 16384
  s_add_u32 s54, s57, 983040
  buffer_load_dwordx4 v10, s[8:11], s54 offen lds
  s_add_u32 m0, s83, 17408
  s_add_u32 s54, s57, 1007616
  buffer_load_dwordx4 v10, s[8:11], s54 offen lds
  s_add_u32 m0, s83, 18432
  s_add_u32 s54, s57, 1032192
  buffer_load_dwordx4 v10, s[8:11], s54 offen lds
  s_add_u32 m0, s83, 19456
  s_add_u32 s54, s57, 1056768
  buffer_load_dwordx4 v10, s[8:11], s54 offen lds
  s_add_u32 m0, s83, 20480
  s_add_u32 s54, s57, 1081344
  buffer_load_dwordx4 v10, s[8:11], s54 offen lds
  s_add_u32 m0, s83, 21504
  s_add_u32 s54, s57, 1105920
  buffer_load_dwordx4 v10, s[8:11], s54 offen lds
  s_add_u32 m0, s83, 22528
  s_add_u32 s54, s57, 1130496
  buffer_load_dwordx4 v10, s[8:11], s54 offen lds
  s_add_u32 m0, s83, 23552
  s_add_u32 s54, s57, 1155072
  buffer_load_dwordx4 v10, s[8:11], s54 offen lds
  s_cmp_lt_u32 s20, 2
  s_cbranch_scc0 Lws_5
  v_mfma_f32_32x32x16_bf16 v[48:63], a[64:67], v[100:103], v[48:63]
  v_mfma_f32_32x32x16_bf16 v[64:79], a[68:71], v[100:103], v[64:79]
  v_mfma_f32_32x32x16_bf16 v[48:63], a[72:75], v[100:103], v[48:63]
  v_mfma_f32_32x32x16_bf16 v[64:79], a[76:79], v[100:103], v[64:79]
  v_mfma_f32_32x32x16_bf16 v[48:63], a[80:83], v[100:103], v[48:63]
  v_mfma_f32_32x32x16_bf16 v[64:79], a[84:87], v[100:103], v[64:79]
  v_mfma_f32_32x32x16_bf16 v[48:63], a[88:91], v[100:103], v[48:63]
  v_mfma_f32_32x32x16_bf16 v[64:79], a[92:95], v[100:103], v[64:79]
  s_nop 10
  s_branch Lws_6
Lws_5:
  v_mfma_f32_32x32x16_bf16 v[48:63], v[100:103], a[64:67], v[48:63]
  v_mfma_f32_32x32x16_bf16 v[64:79], v[100:103], a[68:71], v[64:79]
  v_mfma_f32_32x32x16_bf16 v[48:63], v[100:103], a[72:75], v[48:63]
  v_mfma_f32_32x32x16_bf16 v[64:79], v[100:103], a[76:79], v[64:79]
  v_mfma_f32_32x32x16_bf16 v[48:63], v[100:103], a[80:83], v[48:63]
  v_mfma_f32_32x32x16_bf16 v[64:79], v[100:103], a[84:87], v[64:79]
  v_mfma_f32_32x32x16_bf16 v[48:63], v[100:103], a[88:91], v[48:63]
  v_mfma_f32_32x32x16_bf16 v[64:79], v[100:103], a[92:95], v[64:79]
  s_nop 11
Lws_6:
  s_waitcnt vmcnt(16)
  ds_read_b64_tr_b16 a[96:97], v13 offset:0
  ds_read_b64_tr_b16 a[98:99], v13 offset:512
  ds_read_b64_tr_b16 a[100:101], v14 offset:0
  ds_read_b64_tr_b16 a[102:103], v14 offset:512
  ds_read_b64_tr_b16 a[104:105], v13 offset:2048
  ds_read_b64_tr_b16 a[106:107], v13 offset:2560
  ds_read_b64_tr_b16 a[108:109], v14 offset:2048
  ds_read_b64_tr_b16 a[110:111], v14 offset:2560
  ds_read_b64_tr_b16 a[112:113], v13 offset:4096
  ds_read_b64_tr_b16 a[114:115], v13 offset:4608
  ds_read_b64_tr_b16 a[116:117], v14 offset:4096
  ds_read_b64_tr_b16 a[118:119], v14 offset:4608
  ds_read_b64_tr_b16 a[120:121], v13 offset:6144
  ds_read_b64_tr_b16 a[122:123], v13 offset:6656
  ds_read_b64_tr_b16 a[124:125], v14 offset:6144
  ds_read_b64_tr_b16 a[126:127], v14 offset:6656
  s_waitcnt lgkmcnt(0)
  s_add_u32 m0, s83, 0
  s_add_u32 s54, s57, 1179648
  buffer_load_dwordx4 v10, s[8:11], s54 offen lds
  s_add_u32 m0, s83, 1024
  s_add_u32 s54, s57, 1204224
  buffer_load_dwordx4 v10, s[8:11], s54 offen lds
  s_add_u32 m0, s83, 2048
  s_add_u32 s54, s57, 1228800
  buffer_load_dwordx4 v10, s[8:11], s54 offen lds
  s_add_u32 m0, s83, 3072
  s_add_u32 s54, s57, 1253376
  buffer_load_dwordx4 v10, s[8:11], s54 offen lds
  s_add_u32 m0, s83, 4096
  s_add_u32 s54, s57, 1277952
  buffer_load_dwordx4 v10, s[8:11], s54 offen lds
  s_add_u32 m0, s83, 5120
  s_add_u32 s54, s57, 1302528
  buffer_load_dwordx4 v10, s[8:11], s54 offen lds
  s_add_u32 m0, s83, 6144
  s_add_u32 s54, s57, 1327104
  buffer_load_dwordx4 v10, s[8:11], s54 offen lds
  s_add_u32 m0, s83, 7168
  s_add_u32 s54, s57, 1351680
  buffer_load_dwordx4 v10, s[8:11], s54 offen lds
  s_cmp_lt_u32 s20, 2
  s_cbranch_scc0 Lws_7
  v_mfma_f32_32x32x16_bf16 v[48:63], a[96:99], v[100:103], v[48:63]
  v_mfma_f32_32x32x16_bf16 v[64:79], a[100:103], v[100:103], v[64:79]
  v_mfma_f32_32x32x16_bf16 v[48:63], a[104:107], v[100:103], v[48:63]
  v_mfma_f32_32x32x16_bf16 v[64:79], a[108:111], v[100:103], v[64:79]
  v_mfma_f32_32x32x16_bf16 v[48:63], a[112:115], v[100:103], v[48:63]
  v_mfma_f32_32x32x16_bf16 v[64:79], a[116:119], v[100:103], v[64:79]
  v_mfma_f32_32x32x16_bf16 v[48:63], a[120:123], v[100:103], v[48:63]
  v_mfma_f32_32x32x16_bf16 v[64:79], a[124:127], v[100:103], v[64:79]
  s_nop 10
  s_branch Lws_8
Lws_7:
  v_mfma_f32_32x32x16_bf16 v[48:63], v[100:103], a[96:99], v[48:63]
  v_mfma_f32_32x32x16_bf16 v[64:79], v[100:103], a[100:103], v[64:79]
  v_mfma_f32_32x32x16_bf16 v[48:63], v[100:103], a[104:107], v[48:63]
  v_mfma_f32_32x32x16_bf16 v[64:79], v[100:103], a[108:111], v[64:79]
  v_mfma_f32_32x32x16_bf16 v[48:63], v[100:103], a[112:115], v[48:63]
  v_mfma_f32_32x32x16_bf16 v[64:79], v[100:103], a[116:119], v[64:79]
  v_mfma_f32_32x32x16_bf16 v[48:63], v[100:103], a[120:123], v[48:63]
  v_mfma_f32_32x32x16_bf16 v[64:79], v[100:103], a[124:127], v[64:79]
  s_nop 11
Lws_8:
  s_waitcnt vmcnt(16)
  ds_read_b64_tr_b16 a[128:129], v13 offset:8192
  ds_read_b64_tr_b16 a[130:131], v13 offset:8704
  ds_read_b64_tr_b16 a[132:133], v14 offset:8192
  ds_read_b64_tr_b16 a[134:135], v14 offset:8704
  ds_read_b64_tr_b16 a[136:137], v13 offset:10240
  ds_read_b64_tr_b16 a[138:139], v13 offset:10752
  ds_read_b64_tr_b16 a[140:141], v14 offset:10240
  ds_read_b64_tr_b16 a[142:143], v14 offset:10752
  ds_read_b64_tr_b16 a[144:145], v13 offset:12288
  ds_read_b64_tr_b16 a[146:147], v13 offset:12800
  ds_read_b64_tr_b16 a[148:149], v14 offset:12288
  ds_read_b64_tr_b16 a[150:151], v14 offset:12800
  ds_read_b64_tr_b16 a[152:153], v13 offset:14336
  ds_read_b64_tr_b16 a[154:155], v13 offset:14848
  ds_read_b64_tr_b16 a[156:157], v14 offset:14336
  ds_read_b64_tr_b16 a[158:159], v14 offset:14848
  s_waitcnt lgkmcnt(0)
  s_add_u32 m0, s83, 8192
  s_add_u32 s54, s57, 1376256
  buffer_load_dwordx4 v10, s[8:11], s54 offen lds
  s_add_u32 m0, s83, 9216
  s_add_u32 s54, s57, 1400832
  buffer_load_dwordx4 v10, s[8:11], s54 offen lds
  s_add_u32 m0, s83, 10240
  s_add_u32 s54, s57, 1425408
  buffer_load_dwordx4 v10, s[8:11], s54 offen lds
  s_add_u32 m0, s83, 11264
  s_add_u32 s54, s57, 1449984
  buffer_load_dwordx4 v10, s[8:11], s54 offen lds
  s_add_u32 m0, s83, 12288
  s_add_u32 s54, s57, 1474560
  buffer_load_dwordx4 v10, s[8:11], s54 offen lds
  s_add_u32 m0, s83, 13312
  s_add_u32 s54, s57, 1499136
  buffer_load_dwordx4 v10, s[8:11], s54 offen lds
  s_add_u32 m0, s83, 14336
  s_add_u32 s54, s57, 1523712
  buffer_load_dwordx4 v10, s[8:11], s54 offen lds
  s_add_u32 m0, s83, 15360
  s_add_u32 s54, s57, 1548288
  buffer_load_dwordx4 v10, s[8:11], s54 offen lds
  s_cmp_lt_u32 s20, 2
  s_cbranch_scc0 Lws_9
  v_mfma_f32_32x32x16_bf16 v[48:63], a[128:131], v[100:103], v[48:63]
  v_mfma_f32_32x32x16_bf16 v[64:79], a[132:135], v[100:103], v[64:79]
  v_mfma_f32_32x32x16_bf16 v[48:63], a[136:139], v[100:103], v[48:63]
  v_mfma_f32_32x32x16_bf16 v[64:79], a[140:143], v[100:103], v[64:79]
  v_mfma_f32_32x32x16_bf16 v[48:63], a[144:147], v[100:103], v[48:63]
  v_mfma_f32_32x32x16_bf16 v[64:79], a[148:151], v[100:103], v[64:79]
  v_mfma_f32_32x32x16_bf16 v[48:63], a[152:155], v[100:103], v[48:63]
  v_mfma_f32_32x32x16_bf16 v[64:79], a[156:159], v[100:103], v[64:79]
  s_nop 10
  s_branch Lws_10
Lws_9:
  v_mfma_f32_32x32x16_bf16 v[48:63], v[100:103], a[128:131], v[48:63]
  v_mfma_f32_32x32x16_bf16 v[64:79], v[100:103], a[132:135], v[64:79]
  v_mfma_f32_32x32x16_bf16 v[48:63], v[100:103], a[136:139], v[48:63]
  v_mfma_f32_32x32x16_bf16 v[64:79], v[100:103], a[140:143], v[64:79]
  v_mfma_f32_32x32x16_bf16 v[48:63], v[100:103], a[144:147], v[48:63]
  v_mfma_f32_32x32x16_bf16 v[64:79], v[100:103], a[148:151], v[64:79]
  v_mfma_f32_32x32x16_bf16 v[48:63], v[100:103], a[152:155], v[48:63]
  v_mfma_f32_32x32x16_bf16 v[64:79], v[100:103], a[156:159], v[64:79]
  s_nop 11
Lws_10:
  s_waitcnt vmcnt(16)
  ds_read_b64_tr_b16 a[160:161], v13 offset:16384
  ds_read_b64_tr_b16 a[162:163], v13 offset:16896
  ds_read_b64_tr_b16 a[164:165], v14 offset:16384
  ds_read_b64_tr_b16 a[166:167], v14 offset:16896
  ds_read_b64_tr_b16 a[168:169], v13 offset:18432
  ds_read_b64_tr_b16 a[170:171], v13 offset:18944
  ds_read_b64_tr_b16 a[172:173], v14 offset:18432
  ds_read_b64_tr_b16 a[174:175], v14 offset:18944
  ds_read_b64_tr_b16 a[176:177], v13 offset:20480
  ds_read_b64_tr_b16 a[178:179], v13 offset:20992
  ds_read_b64_tr_b16 a[180:181], v14 offset:20480
  ds_read_b64_tr_b16 a[182:183], v14 offset:20992
  ds_read_b64_tr_b16 a[184:185], v13 offset:22528
  ds_read_b64_tr_b16 a[186:187], v13 offset:23040
  ds_read_b64_tr_b16 a[188:189], v14 offset:22528
  ds_read_b64_tr_b16 a[190:191], v14 offset:23040
  s_waitcnt lgkmcnt(0)
  s_mov_b32 s12, s92
  s_and_b32 s13, s93, 0xffff
  s_mov_b32 s14, 256
  s_mov_b32 s15, 0x20000
  s_mov_b32 s26, 0
Lwi_11:
  buffer_load_dword v18, off, s[12:15], 0 offset:12 sc1
  s_waitcnt vmcnt(0)
  v_readfirstlane_b32 s29, v18
  s_nop 0
  s_cmp_ge_u32 s29, 4
  s_nop 1
  s_cbranch_scc1 Lwi_12
  s_sleep 2
  s_add_u32 s26, s26, 1
  s_cmp_lt_u32 s26, 0x40000
  s_cbranch_scc1 Lwi_11
  s_branch L_end
Lwi_12:
  s_cmp_lt_u32 s20, 2
  s_cbranch_scc0 Lws_13
  v_mfma_f32_32x32x16_bf16 v[48:63], a[160:163], v[100:103], v[48:63]
  v_mfma_f32_32x32x16_bf16 v[64:79], a[164:167], v[100:103], v[64:79]
  v_mfma_f32_32x32x16_bf16 v[48:63], a[168:171], v[100:103], v[48:63]
  v_mfma_f32_32x32x16_bf16 v[64:79], a[172:175], v[100:103], v[64:79]
  v_mfma_f32_32x32x16_bf16 v[48:63], a[176:179], v[100:103], v[48:63]
  v_mfma_f32_32x32x16_bf16 v[64:79], a[180:183], v[100:103], v[64:79]
  v_mfma_f32_32x32x16_bf16 v[48:63], a[184:187], v[100:103], v[48:63]
  v_mfma_f32_32x32x16_bf16 v[64:79], a[188:191], v[100:103], v[64:79]
  s_nop 10
  s_branch Lws_14
Lws_13:
  v_mfma_f32_32x32x16_bf16 v[48:63], v[100:103], a[160:163], v[48:63]
  v_mfma_f32_32x32x16_bf16 v[64:79], v[100:103], a[164:167], v[64:79]
  v_mfma_f32_32x32x16_bf16 v[48:63], v[100:103], a[168:171], v[48:63]
  v_mfma_f32_32x32x16_bf16 v[64:79], v[100:103], a[172:175], v[64:79]
  v_mfma_f32_32x32x16_bf16 v[48:63], v[100:103], a[176:179], v[48:63]
  v_mfma_f32_32x32x16_bf16 v[64:79], v[100:103], a[180:183], v[64:79]
  v_mfma_f32_32x32x16_bf16 v[48:63], v[100:103], a[184:187], v[48:63]
  v_mfma_f32_32x32x16_bf16 v[64:79], v[100:103], a[188:191], v[64:79]
  s_nop 11
Lws_14:
  ds_read_b64_tr_b16 a[192:193], v13 offset:0
  ds_read_b64_tr_b16 a[194:195], v13 offset:512
  ds_read_b64_tr_b16 a[196:197], v14 offset:0
  ds_read_b64_tr_b16 a[198:199], v14 offset:512
  ds_read_b64_tr_b16 a[200:201], v13 offset:2048
  ds_read_b64_tr_b16 a[202:203], v13 offset:2560
  ds_read_b64_tr_b16 a[204:205], v14 offset:2048
  ds_read_b64_tr_b16 a[206:207], v14 offset:2560
  ds_read_b64_tr_b16 a[208:209], v13 offset:4096
  ds_read_b64_tr_b16 a[210:211], v13 offset:4608
  ds_read_b64_tr_b16 a[212:213], v14 offset:4096
  ds_read_b64_tr_b16 a[214:215], v14 offset:4608
  ds_read_b64_tr_b16 a[216:217], v13 offset:6144
  ds_read_b64_tr_b16 a[218:219], v13 offset:6656
  ds_read_b64_tr_b16 a[220:221], v14 offset:6144
  ds_read_b64_tr_b16 a[222:223], v14 offset:6656
  s_waitcnt lgkmcnt(0)
  s_cmp_lt_u32 s20, 2
  s_cbranch_scc0 Lws_15
  v_mfma_f32_32x32x16_bf16 v[48:63], a[192:195], v[100:103], v[48:63]
  v_mfma_f32_32x32x16_bf16 v[64:79], a[196:199], v[100:103], v[64:79]
  v_mfma_f32_32x32x16_bf16 v[48:63], a[200:203], v[100:103], v[48:63]
  v_mfma_f32_32x32x16_bf16 v[64:79], a[204:207], v[100:103], v[64:79]
  v_mfma_f32_32x32x16_bf16 v[48:63], a[208:211], v[100:103], v[48:63]
  v_mfma_f32_32x32x16_bf16 v[64:79], a[212:215], v[100:103], v[64:79]
  v_mfma_f32_32x32x16_bf16 v[48:63], a[216:219], v[100:103], v[48:63]
  v_mfma_f32_32x32x16_bf16 v[64:79], a[220:223], v[100:103], v[64:79]
  s_nop 10
  s_branch Lws_16
Lws_15:
  v_mfma_f32_32x32x16_bf16 v[48:63], v[100:103], a[192:195], v[48:63]
  v_mfma_f32_32x32x16_bf16 v[64:79], v[100:103], a[196:199], v[64:79]
  v_mfma_f32_32x32x16_bf16 v[48:63], v[100:103], a[200:203], v[48:63]
  v_mfma_f32_32x32x16_bf16 v[64:79], v[100:103], a[204:207], v[64:79]
  v_mfma_f32_32x32x16_bf16 v[48:63], v[100:103], a[208:211], v[48:63]
  v_mfma_f32_32x32x16_bf16 v[64:79], v[100:103], a[212:215], v[64:79]
  v_mfma_f32_32x32x16_bf16 v[48:63], v[100:103], a[216:219], v[48:63]
  v_mfma_f32_32x32x16_bf16 v[64:79], v[100:103], a[220:223], v[64:79]
  s_nop 11
Lws_16:
  ds_read_b64_tr_b16 a[224:225], v13 offset:8192
  ds_read_b64_tr_b16 a[226:227], v13 offset:8704
  ds_read_b64_tr_b16 a[228:229], v14 offset:8192
  ds_read_b64_tr_b16 a[230:231], v14 offset:8704
  ds_read_b64_tr_b16 a[232:233], v13 offset:10240
  ds_read_b64_tr_b16 a[234:235], v13 offset:10752
  ds_read_b64_tr_b16 a[236:237], v14 offset:10240
  ds_read_b64_tr_b16 a[238:239], v14 offset:10752
  ds_read_b64_tr_b16 a[240:241], v13 offset:12288
  ds_read_b64_tr_b16 a[242:243], v13 offset:12800
  ds_read_b64_tr_b16 a[244:245], v14 offset:12288
  ds_read_b64_tr_b16 a[246:247], v14 offset:12800
  ds_read_b64_tr_b16 a[248:249], v13 offset:14336
  ds_read_b64_tr_b16 a[250:251], v13 offset:14848
  ds_read_b64_tr_b16 a[252:253], v14 offset:14336
  ds_read_b64_tr_b16 a[254:255], v14 offset:14848
  s_waitcnt lgkmcnt(0)
  s_cmp_lt_u32 s20, 2
  s_cbranch_scc0 Lws_17
  v_mfma_f32_32x32x16_bf16 v[48:63], a[224:227], v[100:103], v[48:63]
  v_mfma_f32_32x32x16_bf16 v[64:79], a[228:231], v[100:103], v[64:79]
  v_mfma_f32_32x32x16_bf16 v[48:63], a[232:235], v[100:103], v[48:63]
  v_mfma_f32_32x32x16_bf16 v[64:79], a[236:239], v[100:103], v[64:79]
  v_mfma_f32_32x32x16_bf16 v[48:63], a[240:243], v[100:103], v[48:63]
  v_mfma_f32_32x32x16_bf16 v[64:79], a[244:247], v[100:103], v[64:79]
  v_mfma_f32_32x32x16_bf16 v[48:63], a[248:251], v[100:103], v[48:63]
  v_mfma_f32_32x32x16_bf16 v[64:79], a[252:255], v[100:103], v[64:79]
  s_nop 10
  s_branch Lws_18
Lws_17:
  v_mfma_f32_32x32x16_bf16 v[48:63], v[100:103], a[224:227], v[48:63]
  v_mfma_f32_32x32x16_bf16 v[64:79], v[100:103], a[228:231], v[64:79]
  v_mfma_f32_32x32x16_bf16 v[48:63], v[100:103], a[232:235], v[48:63]
  v_mfma_f32_32x32x16_bf16 v[64:79], v[100:103], a[236:239], v[64:79]
  v_mfma_f32_32x32x16_bf16 v[48:63], v[100:103], a[240:243], v[48:63]
  v_mfma_f32_32x32x16_bf16 v[64:79], v[100:103], a[244:247], v[64:79]
  v_mfma_f32_32x32x16_bf16 v[48:63], v[100:103], a[248:251], v[48:63]
  v_mfma_f32_32x32x16_bf16 v[64:79], v[100:103], a[252:255], v[64:79]
  s_nop 11
Lws_18:
  s_barrier
  s_mov_b32 s47, s46
  s_mov_b32 s49, 32
  s_mov_b32 s12, s86
  s_and_b32 s13, s87, 0xffff
  s_mov_b32 s14, 2097152
  s_mov_b32 s15, 0x20000
  s_mov_b32 s48, 64
  s_cmp_ge_u32 s20, 2
  s_cbranch_scc1 La1_19
  s_lshl_b32 s29, s20, 14
  s_lshl_b32 s30, s21, 12
  s_add_u32 s29, s29, s30
  v_add_u32 v98, s29, v1
  s_mov_b32 s69, 0
  s_mov_b32 s51, 0
  s_mov_b32 s61, 0
Lsl_21:
  s_add_u32 s66, s47, s49
  s_waitcnt vmcnt(0)
  s_barrier
  s_cmp_eq_u32 s61, 0
  s_cbranch_scc1 Lsl_26
  v_mov_b32 v10, 1
  s_mov_b64 exec, 1
  buffer_atomic_add v10, off, s[4:7], s61 sc1
  s_mov_b64 exec, -1
Lsl_26:
  s_xor_b32 s53, s51, 33280
  s_mov_b32 s58, 1
  s_cmp_lt_u32 s66, s48
  s_cselect_b32 s58, s58, 0
  s_cmp_eq_u32 s58, 0
  s_cbranch_scc1 Lsl_24
  s_mov_b32 s67, s53
  s_lshl_b32 s57, s66, 15
  s_mul_i32 s53, s21, 8320
  s_add_u32 s53, s53, s67
  s_add_u32 m0, s53, 0
  s_add_u32 s54, s57, 0
  buffer_load_dwordx4 v6, s[12:15], s54 offen sc1 lds
  s_add_u32 m0, s53, 1040
  s_add_u32 s54, s57, 1024
  buffer_load_dwordx4 v6, s[12:15], s54 offen sc1 lds
  s_add_u32 m0, s53, 2080
  s_add_u32 s54, s57, 2048
  buffer_load_dwordx4 v6, s[12:15], s54 offen sc1 lds
  s_add_u32 m0, s53, 3120
  s_add_u32 s54, s57, 3072
  buffer_load_dwordx4 v6, s[12:15], s54 offen sc1 lds
  s_add_u32 m0, s53, 4160
  s_add_u32 s54, s57, 4096
  buffer_load_dwordx4 v6, s[12:15], s54 offen sc1 lds
  s_add_u32 m0, s53, 5200
  s_add_u32 s54, s57, 5120
  buffer_load_dwordx4 v6, s[12:15], s54 offen sc1 lds
  s_add_u32 m0, s53, 6240
  s_add_u32 s54, s57, 6144
  buffer_load_dwordx4 v6, s[12:15], s54 offen sc1 lds
  s_add_u32 m0, s53, 7280
  s_add_u32 s54, s57, 7168
  buffer_load_dwordx4 v6, s[12:15], s54 offen sc1 lds
Lsl_24:
  s_lshr_b32 s69, s47, 5
  s_lshl_b32 s69, s69, 2
  s_mul_i32 s53, s21, 256
  s_add_u32 s53, s53, s51
  v_add_u32 v9, s53, v5
  v_mov_b32 v96, 0
  v_mov_b32 v97, 0
  ds_read_b128 v[104:107], v9 offset:0
  ds_read_b128 v[108:111], v9 offset:32
  ds_read_b128 v[112:115], v9 offset:64
  ds_read_b128 v[116:119], v9 offset:96
  ds_read_b128 v[120:123], v9 offset:128
  ds_read_b128 v[124:127], v9 offset:160
  ds_read_b128 v[128:131], v9 offset:192
  ds_read_b128 v[132:135], v9 offset:224
  s_waitcnt lgkmcnt(7)
  v_dot2c_f32_bf16 v96, v104, v100
  v_dot2c_f32_bf16 v97, v104, v104
  v_dot2c_f32_bf16 v96, v105, v100
  v_dot2c_f32_bf16 v97, v105, v105
  v_dot2c_f32_bf16 v96, v106, v100
  v_dot2c_f32_bf16 v97, v106, v106
  v_dot2c_f32_bf16 v96, v107, v100
  v_dot2c_f32_bf16 v97, v107, v107
  s_waitcnt lgkmcnt(6)
  v_dot2c_f32_bf16 v96, v108, v100
  v_dot2c_f32_bf16 v97, v108, v108
  v_dot2c_f32_bf16 v96, v109, v100
  v_dot2c_f32_bf16 v97, v109, v109
  v_dot2c_f32_bf16 v96, v110, v100
  v_dot2c_f32_bf16 v97, v110, v110
  v_dot2c_f32_bf16 v96, v111, v100
  v_dot2c_f32_bf16 v97, v111, v111
  s_waitcnt lgkmcnt(5)
  v_dot2c_f32_bf16 v96, v112, v100
  v_dot2c_f32_bf16 v97, v112, v112
  v_dot2c_f32_bf16 v96, v113, v100
  v_dot2c_f32_bf16 v97, v113, v113
  v_dot2c_f32_bf16 v96, v114, v100
  v_dot2c_f32_bf16 v97, v114, v114
  v_dot2c_f32_bf16 v96, v115, v100
  v_dot2c_f32_bf16 v97, v115, v115
  s_waitcnt lgkmcnt(4)
  v_dot2c_f32_bf16 v96, v116, v100
  v_dot2c_f32_bf16 v97, v116, v116
  v_dot2c_f32_bf16 v96, v117, v100
  v_dot2c_f32_bf16 v97, v117, v117
  v_dot2c_f32_bf16 v96, v118, v100
  v_dot2c_f32_bf16 v97, v118, v118
  v_dot2c_f32_bf16 v96, v119, v100
  v_dot2c_f32_bf16 v97, v119, v119
  s_waitcnt lgkmcnt(3)
  v_dot2c_f32_bf16 v96, v120, v100
  v_dot2c_f32_bf16 v97, v120, v120
  v_dot2c_f32_bf16 v96, v121, v100
  v_dot2c_f32_bf16 v97, v121, v121
  v_dot2c_f32_bf16 v96, v122, v100
  v_dot2c_f32_bf16 v97, v122, v122
  v_dot2c_f32_bf16 v96, v123, v100
  v_dot2c_f32_bf16 v97, v123, v123
  s_waitcnt lgkmcnt(2)
  v_dot2c_f32_bf16 v96, v124, v100
  v_dot2c_f32_bf16 v97, v124, v124
  v_dot2c_f32_bf16 v96, v125, v100
  v_dot2c_f32_bf16 v97, v125, v125
  v_dot2c_f32_bf16 v96, v126, v100
  v_dot2c_f32_bf16 v97, v126, v126
  v_dot2c_f32_bf16 v96, v127, v100
  v_dot2c_f32_bf16 v97, v127, v127
  s_waitcnt lgkmcnt(1)
  v_dot2c_f32_bf16 v96, v128, v100
  v_dot2c_f32_bf16 v97, v128, v128
  v_dot2c_f32_bf16 v96, v129, v100
  v_dot2c_f32_bf16 v97, v129, v129
  v_dot2c_f32_bf16 v96, v130, v100
  v_dot2c_f32_bf16 v97, v130, v130
  v_dot2c_f32_bf16 v96, v131, v100
  v_dot2c_f32_bf16 v97, v131, v131
  s_waitcnt lgkmcnt(0)
  v_dot2c_f32_bf16 v96, v132, v100
  v_dot2c_f32_bf16 v97, v132, v132
  v_dot2c_f32_bf16 v96, v133, v100
  v_dot2c_f32_bf16 v97, v133, v133
  v_dot2c_f32_bf16 v96, v134, v100
  v_dot2c_f32_bf16 v97, v134, v134
  v_dot2c_f32_bf16 v96, v135, v100
  v_dot2c_f32_bf16 v97, v135, v135
  s_nop 2
  v_permlane32_swap_b32 v96, v97
  v_add_f32 v96, v96, v97
  v_lshlrev_b32 v10, 2, v0
  s_lshl_b32 s53, s21, 8
  s_add_u32 s53, s53, 68608
  v_add_u32 v10, s53, v10
  ds_write_b32 v10, v96
  v_add_u32 v9, s51, v5
  ds_read_b128 v[80:83], v9 offset:0
  ds_read_b128 v[84:87], v9 offset:32
  ds_read_b128 v[88:91], v9 offset:64
  s_waitcnt lgkmcnt(2)
  v_mfma_f32_32x32x16_bf16 v[16:31], a[0:3], v[80:83], 0
  ds_read_b128 v[92:95], v9 offset:96
  v_mfma_f32_32x32x16_bf16 v[32:47], a[4:7], v[80:83], 0
  s_waitcnt lgkmcnt(2)
  v_mfma_f32_32x32x16_bf16 v[16:31], a[8:11], v[84:87], v[16:31]
  ds_read_b128 v[80:83], v9 offset:128
  v_mfma_f32_32x32x16_bf16 v[32:47], a[12:15], v[84:87], v[32:47]
  s_waitcnt lgkmcnt(2)
  v_mfma_f32_32x32x16_bf16 v[16:31], a[16:19], v[88:91], v[16:31]
  ds_read_b128 v[84:87], v9 offset:160
  v_mfma_f32_32x32x16_bf16 v[32:47], a[20:23], v[88:91], v[32:47]
  s_waitcnt lgkmcnt(2)
  v_mfma_f32_32x32x16_bf16 v[16:31], a[24:27], v[92:95], v[16:31]
  ds_read_b128 v[88:91], v9 offset:192
  v_mfma_f32_32x32x16_bf16 v[32:47], a[28:31], v[92:95], v[32:47]
  s_waitcnt lgkmcnt(2)
  v_mfma_f32_32x32x16_bf16 v[16:31], a[32:35], v[80:83], v[16:31]
  ds_read_b128 v[92:95], v9 offset:224
  v_mfma_f32_32x32x16_bf16 v[32:47], a[36:39], v[80:83], v[32:47]
  s_waitcnt lgkmcnt(2)
  v_mfma_f32_32x32x16_bf16 v[16:31], a[40:43], v[84:87], v[16:31]
  ds_read_b128 v[80:83], v9 offset:256
  v_mfma_f32_32x32x16_bf16 v[32:47], a[44:47], v[84:87], v[32:47]
  s_waitcnt lgkmcnt(2)
  v_mfma_f32_32x32x16_bf16 v[16:31], a[48:51], v[88:91], v[16:31]
  ds_read_b128 v[84:87], v9 offset:288
  v_mfma_f32_32x32x16_bf16 v[32:47], a[52:55], v[88:91], v[32:47]
  s_waitcnt lgkmcnt(2)
  v_mfma_f32_32x32x16_bf16 v[16:31], a[56:59], v[92:95], v[16:31]
  ds_read_b128 v[88:91], v9 offset:320
  v_mfma_f32_32x32x16_bf16 v[32:47], a[60:63], v[92:95], v[32:47]
  s_waitcnt lgkmcnt(2)
  v_mfma_f32_32x32x16_bf16 v[16:31], a[64:67], v[80:83], v[16:31]
  ds_read_b128 v[92:95], v9 offset:352
  v_mfma_f32_32x32x16_bf16 v[32:47], a[68:71], v[80:83], v[32:47]
  s_waitcnt lgkmcnt(2)
  v_mfma_f32_32x32x16_bf16 v[16:31], a[72:75], v[84:87], v[16:31]
  ds_read_b128 v[80:83], v9 offset:384
  v_mfma_f32_32x32x16_bf16 v[32:47], a[76:79], v[84:87], v[32:47]
  s_waitcnt lgkmcnt(2)
  v_mfma_f32_32x32x16_bf16 v[16:31], a[80:83], v[88:91], v[16:31]
  ds_read_b128 v[84:87], v9 offset:416
  v_mfma_f32_32x32x16_bf16 v[32:47], a[84:87], v[88:91], v[32:47]
  s_waitcnt lgkmcnt(2)
  v_mfma_f32_32x32x16_bf16 v[16:31], a[88:91], v[92:95], v[16:31]
  ds_read_b128 v[88:91], v9 offset:448
  v_mfma_f32_32x32x16_bf16 v[32:47], a[92:95], v[92:95], v[32:47]
  s_waitcnt lgkmcnt(2)
  v_mfma_f32_32x32x16_bf16 v[16:31], a[96:99], v[80:83], v[16:31]
  ds_read_b128 v[92:95], v9 offset:480
  v_mfma_f32_32x32x16_bf16 v[32:47], a[100:103], v[80:83], v[32:47]
  s_waitcnt lgkmcnt(2)
  v_mfma_f32_32x32x16_bf16 v[16:31], a[104:107], v[84:87], v[16:31]
  ds_read_b128 v[80:83], v9 offset:512
  v_mfma_f32_32x32x16_bf16 v[32:47], a[108:111], v[84:87], v[32:47]
  s_waitcnt lgkmcnt(2)
  v_mfma_f32_32x32x16_bf16 v[16:31], a[112:115], v[88:91], v[16:31]
  ds_read_b128 v[84:87], v9 offset:544
  v_mfma_f32_32x32x16_bf16 v[32:47], a[116:119], v[88:91], v[32:47]
  s_waitcnt lgkmcnt(2)
  v_mfma_f32_32x32x16_bf16 v[16:31], a[120:123], v[92:95], v[16:31]
  ds_read_b128 v[88:91], v9 offset:576
  v_mfma_f32_32x32x16_bf16 v[32:47], a[124:127], v[92:95], v[32:47]
  s_waitcnt lgkmcnt(2)
  v_mfma_f32_32x32x16_bf16 v[16:31], a[128:131], v[80:83], v[16:31]
  ds_read_b128 v[92:95], v9 offset:608
  v_mfma_f32_32x32x16_bf16 v[32:47], a[132:135], v[80:83], v[32:47]
  s_waitcnt lgkmcnt(2)
  v_mfma_f32_32x32x16_bf16 v[16:31], a[136:139], v[84:87], v[16:31]
  ds_read_b128 v[80:83], v9 offset:640
  v_mfma_f32_32x32x16_bf16 v[32:47], a[140:143], v[84:87], v[32:47]
  s_waitcnt lgkmcnt(2)
  v_mfma_f32_32x32x16_bf16 v[16:31], a[144:147], v[88:91], v[16:31]
  ds_read_b128 v[84:87], v9 offset:672
  v_mfma_f32_32x32x16_bf16 v[32:47], a[148:151], v[88:91], v[32:47]
  s_waitcnt lgkmcnt(2)
  v_mfma_f32_32x32x16_bf16 v[16:31], a[152:155], v[92:95], v[16:31]
  ds_read_b128 v[88:91], v9 offset:704
  v_mfma_f32_32x32x16_bf16 v[32:47], a[156:159], v[92:95], v[32:47]
  s_waitcnt lgkmcnt(2)
  v_mfma_f32_32x32x16_bf16 v[16:31], a[160:163], v[80:83], v[16:31]
  ds_read_b128 v[92:95], v9 offset:736
  v_mfma_f32_32x32x16_bf16 v[32:47], a[164:167], v[80:83], v[32:47]
  s_waitcnt lgkmcnt(2)
  v_mfma_f32_32x32x16_bf16 v[16:31], a[168:171], v[84:87], v[16:31]
  ds_read_b128 v[80:83], v9 offset:768
  v_mfma_f32_32x32x16_bf16 v[32:47], a[172:175], v[84:87], v[32:47]
  s_waitcnt lgkmcnt(2)
  v_mfma_f32_32x32x16_bf16 v[16:31], a[176:179], v[88:91], v[16:31]
  ds_read_b128 v[84:87], v9 offset:800
  v_mfma_f32_32x32x16_bf16 v[32:47], a[180:183], v[88:91], v[32:47]
  s_waitcnt lgkmcnt(2)
  v_mfma_f32_32x32x16_bf16 v[16:31], a[184:187], v[92:95], v[16:31]
  ds_read_b128 v[88:91], v9 offset:832
  v_mfma_f32_32x32x16_bf16 v[32:47], a[188:191], v[92:95], v[32:47]
  s_waitcnt lgkmcnt(2)
  v_mfma_f32_32x32x16_bf16 v[16:31], a[192:195], v[80:83], v[16:31]
  ds_read_b128 v[92:95], v9 offset:864
  v_mfma_f32_32x32x16_bf16 v[32:47], a[196:199], v[80:83], v[32:47]
  s_waitcnt lgkmcnt(2)
  v_mfma_f32_32x32x16_bf16 v[16:31], a[200:203], v[84:87], v[16:31]
  ds_read_b128 v[80:83], v9 offset:896
  v_mfma_f32_32x32x16_bf16 v[32:47], a[204:207], v[84:87], v[32:47]
  s_waitcnt lgkmcnt(2)
  v_mfma_f32_32x32x16_bf16 v[16:31], a[208:211], v[88:91], v[16:31]
  ds_read_b128 v[84:87], v9 offset:928
  v_mfma_f32_32x32x16_bf16 v[32:47], a[212:215], v[88:91], v[32:47]
  s_waitcnt lgkmcnt(2)
  v_mfma_f32_32x32x16_bf16 v[16:31], a[216:219], v[92:95], v[16:31]
  ds_read_b128 v[88:91], v9 offset:960
  v_mfma_f32_32x32x16_bf16 v[32:47], a[220:223], v[92:95], v[32:47]
  s_waitcnt lgkmcnt(2)
  v_mfma_f32_32x32x16_bf16 v[16:31], a[224:227], v[80:83], v[16:31]
  ds_read_b128 v[92:95], v9 offset:992
  v_mfma_f32_32x32x16_bf16 v[32:47], a[228:231], v[80:83], v[32:47]
  s_waitcnt lgkmcnt(2)
  v_mfma_f32_32x32x16_bf16 v[16:31], a[232:235], v[84:87], v[16:31]
  v_mfma_f32_32x32x16_bf16 v[32:47], a[236:239], v[84:87], v[32:47]
  s_waitcnt lgkmcnt(1)
  v_mfma_f32_32x32x16_bf16 v[16:31], a[240:243], v[88:91], v[16:31]
  v_mfma_f32_32x32x16_bf16 v[32:47], a[244:247], v[88:91], v[32:47]
  s_waitcnt lgkmcnt(0)
  v_mfma_f32_32x32x16_bf16 v[16:31], a[248:251], v[92:95], v[16:31]
  v_mfma_f32_32x32x16_bf16 v[32:47], a[252:255], v[92:95], v[32:47]
  s_barrier
  v_lshlrev_b32 v10, 2, v2
  v_add_u32 v10, 68608, v10
  ds_read2_b32 v[104:105], v10 offset0:0 offset1:32
  ds_read2_b32 v[106:107], v10 offset0:64 offset1:96
  ds_read2_b32 v[108:109], v10 offset0:128 offset1:160
  ds_read2_b32 v[110:111], v10 offset0:192 offset1:224
  s_waitcnt lgkmcnt(0)
  v_pk_add_f32 v[104:105], v[104:105], v[106:107]
  v_pk_add_f32 v[108:109], v[108:109], v[110:111]
  v_pk_add_f32 v[96:97], v[104:105], v[108:109]
  v_mul_f32 v96, s59, v96
  v_mul_f32 v97, s59, v97
  v_fma_f32 v97, -v96, v96, v97
  v_max_f32 v97, 0, v97
  v_cvt_pk_bf16_f32 v96, v96, v96
  v_and_b32 v96, 0xffff0000, v96
  v_cvt_pk_bf16_f32 v97, v97, v97
  v_and_b32 v97, 0xffff0000, v97
  v_add_f32 v97, s60, v97
  v_cvt_pk_bf16_f32 v97, v97, v97
  v_and_b32 v97, 0xffff0000, v97
  v_sqrt_f32 v97, v97
  s_nop 0
  v_cvt_pk_bf16_f32 v97, v97, v97
  v_and_b32 v97, 0xffff0000, v97
  v_rcp_f32 v97, v97
  s_nop 0
  v_mul_f32 v96, v96, v97
  v_pk_mul_f32 v[10:11], v[48:49], v[96:97] op_sel_hi:[1,0]
  v_pk_fma_f32 v[16:17], v[16:17], v[96:97], v[10:11] op_sel:[0,1,0] op_sel_hi:[1,1,1] neg_lo:[0,0,1] neg_hi:[0,0,1]
  v_pk_mul_f32 v[10:11], v[50:51], v[96:97] op_sel_hi:[1,0]
  v_pk_fma_f32 v[18:19], v[18:19], v[96:97], v[10:11] op_sel:[0,1,0] op_sel_hi:[1,1,1] neg_lo:[0,0,1] neg_hi:[0,0,1]
  v_pk_mul_f32 v[10:11], v[52:53], v[96:97] op_sel_hi:[1,0]
  v_pk_fma_f32 v[20:21], v[20:21], v[96:97], v[10:11] op_sel:[0,1,0] op_sel_hi:[1,1,1] neg_lo:[0,0,1] neg_hi:[0,0,1]
  v_pk_mul_f32 v[10:11], v[54:55], v[96:97] op_sel_hi:[1,0]
  v_pk_fma_f32 v[22:23], v[22:23], v[96:97], v[10:11] op_sel:[0,1,0] op_sel_hi:[1,1,1] neg_lo:[0,0,1] neg_hi:[0,0,1]
  v_pk_mul_f32 v[10:11], v[56:57], v[96:97] op_sel_hi:[1,0]
  v_pk_fma_f32 v[24:25], v[24:25], v[96:97], v[10:11] op_sel:[0,1,0] op_sel_hi:[1,1,1] neg_lo:[0,0,1] neg_hi:[0,0,1]
  v_pk_mul_f32 v[10:11], v[58:59], v[96:97] op_sel_hi:[1,0]
  v_pk_fma_f32 v[26:27], v[26:27], v[96:97], v[10:11] op_sel:[0,1,0] op_sel_hi:[1,1,1] neg_lo:[0,0,1] neg_hi:[0,0,1]
  v_pk_mul_f32 v[10:11], v[60:61], v[96:97] op_sel_hi:[1,0]
  v_pk_fma_f32 v[28:29], v[28:29], v[96:97], v[10:11] op_sel:[0,1,0] op_sel_hi:[1,1,1] neg_lo:[0,0,1] neg_hi:[0,0,1]
  v_pk_mul_f32 v[10:11], v[62:63], v[96:97] op_sel_hi:[1,0]
  v_pk_fma_f32 v[30:31], v[30:31], v[96:97], v[10:11] op_sel:[0,1,0] op_sel_hi:[1,1,1] neg_lo:[0,0,1] neg_hi:[0,0,1]
  v_pk_mul_f32 v[10:11], v[64:65], v[96:97] op_sel_hi:[1,0]
  v_pk_fma_f32 v[32:33], v[32:33], v[96:97], v[10:11] op_sel:[0,1,0] op_sel_hi:[1,1,1] neg_lo:[0,0,1] neg_hi:[0,0,1]
  v_pk_mul_f32 v[10:11], v[66:67], v[96:97] op_sel_hi:[1,0]
  v_pk_fma_f32 v[34:35], v[34:35], v[96:97], v[10:11] op_sel:[0,1,0] op_sel_hi:[1,1,1] neg_lo:[0,0,1] neg_hi:[0,0,1]
  v_pk_mul_f32 v[10:11], v[68:69], v[96:97] op_sel_hi:[1,0]
  v_pk_fma_f32 v[36:37], v[36:37], v[96:97], v[10:11] op_sel:[0,1,0] op_sel_hi:[1,1,1] neg_lo:[0,0,1] neg_hi:[0,0,1]
  v_pk_mul_f32 v[10:11], v[70:71], v[96:97] op_sel_hi:[1,0]
  v_pk_fma_f32 v[38:39], v[38:39], v[96:97], v[10:11] op_sel:[0,1,0] op_sel_hi:[1,1,1] neg_lo:[0,0,1] neg_hi:[0,0,1]
  v_pk_mul_f32 v[10:11], v[72:73], v[96:97] op_sel_hi:[1,0]
  v_pk_fma_f32 v[40:41], v[40:41], v[96:97], v[10:11] op_sel:[0,1,0] op_sel_hi:[1,1,1] neg_lo:[0,0,1] neg_hi:[0,0,1]
  v_pk_mul_f32 v[10:11], v[74:75], v[96:97] op_sel_hi:[1,0]
  v_pk_fma_f32 v[42:43], v[42:43], v[96:97], v[10:11] op_sel:[0,1,0] op_sel_hi:[1,1,1] neg_lo:[0,0,1] neg_hi:[0,0,1]
  v_pk_mul_f32 v[10:11], v[76:77], v[96:97] op_sel_hi:[1,0]
  v_pk_fma_f32 v[44:45], v[44:45], v[96:97], v[10:11] op_sel:[0,1,0] op_sel_hi:[1,1,1] neg_lo:[0,0,1] neg_hi:[0,0,1]
  v_pk_mul_f32 v[10:11], v[78:79], v[96:97] op_sel_hi:[1,0]
  v_pk_fma_f32 v[46:47], v[46:47], v[96:97], v[10:11] op_sel:[0,1,0] op_sel_hi:[1,1,1] neg_lo:[0,0,1] neg_hi:[0,0,1]
  v_pk_mul_f32 v[10:11], v[16:17], s[72:73]
  v_exp_f32 v10, v10 clamp
  v_exp_f32 v11, v11 clamp
  v_max_f32 v16, 0, v16
  v_max_f32 v17, 0, v17
  v_pk_add_f32 v[10:11], v[10:11], s[70:71]
  v_pk_add_f32 v[16:17], v[16:17], v[10:11]
  v_pk_mul_f32 v[10:11], v[18:19], s[72:73]
  v_exp_f32 v10, v10 clamp
  v_exp_f32 v11, v11 clamp
  v_max_f32 v18, 0, v18
  v_max_f32 v19, 0, v19
  v_pk_add_f32 v[10:11], v[10:11], s[70:71]
  v_pk_add_f32 v[18:19], v[18:19], v[10:11]
  v_pk_mul_f32 v[10:11], v[20:21], s[72:73]
  v_exp_f32 v10, v10 clamp
  v_exp_f32 v11, v11 clamp
  v_max_f32 v20, 0, v20
  v_max_f32 v21, 0, v21
  v_pk_add_f32 v[10:11], v[10:11], s[70:71]
  v_pk_add_f32 v[20:21], v[20:21], v[10:11]
  v_pk_mul_f32 v[10:11], v[22:23], s[72:73]
  v_exp_f32 v10, v10 clamp
  v_exp_f32 v11, v11 clamp
  v_max_f32 v22, 0, v22
  v_max_f32 v23, 0, v23
  v_pk_add_f32 v[10:11], v[10:11], s[70:71]
  v_pk_add_f32 v[22:23], v[22:23], v[10:11]
  v_pk_mul_f32 v[10:11], v[24:25], s[72:73]
  v_exp_f32 v10, v10 clamp
  v_exp_f32 v11, v11 clamp
  v_max_f32 v24, 0, v24
  v_max_f32 v25, 0, v25
  v_pk_add_f32 v[10:11], v[10:11], s[70:71]
  v_pk_add_f32 v[24:25], v[24:25], v[10:11]
  v_pk_mul_f32 v[10:11], v[26:27], s[72:73]
  v_exp_f32 v10, v10 clamp
  v_exp_f32 v11, v11 clamp
  v_max_f32 v26, 0, v26
  v_max_f32 v27, 0, v27
  v_pk_add_f32 v[10:11], v[10:11], s[70:71]
  v_pk_add_f32 v[26:27], v[26:27], v[10:11]
  v_pk_mul_f32 v[10:11], v[28:29], s[72:73]
  v_exp_f32 v10, v10 clamp
  v_exp_f32 v11, v11 clamp
  v_max_f32 v28, 0, v28
  v_max_f32 v29, 0, v29
  v_pk_add_f32 v[10:11], v[10:11], s[70:71]
  v_pk_add_f32 v[28:29], v[28:29], v[10:11]
  v_pk_mul_f32 v[10:11], v[30:31], s[72:73]
  v_exp_f32 v10, v10 clamp
  v_exp_f32 v11, v11 clamp
  v_max_f32 v30, 0, v30
  v_max_f32 v31, 0, v31
  v_pk_add_f32 v[10:11], v[10:11], s[70:71]
  v_pk_add_f32 v[30:31], v[30:31], v[10:11]
  v_pk_mul_f32 v[10:11], v[32:33], s[72:73]
  v_exp_f32 v10, v10 clamp
  v_exp_f32 v11, v11 clamp
  v_max_f32 v32, 0, v32
  v_max_f32 v33, 0, v33
  v_pk_add_f32 v[10:11], v[10:11], s[70:71]
  v_pk_add_f32 v[32:33], v[32:33], v[10:11]
  v_pk_mul_f32 v[10:11], v[34:35], s[72:73]
  v_exp_f32 v10, v10 clamp
  v_exp_f32 v11, v11 clamp
  v_max_f32 v34, 0, v34
  v_max_f32 v35, 0, v35
  v_pk_add_f32 v[10:11], v[10:11], s[70:71]
  v_pk_add_f32 v[34:35], v[34:35], v[10:11]
  v_pk_mul_f32 v[10:11], v[36:37], s[72:73]
  v_exp_f32 v10, v10 clamp
  v_exp_f32 v11, v11 clamp
  v_max_f32 v36, 0, v36
  v_max_f32 v37, 0, v37
  v_pk_add_f32 v[10:11], v[10:11], s[70:71]
  v_pk_add_f32 v[36:37], v[36:37], v[10:11]
  v_pk_mul_f32 v[10:11], v[38:39], s[72:73]
  v_exp_f32 v10, v10 clamp
  v_exp_f32 v11, v11 clamp
  v_max_f32 v38, 0, v38
  v_max_f32 v39, 0, v39
  v_pk_add_f32 v[10:11], v[10:11], s[70:71]
  v_pk_add_f32 v[38:39], v[38:39], v[10:11]
  v_pk_mul_f32 v[10:11], v[40:41], s[72:73]
  v_exp_f32 v10, v10 clamp
  v_exp_f32 v11, v11 clamp
  v_max_f32 v40, 0, v40
  v_max_f32 v41, 0, v41
  v_pk_add_f32 v[10:11], v[10:11], s[70:71]
  v_pk_add_f32 v[40:41], v[40:41], v[10:11]
  v_pk_mul_f32 v[10:11], v[42:43], s[72:73]
  v_exp_f32 v10, v10 clamp
  v_exp_f32 v11, v11 clamp
  v_max_f32 v42, 0, v42
  v_max_f32 v43, 0, v43
  v_pk_add_f32 v[10:11], v[10:11], s[70:71]
  v_pk_add_f32 v[42:43], v[42:43], v[10:11]
  v_pk_mul_f32 v[10:11], v[44:45], s[72:73]
  v_exp_f32 v10, v10 clamp
  v_exp_f32 v11, v11 clamp
  v_max_f32 v44, 0, v44
  v_max_f32 v45, 0, v45
  v_pk_add_f32 v[10:11], v[10:11], s[70:71]
  v_pk_add_f32 v[44:45], v[44:45], v[10:11]
  v_pk_mul_f32 v[10:11], v[46:47], s[72:73]
  v_exp_f32 v10, v10 clamp
  v_exp_f32 v11, v11 clamp
  v_max_f32 v46, 0, v46
  v_max_f32 v47, 0, v47
  v_pk_add_f32 v[10:11], v[10:11], s[70:71]
  v_pk_add_f32 v[46:47], v[46:47], v[10:11]
  v_cvt_pk_bf16_f32 v104, v16, v17
  v_cvt_pk_bf16_f32 v105, v18, v19
  v_cvt_pk_bf16_f32 v106, v20, v21
  v_cvt_pk_bf16_f32 v107, v22, v23
  v_cvt_pk_bf16_f32 v108, v24, v25
  v_cvt_pk_bf16_f32 v109, v26, v27
  v_cvt_pk_bf16_f32 v110, v28, v29
  v_cvt_pk_bf16_f32 v111, v30, v31
  v_cvt_pk_bf16_f32 v112, v32, v33
  v_cvt_pk_bf16_f32 v113, v34, v35
  v_cvt_pk_bf16_f32 v114, v36, v37
  v_cvt_pk_bf16_f32 v115, v38, v39
  v_cvt_pk_bf16_f32 v116, v40, v41
  v_cvt_pk_bf16_f32 v117, v42, v43
  v_cvt_pk_bf16_f32 v118, v44, v45
  v_cvt_pk_bf16_f32 v119, v46, v47
  s_lshl_b32 s53, s47, 15
  s_add_u32 s53, s53, 26214400
  buffer_store_dwordx4 v[104:107], v98, s[4:7], s53 offen offset:0 sc1
  buffer_store_dwordx4 v[108:111], v98, s[4:7], s53 offen offset:1024 sc1
  buffer_store_dwordx4 v[112:115], v98, s[4:7], s53 offen offset:2048 sc1
  buffer_store_dwordx4 v[116:119], v98, s[4:7], s53 offen offset:3072 sc1
  s_min_u32 s61, s47, 4
  s_cmp_lt_u32 s47, 4
  s_cselect_b32 s29, 0, 4
  s_add_u32 s61, s61, s29
  s_lshl_b32 s61, s61, 7
  s_add_u32 s61, s61, 55296
  s_mov_b32 s68, s47
  s_xor_b32 s51, s51, 33280
  s_mov_b32 s47, s66
  s_cmp_eq_u32 s58, 1
  s_cbranch_scc1 Lsl_21
  s_waitcnt vmcnt(0)
  v_mov_b32 v10, 1
  s_mov_b64 exec, 1
  buffer_atomic_add v10, off, s[4:7], s61 sc1
  s_mov_b64 exec, -1
  s_mov_b32 s61, 0
Lsl_25:
  s_cmp_ge_u32 s47, s48
  s_cbranch_scc1 Lsl_23
  s_lshl_b32 s57, s47, 15
  s_mul_i32 s53, s21, 8320
  s_add_u32 s53, s53, s51
  s_add_u32 m0, s53, 0
  s_add_u32 s54, s57, 0
  buffer_load_dwordx4 v6, s[12:15], s54 offen sc1 lds
  s_add_u32 m0, s53, 1040
  s_add_u32 s54, s57, 1024
  buffer_load_dwordx4 v6, s[12:15], s54 offen sc1 lds
  s_add_u32 m0, s53, 2080
  s_add_u32 s54, s57, 2048
  buffer_load_dwordx4 v6, s[12:15], s54 offen sc1 lds
  s_add_u32 m0, s53, 3120
  s_add_u32 s54, s57, 3072
  buffer_load_dwordx4 v6, s[12:15], s54 offen sc1 lds
  s_add_u32 m0, s53, 4160
  s_add_u32 s54, s57, 4096
  buffer_load_dwordx4 v6, s[12:15], s54 offen sc1 lds
  s_add_u32 m0, s53, 5200
  s_add_u32 s54, s57, 5120
  buffer_load_dwordx4 v6, s[12:15], s54 offen sc1 lds
  s_add_u32 m0, s53, 6240
  s_add_u32 s54, s57, 6144
  buffer_load_dwordx4 v6, s[12:15], s54 offen sc1 lds
  s_add_u32 m0, s53, 7280
  s_add_u32 s54, s57, 7168
  buffer_load_dwordx4 v6, s[12:15], s54 offen sc1 lds
  s_branch Lsl_21
Lsl_23:
  s_branch La1_20
La1_19:
  v_mov_b64 v[136:137], 0
  v_mov_b64 v[138:139], 0
  v_mov_b64 v[140:141], 0
  v_mov_b64 v[142:143], 0
  v_mov_b64 v[144:145], 0
  v_mov_b64 v[146:147], 0
  v_mov_b64 v[148:149], 0
  v_mov_b64 v[150:151], 0
  v_mov_b64 v[152:153], 0
  v_mov_b64 v[154:155], 0
  v_mov_b64 v[156:157], 0
  v_mov_b64 v[158:159], 0
  v_mov_b64 v[160:161], 0
  v_mov_b64 v[162:163], 0
  v_mov_b64 v[164:165], 0
  v_mov_b64 v[166:167], 0
  s_mov_b32 s69, 0
  s_mov_b32 s51, 0
  s_mov_b32 s61, 0
Lsl_27:
  s_add_u32 s66, s47, s49
  s_waitcnt vmcnt(0)
  s_barrier
  s_xor_b32 s53, s51, 33280
  s_mov_b32 s58, 1
  s_cmp_lt_u32 s66, s48
  s_cselect_b32 s58, s58, 0
  s_cmp_eq_u32 s58, 0
  s_cbranch_scc1 Lsl_30
  s_mov_b32 s67, s53
  s_lshl_b32 s57, s66, 15
  s_mul_i32 s53, s21, 8320
  s_add_u32 s53, s53, s67
  s_add_u32 m0, s53, 0
  s_add_u32 s54, s57, 0
  buffer_load_dwordx4 v6, s[12:15], s54 offen sc1 lds
  s_add_u32 m0, s53, 1040
  s_add_u32 s54, s57, 1024
  buffer_load_dwordx4 v6, s[12:15], s54 offen sc1 lds
  s_add_u32 m0, s53, 2080
  s_add_u32 s54, s57, 2048
  buffer_load_dwordx4 v6, s[12:15], s54 offen sc1 lds
  s_add_u32 m0, s53, 3120
  s_add_u32 s54, s57, 3072
  buffer_load_dwordx4 v6, s[12:15], s54 offen sc1 lds
  s_add_u32 m0, s53, 4160
  s_add_u32 s54, s57, 4096
  buffer_load_dwordx4 v6, s[12:15], s54 offen sc1 lds
  s_add_u32 m0, s53, 5200
  s_add_u32 s54, s57, 5120
  buffer_load_dwordx4 v6, s[12:15], s54 offen sc1 lds
  s_add_u32 m0, s53, 6240
  s_add_u32 s54, s57, 6144
  buffer_load_dwordx4 v6, s[12:15], s54 offen sc1 lds
  s_add_u32 m0, s53, 7280
  s_add_u32 s54, s57, 7168
  buffer_load_dwordx4 v6, s[12:15], s54 offen sc1 lds
Lsl_30:
  s_lshr_b32 s69, s47, 5
  s_lshl_b32 s69, s69, 2
  s_mul_i32 s53, s21, 256
  s_add_u32 s53, s53, s51
  v_add_u32 v9, s53, v5
  v_mov_b32 v96, 0
  v_mov_b32 v97, 0
  ds_read_b128 v[104:107], v9 offset:0
  ds_read_b128 v[108:111], v9 offset:32
  ds_read_b128 v[112:115], v9 offset:64
  ds_read_b128 v[116:119], v9 offset:96
  ds_read_b128 v[120:123], v9 offset:128
  ds_read_b128 v[124:127], v9 offset:160
  ds_read_b128 v[128:131], v9 offset:192
  ds_read_b128 v[132:135], v9 offset:224
  s_waitcnt lgkmcnt(7)
  v_dot2c_f32_bf16 v96, v104, v100
  v_dot2c_f32_bf16 v97, v104, v104
  v_dot2c_f32_bf16 v96, v105, v100
  v_dot2c_f32_bf16 v97, v105, v105
  v_dot2c_f32_bf16 v96, v106, v100
  v_dot2c_f32_bf16 v97, v106, v106
  v_dot2c_f32_bf16 v96, v107, v100
  v_dot2c_f32_bf16 v97, v107, v107
  s_waitcnt lgkmcnt(6)
  v_dot2c_f32_bf16 v96, v108, v100
  v_dot2c_f32_bf16 v97, v108, v108
  v_dot2c_f32_bf16 v96, v109, v100
  v_dot2c_f32_bf16 v97, v109, v109
  v_dot2c_f32_bf16 v96, v110, v100
  v_dot2c_f32_bf16 v97, v110, v110
  v_dot2c_f32_bf16 v96, v111, v100
  v_dot2c_f32_bf16 v97, v111, v111
  s_waitcnt lgkmcnt(5)
  v_dot2c_f32_bf16 v96, v112, v100
  v_dot2c_f32_bf16 v97, v112, v112
  v_dot2c_f32_bf16 v96, v113, v100
  v_dot2c_f32_bf16 v97, v113, v113
  v_dot2c_f32_bf16 v96, v114, v100
  v_dot2c_f32_bf16 v97, v114, v114
  v_dot2c_f32_bf16 v96, v115, v100
  v_dot2c_f32_bf16 v97, v115, v115
  s_waitcnt lgkmcnt(4)
  v_dot2c_f32_bf16 v96, v116, v100
  v_dot2c_f32_bf16 v97, v116, v116
  v_dot2c_f32_bf16 v96, v117, v100
  v_dot2c_f32_bf16 v97, v117, v117
  v_dot2c_f32_bf16 v96, v118, v100
  v_dot2c_f32_bf16 v97, v118, v118
  v_dot2c_f32_bf16 v96, v119, v100
  v_dot2c_f32_bf16 v97, v119, v119
  s_waitcnt lgkmcnt(3)
  v_dot2c_f32_bf16 v96, v120, v100
  v_dot2c_f32_bf16 v97, v120, v120
  v_dot2c_f32_bf16 v96, v121, v100
  v_dot2c_f32_bf16 v97, v121, v121
  v_dot2c_f32_bf16 v96, v122, v100
  v_dot2c_f32_bf16 v97, v122, v122
  v_dot2c_f32_bf16 v96, v123, v100
  v_dot2c_f32_bf16 v97, v123, v123
  s_waitcnt lgkmcnt(2)
  v_dot2c_f32_bf16 v96, v124, v100
  v_dot2c_f32_bf16 v97, v124, v124
  v_dot2c_f32_bf16 v96, v125, v100
  v_dot2c_f32_bf16 v97, v125, v125
  v_dot2c_f32_bf16 v96, v126, v100
  v_dot2c_f32_bf16 v97, v126, v126
  v_dot2c_f32_bf16 v96, v127, v100
  v_dot2c_f32_bf16 v97, v127, v127
  s_waitcnt lgkmcnt(1)
  v_dot2c_f32_bf16 v96, v128, v100
  v_dot2c_f32_bf16 v97, v128, v128
  v_dot2c_f32_bf16 v96, v129, v100
  v_dot2c_f32_bf16 v97, v129, v129
  v_dot2c_f32_bf16 v96, v130, v100
  v_dot2c_f32_bf16 v97, v130, v130
  v_dot2c_f32_bf16 v96, v131, v100
  v_dot2c_f32_bf16 v97, v131, v131
  s_waitcnt lgkmcnt(0)
  v_dot2c_f32_bf16 v96, v132, v100
  v_dot2c_f32_bf16 v97, v132, v132
  v_dot2c_f32_bf16 v96, v133, v100
  v_dot2c_f32_bf16 v97, v133, v133
  v_dot2c_f32_bf16 v96, v134, v100
  v_dot2c_f32_bf16 v97, v134, v134
  v_dot2c_f32_bf16 v96, v135, v100
  v_dot2c_f32_bf16 v97, v135, v135
  s_nop 2
  v_permlane32_swap_b32 v96, v97
  v_add_f32 v96, v96, v97
  v_lshlrev_b32 v10, 2, v0
  s_lshl_b32 s53, s21, 8
  s_add_u32 s53, s53, 68608
  v_add_u32 v10, s53, v10
  ds_write_b32 v10, v96
  v_add_u32 v9, s51, v5
  ds_read_b128 v[80:83], v9 offset:0
  ds_read_b128 v[84:87], v9 offset:32
  ds_read_b128 v[88:91], v9 offset:64
  s_waitcnt lgkmcnt(2)
  v_mfma_f32_32x32x16_bf16 v[16:31], v[80:83], a[0:3], 0
  ds_read_b128 v[92:95], v9 offset:96
  v_mfma_f32_32x32x16_bf16 v[32:47], v[80:83], a[4:7], 0
  s_waitcnt lgkmcnt(2)
  v_mfma_f32_32x32x16_bf16 v[16:31], v[84:87], a[8:11], v[16:31]
  ds_read_b128 v[80:83], v9 offset:128
  v_mfma_f32_32x32x16_bf16 v[32:47], v[84:87], a[12:15], v[32:47]
  s_waitcnt lgkmcnt(2)
  v_mfma_f32_32x32x16_bf16 v[16:31], v[88:91], a[16:19], v[16:31]
  ds_read_b128 v[84:87], v9 offset:160
  v_mfma_f32_32x32x16_bf16 v[32:47], v[88:91], a[20:23], v[32:47]
  s_waitcnt lgkmcnt(2)
  v_mfma_f32_32x32x16_bf16 v[16:31], v[92:95], a[24:27], v[16:31]
  ds_read_b128 v[88:91], v9 offset:192
  v_mfma_f32_32x32x16_bf16 v[32:47], v[92:95], a[28:31], v[32:47]
  s_waitcnt lgkmcnt(2)
  v_mfma_f32_32x32x16_bf16 v[16:31], v[80:83], a[32:35], v[16:31]
  ds_read_b128 v[92:95], v9 offset:224
  v_mfma_f32_32x32x16_bf16 v[32:47], v[80:83], a[36:39], v[32:47]
  s_waitcnt lgkmcnt(2)
  v_mfma_f32_32x32x16_bf16 v[16:31], v[84:87], a[40:43], v[16:31]
  ds_read_b128 v[80:83], v9 offset:256
  v_mfma_f32_32x32x16_bf16 v[32:47], v[84:87], a[44:47], v[32:47]
  s_waitcnt lgkmcnt(2)
  v_mfma_f32_32x32x16_bf16 v[16:31], v[88:91], a[48:51], v[16:31]
  ds_read_b128 v[84:87], v9 offset:288
  v_mfma_f32_32x32x16_bf16 v[32:47], v[88:91], a[52:55], v[32:47]
  s_waitcnt lgkmcnt(2)
  v_mfma_f32_32x32x16_bf16 v[16:31], v[92:95], a[56:59], v[16:31]
  ds_read_b128 v[88:91], v9 offset:320
  v_mfma_f32_32x32x16_bf16 v[32:47], v[92:95], a[60:63], v[32:47]
  s_waitcnt lgkmcnt(2)
  v_mfma_f32_32x32x16_bf16 v[16:31], v[80:83], a[64:67], v[16:31]
  ds_read_b128 v[92:95], v9 offset:352
  v_mfma_f32_32x32x16_bf16 v[32:47], v[80:83], a[68:71], v[32:47]
  s_waitcnt lgkmcnt(2)
  v_mfma_f32_32x32x16_bf16 v[16:31], v[84:87], a[72:75], v[16:31]
  ds_read_b128 v[80:83], v9 offset:384
  v_mfma_f32_32x32x16_bf16 v[32:47], v[84:87], a[76:79], v[32:47]
  s_waitcnt lgkmcnt(2)
  v_mfma_f32_32x32x16_bf16 v[16:31], v[88:91], a[80:83], v[16:31]
  ds_read_b128 v[84:87], v9 offset:416
  v_mfma_f32_32x32x16_bf16 v[32:47], v[88:91], a[84:87], v[32:47]
  s_waitcnt lgkmcnt(2)
  v_mfma_f32_32x32x16_bf16 v[16:31], v[92:95], a[88:91], v[16:31]
  ds_read_b128 v[88:91], v9 offset:448
  v_mfma_f32_32x32x16_bf16 v[32:47], v[92:95], a[92:95], v[32:47]
  s_waitcnt lgkmcnt(2)
  v_mfma_f32_32x32x16_bf16 v[16:31], v[80:83], a[96:99], v[16:31]
  ds_read_b128 v[92:95], v9 offset:480
  v_mfma_f32_32x32x16_bf16 v[32:47], v[80:83], a[100:103], v[32:47]
  s_waitcnt lgkmcnt(2)
  v_mfma_f32_32x32x16_bf16 v[16:31], v[84:87], a[104:107], v[16:31]
  ds_read_b128 v[80:83], v9 offset:512
  v_mfma_f32_32x32x16_bf16 v[32:47], v[84:87], a[108:111], v[32:47]
  s_waitcnt lgkmcnt(2)
  v_mfma_f32_32x32x16_bf16 v[16:31], v[88:91], a[112:115], v[16:31]
  ds_read_b128 v[84:87], v9 offset:544
  v_mfma_f32_32x32x16_bf16 v[32:47], v[88:91], a[116:119], v[32:47]
  s_waitcnt lgkmcnt(2)
  v_mfma_f32_32x32x16_bf16 v[16:31], v[92:95], a[120:123], v[16:31]
  ds_read_b128 v[88:91], v9 offset:576
  v_mfma_f32_32x32x16_bf16 v[32:47], v[92:95], a[124:127], v[32:47]
  s_waitcnt lgkmcnt(2)
  v_mfma_f32_32x32x16_bf16 v[16:31], v[80:83], a[128:131], v[16:31]
  ds_read_b128 v[92:95], v9 offset:608
  v_mfma_f32_32x32x16_bf16 v[32:47], v[80:83], a[132:135], v[32:47]
  s_waitcnt lgkmcnt(2)
  v_mfma_f32_32x32x16_bf16 v[16:31], v[84:87], a[136:139], v[16:31]
  ds_read_b128 v[80:83], v9 offset:640
  v_mfma_f32_32x32x16_bf16 v[32:47], v[84:87], a[140:143], v[32:47]
  s_waitcnt lgkmcnt(2)
  v_mfma_f32_32x32x16_bf16 v[16:31], v[88:91], a[144:147], v[16:31]
  ds_read_b128 v[84:87], v9 offset:672
  v_mfma_f32_32x32x16_bf16 v[32:47], v[88:91], a[148:151], v[32:47]
  s_waitcnt lgkmcnt(2)
  v_mfma_f32_32x32x16_bf16 v[16:31], v[92:95], a[152:155], v[16:31]
  ds_read_b128 v[88:91], v9 offset:704
  v_mfma_f32_32x32x16_bf16 v[32:47], v[92:95], a[156:159], v[32:47]
  s_waitcnt lgkmcnt(2)
  v_mfma_f32_32x32x16_bf16 v[16:31], v[80:83], a[160:163], v[16:31]
  ds_read_b128 v[92:95], v9 offset:736
  v_mfma_f32_32x32x16_bf16 v[32:47], v[80:83], a[164:167], v[32:47]
  s_waitcnt lgkmcnt(2)
  v_mfma_f32_32x32x16_bf16 v[16:31], v[84:87], a[168:171], v[16:31]
  ds_read_b128 v[80:83], v9 offset:768
  v_mfma_f32_32x32x16_bf16 v[32:47], v[84:87], a[172:175], v[32:47]
  s_waitcnt lgkmcnt(2)
  v_mfma_f32_32x32x16_bf16 v[16:31], v[88:91], a[176:179], v[16:31]
  ds_read_b128 v[84:87], v9 offset:800
  v_mfma_f32_32x32x16_bf16 v[32:47], v[88:91], a[180:183], v[32:47]
  s_waitcnt lgkmcnt(2)
  v_mfma_f32_32x32x16_bf16 v[16:31], v[92:95], a[184:187], v[16:31]
  ds_read_b128 v[88:91], v9 offset:832
  v_mfma_f32_32x32x16_bf16 v[32:47], v[92:95], a[188:191], v[32:47]
  s_waitcnt lgkmcnt(2)
  v_mfma_f32_32x32x16_bf16 v[16:31], v[80:83], a[192:195], v[16:31]
  ds_read_b128 v[92:95], v9 offset:864
  v_mfma_f32_32x32x16_bf16 v[32:47], v[80:83], a[196:199], v[32:47]
  s_waitcnt lgkmcnt(2)
  v_mfma_f32_32x32x16_bf16 v[16:31], v[84:87], a[200:203], v[16:31]
  ds_read_b128 v[80:83], v9 offset:896
  v_mfma_f32_32x32x16_bf16 v[32:47], v[84:87], a[204:207], v[32:47]
  s_waitcnt lgkmcnt(2)
  v_mfma_f32_32x32x16_bf16 v[16:31], v[88:91], a[208:211], v[16:31]
  ds_read_b128 v[84:87], v9 offset:928
  v_mfma_f32_32x32x16_bf16 v[32:47], v[88:91], a[212:215], v[32:47]
  s_waitcnt lgkmcnt(2)
  v_mfma_f32_32x32x16_bf16 v[16:31], v[92:95], a[216:219], v[16:31]
  ds_read_b128 v[88:91], v9 offset:960
  v_mfma_f32_32x32x16_bf16 v[32:47], v[92:95], a[220:223], v[32:47]
  s_waitcnt lgkmcnt(2)
  v_mfma_f32_32x32x16_bf16 v[16:31], v[80:83], a[224:227], v[16:31]
  ds_read_b128 v[92:95], v9 offset:992
  v_mfma_f32_32x32x16_bf16 v[32:47], v[80:83], a[228:231], v[32:47]
  s_waitcnt lgkmcnt(2)
  v_mfma_f32_32x32x16_bf16 v[16:31], v[84:87], a[232:235], v[16:31]
  v_mfma_f32_32x32x16_bf16 v[32:47], v[84:87], a[236:239], v[32:47]
  s_waitcnt lgkmcnt(1)
  v_mfma_f32_32x32x16_bf16 v[16:31], v[88:91], a[240:243], v[16:31]
  v_mfma_f32_32x32x16_bf16 v[32:47], v[88:91], a[244:247], v[32:47]
  s_waitcnt lgkmcnt(0)
  v_mfma_f32_32x32x16_bf16 v[16:31], v[92:95], a[248:251], v[16:31]
  v_mfma_f32_32x32x16_bf16 v[32:47], v[92:95], a[252:255], v[32:47]
  s_barrier
  v_lshlrev_b32 v10, 2, v2
  v_add_u32 v10, 68608, v10
  ds_read2_b32 v[104:105], v10 offset0:0 offset1:32
  ds_read2_b32 v[106:107], v10 offset0:64 offset1:96
  ds_read2_b32 v[108:109], v10 offset0:128 offset1:160
  ds_read2_b32 v[110:111], v10 offset0:192 offset1:224
  s_waitcnt lgkmcnt(0)
  v_pk_add_f32 v[104:105], v[104:105], v[106:107]
  v_pk_add_f32 v[108:109], v[108:109], v[110:111]
  v_pk_add_f32 v[96:97], v[104:105], v[108:109]
  v_mul_f32 v96, s59, v96
  v_mul_f32 v97, s59, v97
  v_fma_f32 v97, -v96, v96, v97
  v_max_f32 v97, 0, v97
  v_cvt_pk_bf16_f32 v96, v96, v96
  v_and_b32 v96, 0xffff0000, v96
  v_cvt_pk_bf16_f32 v97, v97, v97
  v_and_b32 v97, 0xffff0000, v97
  v_add_f32 v97, s60, v97
  v_cvt_pk_bf16_f32 v97, v97, v97
  v_and_b32 v97, 0xffff0000, v97
  v_sqrt_f32 v97, v97
  s_nop 0
  v_cvt_pk_bf16_f32 v97, v97, v97
  v_and_b32 v97, 0xffff0000, v97
  v_rcp_f32 v97, v97
  s_nop 0
  v_mul_f32 v96, v96, v97
  ds_write2_b32 v7, v96, v97 offset0:0 offset1:32
  s_waitcnt lgkmcnt(0)
  ds_read_b128 v[104:107], v8 offset:0
  ds_read_b128 v[120:123], v8 offset:128
  ds_read_b128 v[108:111], v8 offset:32
  ds_read_b128 v[124:127], v8 offset:160
  ds_read_b128 v[112:115], v8 offset:64
  ds_read_b128 v[128:131], v8 offset:192
  ds_read_b128 v[116:119], v8 offset:96
  ds_read_b128 v[132:135], v8 offset:224
  s_waitcnt lgkmcnt(0)
  v_pk_mul_f32 v[10:11], v[104:105], v[48:49]
  v_pk_fma_f32 v[16:17], v[16:17], v[120:121], v[10:11] neg_lo:[0,0,1] neg_hi:[0,0,1]
  v_pk_mul_f32 v[10:11], v[106:107], v[48:49]
  v_pk_fma_f32 v[18:19], v[18:19], v[122:123], v[10:11] neg_lo:[0,0,1] neg_hi:[0,0,1]
  v_pk_mul_f32 v[10:11], v[108:109], v[48:49]
  v_pk_fma_f32 v[20:21], v[20:21], v[124:125], v[10:11] neg_lo:[0,0,1] neg_hi:[0,0,1]
  v_pk_mul_f32 v[10:11], v[110:111], v[48:49]
  v_pk_fma_f32 v[22:23], v[22:23], v[126:127], v[10:11] neg_lo:[0,0,1] neg_hi:[0,0,1]
  v_pk_mul_f32 v[10:11], v[112:113], v[48:49]
  v_pk_fma_f32 v[24:25], v[24:25], v[128:129], v[10:11] neg_lo:[0,0,1] neg_hi:[0,0,1]
  v_pk_mul_f32 v[10:11], v[114:115], v[48:49]
  v_pk_fma_f32 v[26:27], v[26:27], v[130:131], v[10:11] neg_lo:[0,0,1] neg_hi:[0,0,1]
  v_pk_mul_f32 v[10:11], v[116:117], v[48:49]
  v_pk_fma_f32 v[28:29], v[28:29], v[132:133], v[10:11] neg_lo:[0,0,1] neg_hi:[0,0,1]
  v_pk_mul_f32 v[10:11], v[118:119], v[48:49]
  v_pk_fma_f32 v[30:31], v[30:31], v[134:135], v[10:11] neg_lo:[0,0,1] neg_hi:[0,0,1]
  v_pk_mul_f32 v[10:11], v[104:105], v[64:65]
  v_pk_fma_f32 v[32:33], v[32:33], v[120:121], v[10:11] neg_lo:[0,0,1] neg_hi:[0,0,1]
  v_pk_mul_f32 v[10:11], v[106:107], v[64:65]
  v_pk_fma_f32 v[34:35], v[34:35], v[122:123], v[10:11] neg_lo:[0,0,1] neg_hi:[0,0,1]
  v_pk_mul_f32 v[10:11], v[108:109], v[64:65]
  v_pk_fma_f32 v[36:37], v[36:37], v[124:125], v[10:11] neg_lo:[0,0,1] neg_hi:[0,0,1]
  v_pk_mul_f32 v[10:11], v[110:111], v[64:65]
  v_pk_fma_f32 v[38:39], v[38:39], v[126:127], v[10:11] neg_lo:[0,0,1] neg_hi:[0,0,1]
  v_pk_mul_f32 v[10:11], v[112:113], v[64:65]
  v_pk_fma_f32 v[40:41], v[40:41], v[128:129], v[10:11] neg_lo:[0,0,1] neg_hi:[0,0,1]
  v_pk_mul_f32 v[10:11], v[114:115], v[64:65]
  v_pk_fma_f32 v[42:43], v[42:43], v[130:131], v[10:11] neg_lo:[0,0,1] neg_hi:[0,0,1]
  v_pk_mul_f32 v[10:11], v[116:117], v[64:65]
  v_pk_fma_f32 v[44:45], v[44:45], v[132:133], v[10:11] neg_lo:[0,0,1] neg_hi:[0,0,1]
  v_pk_mul_f32 v[10:11], v[118:119], v[64:65]
  v_pk_fma_f32 v[46:47], v[46:47], v[134:135], v[10:11] neg_lo:[0,0,1] neg_hi:[0,0,1]
  v_pk_mul_f32 v[10:11], v[16:17], s[72:73]
  v_exp_f32 v10, v10 clamp
  v_exp_f32 v11, v11 clamp
  v_max_f32 v16, 0, v16
  v_max_f32 v17, 0, v17
  v_pk_add_f32 v[10:11], v[10:11], s[70:71]
  v_pk_add_f32 v[16:17], v[16:17], v[10:11]
  v_pk_mul_f32 v[10:11], v[18:19], s[72:73]
  v_exp_f32 v10, v10 clamp
  v_exp_f32 v11, v11 clamp
  v_max_f32 v18, 0, v18
  v_max_f32 v19, 0, v19
  v_pk_add_f32 v[10:11], v[10:11], s[70:71]
  v_pk_add_f32 v[18:19], v[18:19], v[10:11]
  v_pk_mul_f32 v[10:11], v[20:21], s[72:73]
  v_exp_f32 v10, v10 clamp
  v_exp_f32 v11, v11 clamp
  v_max_f32 v20, 0, v20
  v_max_f32 v21, 0, v21
  v_pk_add_f32 v[10:11], v[10:11], s[70:71]
  v_pk_add_f32 v[20:21], v[20:21], v[10:11]
  v_pk_mul_f32 v[10:11], v[22:23], s[72:73]
  v_exp_f32 v10, v10 clamp
  v_exp_f32 v11, v11 clamp
  v_max_f32 v22, 0, v22
  v_max_f32 v23, 0, v23
  v_pk_add_f32 v[10:11], v[10:11], s[70:71]
  v_pk_add_f32 v[22:23], v[22:23], v[10:11]
  v_pk_mul_f32 v[10:11], v[24:25], s[72:73]
  v_exp_f32 v10, v10 clamp
  v_exp_f32 v11, v11 clamp
  v_max_f32 v24, 0, v24
  v_max_f32 v25, 0, v25
  v_pk_add_f32 v[10:11], v[10:11], s[70:71]
  v_pk_add_f32 v[24:25], v[24:25], v[10:11]
  v_pk_mul_f32 v[10:11], v[26:27], s[72:73]
  v_exp_f32 v10, v10 clamp
  v_exp_f32 v11, v11 clamp
  v_max_f32 v26, 0, v26
  v_max_f32 v27, 0, v27
  v_pk_add_f32 v[10:11], v[10:11], s[70:71]
  v_pk_add_f32 v[26:27], v[26:27], v[10:11]
  v_pk_mul_f32 v[10:11], v[28:29], s[72:73]
  v_exp_f32 v10, v10 clamp
  v_exp_f32 v11, v11 clamp
  v_max_f32 v28, 0, v28
  v_max_f32 v29, 0, v29
  v_pk_add_f32 v[10:11], v[10:11], s[70:71]
  v_pk_add_f32 v[28:29], v[28:29], v[10:11]
  v_pk_mul_f32 v[10:11], v[30:31], s[72:73]
  v_exp_f32 v10, v10 clamp
  v_exp_f32 v11, v11 clamp
  v_max_f32 v30, 0, v30
  v_max_f32 v31, 0, v31
  v_pk_add_f32 v[10:11], v[10:11], s[70:71]
  v_pk_add_f32 v[30:31], v[30:31], v[10:11]
  v_cvt_pk_bf16_f32 v104, v16, v17
  v_cvt_pk_bf16_f32 v105, v18, v19
  v_cvt_pk_bf16_f32 v106, v20, v21
  v_cvt_pk_bf16_f32 v107, v22, v23
  v_cvt_pk_bf16_f32 v108, v24, v25
  v_cvt_pk_bf16_f32 v109, v26, v27
  v_cvt_pk_bf16_f32 v110, v28, v29
  v_cvt_pk_bf16_f32 v111, v30, v31
  v_cvt_pk_bf16_f32 v112, v32, v33
  v_cvt_pk_bf16_f32 v113, v34, v35
  v_cvt_pk_bf16_f32 v114, v36, v37
  v_cvt_pk_bf16_f32 v115, v38, v39
  v_cvt_pk_bf16_f32 v116, v40, v41
  v_cvt_pk_bf16_f32 v117, v42, v43
  v_cvt_pk_bf16_f32 v118, v44, v45
  v_cvt_pk_bf16_f32 v119, v46, v47
  v_mfma_f32_32x32x16_bf16 v[136:151], v[104:107], v[112:115], v[136:151]
  v_mfma_f32_32x32x16_bf16 v[152:167], v[100:103], v[104:107], v[152:167]
  v_mfma_f32_32x32x16_bf16 v[136:151], v[108:111], v[116:119], v[136:151]
  v_mfma_f32_32x32x16_bf16 v[152:167], v[100:103], v[108:111], v[152:167]
  s_xor_b32 s51, s51, 33280
  s_mov_b32 s47, s66
  s_cmp_eq_u32 s58, 1
  s_nop 7
  s_cbranch_scc1 Lsl_27
Lsl_31:
  s_cmp_ge_u32 s47, s48
  s_cbranch_scc1 Lsl_29
  s_lshl_b32 s57, s47, 15
  s_mul_i32 s53, s21, 8320
  s_add_u32 s53, s53, s51
  s_add_u32 m0, s53, 0
  s_add_u32 s54, s57, 0
  buffer_load_dwordx4 v6, s[12:15], s54 offen sc1 lds
  s_add_u32 m0, s53, 1040
  s_add_u32 s54, s57, 1024
  buffer_load_dwordx4 v6, s[12:15], s54 offen sc1 lds
  s_add_u32 m0, s53, 2080
  s_add_u32 s54, s57, 2048
  buffer_load_dwordx4 v6, s[12:15], s54 offen sc1 lds
  s_add_u32 m0, s53, 3120
  s_add_u32 s54, s57, 3072
  buffer_load_dwordx4 v6, s[12:15], s54 offen sc1 lds
  s_add_u32 m0, s53, 4160
  s_add_u32 s54, s57, 4096
  buffer_load_dwordx4 v6, s[12:15], s54 offen sc1 lds
  s_add_u32 m0, s53, 5200
  s_add_u32 s54, s57, 5120
  buffer_load_dwordx4 v6, s[12:15], s54 offen sc1 lds
  s_add_u32 m0, s53, 6240
  s_add_u32 s54, s57, 6144
  buffer_load_dwordx4 v6, s[12:15], s54 offen sc1 lds
  s_add_u32 m0, s53, 7280
  s_add_u32 s54, s57, 7168
  buffer_load_dwordx4 v6, s[12:15], s54 offen sc1 lds
  s_branch Lsl_27
Lsl_29:
  s_lshl_b32 s29, s20, 14
  s_lshl_b32 s30, s21, 12
  s_add_u32 s53, s29, s30
  s_add_u32 s53, s53, 30375936
  v_bfe_u32 v11, v0, 4, 1
  v_lshlrev_b32 v12, 11, v11
  v_lshl_add_u32 v14, v3, 10, v12
  v_and_b32 v13, 15, v0
  v_lshl_add_u32 v14, v13, 5, v14
  v_lshlrev_b32 v12, 2, v0
  v_add_u32 v12, 512, v12
  v_mov_b32 v15, 0x80000000
  v_cmp_eq_u32 vcc, 0, v3
  s_nop 1
  v_cndmask_b32 v12, v15, v12, vcc
  v_cmp_eq_u32 vcc, 1, v11
  s_nop 1
  v_cndmask_b32 v104, v136, v144, vcc
  v_cndmask_b32 v105, v137, v145, vcc
  v_cndmask_b32 v106, v138, v146, vcc
  v_cndmask_b32 v107, v139, v147, vcc
  v_cndmask_b32 v108, v140, v148, vcc
  v_cndmask_b32 v109, v141, v149, vcc
  v_cndmask_b32 v110, v142, v150, vcc
  v_cndmask_b32 v111, v143, v151, vcc
  s_lshl_b32 s29, s21, 11
  s_add_u32 s29, s29, 69632
  v_lshlrev_b32 v15, 5, v0
  v_add_u32 v15, s29, v15
  ds_write_b128 v15, v[104:107]
  ds_write_b128 v15, v[108:111] offset:16
  v_lshlrev_b32 v15, 2, v0
  v_add_u32 v13, s29, v15
  s_waitcnt lgkmcnt(0)
  ds_read_b32 v112, v13 offset:0
  ds_read_b32 v113, v13 offset:256
  ds_read_b32 v114, v13 offset:512
  ds_read_b32 v115, v13 offset:768
  ds_read_b32 v116, v13 offset:1024
  ds_read_b32 v117, v13 offset:1280
  ds_read_b32 v118, v13 offset:1536
  ds_read_b32 v119, v13 offset:1792
  buffer_atomic_add_f32 v152, v12, s[4:7], s53 offen
  s_waitcnt lgkmcnt(0)
  buffer_atomic_add_f32 v112, v15, s[4:7], s53 offen offset:0
  buffer_atomic_add_f32 v113, v15, s[4:7], s53 offen offset:256
  buffer_atomic_add_f32 v114, v15, s[4:7], s53 offen offset:2048
  buffer_atomic_add_f32 v115, v15, s[4:7], s53 offen offset:2304
  buffer_atomic_add_f32 v116, v15, s[4:7], s53 offen offset:1024
  buffer_atomic_add_f32 v117, v15, s[4:7], s53 offen offset:1280
  buffer_atomic_add_f32 v118, v15, s[4:7], s53 offen offset:3072
  buffer_atomic_add_f32 v119, v15, s[4:7], s53 offen offset:3328
La1_20:
  s_and_b32 s53, s50, 7
  s_lshl_b32 s53, s53, 7
  s_add_u32 s53, s53, 36864
  s_waitcnt vmcnt(0)
  s_barrier
  s_cmp_lg_u32 s21, 0
  s_cbranch_scc1 Lsg_33
  v_mov_b32 v10, 1
  s_mov_b64 exec, 1
  buffer_atomic_add v10, off, s[4:7], s53 sc1
  s_mov_b64 exec, -1
Lsg_33:
  s_branch L_after1
L_a1b:
  v_lshlrev_b32 v1, 4, v0
  v_and_b32 v2, 31, v0
  v_lshrrev_b32 v3, 5, v0
  v_bfe_u32 v4, v0, 2, 2
  s_mov_b32 s70, 0x358637bd
  s_mov_b32 s71, 0x358637bd
  s_mov_b32 s73, 0x3fb8aa3b
  s_mov_b32 s72, 0x3fb8aa3b
  s_mov_b32 s59, 0x3b000000
  s_mov_b32 s60, 0x3727c5ac
  v_mov_b32 v100, 0x3f803f80
  v_mov_b32 v101, 0x3f803f80
  v_mov_b32 v102, 0x3f803f80
  v_mov_b32 v103, 0x3f803f80
  v_mov_b32 v5, v1
  s_lshl_b32 s29, s21, 13
  v_add_u32 v6, s29, v1
  s_lshl_b32 s29, s21, 8
  s_add_u32 s29, s29, 67584
  v_lshlrev_b32 v7, 2, v2
  v_add_u32 v7, s29, v7
  v_lshlrev_b32 v8, 4, v3
  v_add_u32 v8, s29, v8
  s_mov_b32 s8, s84
  s_and_b32 s9, s85, 0xffff
  s_mov_b32 s10, 1572864
  s_mov_b32 s11, 0x20000
  s_lshl_b32 s54, s75, 2
  s_add_u32 s54, s54, s21
  s_mul_i32 s54, s54, 12288
  v_lshlrev_b32 v17, 7, v0
  v_lshlrev_b32 v18, 7, v2
  buffer_load_dword v16, v17, s[8:11], s54 offen
  s_add_u32 s54, s54, 8192
  buffer_load_dword v16, v18, s[8:11], s54 offen
  s_lshl_b32 s57, s20, 9
  s_lshl_b32 s29, s21, 7
  s_add_u32 s57, s57, s29
  s_add_u32 s52, s57, 64
  s_lshl_b32 s53, s20, 8
  s_lshl_b32 s29, s21, 6
  s_add_u32 s53, s53, s29
  s_add_u32 s53, s53, 512
  s_add_u32 s54, s53, 1024
  s_cmp_lt_u32 s20, 2
  s_cselect_b32 s57, s57, s53
  s_cselect_b32 s52, s52, s54
  v_lshrrev_b32 v10, 3, v0
  v_and_b32 v11, 7, v0
  v_bfe_u32 v12, v0, 4, 1
  v_lshlrev_b32 v12, 2, v12
  v_xor_b32 v11, v11, v12
  s_mov_b32 s29, 3072
  v_mul_lo_u32 v10, v10, s29
  v_and_b32 v12, 3, v11
  v_lshl_add_u32 v10, v12, 4, v10
  s_sub_u32 s29, s52, s57
  v_lshrrev_b32 v12, 2, v11
  v_mul_lo_u32 v12, v12, s29
  v_add_u32 v10, v10, v12
  v_lshl_add_u32 v13, v3, 2, v4
  v_mul_u32_u24 v13, 128, v13
  v_bfe_u32 v12, v0, 4, 1
  v_lshl_add_u32 v13, v12, 5, v13
  v_and_b32 v12, 3, v0
  v_lshl_add_u32 v13, v12, 3, v13
  s_mul_i32 s83, s21, 24576
  s_add_u32 s83, s83, 33792
  v_add_u32 v13, s83, v13
  v_bfe_u32 v12, v0, 3, 1
  v_lshlrev_b32 v12, 6, v12
  v_xor_b32 v13, v13, v12
  v_xor_b32 v14, 64, v13
  s_waitcnt lgkmcnt(0)
  s_add_u32 m0, s83, 0
  s_add_u32 s54, s57, 0
  buffer_load_dwordx4 v10, s[8:11], s54 offen lds
  s_add_u32 m0, s83, 1024
  s_add_u32 s54, s57, 24576
  buffer_load_dwordx4 v10, s[8:11], s54 offen lds
  s_add_u32 m0, s83, 2048
  s_add_u32 s54, s57, 49152
  buffer_load_dwordx4 v10, s[8:11], s54 offen lds
  s_add_u32 m0, s83, 3072
  s_add_u32 s54, s57, 73728
  buffer_load_dwordx4 v10, s[8:11], s54 offen lds
  s_add_u32 m0, s83, 4096
  s_add_u32 s54, s57, 98304
  buffer_load_dwordx4 v10, s[8:11], s54 offen lds
  s_add_u32 m0, s83, 5120
  s_add_u32 s54, s57, 122880
  buffer_load_dwordx4 v10, s[8:11], s54 offen lds
  s_add_u32 m0, s83, 6144
  s_add_u32 s54, s57, 147456
  buffer_load_dwordx4 v10, s[8:11], s54 offen lds
  s_add_u32 m0, s83, 7168
  s_add_u32 s54, s57, 172032
  buffer_load_dwordx4 v10, s[8:11], s54 offen lds
  s_add_u32 m0, s83, 8192
  s_add_u32 s54, s57, 196608
  buffer_load_dwordx4 v10, s[8:11], s54 offen lds
  s_add_u32 m0, s83, 9216
  s_add_u32 s54, s57, 221184
  buffer_load_dwordx4 v10, s[8:11], s54 offen lds
  s_add_u32 m0, s83, 10240
  s_add_u32 s54, s57, 245760
  buffer_load_dwordx4 v10, s[8:11], s54 offen lds
  s_add_u32 m0, s83, 11264
  s_add_u32 s54, s57, 270336
  buffer_load_dwordx4 v10, s[8:11], s54 offen lds
  s_add_u32 m0, s83, 12288
  s_add_u32 s54, s57, 294912
  buffer_load_dwordx4 v10, s[8:11], s54 offen lds
  s_add_u32 m0, s83, 13312
  s_add_u32 s54, s57, 319488
  buffer_load_dwordx4 v10, s[8:11], s54 offen lds
  s_add_u32 m0, s83, 14336
  s_add_u32 s54, s57, 344064
  buffer_load_dwordx4 v10, s[8:11], s54 offen lds
  s_add_u32 m0, s83, 15360
  s_add_u32 s54, s57, 368640
  buffer_load_dwordx4 v10, s[8:11], s54 offen lds
  s_add_u32 m0, s83, 16384
  s_add_u32 s54, s57, 393216
  buffer_load_dwordx4 v10, s[8:11], s54 offen lds
  s_add_u32 m0, s83, 17408
  s_add_u32 s54, s57, 417792
  buffer_load_dwordx4 v10, s[8:11], s54 offen lds
  s_add_u32 m0, s83, 18432
  s_add_u32 s54, s57, 442368
  buffer_load_dwordx4 v10, s[8:11], s54 offen lds
  s_add_u32 m0, s83, 19456
  s_add_u32 s54, s57, 466944
  buffer_load_dwordx4 v10, s[8:11], s54 offen lds
  s_add_u32 m0, s83, 20480
  s_add_u32 s54, s57, 491520
  buffer_load_dwordx4 v10, s[8:11], s54 offen lds
  s_add_u32 m0, s83, 21504
  s_add_u32 s54, s57, 516096
  buffer_load_dwordx4 v10, s[8:11], s54 offen lds
  s_add_u32 m0, s83, 22528
  s_add_u32 s54, s57, 540672
  buffer_load_dwordx4 v10, s[8:11], s54 offen lds
  s_add_u32 m0, s83, 23552
  s_add_u32 s54, s57, 565248
  buffer_load_dwordx4 v10, s[8:11], s54 offen lds
  s_waitcnt vmcnt(16)
  ds_read_b64_tr_b16 a[0:1], v13 offset:0
  ds_read_b64_tr_b16 a[2:3], v13 offset:1024
  ds_read_b64_tr_b16 a[4:5], v14 offset:0
  ds_read_b64_tr_b16 a[6:7], v14 offset:1024
  ds_read_b64_tr_b16 a[8:9], v13 offset:2048
  ds_read_b64_tr_b16 a[10:11], v13 offset:3072
  ds_read_b64_tr_b16 a[12:13], v14 offset:2048
  ds_read_b64_tr_b16 a[14:15], v14 offset:3072
  ds_read_b64_tr_b16 a[16:17], v13 offset:4096
  ds_read_b64_tr_b16 a[18:19], v13 offset:5120
  ds_read_b64_tr_b16 a[20:21], v14 offset:4096
  ds_read_b64_tr_b16 a[22:23], v14 offset:5120
  ds_read_b64_tr_b16 a[24:25], v13 offset:6144
  ds_read_b64_tr_b16 a[26:27], v13 offset:7168
  ds_read_b64_tr_b16 a[28:29], v14 offset:6144
  ds_read_b64_tr_b16 a[30:31], v14 offset:7168
  s_waitcnt lgkmcnt(0)
  s_add_u32 m0, s83, 0
  s_add_u32 s54, s57, 589824
  buffer_load_dwordx4 v10, s[8:11], s54 offen lds
  s_add_u32 m0, s83, 1024
  s_add_u32 s54, s57, 614400
  buffer_load_dwordx4 v10, s[8:11], s54 offen lds
  s_add_u32 m0, s83, 2048
  s_add_u32 s54, s57, 638976
  buffer_load_dwordx4 v10, s[8:11], s54 offen lds
  s_add_u32 m0, s83, 3072
  s_add_u32 s54, s57, 663552
  buffer_load_dwordx4 v10, s[8:11], s54 offen lds
  s_add_u32 m0, s83, 4096
  s_add_u32 s54, s57, 688128
  buffer_load_dwordx4 v10, s[8:11], s54 offen lds
  s_add_u32 m0, s83, 5120
  s_add_u32 s54, s57, 712704
  buffer_load_dwordx4 v10, s[8:11], s54 offen lds
  s_add_u32 m0, s83, 6144
  s_add_u32 s54, s57, 737280
  buffer_load_dwordx4 v10, s[8:11], s54 offen lds
  s_add_u32 m0, s83, 7168
  s_add_u32 s54, s57, 761856
  buffer_load_dwordx4 v10, s[8:11], s54 offen lds
  s_cmp_lt_u32 s20, 2
  s_cbranch_scc0 Lws_34
  v_mfma_f32_32x32x16_bf16 v[48:63], a[0:3], v[100:103], 0
  v_mfma_f32_32x32x16_bf16 v[64:79], a[4:7], v[100:103], 0
  v_mfma_f32_32x32x16_bf16 v[48:63], a[8:11], v[100:103], v[48:63]
  v_mfma_f32_32x32x16_bf16 v[64:79], a[12:15], v[100:103], v[64:79]
  v_mfma_f32_32x32x16_bf16 v[48:63], a[16:19], v[100:103], v[48:63]
  v_mfma_f32_32x32x16_bf16 v[64:79], a[20:23], v[100:103], v[64:79]
  v_mfma_f32_32x32x16_bf16 v[48:63], a[24:27], v[100:103], v[48:63]
  v_mfma_f32_32x32x16_bf16 v[64:79], a[28:31], v[100:103], v[64:79]
  s_nop 10
  s_branch Lws_35
Lws_34:
  v_mfma_f32_32x32x16_bf16 v[48:63], v[100:103], a[0:3], 0
  v_mfma_f32_32x32x16_bf16 v[64:79], v[100:103], a[4:7], 0
  v_mfma_f32_32x32x16_bf16 v[48:63], v[100:103], a[8:11], v[48:63]
  v_mfma_f32_32x32x16_bf16 v[64:79], v[100:103], a[12:15], v[64:79]
  v_mfma_f32_32x32x16_bf16 v[48:63], v[100:103], a[16:19], v[48:63]
  v_mfma_f32_32x32x16_bf16 v[64:79], v[100:103], a[20:23], v[64:79]
  v_mfma_f32_32x32x16_bf16 v[48:63], v[100:103], a[24:27], v[48:63]
  v_mfma_f32_32x32x16_bf16 v[64:79], v[100:103], a[28:31], v[64:79]
  s_nop 11
Lws_35:
  s_waitcnt vmcnt(16)
  ds_read_b64_tr_b16 a[32:33], v13 offset:8192
  ds_read_b64_tr_b16 a[34:35], v13 offset:9216
  ds_read_b64_tr_b16 a[36:37], v14 offset:8192
  ds_read_b64_tr_b16 a[38:39], v14 offset:9216
  ds_read_b64_tr_b16 a[40:41], v13 offset:10240
  ds_read_b64_tr_b16 a[42:43], v13 offset:11264
  ds_read_b64_tr_b16 a[44:45], v14 offset:10240
  ds_read_b64_tr_b16 a[46:47], v14 offset:11264
  ds_read_b64_tr_b16 a[48:49], v13 offset:12288
  ds_read_b64_tr_b16 a[50:51], v13 offset:13312
  ds_read_b64_tr_b16 a[52:53], v14 offset:12288
  ds_read_b64_tr_b16 a[54:55], v14 offset:13312
  ds_read_b64_tr_b16 a[56:57], v13 offset:14336
  ds_read_b64_tr_b16 a[58:59], v13 offset:15360
  ds_read_b64_tr_b16 a[60:61], v14 offset:14336
  ds_read_b64_tr_b16 a[62:63], v14 offset:15360
  s_waitcnt lgkmcnt(0)
  s_add_u32 m0, s83, 8192
  s_add_u32 s54, s57, 786432
  buffer_load_dwordx4 v10, s[8:11], s54 offen lds
  s_add_u32 m0, s83, 9216
  s_add_u32 s54, s57, 811008
  buffer_load_dwordx4 v10, s[8:11], s54 offen lds
  s_add_u32 m0, s83, 10240
  s_add_u32 s54, s57, 835584
  buffer_load_dwordx4 v10, s[8:11], s54 offen lds
  s_add_u32 m0, s83, 11264
  s_add_u32 s54, s57, 860160
  buffer_load_dwordx4 v10, s[8:11], s54 offen lds
  s_add_u32 m0, s83, 12288
  s_add_u32 s54, s57, 884736
  buffer_load_dwordx4 v10, s[8:11], s54 offen lds
  s_add_u32 m0, s83, 13312
  s_add_u32 s54, s57, 909312
  buffer_load_dwordx4 v10, s[8:11], s54 offen lds
  s_add_u32 m0, s83, 14336
  s_add_u32 s54, s57, 933888
  buffer_load_dwordx4 v10, s[8:11], s54 offen lds
  s_add_u32 m0, s83, 15360
  s_add_u32 s54, s57, 958464
  buffer_load_dwordx4 v10, s[8:11], s54 offen lds
  s_cmp_lt_u32 s20, 2
  s_cbranch_scc0 Lws_36
  v_mfma_f32_32x32x16_bf16 v[48:63], a[32:35], v[100:103], v[48:63]
  v_mfma_f32_32x32x16_bf16 v[64:79], a[36:39], v[100:103], v[64:79]
  v_mfma_f32_32x32x16_bf16 v[48:63], a[40:43], v[100:103], v[48:63]
  v_mfma_f32_32x32x16_bf16 v[64:79], a[44:47], v[100:103], v[64:79]
  v_mfma_f32_32x32x16_bf16 v[48:63], a[48:51], v[100:103], v[48:63]
  v_mfma_f32_32x32x16_bf16 v[64:79], a[52:55], v[100:103], v[64:79]
  v_mfma_f32_32x32x16_bf16 v[48:63], a[56:59], v[100:103], v[48:63]
  v_mfma_f32_32x32x16_bf16 v[64:79], a[60:63], v[100:103], v[64:79]
  s_nop 10
  s_branch Lws_37
Lws_36:
  v_mfma_f32_32x32x16_bf16 v[48:63], v[100:103], a[32:35], v[48:63]
  v_mfma_f32_32x32x16_bf16 v[64:79], v[100:103], a[36:39], v[64:79]
  v_mfma_f32_32x32x16_bf16 v[48:63], v[100:103], a[40:43], v[48:63]
  v_mfma_f32_32x32x16_bf16 v[64:79], v[100:103], a[44:47], v[64:79]
  v_mfma_f32_32x32x16_bf16 v[48:63], v[100:103], a[48:51], v[48:63]
  v_mfma_f32_32x32x16_bf16 v[64:79], v[100:103], a[52:55], v[64:79]
  v_mfma_f32_32x32x16_bf16 v[48:63], v[100:103], a[56:59], v[48:63]
  v_mfma_f32_32x32x16_bf16 v[64:79], v[100:103], a[60:63], v[64:79]
  s_nop 11
Lws_37:
  s_waitcnt vmcnt(16)
  ds_read_b64_tr_b16 a[64:65], v13 offset:16384
  ds_read_b64_tr_b16 a[66:67], v13 offset:17408
  ds_read_b64_tr_b16 a[68:69], v14 offset:16384
  ds_read_b64_tr_b16 a[70:71], v14 offset:17408
  ds_read_b64_tr_b16 a[72:73], v13 offset:18432
  ds_read_b64_tr_b16 a[74:75], v13 offset:19456
  ds_read_b64_tr_b16 a[76:77], v14 offset:18432
  ds_read_b64_tr_b16 a[78:79], v14 offset:19456
  ds_read_b64_tr_b16 a[80:81], v13 offset:20480
  ds_read_b64_tr_b16 a[82:83], v13 offset:21504
  ds_read_b64_tr_b16 a[84:85], v14 offset:20480
  ds_read_b64_tr_b16 a[86:87], v14 offset:21504
  ds_read_b64_tr_b16 a[88:89], v13 offset:22528
  ds_read_b64_tr_b16 a[90:91], v13 offset:23552
  ds_read_b64_tr_b16 a[92:93], v14 offset:22528
  ds_read_b64_tr_b16 a[94:95], v14 offset:23552
  s_waitcnt lgkmcnt(0)
  s_add_u32 m0, s83, 16384
  s_add_u32 s54, s57, 983040
  buffer_load_dwordx4 v10, s[8:11], s54 offen lds
  s_add_u32 m0, s83, 17408
  s_add_u32 s54, s57, 1007616
  buffer_load_dwordx4 v10, s[8:11], s54 offen lds
  s_add_u32 m0, s83, 18432
  s_add_u32 s54, s57, 1032192
  buffer_load_dwordx4 v10, s[8:11], s54 offen lds
  s_add_u32 m0, s83, 19456
  s_add_u32 s54, s57, 1056768
  buffer_load_dwordx4 v10, s[8:11], s54 offen lds
  s_add_u32 m0, s83, 20480
  s_add_u32 s54, s57, 1081344
  buffer_load_dwordx4 v10, s[8:11], s54 offen lds
  s_add_u32 m0, s83, 21504
  s_add_u32 s54, s57, 1105920
  buffer_load_dwordx4 v10, s[8:11], s54 offen lds
  s_add_u32 m0, s83, 22528
  s_add_u32 s54, s57, 1130496
  buffer_load_dwordx4 v10, s[8:11], s54 offen lds
  s_add_u32 m0, s83, 23552
  s_add_u32 s54, s57, 1155072
  buffer_load_dwordx4 v10, s[8:11], s54 offen lds
  s_cmp_lt_u32 s20, 2
  s_cbranch_scc0 Lws_38
  v_mfma_f32_32x32x16_bf16 v[48:63], a[64:67], v[100:103], v[48:63]
  v_mfma_f32_32x32x16_bf16 v[64:79], a[68:71], v[100:103], v[64:79]
  v_mfma_f32_32x32x16_bf16 v[48:63], a[72:75], v[100:103], v[48:63]
  v_mfma_f32_32x32x16_bf16 v[64:79], a[76:79], v[100:103], v[64:79]
  v_mfma_f32_32x32x16_bf16 v[48:63], a[80:83], v[100:103], v[48:63]
  v_mfma_f32_32x32x16_bf16 v[64:79], a[84:87], v[100:103], v[64:79]
  v_mfma_f32_32x32x16_bf16 v[48:63], a[88:91], v[100:103], v[48:63]
  v_mfma_f32_32x32x16_bf16 v[64:79], a[92:95], v[100:103], v[64:79]
  s_nop 10
  s_branch Lws_39
Lws_38:
  v_mfma_f32_32x32x16_bf16 v[48:63], v[100:103], a[64:67], v[48:63]
  v_mfma_f32_32x32x16_bf16 v[64:79], v[100:103], a[68:71], v[64:79]
  v_mfma_f32_32x32x16_bf16 v[48:63], v[100:103], a[72:75], v[48:63]
  v_mfma_f32_32x32x16_bf16 v[64:79], v[100:103], a[76:79], v[64:79]
  v_mfma_f32_32x32x16_bf16 v[48:63], v[100:103], a[80:83], v[48:63]
  v_mfma_f32_32x32x16_bf16 v[64:79], v[100:103], a[84:87], v[64:79]
  v_mfma_f32_32x32x16_bf16 v[48:63], v[100:103], a[88:91], v[48:63]
  v_mfma_f32_32x32x16_bf16 v[64:79], v[100:103], a[92:95], v[64:79]
  s_nop 11
Lws_39:
  s_waitcnt vmcnt(16)
  ds_read_b64_tr_b16 a[96:97], v13 offset:0
  ds_read_b64_tr_b16 a[98:99], v13 offset:1024
  ds_read_b64_tr_b16 a[100:101], v14 offset:0
  ds_read_b64_tr_b16 a[102:103], v14 offset:1024
  ds_read_b64_tr_b16 a[104:105], v13 offset:2048
  ds_read_b64_tr_b16 a[106:107], v13 offset:3072
  ds_read_b64_tr_b16 a[108:109], v14 offset:2048
  ds_read_b64_tr_b16 a[110:111], v14 offset:3072
  ds_read_b64_tr_b16 a[112:113], v13 offset:4096
  ds_read_b64_tr_b16 a[114:115], v13 offset:5120
  ds_read_b64_tr_b16 a[116:117], v14 offset:4096
  ds_read_b64_tr_b16 a[118:119], v14 offset:5120
  ds_read_b64_tr_b16 a[120:121], v13 offset:6144
  ds_read_b64_tr_b16 a[122:123], v13 offset:7168
  ds_read_b64_tr_b16 a[124:125], v14 offset:6144
  ds_read_b64_tr_b16 a[126:127], v14 offset:7168
  s_waitcnt lgkmcnt(0)
  s_add_u32 m0, s83, 0
  s_add_u32 s54, s57, 1179648
  buffer_load_dwordx4 v10, s[8:11], s54 offen lds
  s_add_u32 m0, s83, 1024
  s_add_u32 s54, s57, 1204224
  buffer_load_dwordx4 v10, s[8:11], s54 offen lds
  s_add_u32 m0, s83, 2048
  s_add_u32 s54, s57, 1228800
  buffer_load_dwordx4 v10, s[8:11], s54 offen lds
  s_add_u32 m0, s83, 3072
  s_add_u32 s54, s57, 1253376
  buffer_load_dwordx4 v10, s[8:11], s54 offen lds
  s_add_u32 m0, s83, 4096
  s_add_u32 s54, s57, 1277952
  buffer_load_dwordx4 v10, s[8:11], s54 offen lds
  s_add_u32 m0, s83, 5120
  s_add_u32 s54, s57, 1302528
  buffer_load_dwordx4 v10, s[8:11], s54 offen lds
  s_add_u32 m0, s83, 6144
  s_add_u32 s54, s57, 1327104
  buffer_load_dwordx4 v10, s[8:11], s54 offen lds
  s_add_u32 m0, s83, 7168
  s_add_u32 s54, s57, 1351680
  buffer_load_dwordx4 v10, s[8:11], s54 offen lds
  s_cmp_lt_u32 s20, 2
  s_cbranch_scc0 Lws_40
  v_mfma_f32_32x32x16_bf16 v[48:63], a[96:99], v[100:103], v[48:63]
  v_mfma_f32_32x32x16_bf16 v[64:79], a[100:103], v[100:103], v[64:79]
  v_mfma_f32_32x32x16_bf16 v[48:63], a[104:107], v[100:103], v[48:63]
  v_mfma_f32_32x32x16_bf16 v[64:79], a[108:111], v[100:103], v[64:79]
  v_mfma_f32_32x32x16_bf16 v[48:63], a[112:115], v[100:103], v[48:63]
  v_mfma_f32_32x32x16_bf16 v[64:79], a[116:119], v[100:103], v[64:79]
  v_mfma_f32_32x32x16_bf16 v[48:63], a[120:123], v[100:103], v[48:63]
  v_mfma_f32_32x32x16_bf16 v[64:79], a[124:127], v[100:103], v[64:79]
  s_nop 10
  s_branch Lws_41
Lws_40:
  v_mfma_f32_32x32x16_bf16 v[48:63], v[100:103], a[96:99], v[48:63]
  v_mfma_f32_32x32x16_bf16 v[64:79], v[100:103], a[100:103], v[64:79]
  v_mfma_f32_32x32x16_bf16 v[48:63], v[100:103], a[104:107], v[48:63]
  v_mfma_f32_32x32x16_bf16 v[64:79], v[100:103], a[108:111], v[64:79]
  v_mfma_f32_32x32x16_bf16 v[48:63], v[100:103], a[112:115], v[48:63]
  v_mfma_f32_32x32x16_bf16 v[64:79], v[100:103], a[116:119], v[64:79]
  v_mfma_f32_32x32x16_bf16 v[48:63], v[100:103], a[120:123], v[48:63]
  v_mfma_f32_32x32x16_bf16 v[64:79], v[100:103], a[124:127], v[64:79]
  s_nop 11
Lws_41:
  s_waitcnt vmcnt(16)
  ds_read_b64_tr_b16 a[128:129], v13 offset:8192
  ds_read_b64_tr_b16 a[130:131], v13 offset:9216
  ds_read_b64_tr_b16 a[132:133], v14 offset:8192
  ds_read_b64_tr_b16 a[134:135], v14 offset:9216
  ds_read_b64_tr_b16 a[136:137], v13 offset:10240
  ds_read_b64_tr_b16 a[138:139], v13 offset:11264
  ds_read_b64_tr_b16 a[140:141], v14 offset:10240
  ds_read_b64_tr_b16 a[142:143], v14 offset:11264
  ds_read_b64_tr_b16 a[144:145], v13 offset:12288
  ds_read_b64_tr_b16 a[146:147], v13 offset:13312
  ds_read_b64_tr_b16 a[148:149], v14 offset:12288
  ds_read_b64_tr_b16 a[150:151], v14 offset:13312
  ds_read_b64_tr_b16 a[152:153], v13 offset:14336
  ds_read_b64_tr_b16 a[154:155], v13 offset:15360
  ds_read_b64_tr_b16 a[156:157], v14 offset:14336
  ds_read_b64_tr_b16 a[158:159], v14 offset:15360
  s_waitcnt lgkmcnt(0)
  s_add_u32 m0, s83, 8192
  s_add_u32 s54, s57, 1376256
  buffer_load_dwordx4 v10, s[8:11], s54 offen lds
  s_add_u32 m0, s83, 9216
  s_add_u32 s54, s57, 1400832
  buffer_load_dwordx4 v10, s[8:11], s54 offen lds
  s_add_u32 m0, s83, 10240
  s_add_u32 s54, s57, 1425408
  buffer_load_dwordx4 v10, s[8:11], s54 offen lds
  s_add_u32 m0, s83, 11264
  s_add_u32 s54, s57, 1449984
  buffer_load_dwordx4 v10, s[8:11], s54 offen lds
  s_add_u32 m0, s83, 12288
  s_add_u32 s54, s57, 1474560
  buffer_load_dwordx4 v10, s[8:11], s54 offen lds
  s_add_u32 m0, s83, 13312
  s_add_u32 s54, s57, 1499136
  buffer_load_dwordx4 v10, s[8:11], s54 offen lds
  s_add_u32 m0, s83, 14336
  s_add_u32 s54, s57, 1523712
  buffer_load_dwordx4 v10, s[8:11], s54 offen lds
  s_add_u32 m0, s83, 15360
  s_add_u32 s54, s57, 1548288
  buffer_load_dwordx4 v10, s[8:11], s54 offen lds
  s_cmp_lt_u32 s20, 2
  s_cbranch_scc0 Lws_42
  v_mfma_f32_32x32x16_bf16 v[48:63], a[128:131], v[100:103], v[48:63]
  v_mfma_f32_32x32x16_bf16 v[64:79], a[132:135], v[100:103], v[64:79]
  v_mfma_f32_32x32x16_bf16 v[48:63], a[136:139], v[100:103], v[48:63]
  v_mfma_f32_32x32x16_bf16 v[64:79], a[140:143], v[100:103], v[64:79]
  v_mfma_f32_32x32x16_bf16 v[48:63], a[144:147], v[100:103], v[48:63]
  v_mfma_f32_32x32x16_bf16 v[64:79], a[148:151], v[100:103], v[64:79]
  v_mfma_f32_32x32x16_bf16 v[48:63], a[152:155], v[100:103], v[48:63]
  v_mfma_f32_32x32x16_bf16 v[64:79], a[156:159], v[100:103], v[64:79]
  s_nop 10
  s_branch Lws_43
Lws_42:
  v_mfma_f32_32x32x16_bf16 v[48:63], v[100:103], a[128:131], v[48:63]
  v_mfma_f32_32x32x16_bf16 v[64:79], v[100:103], a[132:135], v[64:79]
  v_mfma_f32_32x32x16_bf16 v[48:63], v[100:103], a[136:139], v[48:63]
  v_mfma_f32_32x32x16_bf16 v[64:79], v[100:103], a[140:143], v[64:79]
  v_mfma_f32_32x32x16_bf16 v[48:63], v[100:103], a[144:147], v[48:63]
  v_mfma_f32_32x32x16_bf16 v[64:79], v[100:103], a[148:151], v[64:79]
  v_mfma_f32_32x32x16_bf16 v[48:63], v[100:103], a[152:155], v[48:63]
  v_mfma_f32_32x32x16_bf16 v[64:79], v[100:103], a[156:159], v[64:79]
  s_nop 11
Lws_43:
  s_waitcnt vmcnt(16)
  ds_read_b64_tr_b16 a[160:161], v13 offset:16384
  ds_read_b64_tr_b16 a[162:163], v13 offset:17408
  ds_read_b64_tr_b16 a[164:165], v14 offset:16384
  ds_read_b64_tr_b16 a[166:167], v14 offset:17408
  ds_read_b64_tr_b16 a[168:169], v13 offset:18432
  ds_read_b64_tr_b16 a[170:171], v13 offset:19456
  ds_read_b64_tr_b16 a[172:173], v14 offset:18432
  ds_read_b64_tr_b16 a[174:175], v14 offset:19456
  ds_read_b64_tr_b16 a[176:177], v13 offset:20480
  ds_read_b64_tr_b16 a[178:179], v13 offset:21504
  ds_read_b64_tr_b16 a[180:181], v14 offset:20480
  ds_read_b64_tr_b16 a[182:183], v14 offset:21504
  ds_read_b64_tr_b16 a[184:185], v13 offset:22528
  ds_read_b64_tr_b16 a[186:187], v13 offset:23552
  ds_read_b64_tr_b16 a[188:189], v14 offset:22528
  ds_read_b64_tr_b16 a[190:191], v14 offset:23552
  s_waitcnt lgkmcnt(0)
  s_mov_b32 s12, s92
  s_and_b32 s13, s93, 0xffff
  s_mov_b32 s14, 256
  s_mov_b32 s15, 0x20000
  s_mov_b32 s26, 0
Lwi_44:
  buffer_load_dword v18, off, s[12:15], 0 offset:12 sc1
  s_waitcnt vmcnt(0)
  v_readfirstlane_b32 s29, v18
  s_nop 0
  s_cmp_ge_u32 s29, 4
  s_nop 1
  s_cbranch_scc1 Lwi_45
  s_sleep 2
  s_add_u32 s26, s26, 1
  s_cmp_lt_u32 s26, 0x40000
  s_cbranch_scc1 Lwi_44
  s_branch L_end
Lwi_45:
  s_cmp_lt_u32 s20, 2
  s_cbranch_scc0 Lws_46
  v_mfma_f32_32x32x16_bf16 v[48:63], a[160:163], v[100:103], v[48:63]
  v_mfma_f32_32x32x16_bf16 v[64:79], a[164:167], v[100:103], v[64:79]
  v_mfma_f32_32x32x16_bf16 v[48:63], a[168:171], v[100:103], v[48:63]
  v_mfma_f32_32x32x16_bf16 v[64:79], a[172:175], v[100:103], v[64:79]
  v_mfma_f32_32x32x16_bf16 v[48:63], a[176:179], v[100:103], v[48:63]
  v_mfma_f32_32x32x16_bf16 v[64:79], a[180:183], v[100:103], v[64:79]
  v_mfma_f32_32x32x16_bf16 v[48:63], a[184:187], v[100:103], v[48:63]
  v_mfma_f32_32x32x16_bf16 v[64:79], a[188:191], v[100:103], v[64:79]
  s_nop 10
  s_branch Lws_47
Lws_46:
  v_mfma_f32_32x32x16_bf16 v[48:63], v[100:103], a[160:163], v[48:63]
  v_mfma_f32_32x32x16_bf16 v[64:79], v[100:103], a[164:167], v[64:79]
  v_mfma_f32_32x32x16_bf16 v[48:63], v[100:103], a[168:171], v[48:63]
  v_mfma_f32_32x32x16_bf16 v[64:79], v[100:103], a[172:175], v[64:79]
  v_mfma_f32_32x32x16_bf16 v[48:63], v[100:103], a[176:179], v[48:63]
  v_mfma_f32_32x32x16_bf16 v[64:79], v[100:103], a[180:183], v[64:79]
  v_mfma_f32_32x32x16_bf16 v[48:63], v[100:103], a[184:187], v[48:63]
  v_mfma_f32_32x32x16_bf16 v[64:79], v[100:103], a[188:191], v[64:79]
  s_nop 11
Lws_47:
  ds_read_b64_tr_b16 a[192:193], v13 offset:0
  ds_read_b64_tr_b16 a[194:195], v13 offset:1024
  ds_read_b64_tr_b16 a[196:197], v14 offset:0
  ds_read_b64_tr_b16 a[198:199], v14 offset:1024
  ds_read_b64_tr_b16 a[200:201], v13 offset:2048
  ds_read_b64_tr_b16 a[202:203], v13 offset:3072
  ds_read_b64_tr_b16 a[204:205], v14 offset:2048
  ds_read_b64_tr_b16 a[206:207], v14 offset:3072
  ds_read_b64_tr_b16 a[208:209], v13 offset:4096
  ds_read_b64_tr_b16 a[210:211], v13 offset:5120
  ds_read_b64_tr_b16 a[212:213], v14 offset:4096
  ds_read_b64_tr_b16 a[214:215], v14 offset:5120
  ds_read_b64_tr_b16 a[216:217], v13 offset:6144
  ds_read_b64_tr_b16 a[218:219], v13 offset:7168
  ds_read_b64_tr_b16 a[220:221], v14 offset:6144
  ds_read_b64_tr_b16 a[222:223], v14 offset:7168
  s_waitcnt lgkmcnt(0)
  s_cmp_lt_u32 s20, 2
  s_cbranch_scc0 Lws_48
  v_mfma_f32_32x32x16_bf16 v[48:63], a[192:195], v[100:103], v[48:63]
  v_mfma_f32_32x32x16_bf16 v[64:79], a[196:199], v[100:103], v[64:79]
  v_mfma_f32_32x32x16_bf16 v[48:63], a[200:203], v[100:103], v[48:63]
  v_mfma_f32_32x32x16_bf16 v[64:79], a[204:207], v[100:103], v[64:79]
  v_mfma_f32_32x32x16_bf16 v[48:63], a[208:211], v[100:103], v[48:63]
  v_mfma_f32_32x32x16_bf16 v[64:79], a[212:215], v[100:103], v[64:79]
  v_mfma_f32_32x32x16_bf16 v[48:63], a[216:219], v[100:103], v[48:63]
  v_mfma_f32_32x32x16_bf16 v[64:79], a[220:223], v[100:103], v[64:79]
  s_nop 10
  s_branch Lws_49
Lws_48:
  v_mfma_f32_32x32x16_bf16 v[48:63], v[100:103], a[192:195], v[48:63]
  v_mfma_f32_32x32x16_bf16 v[64:79], v[100:103], a[196:199], v[64:79]
  v_mfma_f32_32x32x16_bf16 v[48:63], v[100:103], a[200:203], v[48:63]
  v_mfma_f32_32x32x16_bf16 v[64:79], v[100:103], a[204:207], v[64:79]
  v_mfma_f32_32x32x16_bf16 v[48:63], v[100:103], a[208:211], v[48:63]
  v_mfma_f32_32x32x16_bf16 v[64:79], v[100:103], a[212:215], v[64:79]
  v_mfma_f32_32x32x16_bf16 v[48:63], v[100:103], a[216:219], v[48:63]
  v_mfma_f32_32x32x16_bf16 v[64:79], v[100:103], a[220:223], v[64:79]
  s_nop 11
Lws_49:
  ds_read_b64_tr_b16 a[224:225], v13 offset:8192
  ds_read_b64_tr_b16 a[226:227], v13 offset:9216
  ds_read_b64_tr_b16 a[228:229], v14 offset:8192
  ds_read_b64_tr_b16 a[230:231], v14 offset:9216
  ds_read_b64_tr_b16 a[232:233], v13 offset:10240
  ds_read_b64_tr_b16 a[234:235], v13 offset:11264
  ds_read_b64_tr_b16 a[236:237], v14 offset:10240
  ds_read_b64_tr_b16 a[238:239], v14 offset:11264
  ds_read_b64_tr_b16 a[240:241], v13 offset:12288
  ds_read_b64_tr_b16 a[242:243], v13 offset:13312
  ds_read_b64_tr_b16 a[244:245], v14 offset:12288
  ds_read_b64_tr_b16 a[246:247], v14 offset:13312
  ds_read_b64_tr_b16 a[248:249], v13 offset:14336
  ds_read_b64_tr_b16 a[250:251], v13 offset:15360
  ds_read_b64_tr_b16 a[252:253], v14 offset:14336
  ds_read_b64_tr_b16 a[254:255], v14 offset:15360
  s_waitcnt lgkmcnt(0)
  s_cmp_lt_u32 s20, 2
  s_cbranch_scc0 Lws_50
  v_mfma_f32_32x32x16_bf16 v[48:63], a[224:227], v[100:103], v[48:63]
  v_mfma_f32_32x32x16_bf16 v[64:79], a[228:231], v[100:103], v[64:79]
  v_mfma_f32_32x32x16_bf16 v[48:63], a[232:235], v[100:103], v[48:63]
  v_mfma_f32_32x32x16_bf16 v[64:79], a[236:239], v[100:103], v[64:79]
  v_mfma_f32_32x32x16_bf16 v[48:63], a[240:243], v[100:103], v[48:63]
  v_mfma_f32_32x32x16_bf16 v[64:79], a[244:247], v[100:103], v[64:79]
  v_mfma_f32_32x32x16_bf16 v[48:63], a[248:251], v[100:103], v[48:63]
  v_mfma_f32_32x32x16_bf16 v[64:79], a[252:255], v[100:103], v[64:79]
  s_nop 10
  s_branch Lws_51
Lws_50:
  v_mfma_f32_32x32x16_bf16 v[48:63], v[100:103], a[224:227], v[48:63]
  v_mfma_f32_32x32x16_bf16 v[64:79], v[100:103], a[228:231], v[64:79]
  v_mfma_f32_32x32x16_bf16 v[48:63], v[100:103], a[232:235], v[48:63]
  v_mfma_f32_32x32x16_bf16 v[64:79], v[100:103], a[236:239], v[64:79]
  v_mfma_f32_32x32x16_bf16 v[48:63], v[100:103], a[240:243], v[48:63]
  v_mfma_f32_32x32x16_bf16 v[64:79], v[100:103], a[244:247], v[64:79]
  v_mfma_f32_32x32x16_bf16 v[48:63], v[100:103], a[248:251], v[48:63]
  v_mfma_f32_32x32x16_bf16 v[64:79], v[100:103], a[252:255], v[64:79]
  s_nop 11
Lws_51:
  s_barrier
  s_mov_b32 s47, s46
  s_mov_b32 s49, 4
  s_lshl_b32 s50, s46, 2
  s_add_u32 s50, s50, s20
  s_add_u32 s50, s50, 6
  s_mov_b32 s48, 64
  s_cmp_ge_u32 s20, 2
  s_cbranch_scc1 La1_52
  s_lshl_b32 s29, s20, 14
  s_lshl_b32 s30, s21, 12
  s_add_u32 s29, s29, s30
  v_add_u32 v98, s29, v1
  s_mov_b32 s69, 0
  s_mov_b32 s51, 0
  s_mov_b32 s61, 0
  s_branch Lsl_58
Lsl_54:
  s_add_u32 s66, s47, s49
  s_sub_u32 s53, s48, 1
  s_min_u32 s53, s53, s66
  s_lshl_b32 s67, s53, 7
  s_add_u32 s67, s67, 28672
  s_mov_b32 s52, 32
  buffer_load_dword v11, off, s[4:7], s67 sc1
  s_waitcnt vmcnt(0)
  v_readfirstlane_b32 s58, v11
  s_barrier
  s_cmp_eq_u32 s61, 0
  s_nop 1
  s_cbranch_scc1 Lsl_59
  v_mov_b32 v10, 1
  s_mov_b64 exec, 1
  buffer_atomic_add v10, off, s[4:7], s61 sc1
  s_mov_b64 exec, -1
Lsl_59:
  s_xor_b32 s53, s51, 33280
  s_cmp_ge_u32 s58, s52
  s_cselect_b32 s58, 1, 0
  s_cmp_lt_u32 s66, s48
  s_cselect_b32 s58, s58, 0
  s_cmp_eq_u32 s58, 0
  s_cbranch_scc1 Lsl_57
  s_mov_b32 s67, s53
  s_lshl_b32 s57, s66, 15
  s_add_u32 s57, s57, 22020096
  s_mul_i32 s53, s21, 8192
  s_add_u32 s53, s53, s67
  s_add_u32 m0, s53, 0
  s_add_u32 s54, s57, 0
  buffer_load_dwordx4 v6, s[4:7], s54 offen sc1 lds
  s_add_u32 m0, s53, 1024
  s_add_u32 s54, s57, 1024
  buffer_load_dwordx4 v6, s[4:7], s54 offen sc1 lds
  s_add_u32 m0, s53, 2048
  s_add_u32 s54, s57, 2048
  buffer_load_dwordx4 v6, s[4:7], s54 offen sc1 lds
  s_add_u32 m0, s53, 3072
  s_add_u32 s54, s57, 3072
  buffer_load_dwordx4 v6, s[4:7], s54 offen sc1 lds
  s_add_u32 m0, s53, 4096
  s_add_u32 s54, s57, 4096
  buffer_load_dwordx4 v6, s[4:7], s54 offen sc1 lds
  s_add_u32 m0, s53, 5120
  s_add_u32 s54, s57, 5120
  buffer_load_dwordx4 v6, s[4:7], s54 offen sc1 lds
  s_add_u32 m0, s53, 6144
  s_add_u32 s54, s57, 6144
  buffer_load_dwordx4 v6, s[4:7], s54 offen sc1 lds
  s_add_u32 m0, s53, 7168
  s_add_u32 s54, s57, 7168
  buffer_load_dwordx4 v6, s[4:7], s54 offen sc1 lds
Lsl_57:
  s_mul_i32 s53, s21, 8192
  s_add_u32 s53, s53, s51
  v_add_u32 v9, s53, v5
  v_mov_b32 v96, 0
  v_mov_b32 v97, 0
  ds_read_b128 v[104:107], v9 offset:0
  ds_read_b128 v[108:111], v9 offset:1024
  ds_read_b128 v[112:115], v9 offset:2048
  ds_read_b128 v[116:119], v9 offset:3072
  ds_read_b128 v[120:123], v9 offset:4096
  ds_read_b128 v[124:127], v9 offset:5120
  ds_read_b128 v[128:131], v9 offset:6144
  ds_read_b128 v[132:135], v9 offset:7168
  s_waitcnt lgkmcnt(7)
  v_dot2c_f32_bf16 v96, v104, v100
  v_dot2c_f32_bf16 v97, v104, v104
  v_dot2c_f32_bf16 v96, v105, v100
  v_dot2c_f32_bf16 v97, v105, v105
  v_dot2c_f32_bf16 v96, v106, v100
  v_dot2c_f32_bf16 v97, v106, v106
  v_dot2c_f32_bf16 v96, v107, v100
  v_dot2c_f32_bf16 v97, v107, v107
  s_waitcnt lgkmcnt(6)
  v_dot2c_f32_bf16 v96, v108, v100
  v_dot2c_f32_bf16 v97, v108, v108
  v_dot2c_f32_bf16 v96, v109, v100
  v_dot2c_f32_bf16 v97, v109, v109
  v_dot2c_f32_bf16 v96, v110, v100
  v_dot2c_f32_bf16 v97, v110, v110
  v_dot2c_f32_bf16 v96, v111, v100
  v_dot2c_f32_bf16 v97, v111, v111
  s_waitcnt lgkmcnt(5)
  v_dot2c_f32_bf16 v96, v112, v100
  v_dot2c_f32_bf16 v97, v112, v112
  v_dot2c_f32_bf16 v96, v113, v100
  v_dot2c_f32_bf16 v97, v113, v113
  v_dot2c_f32_bf16 v96, v114, v100
  v_dot2c_f32_bf16 v97, v114, v114
  v_dot2c_f32_bf16 v96, v115, v100
  v_dot2c_f32_bf16 v97, v115, v115
  s_waitcnt lgkmcnt(4)
  v_dot2c_f32_bf16 v96, v116, v100
  v_dot2c_f32_bf16 v97, v116, v116
  v_dot2c_f32_bf16 v96, v117, v100
  v_dot2c_f32_bf16 v97, v117, v117
  v_dot2c_f32_bf16 v96, v118, v100
  v_dot2c_f32_bf16 v97, v118, v118
  v_dot2c_f32_bf16 v96, v119, v100
  v_dot2c_f32_bf16 v97, v119, v119
  s_waitcnt lgkmcnt(3)
  v_dot2c_f32_bf16 v96, v120, v100
  v_dot2c_f32_bf16 v97, v120, v120
  v_dot2c_f32_bf16 v96, v121, v100
  v_dot2c_f32_bf16 v97, v121, v121
  v_dot2c_f32_bf16 v96, v122, v100
  v_dot2c_f32_bf16 v97, v122, v122
  v_dot2c_f32_bf16 v96, v123, v100
  v_dot2c_f32_bf16 v97, v123, v123
  s_waitcnt lgkmcnt(2)
  v_dot2c_f32_bf16 v96, v124, v100
  v_dot2c_f32_bf16 v97, v124, v124
  v_dot2c_f32_bf16 v96, v125, v100
  v_dot2c_f32_bf16 v97, v125, v125
  v_dot2c_f32_bf16 v96, v126, v100
  v_dot2c_f32_bf16 v97, v126, v126
  v_dot2c_f32_bf16 v96, v127, v100
  v_dot2c_f32_bf16 v97, v127, v127
  s_waitcnt lgkmcnt(1)
  v_dot2c_f32_bf16 v96, v128, v100
  v_dot2c_f32_bf16 v97, v128, v128
  v_dot2c_f32_bf16 v96, v129, v100
  v_dot2c_f32_bf16 v97, v129, v129
  v_dot2c_f32_bf16 v96, v130, v100
  v_dot2c_f32_bf16 v97, v130, v130
  v_dot2c_f32_bf16 v96, v131, v100
  v_dot2c_f32_bf16 v97, v131, v131
  s_waitcnt lgkmcnt(0)
  v_dot2c_f32_bf16 v96, v132, v100
  v_dot2c_f32_bf16 v97, v132, v132
  v_dot2c_f32_bf16 v96, v133, v100
  v_dot2c_f32_bf16 v97, v133, v133
  v_dot2c_f32_bf16 v96, v134, v100
  v_dot2c_f32_bf16 v97, v134, v134
  v_dot2c_f32_bf16 v96, v135, v100
  v_dot2c_f32_bf16 v97, v135, v135
  s_nop 2
  v_permlane32_swap_b32 v96, v97
  v_add_f32 v96, v96, v97
  v_lshlrev_b32 v10, 2, v0
  s_lshl_b32 s53, s21, 8
  s_add_u32 s53, s53, 68608
  v_add_u32 v10, s53, v10
  ds_write_b32 v10, v96
  v_add_u32 v9, s51, v5
  ds_read_b128 v[80:83], v9 offset:0
  ds_read_b128 v[84:87], v9 offset:1024
  ds_read_b128 v[88:91], v9 offset:2048
  s_waitcnt lgkmcnt(2)
  v_mfma_f32_32x32x16_bf16 v[16:31], a[0:3], v[80:83], 0
  ds_read_b128 v[92:95], v9 offset:3072
  v_mfma_f32_32x32x16_bf16 v[32:47], a[4:7], v[80:83], 0
  s_waitcnt lgkmcnt(2)
  v_mfma_f32_32x32x16_bf16 v[16:31], a[8:11], v[84:87], v[16:31]
  ds_read_b128 v[80:83], v9 offset:4096
  v_mfma_f32_32x32x16_bf16 v[32:47], a[12:15], v[84:87], v[32:47]
  s_waitcnt lgkmcnt(2)
  v_mfma_f32_32x32x16_bf16 v[16:31], a[16:19], v[88:91], v[16:31]
  ds_read_b128 v[84:87], v9 offset:5120
  v_mfma_f32_32x32x16_bf16 v[32:47], a[20:23], v[88:91], v[32:47]
  s_waitcnt lgkmcnt(2)
  v_mfma_f32_32x32x16_bf16 v[16:31], a[24:27], v[92:95], v[16:31]
  ds_read_b128 v[88:91], v9 offset:6144
  v_mfma_f32_32x32x16_bf16 v[32:47], a[28:31], v[92:95], v[32:47]
  s_waitcnt lgkmcnt(2)
  v_mfma_f32_32x32x16_bf16 v[16:31], a[32:35], v[80:83], v[16:31]
  ds_read_b128 v[92:95], v9 offset:7168
  v_mfma_f32_32x32x16_bf16 v[32:47], a[36:39], v[80:83], v[32:47]
  s_waitcnt lgkmcnt(2)
  v_mfma_f32_32x32x16_bf16 v[16:31], a[40:43], v[84:87], v[16:31]
  ds_read_b128 v[80:83], v9 offset:8192
  v_mfma_f32_32x32x16_bf16 v[32:47], a[44:47], v[84:87], v[32:47]
  s_waitcnt lgkmcnt(2)
  v_mfma_f32_32x32x16_bf16 v[16:31], a[48:51], v[88:91], v[16:31]
  ds_read_b128 v[84:87], v9 offset:9216
  v_mfma_f32_32x32x16_bf16 v[32:47], a[52:55], v[88:91], v[32:47]
  s_waitcnt lgkmcnt(2)
  v_mfma_f32_32x32x16_bf16 v[16:31], a[56:59], v[92:95], v[16:31]
  ds_read_b128 v[88:91], v9 offset:10240
  v_mfma_f32_32x32x16_bf16 v[32:47], a[60:63], v[92:95], v[32:47]
  s_waitcnt lgkmcnt(2)
  v_mfma_f32_32x32x16_bf16 v[16:31], a[64:67], v[80:83], v[16:31]
  ds_read_b128 v[92:95], v9 offset:11264
  v_mfma_f32_32x32x16_bf16 v[32:47], a[68:71], v[80:83], v[32:47]
  s_waitcnt lgkmcnt(2)
  v_mfma_f32_32x32x16_bf16 v[16:31], a[72:75], v[84:87], v[16:31]
  ds_read_b128 v[80:83], v9 offset:12288
  v_mfma_f32_32x32x16_bf16 v[32:47], a[76:79], v[84:87], v[32:47]
  s_waitcnt lgkmcnt(2)
  v_mfma_f32_32x32x16_bf16 v[16:31], a[80:83], v[88:91], v[16:31]
  ds_read_b128 v[84:87], v9 offset:13312
  v_mfma_f32_32x32x16_bf16 v[32:47], a[84:87], v[88:91], v[32:47]
  s_waitcnt lgkmcnt(2)
  v_mfma_f32_32x32x16_bf16 v[16:31], a[88:91], v[92:95], v[16:31]
  ds_read_b128 v[88:91], v9 offset:14336
  v_mfma_f32_32x32x16_bf16 v[32:47], a[92:95], v[92:95], v[32:47]
  s_waitcnt lgkmcnt(2)
  v_mfma_f32_32x32x16_bf16 v[16:31], a[96:99], v[80:83], v[16:31]
  ds_read_b128 v[92:95], v9 offset:15360
  v_mfma_f32_32x32x16_bf16 v[32:47], a[100:103], v[80:83], v[32:47]
  s_waitcnt lgkmcnt(2)
  v_mfma_f32_32x32x16_bf16 v[16:31], a[104:107], v[84:87], v[16:31]
  ds_read_b128 v[80:83], v9 offset:16384
  v_mfma_f32_32x32x16_bf16 v[32:47], a[108:111], v[84:87], v[32:47]
  s_waitcnt lgkmcnt(2)
  v_mfma_f32_32x32x16_bf16 v[16:31], a[112:115], v[88:91], v[16:31]
  ds_read_b128 v[84:87], v9 offset:17408
  v_mfma_f32_32x32x16_bf16 v[32:47], a[116:119], v[88:91], v[32:47]
  s_waitcnt lgkmcnt(2)
  v_mfma_f32_32x32x16_bf16 v[16:31], a[120:123], v[92:95], v[16:31]
  ds_read_b128 v[88:91], v9 offset:18432
  v_mfma_f32_32x32x16_bf16 v[32:47], a[124:127], v[92:95], v[32:47]
  s_waitcnt lgkmcnt(2)
  v_mfma_f32_32x32x16_bf16 v[16:31], a[128:131], v[80:83], v[16:31]
  ds_read_b128 v[92:95], v9 offset:19456
  v_mfma_f32_32x32x16_bf16 v[32:47], a[132:135], v[80:83], v[32:47]
  s_waitcnt lgkmcnt(2)
  v_mfma_f32_32x32x16_bf16 v[16:31], a[136:139], v[84:87], v[16:31]
  ds_read_b128 v[80:83], v9 offset:20480
  v_mfma_f32_32x32x16_bf16 v[32:47], a[140:143], v[84:87], v[32:47]
  s_waitcnt lgkmcnt(2)
  v_mfma_f32_32x32x16_bf16 v[16:31], a[144:147], v[88:91], v[16:31]
  ds_read_b128 v[84:87], v9 offset:21504
  v_mfma_f32_32x32x16_bf16 v[32:47], a[148:151], v[88:91], v[32:47]
  s_waitcnt lgkmcnt(2)
  v_mfma_f32_32x32x16_bf16 v[16:31], a[152:155], v[92:95], v[16:31]
  ds_read_b128 v[88:91], v9 offset:22528
  v_mfma_f32_32x32x16_bf16 v[32:47], a[156:159], v[92:95], v[32:47]
  s_waitcnt lgkmcnt(2)
  v_mfma_f32_32x32x16_bf16 v[16:31], a[160:163], v[80:83], v[16:31]
  ds_read_b128 v[92:95], v9 offset:23552
  v_mfma_f32_32x32x16_bf16 v[32:47], a[164:167], v[80:83], v[32:47]
  s_waitcnt lgkmcnt(2)
  v_mfma_f32_32x32x16_bf16 v[16:31], a[168:171], v[84:87], v[16:31]
  ds_read_b128 v[80:83], v9 offset:24576
  v_mfma_f32_32x32x16_bf16 v[32:47], a[172:175], v[84:87], v[32:47]
  s_waitcnt lgkmcnt(2)
  v_mfma_f32_32x32x16_bf16 v[16:31], a[176:179], v[88:91], v[16:31]
  ds_read_b128 v[84:87], v9 offset:25600
  v_mfma_f32_32x32x16_bf16 v[32:47], a[180:183], v[88:91], v[32:47]
  s_waitcnt lgkmcnt(2)
  v_mfma_f32_32x32x16_bf16 v[16:31], a[184:187], v[92:95], v[16:31]
  ds_read_b128 v[88:91], v9 offset:26624
  v_mfma_f32_32x32x16_bf16 v[32:47], a[188:191], v[92:95], v[32:47]
  s_waitcnt lgkmcnt(2)
  v_mfma_f32_32x32x16_bf16 v[16:31], a[192:195], v[80:83], v[16:31]
  ds_read_b128 v[92:95], v9 offset:27648
  v_mfma_f32_32x32x16_bf16 v[32:47], a[196:199], v[80:83], v[32:47]
  s_waitcnt lgkmcnt(2)
  v_mfma_f32_32x32x16_bf16 v[16:31], a[200:203], v[84:87], v[16:31]
  ds_read_b128 v[80:83], v9 offset:28672
  v_mfma_f32_32x32x16_bf16 v[32:47], a[204:207], v[84:87], v[32:47]
  s_waitcnt lgkmcnt(2)
  v_mfma_f32_32x32x16_bf16 v[16:31], a[208:211], v[88:91], v[16:31]
  ds_read_b128 v[84:87], v9 offset:29696
  v_mfma_f32_32x32x16_bf16 v[32:47], a[212:215], v[88:91], v[32:47]
  s_waitcnt lgkmcnt(2)
  v_mfma_f32_32x32x16_bf16 v[16:31], a[216:219], v[92:95], v[16:31]
  ds_read_b128 v[88:91], v9 offset:30720
  v_mfma_f32_32x32x16_bf16 v[32:47], a[220:223], v[92:95], v[32:47]
  s_waitcnt lgkmcnt(2)
  v_mfma_f32_32x32x16_bf16 v[16:31], a[224:227], v[80:83], v[16:31]
  ds_read_b128 v[92:95], v9 offset:31744
  v_mfma_f32_32x32x16_bf16 v[32:47], a[228:231], v[80:83], v[32:47]
  s_waitcnt lgkmcnt(2)
  v_mfma_f32_32x32x16_bf16 v[16:31], a[232:235], v[84:87], v[16:31]
  v_mfma_f32_32x32x16_bf16 v[32:47], a[236:239], v[84:87], v[32:47]
  s_waitcnt lgkmcnt(1)
  v_mfma_f32_32x32x16_bf16 v[16:31], a[240:243], v[88:91], v[16:31]
  v_mfma_f32_32x32x16_bf16 v[32:47], a[244:247], v[88:91], v[32:47]
  s_waitcnt lgkmcnt(0)
  v_mfma_f32_32x32x16_bf16 v[16:31], a[248:251], v[92:95], v[16:31]
  v_mfma_f32_32x32x16_bf16 v[32:47], a[252:255], v[92:95], v[32:47]
  s_barrier
  v_lshlrev_b32 v10, 2, v2
  v_add_u32 v10, 68608, v10
  ds_read2_b32 v[104:105], v10 offset0:0 offset1:32
  ds_read2_b32 v[106:107], v10 offset0:64 offset1:96
  ds_read2_b32 v[108:109], v10 offset0:128 offset1:160
  ds_read2_b32 v[110:111], v10 offset0:192 offset1:224
  s_waitcnt lgkmcnt(0)
  v_pk_add_f32 v[104:105], v[104:105], v[106:107]
  v_pk_add_f32 v[108:109], v[108:109], v[110:111]
  v_pk_add_f32 v[96:97], v[104:105], v[108:109]
  v_mul_f32 v96, s59, v96
  v_mul_f32 v97, s59, v97
  v_fma_f32 v97, -v96, v96, v97
  v_max_f32 v97, 0, v97
  v_cvt_pk_bf16_f32 v96, v96, v96
  v_and_b32 v96, 0xffff0000, v96
  v_cvt_pk_bf16_f32 v97, v97, v97
  v_and_b32 v97, 0xffff0000, v97
  v_add_f32 v97, s60, v97
  v_cvt_pk_bf16_f32 v97, v97, v97
  v_and_b32 v97, 0xffff0000, v97
  v_sqrt_f32 v97, v97
  s_nop 0
  v_cvt_pk_bf16_f32 v97, v97, v97
  v_and_b32 v97, 0xffff0000, v97
  v_rcp_f32 v97, v97
  s_nop 0
  v_mul_f32 v96, v96, v97
  v_pk_mul_f32 v[10:11], v[48:49], v[96:97] op_sel_hi:[1,0]
  v_pk_fma_f32 v[16:17], v[16:17], v[96:97], v[10:11] op_sel:[0,1,0] op_sel_hi:[1,1,1] neg_lo:[0,0,1] neg_hi:[0,0,1]
  v_pk_mul_f32 v[10:11], v[50:51], v[96:97] op_sel_hi:[1,0]
  v_pk_fma_f32 v[18:19], v[18:19], v[96:97], v[10:11] op_sel:[0,1,0] op_sel_hi:[1,1,1] neg_lo:[0,0,1] neg_hi:[0,0,1]
  v_pk_mul_f32 v[10:11], v[52:53], v[96:97] op_sel_hi:[1,0]
  v_pk_fma_f32 v[20:21], v[20:21], v[96:97], v[10:11] op_sel:[0,1,0] op_sel_hi:[1,1,1] neg_lo:[0,0,1] neg_hi:[0,0,1]
  v_pk_mul_f32 v[10:11], v[54:55], v[96:97] op_sel_hi:[1,0]
  v_pk_fma_f32 v[22:23], v[22:23], v[96:97], v[10:11] op_sel:[0,1,0] op_sel_hi:[1,1,1] neg_lo:[0,0,1] neg_hi:[0,0,1]
  v_pk_mul_f32 v[10:11], v[56:57], v[96:97] op_sel_hi:[1,0]
  v_pk_fma_f32 v[24:25], v[24:25], v[96:97], v[10:11] op_sel:[0,1,0] op_sel_hi:[1,1,1] neg_lo:[0,0,1] neg_hi:[0,0,1]
  v_pk_mul_f32 v[10:11], v[58:59], v[96:97] op_sel_hi:[1,0]
  v_pk_fma_f32 v[26:27], v[26:27], v[96:97], v[10:11] op_sel:[0,1,0] op_sel_hi:[1,1,1] neg_lo:[0,0,1] neg_hi:[0,0,1]
  v_pk_mul_f32 v[10:11], v[60:61], v[96:97] op_sel_hi:[1,0]
  v_pk_fma_f32 v[28:29], v[28:29], v[96:97], v[10:11] op_sel:[0,1,0] op_sel_hi:[1,1,1] neg_lo:[0,0,1] neg_hi:[0,0,1]
  v_pk_mul_f32 v[10:11], v[62:63], v[96:97] op_sel_hi:[1,0]
  v_pk_fma_f32 v[30:31], v[30:31], v[96:97], v[10:11] op_sel:[0,1,0] op_sel_hi:[1,1,1] neg_lo:[0,0,1] neg_hi:[0,0,1]
  v_pk_mul_f32 v[10:11], v[64:65], v[96:97] op_sel_hi:[1,0]
  v_pk_fma_f32 v[32:33], v[32:33], v[96:97], v[10:11] op_sel:[0,1,0] op_sel_hi:[1,1,1] neg_lo:[0,0,1] neg_hi:[0,0,1]
  v_pk_mul_f32 v[10:11], v[66:67], v[96:97] op_sel_hi:[1,0]
  v_pk_fma_f32 v[34:35], v[34:35], v[96:97], v[10:11] op_sel:[0,1,0] op_sel_hi:[1,1,1] neg_lo:[0,0,1] neg_hi:[0,0,1]
  v_pk_mul_f32 v[10:11], v[68:69], v[96:97] op_sel_hi:[1,0]
  v_pk_fma_f32 v[36:37], v[36:37], v[96:97], v[10:11] op_sel:[0,1,0] op_sel_hi:[1,1,1] neg_lo:[0,0,1] neg_hi:[0,0,1]
  v_pk_mul_f32 v[10:11], v[70:71], v[96:97] op_sel_hi:[1,0]
  v_pk_fma_f32 v[38:39], v[38:39], v[96:97], v[10:11] op_sel:[0,1,0] op_sel_hi:[1,1,1] neg_lo:[0,0,1] neg_hi:[0,0,1]
  v_pk_mul_f32 v[10:11], v[72:73], v[96:97] op_sel_hi:[1,0]
  v_pk_fma_f32 v[40:41], v[40:41], v[96:97], v[10:11] op_sel:[0,1,0] op_sel_hi:[1,1,1] neg_lo:[0,0,1] neg_hi:[0,0,1]
  v_pk_mul_f32 v[10:11], v[74:75], v[96:97] op_sel_hi:[1,0]
  v_pk_fma_f32 v[42:43], v[42:43], v[96:97], v[10:11] op_sel:[0,1,0] op_sel_hi:[1,1,1] neg_lo:[0,0,1] neg_hi:[0,0,1]
  v_pk_mul_f32 v[10:11], v[76:77], v[96:97] op_sel_hi:[1,0]
  v_pk_fma_f32 v[44:45], v[44:45], v[96:97], v[10:11] op_sel:[0,1,0] op_sel_hi:[1,1,1] neg_lo:[0,0,1] neg_hi:[0,0,1]
  v_pk_mul_f32 v[10:11], v[78:79], v[96:97] op_sel_hi:[1,0]
  v_pk_fma_f32 v[46:47], v[46:47], v[96:97], v[10:11] op_sel:[0,1,0] op_sel_hi:[1,1,1] neg_lo:[0,0,1] neg_hi:[0,0,1]
  v_pk_mul_f32 v[10:11], v[16:17], s[72:73]
  v_exp_f32 v10, v10 clamp
  v_exp_f32 v11, v11 clamp
  v_max_f32 v16, 0, v16
  v_max_f32 v17, 0, v17
  v_pk_add_f32 v[10:11], v[10:11], s[70:71]
  v_pk_add_f32 v[16:17], v[16:17], v[10:11]
  v_pk_mul_f32 v[10:11], v[18:19], s[72:73]
  v_exp_f32 v10, v10 clamp
  v_exp_f32 v11, v11 clamp
  v_max_f32 v18, 0, v18
  v_max_f32 v19, 0, v19
  v_pk_add_f32 v[10:11], v[10:11], s[70:71]
  v_pk_add_f32 v[18:19], v[18:19], v[10:11]
  v_pk_mul_f32 v[10:11], v[20:21], s[72:73]
  v_exp_f32 v10, v10 clamp
  v_exp_f32 v11, v11 clamp
  v_max_f32 v20, 0, v20
  v_max_f32 v21, 0, v21
  v_pk_add_f32 v[10:11], v[10:11], s[70:71]
  v_pk_add_f32 v[20:21], v[20:21], v[10:11]
  v_pk_mul_f32 v[10:11], v[22:23], s[72:73]
  v_exp_f32 v10, v10 clamp
  v_exp_f32 v11, v11 clamp
  v_max_f32 v22, 0, v22
  v_max_f32 v23, 0, v23
  v_pk_add_f32 v[10:11], v[10:11], s[70:71]
  v_pk_add_f32 v[22:23], v[22:23], v[10:11]
  v_pk_mul_f32 v[10:11], v[24:25], s[72:73]
  v_exp_f32 v10, v10 clamp
  v_exp_f32 v11, v11 clamp
  v_max_f32 v24, 0, v24
  v_max_f32 v25, 0, v25
  v_pk_add_f32 v[10:11], v[10:11], s[70:71]
  v_pk_add_f32 v[24:25], v[24:25], v[10:11]
  v_pk_mul_f32 v[10:11], v[26:27], s[72:73]
  v_exp_f32 v10, v10 clamp
  v_exp_f32 v11, v11 clamp
  v_max_f32 v26, 0, v26
  v_max_f32 v27, 0, v27
  v_pk_add_f32 v[10:11], v[10:11], s[70:71]
  v_pk_add_f32 v[26:27], v[26:27], v[10:11]
  v_pk_mul_f32 v[10:11], v[28:29], s[72:73]
  v_exp_f32 v10, v10 clamp
  v_exp_f32 v11, v11 clamp
  v_max_f32 v28, 0, v28
  v_max_f32 v29, 0, v29
  v_pk_add_f32 v[10:11], v[10:11], s[70:71]
  v_pk_add_f32 v[28:29], v[28:29], v[10:11]
  v_pk_mul_f32 v[10:11], v[30:31], s[72:73]
  v_exp_f32 v10, v10 clamp
  v_exp_f32 v11, v11 clamp
  v_max_f32 v30, 0, v30
  v_max_f32 v31, 0, v31
  v_pk_add_f32 v[10:11], v[10:11], s[70:71]
  v_pk_add_f32 v[30:31], v[30:31], v[10:11]
  v_pk_mul_f32 v[10:11], v[32:33], s[72:73]
  v_exp_f32 v10, v10 clamp
  v_exp_f32 v11, v11 clamp
  v_max_f32 v32, 0, v32
  v_max_f32 v33, 0, v33
  v_pk_add_f32 v[10:11], v[10:11], s[70:71]
  v_pk_add_f32 v[32:33], v[32:33], v[10:11]
  v_pk_mul_f32 v[10:11], v[34:35], s[72:73]
  v_exp_f32 v10, v10 clamp
  v_exp_f32 v11, v11 clamp
  v_max_f32 v34, 0, v34
  v_max_f32 v35, 0, v35
  v_pk_add_f32 v[10:11], v[10:11], s[70:71]
  v_pk_add_f32 v[34:35], v[34:35], v[10:11]
  v_pk_mul_f32 v[10:11], v[36:37], s[72:73]
  v_exp_f32 v10, v10 clamp
  v_exp_f32 v11, v11 clamp
  v_max_f32 v36, 0, v36
  v_max_f32 v37, 0, v37
  v_pk_add_f32 v[10:11], v[10:11], s[70:71]
  v_pk_add_f32 v[36:37], v[36:37], v[10:11]
  v_pk_mul_f32 v[10:11], v[38:39], s[72:73]
  v_exp_f32 v10, v10 clamp
  v_exp_f32 v11, v11 clamp
  v_max_f32 v38, 0, v38
  v_max_f32 v39, 0, v39
  v_pk_add_f32 v[10:11], v[10:11], s[70:71]
  v_pk_add_f32 v[38:39], v[38:39], v[10:11]
  v_pk_mul_f32 v[10:11], v[40:41], s[72:73]
  v_exp_f32 v10, v10 clamp
  v_exp_f32 v11, v11 clamp
  v_max_f32 v40, 0, v40
  v_max_f32 v41, 0, v41
  v_pk_add_f32 v[10:11], v[10:11], s[70:71]
  v_pk_add_f32 v[40:41], v[40:41], v[10:11]
  v_pk_mul_f32 v[10:11], v[42:43], s[72:73]
  v_exp_f32 v10, v10 clamp
  v_exp_f32 v11, v11 clamp
  v_max_f32 v42, 0, v42
  v_max_f32 v43, 0, v43
  v_pk_add_f32 v[10:11], v[10:11], s[70:71]
  v_pk_add_f32 v[42:43], v[42:43], v[10:11]
  v_pk_mul_f32 v[10:11], v[44:45], s[72:73]
  v_exp_f32 v10, v10 clamp
  v_exp_f32 v11, v11 clamp
  v_max_f32 v44, 0, v44
  v_max_f32 v45, 0, v45
  v_pk_add_f32 v[10:11], v[10:11], s[70:71]
  v_pk_add_f32 v[44:45], v[44:45], v[10:11]
  v_pk_mul_f32 v[10:11], v[46:47], s[72:73]
  v_exp_f32 v10, v10 clamp
  v_exp_f32 v11, v11 clamp
  v_max_f32 v46, 0, v46
  v_max_f32 v47, 0, v47
  v_pk_add_f32 v[10:11], v[10:11], s[70:71]
  v_pk_add_f32 v[46:47], v[46:47], v[10:11]
  v_cvt_pk_bf16_f32 v104, v16, v17
  v_cvt_pk_bf16_f32 v105, v18, v19
  v_cvt_pk_bf16_f32 v106, v20, v21
  v_cvt_pk_bf16_f32 v107, v22, v23
  v_cvt_pk_bf16_f32 v108, v24, v25
  v_cvt_pk_bf16_f32 v109, v26, v27
  v_cvt_pk_bf16_f32 v110, v28, v29
  v_cvt_pk_bf16_f32 v111, v30, v31
  v_cvt_pk_bf16_f32 v112, v32, v33
  v_cvt_pk_bf16_f32 v113, v34, v35
  v_cvt_pk_bf16_f32 v114, v36, v37
  v_cvt_pk_bf16_f32 v115, v38, v39
  v_cvt_pk_bf16_f32 v116, v40, v41
  v_cvt_pk_bf16_f32 v117, v42, v43
  v_cvt_pk_bf16_f32 v118, v44, v45
  v_cvt_pk_bf16_f32 v119, v46, v47
  s_lshl_b32 s53, s47, 15
  s_add_u32 s53, s53, 28311552
  buffer_store_dwordx4 v[104:107], v98, s[4:7], s53 offen offset:0 sc1
  buffer_store_dwordx4 v[108:111], v98, s[4:7], s53 offen offset:1024 sc1
  buffer_store_dwordx4 v[112:115], v98, s[4:7], s53 offen offset:2048 sc1
  buffer_store_dwordx4 v[116:119], v98, s[4:7], s53 offen offset:3072 sc1
  s_min_u32 s61, s47, 4
  s_cmp_lt_u32 s47, 4
  s_cselect_b32 s29, 4, 4
  s_add_u32 s61, s61, s29
  s_lshl_b32 s61, s61, 7
  s_add_u32 s61, s61, 55296
  s_mov_b32 s68, s47
  s_xor_b32 s51, s51, 33280
  s_mov_b32 s47, s66
  s_cmp_eq_u32 s58, 1
  s_cbranch_scc1 Lsl_54
  s_waitcnt vmcnt(0)
  v_mov_b32 v10, 1
  s_mov_b64 exec, 1
  buffer_atomic_add v10, off, s[4:7], s61 sc1
  s_mov_b64 exec, -1
  s_mov_b32 s61, 0
Lsl_58:
  s_cmp_ge_u32 s47, s48
  s_cbranch_scc1 Lsl_56
  s_lshl_b32 s57, s47, 15
  s_add_u32 s57, s57, 22020096
  s_cmp_ge_u32 s47, 60
  s_cbranch_scc0 Lsp_61
  s_mov_b32 s69, 1
  s_mov_b32 s26, 0
  s_mul_i32 s29, s21, 8192
  s_add_u32 s29, s29, s51
  v_add_u32 v12, s29, v1
  v_and_b32 v13, 7, v0
  v_lshlrev_b32 v13, 10, v13
  s_lshl_b32 s29, s21, 13
  v_add_u32 v13, s29, v13
  s_nop 1
Lsp_60:
  buffer_load_dword v10, v13, s[4:7], s57 offen offset:0 sc1
  s_add_u32 s26, s26, 1
  s_cmp_gt_u32 s26, 8192
  s_cbranch_scc1 Lsp_61x
  s_waitcnt vmcnt(0)
  v_cmp_eq_u32 vcc, -1, v10
  s_cbranch_vccnz Lsp_60
  s_mul_i32 s53, s21, 8192
  s_add_u32 s53, s53, s51
  s_add_u32 m0, s53, 0
  s_add_u32 s54, s57, 0
  buffer_load_dwordx4 v6, s[4:7], s54 offen sc1 lds
  s_add_u32 m0, s53, 1024
  s_add_u32 s54, s57, 1024
  buffer_load_dwordx4 v6, s[4:7], s54 offen sc1 lds
  s_add_u32 m0, s53, 2048
  s_add_u32 s54, s57, 2048
  buffer_load_dwordx4 v6, s[4:7], s54 offen sc1 lds
  s_add_u32 m0, s53, 3072
  s_add_u32 s54, s57, 3072
  buffer_load_dwordx4 v6, s[4:7], s54 offen sc1 lds
  s_add_u32 m0, s53, 4096
  s_add_u32 s54, s57, 4096
  buffer_load_dwordx4 v6, s[4:7], s54 offen sc1 lds
  s_add_u32 m0, s53, 5120
  s_add_u32 s54, s57, 5120
  buffer_load_dwordx4 v6, s[4:7], s54 offen sc1 lds
  s_add_u32 m0, s53, 6144
  s_add_u32 s54, s57, 6144
  buffer_load_dwordx4 v6, s[4:7], s54 offen sc1 lds
  s_add_u32 m0, s53, 7168
  s_add_u32 s54, s57, 7168
  buffer_load_dwordx4 v6, s[4:7], s54 offen sc1 lds
  s_waitcnt vmcnt(0)
  ds_read_b128 v[104:107], v12 offset:0
  ds_read_b128 v[108:111], v12 offset:1024
  ds_read_b128 v[112:115], v12 offset:2048
  ds_read_b128 v[116:119], v12 offset:3072
  ds_read_b128 v[120:123], v12 offset:4096
  ds_read_b128 v[124:127], v12 offset:5120
  ds_read_b128 v[128:131], v12 offset:6144
  ds_read_b128 v[132:135], v12 offset:7168
  s_waitcnt lgkmcnt(0)
  v_max3_u32 v10, v104, v105, v106
  v_max3_u32 v10, v10, v107, v108
  v_max3_u32 v10, v10, v109, v110
  v_max3_u32 v10, v10, v111, v112
  v_max3_u32 v10, v10, v113, v114
  v_max3_u32 v10, v10, v115, v116
  v_max3_u32 v10, v10, v117, v118
  v_max3_u32 v10, v10, v119, v120
  v_max3_u32 v10, v10, v121, v122
  v_max3_u32 v10, v10, v123, v124
  v_max3_u32 v10, v10, v125, v126
  v_max3_u32 v10, v10, v127, v128
  v_max3_u32 v10, v10, v129, v130
  v_max3_u32 v10, v10, v131, v132
  v_max3_u32 v10, v10, v133, v134
  v_max_u32 v10, v10, v135
  v_cmp_eq_u32 vcc, -1, v10
  s_cbranch_vccz Lsl_54
  s_sleep 4
  s_branch Lsp_60
  s_nop 1
Lsp_61x:
  s_mov_b32 s69, 0
Lsp_61:
  v_lshlrev_b32 v12, 7, v0
  s_lshl_b32 s29, s21, 13
  v_add_u32 v12, s29, v12
  s_lshl_b32 s67, s47, 7
  s_add_u32 s67, s67, 28672
  s_mov_b32 s52, 32
  s_mov_b32 s26, 0
Lwf_62:
  buffer_load_dword v10, off, s[4:7], s67 sc1
  buffer_load_dword v13, v12, s[4:7], s57 offen sc1
  s_waitcnt vmcnt(1)
  v_readfirstlane_b32 s29, v10
  s_nop 0
  s_cmp_ge_u32 s29, s52
  s_nop 1
  s_cbranch_scc1 Lwf_63
  s_sleep 0
  s_add_u32 s26, s26, 1
  s_cmp_lt_u32 s26, 0x100000
  s_cbranch_scc1 Lwf_62
  s_branch L_end
Lwf_63:
  s_mul_i32 s53, s21, 8192
  s_add_u32 s53, s53, s51
  s_add_u32 m0, s53, 0
  s_add_u32 s54, s57, 0
  buffer_load_dwordx4 v6, s[4:7], s54 offen sc1 lds
  s_add_u32 m0, s53, 1024
  s_add_u32 s54, s57, 1024
  buffer_load_dwordx4 v6, s[4:7], s54 offen sc1 lds
  s_add_u32 m0, s53, 2048
  s_add_u32 s54, s57, 2048
  buffer_load_dwordx4 v6, s[4:7], s54 offen sc1 lds
  s_add_u32 m0, s53, 3072
  s_add_u32 s54, s57, 3072
  buffer_load_dwordx4 v6, s[4:7], s54 offen sc1 lds
  s_add_u32 m0, s53, 4096
  s_add_u32 s54, s57, 4096
  buffer_load_dwordx4 v6, s[4:7], s54 offen sc1 lds
  s_add_u32 m0, s53, 5120
  s_add_u32 s54, s57, 5120
  buffer_load_dwordx4 v6, s[4:7], s54 offen sc1 lds
  s_add_u32 m0, s53, 6144
  s_add_u32 s54, s57, 6144
  buffer_load_dwordx4 v6, s[4:7], s54 offen sc1 lds
  s_add_u32 m0, s53, 7168
  s_add_u32 s54, s57, 7168
  buffer_load_dwordx4 v6, s[4:7], s54 offen sc1 lds
  s_branch Lsl_54
Lsl_56:
  s_add_u32 s53, s46, 60
  s_lshl_b32 s67, s53, 7
  s_add_u32 s67, s67, 28672
  s_mov_b32 s52, 32
  s_mov_b32 s26, 0
Lwf_64:
  buffer_load_dword v10, off, s[4:7], s67 sc1
  s_waitcnt vmcnt(0)
  v_readfirstlane_b32 s29, v10
  s_nop 0
  s_cmp_ge_u32 s29, s52
  s_nop 1
  s_cbranch_scc1 Lwf_65
  s_sleep 0
  s_add_u32 s26, s26, 1
  s_cmp_lt_u32 s26, 0x100000
  s_cbranch_scc1 Lwf_64
  s_branch L_end
Lwf_65:
  s_branch La1_53
La1_52:
  v_mov_b64 v[136:137], 0
  v_mov_b64 v[138:139], 0
  v_mov_b64 v[140:141], 0
  v_mov_b64 v[142:143], 0
  v_mov_b64 v[144:145], 0
  v_mov_b64 v[146:147], 0
  v_mov_b64 v[148:149], 0
  v_mov_b64 v[150:151], 0
  v_mov_b64 v[152:153], 0
  v_mov_b64 v[154:155], 0
  v_mov_b64 v[156:157], 0
  v_mov_b64 v[158:159], 0
  v_mov_b64 v[160:161], 0
  v_mov_b64 v[162:163], 0
  v_mov_b64 v[164:165], 0
  v_mov_b64 v[166:167], 0
  s_lshl_b32 s29, s20, 14
  s_lshl_b32 s30, s21, 12
  s_add_u32 s53, s29, s30
  s_add_u32 s53, s53, 30769152
  v_bfe_u32 v11, v0, 4, 1
  v_lshlrev_b32 v12, 11, v11
  v_lshl_add_u32 v14, v3, 10, v12
  v_and_b32 v13, 15, v0
  v_lshl_add_u32 v14, v13, 5, v14
  v_lshlrev_b32 v12, 2, v0
  v_add_u32 v12, 512, v12
  v_mov_b32 v15, 0x80000000
  v_cmp_eq_u32 vcc, 0, v3
  s_nop 1
  v_cndmask_b32 v12, v15, v12, vcc
  v_cmp_eq_u32 vcc, 1, v11
  s_nop 1
  v_cndmask_b32 v104, v136, v144, vcc
  v_cndmask_b32 v105, v137, v145, vcc
  v_cndmask_b32 v106, v138, v146, vcc
  v_cndmask_b32 v107, v139, v147, vcc
  v_cndmask_b32 v108, v140, v148, vcc
  v_cndmask_b32 v109, v141, v149, vcc
  v_cndmask_b32 v110, v142, v150, vcc
  v_cndmask_b32 v111, v143, v151, vcc
  s_lshl_b32 s29, s46, 16
  s_add_u32 s53, s53, s29
  s_lshl_b32 s29, s21, 11
  s_add_u32 s29, s29, 69632
  v_lshlrev_b32 v15, 5, v0
  v_add_u32 v15, s29, v15
  ds_write_b128 v15, v[104:107]
  ds_write_b128 v15, v[108:111] offset:16
  v_add_u32 v13, s29, v1
  s_waitcnt lgkmcnt(0)
  ds_read_b128 v[112:115], v13
  ds_read_b128 v[116:119], v13 offset:1024
  v_lshlrev_b32 v14, 4, v2
  v_lshl_add_u32 v14, v3, 11, v14
  s_waitcnt lgkmcnt(0)
  v_mov_b32 v104, -1
  v_mov_b32 v105, -1
  v_mov_b32 v106, -1
  v_mov_b32 v107, -1
  buffer_store_dwordx4 v[104:107], v14, s[4:7], s53 offen sc1
  buffer_store_dwordx4 v[104:107], v14, s[4:7], s53 offen offset:1024 sc1
  buffer_store_dword v104, v12, s[4:7], s53 offen sc1
  s_mov_b32 s48, 52
La1_67:
  s_mov_b32 s69, 0
  s_mov_b32 s51, 0
  s_mov_b32 s61, 0
  s_branch Lsl_72
Lsl_68:
  s_add_u32 s66, s47, s49
  s_sub_u32 s53, s48, 1
  s_min_u32 s53, s53, s66
  s_lshl_b32 s67, s53, 7
  s_add_u32 s67, s67, 28672
  s_mov_b32 s52, 32
  buffer_load_dword v11, off, s[4:7], s67 sc1
  s_waitcnt vmcnt(0)
  v_readfirstlane_b32 s58, v11
  s_barrier
  s_xor_b32 s53, s51, 33280
  s_cmp_ge_u32 s58, s52
  s_cselect_b32 s58, 1, 0
  s_cmp_lt_u32 s66, s48
  s_cselect_b32 s58, s58, 0
  s_cmp_eq_u32 s58, 0
  s_cbranch_scc1 Lsl_71
  s_mov_b32 s67, s53
  s_lshl_b32 s57, s66, 15
  s_add_u32 s57, s57, 22020096
  s_mul_i32 s53, s21, 8192
  s_add_u32 s53, s53, s67
  s_add_u32 m0, s53, 0
  s_add_u32 s54, s57, 0
  buffer_load_dwordx4 v6, s[4:7], s54 offen sc1 lds
  s_add_u32 m0, s53, 1024
  s_add_u32 s54, s57, 1024
  buffer_load_dwordx4 v6, s[4:7], s54 offen sc1 lds
  s_add_u32 m0, s53, 2048
  s_add_u32 s54, s57, 2048
  buffer_load_dwordx4 v6, s[4:7], s54 offen sc1 lds
  s_add_u32 m0, s53, 3072
  s_add_u32 s54, s57, 3072
  buffer_load_dwordx4 v6, s[4:7], s54 offen sc1 lds
  s_add_u32 m0, s53, 4096
  s_add_u32 s54, s57, 4096
  buffer_load_dwordx4 v6, s[4:7], s54 offen sc1 lds
  s_add_u32 m0, s53, 5120
  s_add_u32 s54, s57, 5120
  buffer_load_dwordx4 v6, s[4:7], s54 offen sc1 lds
  s_add_u32 m0, s53, 6144
  s_add_u32 s54, s57, 6144
  buffer_load_dwordx4 v6, s[4:7], s54 offen sc1 lds
  s_add_u32 m0, s53, 7168
  s_add_u32 s54, s57, 7168
  buffer_load_dwordx4 v6, s[4:7], s54 offen sc1 lds
Lsl_71:
  s_mul_i32 s53, s21, 8192
  s_add_u32 s53, s53, s51
  v_add_u32 v9, s53, v5
  v_mov_b32 v96, 0
  v_mov_b32 v97, 0
  ds_read_b128 v[104:107], v9 offset:0
  ds_read_b128 v[108:111], v9 offset:1024
  ds_read_b128 v[112:115], v9 offset:2048
  ds_read_b128 v[116:119], v9 offset:3072
  ds_read_b128 v[120:123], v9 offset:4096
  ds_read_b128 v[124:127], v9 offset:5120
  ds_read_b128 v[128:131], v9 offset:6144
  ds_read_b128 v[132:135], v9 offset:7168
  s_waitcnt lgkmcnt(7)
  v_dot2c_f32_bf16 v96, v104, v100
  v_dot2c_f32_bf16 v97, v104, v104
  v_dot2c_f32_bf16 v96, v105, v100
  v_dot2c_f32_bf16 v97, v105, v105
  v_dot2c_f32_bf16 v96, v106, v100
  v_dot2c_f32_bf16 v97, v106, v106
  v_dot2c_f32_bf16 v96, v107, v100
  v_dot2c_f32_bf16 v97, v107, v107
  s_waitcnt lgkmcnt(6)
  v_dot2c_f32_bf16 v96, v108, v100
  v_dot2c_f32_bf16 v97, v108, v108
  v_dot2c_f32_bf16 v96, v109, v100
  v_dot2c_f32_bf16 v97, v109, v109
  v_dot2c_f32_bf16 v96, v110, v100
  v_dot2c_f32_bf16 v97, v110, v110
  v_dot2c_f32_bf16 v96, v111, v100
  v_dot2c_f32_bf16 v97, v111, v111
  s_waitcnt lgkmcnt(5)
  v_dot2c_f32_bf16 v96, v112, v100
  v_dot2c_f32_bf16 v97, v112, v112
  v_dot2c_f32_bf16 v96, v113, v100
  v_dot2c_f32_bf16 v97, v113, v113
  v_dot2c_f32_bf16 v96, v114, v100
  v_dot2c_f32_bf16 v97, v114, v114
  v_dot2c_f32_bf16 v96, v115, v100
  v_dot2c_f32_bf16 v97, v115, v115
  s_waitcnt lgkmcnt(4)
  v_dot2c_f32_bf16 v96, v116, v100
  v_dot2c_f32_bf16 v97, v116, v116
  v_dot2c_f32_bf16 v96, v117, v100
  v_dot2c_f32_bf16 v97, v117, v117
  v_dot2c_f32_bf16 v96, v118, v100
  v_dot2c_f32_bf16 v97, v118, v118
  v_dot2c_f32_bf16 v96, v119, v100
  v_dot2c_f32_bf16 v97, v119, v119
  s_waitcnt lgkmcnt(3)
  v_dot2c_f32_bf16 v96, v120, v100
  v_dot2c_f32_bf16 v97, v120, v120
  v_dot2c_f32_bf16 v96, v121, v100
  v_dot2c_f32_bf16 v97, v121, v121
  v_dot2c_f32_bf16 v96, v122, v100
  v_dot2c_f32_bf16 v97, v122, v122
  v_dot2c_f32_bf16 v96, v123, v100
  v_dot2c_f32_bf16 v97, v123, v123
  s_waitcnt lgkmcnt(2)
  v_dot2c_f32_bf16 v96, v124, v100
  v_dot2c_f32_bf16 v97, v124, v124
  v_dot2c_f32_bf16 v96, v125, v100
  v_dot2c_f32_bf16 v97, v125, v125
  v_dot2c_f32_bf16 v96, v126, v100
  v_dot2c_f32_bf16 v97, v126, v126
  v_dot2c_f32_bf16 v96, v127, v100
  v_dot2c_f32_bf16 v97, v127, v127
  s_waitcnt lgkmcnt(1)
  v_dot2c_f32_bf16 v96, v128, v100
  v_dot2c_f32_bf16 v97, v128, v128
  v_dot2c_f32_bf16 v96, v129, v100
  v_dot2c_f32_bf16 v97, v129, v129
  v_dot2c_f32_bf16 v96, v130, v100
  v_dot2c_f32_bf16 v97, v130, v130
  v_dot2c_f32_bf16 v96, v131, v100
  v_dot2c_f32_bf16 v97, v131, v131
  s_waitcnt lgkmcnt(0)
  v_dot2c_f32_bf16 v96, v132, v100
  v_dot2c_f32_bf16 v97, v132, v132
  v_dot2c_f32_bf16 v96, v133, v100
  v_dot2c_f32_bf16 v97, v133, v133
  v_dot2c_f32_bf16 v96, v134, v100
  v_dot2c_f32_bf16 v97, v134, v134
  v_dot2c_f32_bf16 v96, v135, v100
  v_dot2c_f32_bf16 v97, v135, v135
  s_nop 2
  v_permlane32_swap_b32 v96, v97
  v_add_f32 v96, v96, v97
  v_lshlrev_b32 v10, 2, v0
  s_lshl_b32 s53, s21, 8
  s_add_u32 s53, s53, 68608
  v_add_u32 v10, s53, v10
  ds_write_b32 v10, v96
  v_add_u32 v9, s51, v5
  ds_read_b128 v[80:83], v9 offset:0
  ds_read_b128 v[84:87], v9 offset:1024
  ds_read_b128 v[88:91], v9 offset:2048
  s_waitcnt lgkmcnt(2)
  v_mfma_f32_32x32x16_bf16 v[16:31], v[80:83], a[0:3], 0
  ds_read_b128 v[92:95], v9 offset:3072
  v_mfma_f32_32x32x16_bf16 v[32:47], v[80:83], a[4:7], 0
  s_waitcnt lgkmcnt(2)
  v_mfma_f32_32x32x16_bf16 v[16:31], v[84:87], a[8:11], v[16:31]
  ds_read_b128 v[80:83], v9 offset:4096
  v_mfma_f32_32x32x16_bf16 v[32:47], v[84:87], a[12:15], v[32:47]
  s_waitcnt lgkmcnt(2)
  v_mfma_f32_32x32x16_bf16 v[16:31], v[88:91], a[16:19], v[16:31]
  ds_read_b128 v[84:87], v9 offset:5120
  v_mfma_f32_32x32x16_bf16 v[32:47], v[88:91], a[20:23], v[32:47]
  s_waitcnt lgkmcnt(2)
  v_mfma_f32_32x32x16_bf16 v[16:31], v[92:95], a[24:27], v[16:31]
  ds_read_b128 v[88:91], v9 offset:6144
  v_mfma_f32_32x32x16_bf16 v[32:47], v[92:95], a[28:31], v[32:47]
  s_waitcnt lgkmcnt(2)
  v_mfma_f32_32x32x16_bf16 v[16:31], v[80:83], a[32:35], v[16:31]
  ds_read_b128 v[92:95], v9 offset:7168
  v_mfma_f32_32x32x16_bf16 v[32:47], v[80:83], a[36:39], v[32:47]
  s_waitcnt lgkmcnt(2)
  v_mfma_f32_32x32x16_bf16 v[16:31], v[84:87], a[40:43], v[16:31]
  ds_read_b128 v[80:83], v9 offset:8192
  v_mfma_f32_32x32x16_bf16 v[32:47], v[84:87], a[44:47], v[32:47]
  s_waitcnt lgkmcnt(2)
  v_mfma_f32_32x32x16_bf16 v[16:31], v[88:91], a[48:51], v[16:31]
  ds_read_b128 v[84:87], v9 offset:9216
  v_mfma_f32_32x32x16_bf16 v[32:47], v[88:91], a[52:55], v[32:47]
  s_waitcnt lgkmcnt(2)
  v_mfma_f32_32x32x16_bf16 v[16:31], v[92:95], a[56:59], v[16:31]
  ds_read_b128 v[88:91], v9 offset:10240
  v_mfma_f32_32x32x16_bf16 v[32:47], v[92:95], a[60:63], v[32:47]
  s_waitcnt lgkmcnt(2)
  v_mfma_f32_32x32x16_bf16 v[16:31], v[80:83], a[64:67], v[16:31]
  ds_read_b128 v[92:95], v9 offset:11264
  v_mfma_f32_32x32x16_bf16 v[32:47], v[80:83], a[68:71], v[32:47]
  s_waitcnt lgkmcnt(2)
  v_mfma_f32_32x32x16_bf16 v[16:31], v[84:87], a[72:75], v[16:31]
  ds_read_b128 v[80:83], v9 offset:12288
  v_mfma_f32_32x32x16_bf16 v[32:47], v[84:87], a[76:79], v[32:47]
  s_waitcnt lgkmcnt(2)
  v_mfma_f32_32x32x16_bf16 v[16:31], v[88:91], a[80:83], v[16:31]
  ds_read_b128 v[84:87], v9 offset:13312
  v_mfma_f32_32x32x16_bf16 v[32:47], v[88:91], a[84:87], v[32:47]
  s_waitcnt lgkmcnt(2)
  v_mfma_f32_32x32x16_bf16 v[16:31], v[92:95], a[88:91], v[16:31]
  ds_read_b128 v[88:91], v9 offset:14336
  v_mfma_f32_32x32x16_bf16 v[32:47], v[92:95], a[92:95], v[32:47]
  s_waitcnt lgkmcnt(2)
  v_mfma_f32_32x32x16_bf16 v[16:31], v[80:83], a[96:99], v[16:31]
  ds_read_b128 v[92:95], v9 offset:15360
  v_mfma_f32_32x32x16_bf16 v[32:47], v[80:83], a[100:103], v[32:47]
  s_waitcnt lgkmcnt(2)
  v_mfma_f32_32x32x16_bf16 v[16:31], v[84:87], a[104:107], v[16:31]
  ds_read_b128 v[80:83], v9 offset:16384
  v_mfma_f32_32x32x16_bf16 v[32:47], v[84:87], a[108:111], v[32:47]
  s_waitcnt lgkmcnt(2)
  v_mfma_f32_32x32x16_bf16 v[16:31], v[88:91], a[112:115], v[16:31]
  ds_read_b128 v[84:87], v9 offset:17408
  v_mfma_f32_32x32x16_bf16 v[32:47], v[88:91], a[116:119], v[32:47]
  s_waitcnt lgkmcnt(2)
  v_mfma_f32_32x32x16_bf16 v[16:31], v[92:95], a[120:123], v[16:31]
  ds_read_b128 v[88:91], v9 offset:18432
  v_mfma_f32_32x32x16_bf16 v[32:47], v[92:95], a[124:127], v[32:47]
  s_waitcnt lgkmcnt(2)
  v_mfma_f32_32x32x16_bf16 v[16:31], v[80:83], a[128:131], v[16:31]
  ds_read_b128 v[92:95], v9 offset:19456
  v_mfma_f32_32x32x16_bf16 v[32:47], v[80:83], a[132:135], v[32:47]
  s_waitcnt lgkmcnt(2)
  v_mfma_f32_32x32x16_bf16 v[16:31], v[84:87], a[136:139], v[16:31]
  ds_read_b128 v[80:83], v9 offset:20480
  v_mfma_f32_32x32x16_bf16 v[32:47], v[84:87], a[140:143], v[32:47]
  s_waitcnt lgkmcnt(2)
  v_mfma_f32_32x32x16_bf16 v[16:31], v[88:91], a[144:147], v[16:31]
  ds_read_b128 v[84:87], v9 offset:21504
  v_mfma_f32_32x32x16_bf16 v[32:47], v[88:91], a[148:151], v[32:47]
  s_waitcnt lgkmcnt(2)
  v_mfma_f32_32x32x16_bf16 v[16:31], v[92:95], a[152:155], v[16:31]
  ds_read_b128 v[88:91], v9 offset:22528
  v_mfma_f32_32x32x16_bf16 v[32:47], v[92:95], a[156:159], v[32:47]
  s_waitcnt lgkmcnt(2)
  v_mfma_f32_32x32x16_bf16 v[16:31], v[80:83], a[160:163], v[16:31]
  ds_read_b128 v[92:95], v9 offset:23552
  v_mfma_f32_32x32x16_bf16 v[32:47], v[80:83], a[164:167], v[32:47]
  s_waitcnt lgkmcnt(2)
  v_mfma_f32_32x32x16_bf16 v[16:31], v[84:87], a[168:171], v[16:31]
  ds_read_b128 v[80:83], v9 offset:24576
  v_mfma_f32_32x32x16_bf16 v[32:47], v[84:87], a[172:175], v[32:47]
  s_waitcnt lgkmcnt(2)
  v_mfma_f32_32x32x16_bf16 v[16:31], v[88:91], a[176:179], v[16:31]
  ds_read_b128 v[84:87], v9 offset:25600
  v_mfma_f32_32x32x16_bf16 v[32:47], v[88:91], a[180:183], v[32:47]
  s_waitcnt lgkmcnt(2)
  v_mfma_f32_32x32x16_bf16 v[16:31], v[92:95], a[184:187], v[16:31]
  ds_read_b128 v[88:91], v9 offset:26624
  v_mfma_f32_32x32x16_bf16 v[32:47], v[92:95], a[188:191], v[32:47]
  s_waitcnt lgkmcnt(2)
  v_mfma_f32_32x32x16_bf16 v[16:31], v[80:83], a[192:195], v[16:31]
  ds_read_b128 v[92:95], v9 offset:27648
  v_mfma_f32_32x32x16_bf16 v[32:47], v[80:83], a[196:199], v[32:47]
  s_waitcnt lgkmcnt(2)
  v_mfma_f32_32x32x16_bf16 v[16:31], v[84:87], a[200:203], v[16:31]
  ds_read_b128 v[80:83], v9 offset:28672
  v_mfma_f32_32x32x16_bf16 v[32:47], v[84:87], a[204:207], v[32:47]
  s_waitcnt lgkmcnt(2)
  v_mfma_f32_32x32x16_bf16 v[16:31], v[88:91], a[208:211], v[16:31]
  ds_read_b128 v[84:87], v9 offset:29696
  v_mfma_f32_32x32x16_bf16 v[32:47], v[88:91], a[212:215], v[32:47]
  s_waitcnt lgkmcnt(2)
  v_mfma_f32_32x32x16_bf16 v[16:31], v[92:95], a[216:219], v[16:31]
  ds_read_b128 v[88:91], v9 offset:30720
  v_mfma_f32_32x32x16_bf16 v[32:47], v[92:95], a[220:223], v[32:47]
  s_waitcnt lgkmcnt(2)
  v_mfma_f32_32x32x16_bf16 v[16:31], v[80:83], a[224:227], v[16:31]
  ds_read_b128 v[92:95], v9 offset:31744
  v_mfma_f32_32x32x16_bf16 v[32:47], v[80:83], a[228:231], v[32:47]
  s_waitcnt lgkmcnt(2)
  v_mfma_f32_32x32x16_bf16 v[16:31], v[84:87], a[232:235], v[16:31]
  v_mfma_f32_32x32x16_bf16 v[32:47], v[84:87], a[236:239], v[32:47]
  s_waitcnt lgkmcnt(1)
  v_mfma_f32_32x32x16_bf16 v[16:31], v[88:91], a[240:243], v[16:31]
  v_mfma_f32_32x32x16_bf16 v[32:47], v[88:91], a[244:247], v[32:47]
  s_waitcnt lgkmcnt(0)
  v_mfma_f32_32x32x16_bf16 v[16:31], v[92:95], a[248:251], v[16:31]
  v_mfma_f32_32x32x16_bf16 v[32:47], v[92:95], a[252:255], v[32:47]
  s_barrier
  v_lshlrev_b32 v10, 2, v2
  v_add_u32 v10, 68608, v10
  ds_read2_b32 v[104:105], v10 offset0:0 offset1:32
  ds_read2_b32 v[106:107], v10 offset0:64 offset1:96
  ds_read2_b32 v[108:109], v10 offset0:128 offset1:160
  ds_read2_b32 v[110:111], v10 offset0:192 offset1:224
  s_waitcnt lgkmcnt(0)
  v_pk_add_f32 v[104:105], v[104:105], v[106:107]
  v_pk_add_f32 v[108:109], v[108:109], v[110:111]
  v_pk_add_f32 v[96:97], v[104:105], v[108:109]
  v_mul_f32 v96, s59, v96
  v_mul_f32 v97, s59, v97
  v_fma_f32 v97, -v96, v96, v97
  v_max_f32 v97, 0, v97
  v_cvt_pk_bf16_f32 v96, v96, v96
  v_and_b32 v96, 0xffff0000, v96
  v_cvt_pk_bf16_f32 v97, v97, v97
  v_and_b32 v97, 0xffff0000, v97
  v_add_f32 v97, s60, v97
  v_cvt_pk_bf16_f32 v97, v97, v97
  v_and_b32 v97, 0xffff0000, v97
  v_sqrt_f32 v97, v97
  s_nop 0
  v_cvt_pk_bf16_f32 v97, v97, v97
  v_and_b32 v97, 0xffff0000, v97
  v_rcp_f32 v97, v97
  s_nop 0
  v_mul_f32 v96, v96, v97
  ds_write2_b32 v7, v96, v97 offset0:0 offset1:32
  s_waitcnt lgkmcnt(0)
  ds_read_b128 v[104:107], v8 offset:0
  ds_read_b128 v[120:123], v8 offset:128
  ds_read_b128 v[108:111], v8 offset:32
  ds_read_b128 v[124:127], v8 offset:160
  ds_read_b128 v[112:115], v8 offset:64
  ds_read_b128 v[128:131], v8 offset:192
  ds_read_b128 v[116:119], v8 offset:96
  ds_read_b128 v[132:135], v8 offset:224
  s_waitcnt lgkmcnt(0)
  v_pk_mul_f32 v[10:11], v[104:105], v[48:49]
  v_pk_fma_f32 v[16:17], v[16:17], v[120:121], v[10:11] neg_lo:[0,0,1] neg_hi:[0,0,1]
  v_pk_mul_f32 v[10:11], v[106:107], v[48:49]
  v_pk_fma_f32 v[18:19], v[18:19], v[122:123], v[10:11] neg_lo:[0,0,1] neg_hi:[0,0,1]
  v_pk_mul_f32 v[10:11], v[108:109], v[48:49]
  v_pk_fma_f32 v[20:21], v[20:21], v[124:125], v[10:11] neg_lo:[0,0,1] neg_hi:[0,0,1]
  v_pk_mul_f32 v[10:11], v[110:111], v[48:49]
  v_pk_fma_f32 v[22:23], v[22:23], v[126:127], v[10:11] neg_lo:[0,0,1] neg_hi:[0,0,1]
  v_pk_mul_f32 v[10:11], v[112:113], v[48:49]
  v_pk_fma_f32 v[24:25], v[24:25], v[128:129], v[10:11] neg_lo:[0,0,1] neg_hi:[0,0,1]
  v_pk_mul_f32 v[10:11], v[114:115], v[48:49]
  v_pk_fma_f32 v[26:27], v[26:27], v[130:131], v[10:11] neg_lo:[0,0,1] neg_hi:[0,0,1]
  v_pk_mul_f32 v[10:11], v[116:117], v[48:49]
  v_pk_fma_f32 v[28:29], v[28:29], v[132:133], v[10:11] neg_lo:[0,0,1] neg_hi:[0,0,1]
  v_pk_mul_f32 v[10:11], v[118:119], v[48:49]
  v_pk_fma_f32 v[30:31], v[30:31], v[134:135], v[10:11] neg_lo:[0,0,1] neg_hi:[0,0,1]
  v_pk_mul_f32 v[10:11], v[104:105], v[64:65]
  v_pk_fma_f32 v[32:33], v[32:33], v[120:121], v[10:11] neg_lo:[0,0,1] neg_hi:[0,0,1]
  v_pk_mul_f32 v[10:11], v[106:107], v[64:65]
  v_pk_fma_f32 v[34:35], v[34:35], v[122:123], v[10:11] neg_lo:[0,0,1] neg_hi:[0,0,1]
  v_pk_mul_f32 v[10:11], v[108:109], v[64:65]
  v_pk_fma_f32 v[36:37], v[36:37], v[124:125], v[10:11] neg_lo:[0,0,1] neg_hi:[0,0,1]
  v_pk_mul_f32 v[10:11], v[110:111], v[64:65]
  v_pk_fma_f32 v[38:39], v[38:39], v[126:127], v[10:11] neg_lo:[0,0,1] neg_hi:[0,0,1]
  v_pk_mul_f32 v[10:11], v[112:113], v[64:65]
  v_pk_fma_f32 v[40:41], v[40:41], v[128:129], v[10:11] neg_lo:[0,0,1] neg_hi:[0,0,1]
  v_pk_mul_f32 v[10:11], v[114:115], v[64:65]
  v_pk_fma_f32 v[42:43], v[42:43], v[130:131], v[10:11] neg_lo:[0,0,1] neg_hi:[0,0,1]
  v_pk_mul_f32 v[10:11], v[116:117], v[64:65]
  v_pk_fma_f32 v[44:45], v[44:45], v[132:133], v[10:11] neg_lo:[0,0,1] neg_hi:[0,0,1]
  v_pk_mul_f32 v[10:11], v[118:119], v[64:65]
  v_pk_fma_f32 v[46:47], v[46:47], v[134:135], v[10:11] neg_lo:[0,0,1] neg_hi:[0,0,1]
  v_pk_mul_f32 v[10:11], v[16:17], s[72:73]
  v_exp_f32 v10, v10 clamp
  v_exp_f32 v11, v11 clamp
  v_max_f32 v16, 0, v16
  v_max_f32 v17, 0, v17
  v_pk_add_f32 v[10:11], v[10:11], s[70:71]
  v_pk_add_f32 v[16:17], v[16:17], v[10:11]
  v_pk_mul_f32 v[10:11], v[18:19], s[72:73]
  v_exp_f32 v10, v10 clamp
  v_exp_f32 v11, v11 clamp
  v_max_f32 v18, 0, v18
  v_max_f32 v19, 0, v19
  v_pk_add_f32 v[10:11], v[10:11], s[70:71]
  v_pk_add_f32 v[18:19], v[18:19], v[10:11]
  v_pk_mul_f32 v[10:11], v[20:21], s[72:73]
  v_exp_f32 v10, v10 clamp
  v_exp_f32 v11, v11 clamp
  v_max_f32 v20, 0, v20
  v_max_f32 v21, 0, v21
  v_pk_add_f32 v[10:11], v[10:11], s[70:71]
  v_pk_add_f32 v[20:21], v[20:21], v[10:11]
  v_pk_mul_f32 v[10:11], v[22:23], s[72:73]
  v_exp_f32 v10, v10 clamp
  v_exp_f32 v11, v11 clamp
  v_max_f32 v22, 0, v22
  v_max_f32 v23, 0, v23
  v_pk_add_f32 v[10:11], v[10:11], s[70:71]
  v_pk_add_f32 v[22:23], v[22:23], v[10:11]
  v_pk_mul_f32 v[10:11], v[24:25], s[72:73]
  v_exp_f32 v10, v10 clamp
  v_exp_f32 v11, v11 clamp
  v_max_f32 v24, 0, v24
  v_max_f32 v25, 0, v25
  v_pk_add_f32 v[10:11], v[10:11], s[70:71]
  v_pk_add_f32 v[24:25], v[24:25], v[10:11]
  v_pk_mul_f32 v[10:11], v[26:27], s[72:73]
  v_exp_f32 v10, v10 clamp
  v_exp_f32 v11, v11 clamp
  v_max_f32 v26, 0, v26
  v_max_f32 v27, 0, v27
  v_pk_add_f32 v[10:11], v[10:11], s[70:71]
  v_pk_add_f32 v[26:27], v[26:27], v[10:11]
  v_pk_mul_f32 v[10:11], v[28:29], s[72:73]
  v_exp_f32 v10, v10 clamp
  v_exp_f32 v11, v11 clamp
  v_max_f32 v28, 0, v28
  v_max_f32 v29, 0, v29
  v_pk_add_f32 v[10:11], v[10:11], s[70:71]
  v_pk_add_f32 v[28:29], v[28:29], v[10:11]
  v_pk_mul_f32 v[10:11], v[30:31], s[72:73]
  v_exp_f32 v10, v10 clamp
  v_exp_f32 v11, v11 clamp
  v_max_f32 v30, 0, v30
  v_max_f32 v31, 0, v31
  v_pk_add_f32 v[10:11], v[10:11], s[70:71]
  v_pk_add_f32 v[30:31], v[30:31], v[10:11]
  v_cvt_pk_bf16_f32 v104, v16, v17
  v_cvt_pk_bf16_f32 v105, v18, v19
  v_cvt_pk_bf16_f32 v106, v20, v21
  v_cvt_pk_bf16_f32 v107, v22, v23
  v_cvt_pk_bf16_f32 v108, v24, v25
  v_cvt_pk_bf16_f32 v109, v26, v27
  v_cvt_pk_bf16_f32 v110, v28, v29
  v_cvt_pk_bf16_f32 v111, v30, v31
  v_cvt_pk_bf16_f32 v112, v32, v33
  v_cvt_pk_bf16_f32 v113, v34, v35
  v_cvt_pk_bf16_f32 v114, v36, v37
  v_cvt_pk_bf16_f32 v115, v38, v39
  v_cvt_pk_bf16_f32 v116, v40, v41
  v_cvt_pk_bf16_f32 v117, v42, v43
  v_cvt_pk_bf16_f32 v118, v44, v45
  v_cvt_pk_bf16_f32 v119, v46, v47
  v_mfma_f32_32x32x16_bf16 v[136:151], v[104:107], v[112:115], v[136:151]
  v_mfma_f32_32x32x16_bf16 v[152:167], v[100:103], v[104:107], v[152:167]
  v_mfma_f32_32x32x16_bf16 v[136:151], v[108:111], v[116:119], v[136:151]
  v_mfma_f32_32x32x16_bf16 v[152:167], v[100:103], v[108:111], v[152:167]
  s_xor_b32 s51, s51, 33280
  s_mov_b32 s47, s66
  s_cmp_eq_u32 s58, 1
  s_nop 7
  s_cbranch_scc1 Lsl_68
Lsl_72:
  s_cmp_ge_u32 s47, s48
  s_cbranch_scc1 Lsl_70
  s_lshl_b32 s57, s47, 15
  s_add_u32 s57, s57, 22020096
  s_cmp_ge_u32 s47, 60
  s_cbranch_scc0 Lsp_75
  s_mov_b32 s69, 1
  s_mov_b32 s26, 0
  s_mul_i32 s29, s21, 8192
  s_add_u32 s29, s29, s51
  v_add_u32 v12, s29, v1
  v_and_b32 v13, 7, v0
  v_lshlrev_b32 v13, 10, v13
  s_lshl_b32 s29, s21, 13
  v_add_u32 v13, s29, v13
  s_nop 1
Lsp_74:
  buffer_load_dword v10, v13, s[4:7], s57 offen offset:0 sc1
  s_add_u32 s26, s26, 1
  s_cmp_gt_u32 s26, 8192
  s_cbranch_scc1 Lsp_75x
  s_waitcnt vmcnt(0)
  v_cmp_eq_u32 vcc, -1, v10
  s_cbranch_vccnz Lsp_74
  s_mul_i32 s53, s21, 8192
  s_add_u32 s53, s53, s51
  s_add_u32 m0, s53, 0
  s_add_u32 s54, s57, 0
  buffer_load_dwordx4 v6, s[4:7], s54 offen sc1 lds
  s_add_u32 m0, s53, 1024
  s_add_u32 s54, s57, 1024
  buffer_load_dwordx4 v6, s[4:7], s54 offen sc1 lds
  s_add_u32 m0, s53, 2048
  s_add_u32 s54, s57, 2048
  buffer_load_dwordx4 v6, s[4:7], s54 offen sc1 lds
  s_add_u32 m0, s53, 3072
  s_add_u32 s54, s57, 3072
  buffer_load_dwordx4 v6, s[4:7], s54 offen sc1 lds
  s_add_u32 m0, s53, 4096
  s_add_u32 s54, s57, 4096
  buffer_load_dwordx4 v6, s[4:7], s54 offen sc1 lds
  s_add_u32 m0, s53, 5120
  s_add_u32 s54, s57, 5120
  buffer_load_dwordx4 v6, s[4:7], s54 offen sc1 lds
  s_add_u32 m0, s53, 6144
  s_add_u32 s54, s57, 6144
  buffer_load_dwordx4 v6, s[4:7], s54 offen sc1 lds
  s_add_u32 m0, s53, 7168
  s_add_u32 s54, s57, 7168
  buffer_load_dwordx4 v6, s[4:7], s54 offen sc1 lds
  s_waitcnt vmcnt(0)
  ds_read_b128 v[104:107], v12 offset:0
  ds_read_b128 v[108:111], v12 offset:1024
  ds_read_b128 v[112:115], v12 offset:2048
  ds_read_b128 v[116:119], v12 offset:3072
  ds_read_b128 v[120:123], v12 offset:4096
  ds_read_b128 v[124:127], v12 offset:5120
  ds_read_b128 v[128:131], v12 offset:6144
  ds_read_b128 v[132:135], v12 offset:7168
  s_waitcnt lgkmcnt(0)
  v_max3_u32 v10, v104, v105, v106
  v_max3_u32 v10, v10, v107, v108
  v_max3_u32 v10, v10, v109, v110
  v_max3_u32 v10, v10, v111, v112
  v_max3_u32 v10, v10, v113, v114
  v_max3_u32 v10, v10, v115, v116
  v_max3_u32 v10, v10, v117, v118
  v_max3_u32 v10, v10, v119, v120
  v_max3_u32 v10, v10, v121, v122
  v_max3_u32 v10, v10, v123, v124
  v_max3_u32 v10, v10, v125, v126
  v_max3_u32 v10, v10, v127, v128
  v_max3_u32 v10, v10, v129, v130
  v_max3_u32 v10, v10, v131, v132
  v_max3_u32 v10, v10, v133, v134
  v_max_u32 v10, v10, v135
  v_cmp_eq_u32 vcc, -1, v10
  s_cbranch_vccz Lsl_68
  s_sleep 4
  s_branch Lsp_74
  s_nop 1
Lsp_75x:
  s_mov_b32 s69, 0
Lsp_75:
  v_lshlrev_b32 v12, 7, v0
  s_lshl_b32 s29, s21, 13
  v_add_u32 v12, s29, v12
  s_lshl_b32 s67, s47, 7
  s_add_u32 s67, s67, 28672
  s_mov_b32 s52, 32
  s_mov_b32 s26, 0
Lwf_76:
  buffer_load_dword v10, off, s[4:7], s67 sc1
  buffer_load_dword v13, v12, s[4:7], s57 offen sc1
  s_waitcnt vmcnt(1)
  v_readfirstlane_b32 s29, v10
  s_nop 0
  s_cmp_ge_u32 s29, s52
  s_nop 1
  s_cbranch_scc1 Lwf_77
  s_sleep 0
  s_add_u32 s26, s26, 1
  s_cmp_lt_u32 s26, 0x100000
  s_cbranch_scc1 Lwf_76
  s_branch L_end
Lwf_77:
  s_mul_i32 s53, s21, 8192
  s_add_u32 s53, s53, s51
  s_add_u32 m0, s53, 0
  s_add_u32 s54, s57, 0
  buffer_load_dwordx4 v6, s[4:7], s54 offen sc1 lds
  s_add_u32 m0, s53, 1024
  s_add_u32 s54, s57, 1024
  buffer_load_dwordx4 v6, s[4:7], s54 offen sc1 lds
  s_add_u32 m0, s53, 2048
  s_add_u32 s54, s57, 2048
  buffer_load_dwordx4 v6, s[4:7], s54 offen sc1 lds
  s_add_u32 m0, s53, 3072
  s_add_u32 s54, s57, 3072
  buffer_load_dwordx4 v6, s[4:7], s54 offen sc1 lds
  s_add_u32 m0, s53, 4096
  s_add_u32 s54, s57, 4096
  buffer_load_dwordx4 v6, s[4:7], s54 offen sc1 lds
  s_add_u32 m0, s53, 5120
  s_add_u32 s54, s57, 5120
  buffer_load_dwordx4 v6, s[4:7], s54 offen sc1 lds
  s_add_u32 m0, s53, 6144
  s_add_u32 s54, s57, 6144
  buffer_load_dwordx4 v6, s[4:7], s54 offen sc1 lds
  s_add_u32 m0, s53, 7168
  s_add_u32 s54, s57, 7168
  buffer_load_dwordx4 v6, s[4:7], s54 offen sc1 lds
  s_branch Lsl_68
Lsl_70:
  s_cmp_eq_u32 s48, 64
  s_cbranch_scc1 La1_66
  s_lshl_b32 s29, s20, 14
  s_lshl_b32 s30, s21, 12
  s_add_u32 s53, s29, s30
  s_add_u32 s53, s53, 30441472
  v_bfe_u32 v11, v0, 4, 1
  v_lshlrev_b32 v12, 11, v11
  v_lshl_add_u32 v14, v3, 10, v12
  v_and_b32 v13, 15, v0
  v_lshl_add_u32 v14, v13, 5, v14
  v_lshlrev_b32 v12, 2, v0
  v_add_u32 v12, 512, v12
  v_mov_b32 v15, 0x80000000
  v_cmp_eq_u32 vcc, 0, v3
  s_nop 1
  v_cndmask_b32 v12, v15, v12, vcc
  v_cmp_eq_u32 vcc, 1, v11
  s_nop 1
  v_cndmask_b32 v104, v136, v144, vcc
  v_cndmask_b32 v105, v137, v145, vcc
  v_cndmask_b32 v106, v138, v146, vcc
  v_cndmask_b32 v107, v139, v147, vcc
  v_cndmask_b32 v108, v140, v148, vcc
  v_cndmask_b32 v109, v141, v149, vcc
  v_cndmask_b32 v110, v142, v150, vcc
  v_cndmask_b32 v111, v143, v151, vcc
  s_lshl_b32 s29, s21, 11
  s_add_u32 s29, s29, 69632
  v_lshlrev_b32 v15, 5, v0
  v_add_u32 v15, s29, v15
  ds_write_b128 v15, v[104:107]
  ds_write_b128 v15, v[108:111] offset:16
  v_lshlrev_b32 v15, 2, v0
  v_add_u32 v13, s29, v15
  s_waitcnt lgkmcnt(0)
  ds_read_b32 v112, v13 offset:0
  ds_read_b32 v113, v13 offset:256
  ds_read_b32 v114, v13 offset:512
  ds_read_b32 v115, v13 offset:768
  ds_read_b32 v116, v13 offset:1024
  ds_read_b32 v117, v13 offset:1280
  ds_read_b32 v118, v13 offset:1536
  ds_read_b32 v119, v13 offset:1792
  buffer_atomic_add_f32 v152, v12, s[4:7], s53 offen
  s_waitcnt lgkmcnt(0)
  buffer_atomic_add_f32 v112, v15, s[4:7], s53 offen offset:0
  buffer_atomic_add_f32 v113, v15, s[4:7], s53 offen offset:256
  buffer_atomic_add_f32 v114, v15, s[4:7], s53 offen offset:2048
  buffer_atomic_add_f32 v115, v15, s[4:7], s53 offen offset:2304
  buffer_atomic_add_f32 v116, v15, s[4:7], s53 offen offset:1024
  buffer_atomic_add_f32 v117, v15, s[4:7], s53 offen offset:1280
  buffer_atomic_add_f32 v118, v15, s[4:7], s53 offen offset:3072
  buffer_atomic_add_f32 v119, v15, s[4:7], s53 offen offset:3328
  s_and_b32 s53, s50, 7
  s_lshl_b32 s53, s53, 7
  s_add_u32 s53, s53, 37888
  s_waitcnt vmcnt(0)
  s_barrier
  s_cmp_lg_u32 s21, 0
  s_cbranch_scc1 Lsg_78
  v_mov_b32 v10, 1
  s_mov_b64 exec, 1
  buffer_atomic_add v10, off, s[4:7], s53 sc1
  s_mov_b64 exec, -1
Lsg_78:
  v_mov_b64 v[136:137], 0
  v_mov_b64 v[138:139], 0
  v_mov_b64 v[140:141], 0
  v_mov_b64 v[142:143], 0
  v_mov_b64 v[144:145], 0
  v_mov_b64 v[146:147], 0
  v_mov_b64 v[148:149], 0
  v_mov_b64 v[150:151], 0
  v_mov_b64 v[152:153], 0
  v_mov_b64 v[154:155], 0
  v_mov_b64 v[156:157], 0
  v_mov_b64 v[158:159], 0
  v_mov_b64 v[160:161], 0
  v_mov_b64 v[162:163], 0
  v_mov_b64 v[164:165], 0
  v_mov_b64 v[166:167], 0
  s_mov_b32 s48, 64
  s_branch La1_67
La1_66:
  s_lshl_b32 s29, s20, 14
  s_lshl_b32 s30, s21, 12
  s_add_u32 s53, s29, s30
  s_add_u32 s53, s53, 30769152
  v_bfe_u32 v11, v0, 4, 1
  v_lshlrev_b32 v12, 11, v11
  v_lshl_add_u32 v14, v3, 10, v12
  v_and_b32 v13, 15, v0
  v_lshl_add_u32 v14, v13, 5, v14
  v_lshlrev_b32 v12, 2, v0
  v_add_u32 v12, 512, v12
  v_mov_b32 v15, 0x80000000
  v_cmp_eq_u32 vcc, 0, v3
  s_nop 1
  v_cndmask_b32 v12, v15, v12, vcc
  v_cmp_eq_u32 vcc, 1, v11
  s_nop 1
  v_cndmask_b32 v104, v136, v144, vcc
  v_cndmask_b32 v105, v137, v145, vcc
  v_cndmask_b32 v106, v138, v146, vcc
  v_cndmask_b32 v107, v139, v147, vcc
  v_cndmask_b32 v108, v140, v148, vcc
  v_cndmask_b32 v109, v141, v149, vcc
  v_cndmask_b32 v110, v142, v150, vcc
  v_cndmask_b32 v111, v143, v151, vcc
  s_lshl_b32 s29, s46, 16
  s_add_u32 s53, s53, s29
  s_lshl_b32 s29, s21, 11
  s_add_u32 s29, s29, 69632
  v_lshlrev_b32 v15, 5, v0
  v_add_u32 v15, s29, v15
  ds_write_b128 v15, v[104:107]
  ds_write_b128 v15, v[108:111] offset:16
  v_add_u32 v13, s29, v1
  s_waitcnt lgkmcnt(0)
  ds_read_b128 v[112:115], v13
  ds_read_b128 v[116:119], v13 offset:1024
  v_lshlrev_b32 v14, 4, v2
  v_lshl_add_u32 v14, v3, 11, v14
  s_waitcnt lgkmcnt(0)
  s_cmp_lg_u32 s46, 3
  s_cbranch_scc1 La1_66w
  buffer_store_dwordx4 v[112:115], v14, s[4:7], s53 offen
  buffer_store_dwordx4 v[116:119], v14, s[4:7], s53 offen offset:1024
  buffer_store_dword v152, v12, s[4:7], s53 offen
  s_waitcnt vmcnt(0)
  s_sleep 64
La1_66w:
  buffer_store_dwordx4 v[112:115], v14, s[4:7], s53 offen sc1
  buffer_store_dwordx4 v[116:119], v14, s[4:7], s53 offen offset:1024 sc1
  buffer_store_dword v152, v12, s[4:7], s53 offen sc1
  s_mov_b32 s53, 56576
  s_waitcnt vmcnt(0)
  v_mov_b32 v10, 1
  s_mov_b64 exec, 1
  buffer_atomic_add v10, off, s[4:7], s53 sc1
  s_mov_b64 exec, -1
  s_branch L_end
La1_53:
  s_and_b32 s53, s50, 7
  s_lshl_b32 s53, s53, 7
  s_add_u32 s53, s53, 37888
  s_cmp_lt_u32 s20, 2
  s_cselect_b32 s53, 56704, s53
  s_waitcnt vmcnt(0)
  s_barrier
  s_cmp_lg_u32 s21, 0
  s_cbranch_scc1 Lsg_80
  v_mov_b32 v10, 1
  s_mov_b64 exec, 1
  buffer_atomic_add v10, off, s[4:7], s53 sc1
  s_mov_b64 exec, -1
Lsg_80:
  s_branch L_end
L_after1:
  s_barrier
  s_mov_b32 s20, s75
  s_mov_b32 s46, 0
  s_cmp_eq_u32 s74, 3
  s_cbranch_scc1 L_qa
  s_cmp_lt_u32 s74, 3
  s_cbranch_scc1 L_kv
  s_mov_b32 s46, 1
  s_cmp_eq_u32 s74, 7
  s_cbranch_scc1 L_qa
  s_and_b32 s20, s75, 15
  s_lshr_b32 s46, s75, 4
  s_cmp_eq_u32 s74, 6
  s_cselect_b32 s46, 2, s46
  s_cmp_eq_u32 s74, 4
  s_cselect_b32 s46, 3, s46
  v_lshlrev_b32 v1, 4, v0
  v_and_b32 v2, 31, v0
  v_lshrrev_b32 v3, 5, v0
  v_bfe_u32 v4, v0, 2, 2
  s_mov_b32 s70, 0x358637bd
  s_mov_b32 s71, 0x358637bd
  s_mov_b32 s73, 0x3fb8aa3b
  s_mov_b32 s72, 0x3fb8aa3b
  s_mov_b32 s59, 0x3b000000
  s_mov_b32 s60, 0x3727c5ac
  s_load_dwordx2 s[8:9], s[0:1], 64
  s_waitcnt lgkmcnt(0)
  s_and_b32 s9, s9, 0xffff
  s_mov_b32 s10, 4194304
  s_mov_b32 s11, 0x20000
  s_lshl_b32 s57, s21, 20
  s_lshl_b32 s29, s20, 6
  s_add_u32 s57, s57, s29
  v_lshrrev_b32 v10, 2, v0
  s_mov_b32 s29, 1024
  v_mul_lo_u32 v10, v10, s29
  v_and_b32 v12, 3, v0
  v_lshl_add_u32 v10, v12, 4, v10
  v_lshl_add_u32 v13, v3, 2, v4
  v_mul_u32_u24 v13, 64, v13
  v_bfe_u32 v12, v0, 4, 1
  v_lshl_add_u32 v13, v12, 5, v13
  v_and_b32 v12, 3, v0
  v_lshl_add_u32 v13, v12, 3, v13
  s_mul_i32 s83, s21, 32768
  s_add_u32 s83, s83, 0
  v_add_u32 v13, s83, v13
  s_waitcnt lgkmcnt(0)
  s_add_u32 m0, s83, 0
  s_add_u32 s54, s57, 0
  buffer_load_dwordx4 v10, s[8:11], s54 offen lds
  s_add_u32 m0, s83, 1024
  s_add_u32 s54, s57, 16384
  buffer_load_dwordx4 v10, s[8:11], s54 offen lds
  s_add_u32 m0, s83, 2048
  s_add_u32 s54, s57, 32768
  buffer_load_dwordx4 v10, s[8:11], s54 offen lds
  s_add_u32 m0, s83, 3072
  s_add_u32 s54, s57, 49152
  buffer_load_dwordx4 v10, s[8:11], s54 offen lds
  s_add_u32 m0, s83, 4096
  s_add_u32 s54, s57, 65536
  buffer_load_dwordx4 v10, s[8:11], s54 offen lds
  s_add_u32 m0, s83, 5120
  s_add_u32 s54, s57, 81920
  buffer_load_dwordx4 v10, s[8:11], s54 offen lds
  s_add_u32 m0, s83, 6144
  s_add_u32 s54, s57, 98304
  buffer_load_dwordx4 v10, s[8:11], s54 offen lds
  s_add_u32 m0, s83, 7168
  s_add_u32 s54, s57, 114688
  buffer_load_dwordx4 v10, s[8:11], s54 offen lds
  s_add_u32 m0, s83, 8192
  s_add_u32 s54, s57, 131072
  buffer_load_dwordx4 v10, s[8:11], s54 offen lds
  s_add_u32 m0, s83, 9216
  s_add_u32 s54, s57, 147456
  buffer_load_dwordx4 v10, s[8:11], s54 offen lds
  s_add_u32 m0, s83, 10240
  s_add_u32 s54, s57, 163840
  buffer_load_dwordx4 v10, s[8:11], s54 offen lds
  s_add_u32 m0, s83, 11264
  s_add_u32 s54, s57, 180224
  buffer_load_dwordx4 v10, s[8:11], s54 offen lds
  s_add_u32 m0, s83, 12288
  s_add_u32 s54, s57, 196608
  buffer_load_dwordx4 v10, s[8:11], s54 offen lds
  s_add_u32 m0, s83, 13312
  s_add_u32 s54, s57, 212992
  buffer_load_dwordx4 v10, s[8:11], s54 offen lds
  s_add_u32 m0, s83, 14336
  s_add_u32 s54, s57, 229376
  buffer_load_dwordx4 v10, s[8:11], s54 offen lds
  s_add_u32 m0, s83, 15360
  s_add_u32 s54, s57, 245760
  buffer_load_dwordx4 v10, s[8:11], s54 offen lds
  s_add_u32 m0, s83, 16384
  s_add_u32 s54, s57, 262144
  buffer_load_dwordx4 v10, s[8:11], s54 offen lds
  s_add_u32 m0, s83, 17408
  s_add_u32 s54, s57, 278528
  buffer_load_dwordx4 v10, s[8:11], s54 offen lds
  s_add_u32 m0, s83, 18432
  s_add_u32 s54, s57, 294912
  buffer_load_dwordx4 v10, s[8:11], s54 offen lds
  s_add_u32 m0, s83, 19456
  s_add_u32 s54, s57, 311296
  buffer_load_dwordx4 v10, s[8:11], s54 offen lds
  s_add_u32 m0, s83, 20480
  s_add_u32 s54, s57, 327680
  buffer_load_dwordx4 v10, s[8:11], s54 offen lds
  s_add_u32 m0, s83, 21504
  s_add_u32 s54, s57, 344064
  buffer_load_dwordx4 v10, s[8:11], s54 offen lds
  s_add_u32 m0, s83, 22528
  s_add_u32 s54, s57, 360448
  buffer_load_dwordx4 v10, s[8:11], s54 offen lds
  s_add_u32 m0, s83, 23552
  s_add_u32 s54, s57, 376832
  buffer_load_dwordx4 v10, s[8:11], s54 offen lds
  s_add_u32 m0, s83, 24576
  s_add_u32 s54, s57, 393216
  buffer_load_dwordx4 v10, s[8:11], s54 offen lds
  s_add_u32 m0, s83, 25600
  s_add_u32 s54, s57, 409600
  buffer_load_dwordx4 v10, s[8:11], s54 offen lds
  s_add_u32 m0, s83, 26624
  s_add_u32 s54, s57, 425984
  buffer_load_dwordx4 v10, s[8:11], s54 offen lds
  s_add_u32 m0, s83, 27648
  s_add_u32 s54, s57, 442368
  buffer_load_dwordx4 v10, s[8:11], s54 offen lds
  s_add_u32 m0, s83, 28672
  s_add_u32 s54, s57, 458752
  buffer_load_dwordx4 v10, s[8:11], s54 offen lds
  s_add_u32 m0, s83, 29696
  s_add_u32 s54, s57, 475136
  buffer_load_dwordx4 v10, s[8:11], s54 offen lds
  s_add_u32 m0, s83, 30720
  s_add_u32 s54, s57, 491520
  buffer_load_dwordx4 v10, s[8:11], s54 offen lds
  s_add_u32 m0, s83, 31744
  s_add_u32 s54, s57, 507904
  buffer_load_dwordx4 v10, s[8:11], s54 offen lds
  s_waitcnt vmcnt(24)
  ds_read_b64_tr_b16 a[0:1], v13 offset:0
  ds_read_b64_tr_b16 a[2:3], v13 offset:512
  ds_read_b64_tr_b16 a[4:5], v13 offset:1024
  ds_read_b64_tr_b16 a[6:7], v13 offset:1536
  ds_read_b64_tr_b16 a[8:9], v13 offset:2048
  ds_read_b64_tr_b16 a[10:11], v13 offset:2560
  ds_read_b64_tr_b16 a[12:13], v13 offset:3072
  ds_read_b64_tr_b16 a[14:15], v13 offset:3584
  ds_read_b64_tr_b16 a[16:17], v13 offset:4096
  ds_read_b64_tr_b16 a[18:19], v13 offset:4608
  ds_read_b64_tr_b16 a[20:21], v13 offset:5120
  ds_read_b64_tr_b16 a[22:23], v13 offset:5632
  ds_read_b64_tr_b16 a[24:25], v13 offset:6144
  ds_read_b64_tr_b16 a[26:27], v13 offset:6656
  ds_read_b64_tr_b16 a[28:29], v13 offset:7168
  ds_read_b64_tr_b16 a[30:31], v13 offset:7680
  s_waitcnt lgkmcnt(0)
  s_add_u32 m0, s83, 0
  s_add_u32 s54, s57, 524288
  buffer_load_dwordx4 v10, s[8:11], s54 offen lds
  s_add_u32 m0, s83, 1024
  s_add_u32 s54, s57, 540672
  buffer_load_dwordx4 v10, s[8:11], s54 offen lds
  s_add_u32 m0, s83, 2048
  s_add_u32 s54, s57, 557056
  buffer_load_dwordx4 v10, s[8:11], s54 offen lds
  s_add_u32 m0, s83, 3072
  s_add_u32 s54, s57, 573440
  buffer_load_dwordx4 v10, s[8:11], s54 offen lds
  s_add_u32 m0, s83, 4096
  s_add_u32 s54, s57, 589824
  buffer_load_dwordx4 v10, s[8:11], s54 offen lds
  s_add_u32 m0, s83, 5120
  s_add_u32 s54, s57, 606208
  buffer_load_dwordx4 v10, s[8:11], s54 offen lds
  s_add_u32 m0, s83, 6144
  s_add_u32 s54, s57, 622592
  buffer_load_dwordx4 v10, s[8:11], s54 offen lds
  s_add_u32 m0, s83, 7168
  s_add_u32 s54, s57, 638976
  buffer_load_dwordx4 v10, s[8:11], s54 offen lds
  s_waitcnt vmcnt(24)
  ds_read_b64_tr_b16 a[32:33], v13 offset:8192
  ds_read_b64_tr_b16 a[34:35], v13 offset:8704
  ds_read_b64_tr_b16 a[36:37], v13 offset:9216
  ds_read_b64_tr_b16 a[38:39], v13 offset:9728
  ds_read_b64_tr_b16 a[40:41], v13 offset:10240
  ds_read_b64_tr_b16 a[42:43], v13 offset:10752
  ds_read_b64_tr_b16 a[44:45], v13 offset:11264
  ds_read_b64_tr_b16 a[46:47], v13 offset:11776
  ds_read_b64_tr_b16 a[48:49], v13 offset:12288
  ds_read_b64_tr_b16 a[50:51], v13 offset:12800
  ds_read_b64_tr_b16 a[52:53], v13 offset:13312
  ds_read_b64_tr_b16 a[54:55], v13 offset:13824
  ds_read_b64_tr_b16 a[56:57], v13 offset:14336
  ds_read_b64_tr_b16 a[58:59], v13 offset:14848
  ds_read_b64_tr_b16 a[60:61], v13 offset:15360
  ds_read_b64_tr_b16 a[62:63], v13 offset:15872
  s_waitcnt lgkmcnt(0)
  s_add_u32 m0, s83, 8192
  s_add_u32 s54, s57, 655360
  buffer_load_dwordx4 v10, s[8:11], s54 offen lds
  s_add_u32 m0, s83, 9216
  s_add_u32 s54, s57, 671744
  buffer_load_dwordx4 v10, s[8:11], s54 offen lds
  s_add_u32 m0, s83, 10240
  s_add_u32 s54, s57, 688128
  buffer_load_dwordx4 v10, s[8:11], s54 offen lds
  s_add_u32 m0, s83, 11264
  s_add_u32 s54, s57, 704512
  buffer_load_dwordx4 v10, s[8:11], s54 offen lds
  s_add_u32 m0, s83, 12288
  s_add_u32 s54, s57, 720896
  buffer_load_dwordx4 v10, s[8:11], s54 offen lds
  s_add_u32 m0, s83, 13312
  s_add_u32 s54, s57, 737280
  buffer_load_dwordx4 v10, s[8:11], s54 offen lds
  s_add_u32 m0, s83, 14336
  s_add_u32 s54, s57, 753664
  buffer_load_dwordx4 v10, s[8:11], s54 offen lds
  s_add_u32 m0, s83, 15360
  s_add_u32 s54, s57, 770048
  buffer_load_dwordx4 v10, s[8:11], s54 offen lds
  s_waitcnt vmcnt(24)
  ds_read_b64_tr_b16 a[64:65], v13 offset:16384
  ds_read_b64_tr_b16 a[66:67], v13 offset:16896
  ds_read_b64_tr_b16 a[68:69], v13 offset:17408
  ds_read_b64_tr_b16 a[70:71], v13 offset:17920
  ds_read_b64_tr_b16 a[72:73], v13 offset:18432
  ds_read_b64_tr_b16 a[74:75], v13 offset:18944
  ds_read_b64_tr_b16 a[76:77], v13 offset:19456
  ds_read_b64_tr_b16 a[78:79], v13 offset:19968
  ds_read_b64_tr_b16 a[80:81], v13 offset:20480
  ds_read_b64_tr_b16 a[82:83], v13 offset:20992
  ds_read_b64_tr_b16 a[84:85], v13 offset:21504
  ds_read_b64_tr_b16 a[86:87], v13 offset:22016
  ds_read_b64_tr_b16 a[88:89], v13 offset:22528
  ds_read_b64_tr_b16 a[90:91], v13 offset:23040
  ds_read_b64_tr_b16 a[92:93], v13 offset:23552
  ds_read_b64_tr_b16 a[94:95], v13 offset:24064
  s_waitcnt lgkmcnt(0)
  s_add_u32 m0, s83, 16384
  s_add_u32 s54, s57, 786432
  buffer_load_dwordx4 v10, s[8:11], s54 offen lds
  s_add_u32 m0, s83, 17408
  s_add_u32 s54, s57, 802816
  buffer_load_dwordx4 v10, s[8:11], s54 offen lds
  s_add_u32 m0, s83, 18432
  s_add_u32 s54, s57, 819200
  buffer_load_dwordx4 v10, s[8:11], s54 offen lds
  s_add_u32 m0, s83, 19456
  s_add_u32 s54, s57, 835584
  buffer_load_dwordx4 v10, s[8:11], s54 offen lds
  s_add_u32 m0, s83, 20480
  s_add_u32 s54, s57, 851968
  buffer_load_dwordx4 v10, s[8:11], s54 offen lds
  s_add_u32 m0, s83, 21504
  s_add_u32 s54, s57, 868352
  buffer_load_dwordx4 v10, s[8:11], s54 offen lds
  s_add_u32 m0, s83, 22528
  s_add_u32 s54, s57, 884736
  buffer_load_dwordx4 v10, s[8:11], s54 offen lds
  s_add_u32 m0, s83, 23552
  s_add_u32 s54, s57, 901120
  buffer_load_dwordx4 v10, s[8:11], s54 offen lds
  s_waitcnt vmcnt(24)
  ds_read_b64_tr_b16 a[96:97], v13 offset:24576
  ds_read_b64_tr_b16 a[98:99], v13 offset:25088
  ds_read_b64_tr_b16 a[100:101], v13 offset:25600
  ds_read_b64_tr_b16 a[102:103], v13 offset:26112
  ds_read_b64_tr_b16 a[104:105], v13 offset:26624
  ds_read_b64_tr_b16 a[106:107], v13 offset:27136
  ds_read_b64_tr_b16 a[108:109], v13 offset:27648
  ds_read_b64_tr_b16 a[110:111], v13 offset:28160
  ds_read_b64_tr_b16 a[112:113], v13 offset:28672
  ds_read_b64_tr_b16 a[114:115], v13 offset:29184
  ds_read_b64_tr_b16 a[116:117], v13 offset:29696
  ds_read_b64_tr_b16 a[118:119], v13 offset:30208
  ds_read_b64_tr_b16 a[120:121], v13 offset:30720
  ds_read_b64_tr_b16 a[122:123], v13 offset:31232
  ds_read_b64_tr_b16 a[124:125], v13 offset:31744
  ds_read_b64_tr_b16 a[126:127], v13 offset:32256
  s_waitcnt lgkmcnt(0)
  s_add_u32 m0, s83, 24576
  s_add_u32 s54, s57, 917504
  buffer_load_dwordx4 v10, s[8:11], s54 offen lds
  s_add_u32 m0, s83, 25600
  s_add_u32 s54, s57, 933888
  buffer_load_dwordx4 v10, s[8:11], s54 offen lds
  s_add_u32 m0, s83, 26624
  s_add_u32 s54, s57, 950272
  buffer_load_dwordx4 v10, s[8:11], s54 offen lds
  s_add_u32 m0, s83, 27648
  s_add_u32 s54, s57, 966656
  buffer_load_dwordx4 v10, s[8:11], s54 offen lds
  s_add_u32 m0, s83, 28672
  s_add_u32 s54, s57, 983040
  buffer_load_dwordx4 v10, s[8:11], s54 offen lds
  s_add_u32 m0, s83, 29696
  s_add_u32 s54, s57, 999424
  buffer_load_dwordx4 v10, s[8:11], s54 offen lds
  s_add_u32 m0, s83, 30720
  s_add_u32 s54, s57, 1015808
  buffer_load_dwordx4 v10, s[8:11], s54 offen lds
  s_add_u32 m0, s83, 31744
  s_add_u32 s54, s57, 1032192
  buffer_load_dwordx4 v10, s[8:11], s54 offen lds
  s_waitcnt vmcnt(24)
  ds_read_b64_tr_b16 a[128:129], v13 offset:0
  ds_read_b64_tr_b16 a[130:131], v13 offset:512
  ds_read_b64_tr_b16 a[132:133], v13 offset:1024
  ds_read_b64_tr_b16 a[134:135], v13 offset:1536
  ds_read_b64_tr_b16 a[136:137], v13 offset:2048
  ds_read_b64_tr_b16 a[138:139], v13 offset:2560
  ds_read_b64_tr_b16 a[140:141], v13 offset:3072
  ds_read_b64_tr_b16 a[142:143], v13 offset:3584
  ds_read_b64_tr_b16 a[144:145], v13 offset:4096
  ds_read_b64_tr_b16 a[146:147], v13 offset:4608
  ds_read_b64_tr_b16 a[148:149], v13 offset:5120
  ds_read_b64_tr_b16 a[150:151], v13 offset:5632
  ds_read_b64_tr_b16 a[152:153], v13 offset:6144
  ds_read_b64_tr_b16 a[154:155], v13 offset:6656
  ds_read_b64_tr_b16 a[156:157], v13 offset:7168
  ds_read_b64_tr_b16 a[158:159], v13 offset:7680
  s_waitcnt lgkmcnt(0)
  s_waitcnt vmcnt(16)
  ds_read_b64_tr_b16 a[160:161], v13 offset:8192
  ds_read_b64_tr_b16 a[162:163], v13 offset:8704
  ds_read_b64_tr_b16 a[164:165], v13 offset:9216
  ds_read_b64_tr_b16 a[166:167], v13 offset:9728
  ds_read_b64_tr_b16 a[168:169], v13 offset:10240
  ds_read_b64_tr_b16 a[170:171], v13 offset:10752
  ds_read_b64_tr_b16 a[172:173], v13 offset:11264
  ds_read_b64_tr_b16 a[174:175], v13 offset:11776
  ds_read_b64_tr_b16 a[176:177], v13 offset:12288
  ds_read_b64_tr_b16 a[178:179], v13 offset:12800
  ds_read_b64_tr_b16 a[180:181], v13 offset:13312
  ds_read_b64_tr_b16 a[182:183], v13 offset:13824
  ds_read_b64_tr_b16 a[184:185], v13 offset:14336
  ds_read_b64_tr_b16 a[186:187], v13 offset:14848
  ds_read_b64_tr_b16 a[188:189], v13 offset:15360
  ds_read_b64_tr_b16 a[190:191], v13 offset:15872
  s_waitcnt lgkmcnt(0)
  s_waitcnt vmcnt(8)
  ds_read_b64_tr_b16 a[192:193], v13 offset:16384
  ds_read_b64_tr_b16 a[194:195], v13 offset:16896
  ds_read_b64_tr_b16 a[196:197], v13 offset:17408
  ds_read_b64_tr_b16 a[198:199], v13 offset:17920
  ds_read_b64_tr_b16 a[200:201], v13 offset:18432
  ds_read_b64_tr_b16 a[202:203], v13 offset:18944
  ds_read_b64_tr_b16 a[204:205], v13 offset:19456
  ds_read_b64_tr_b16 a[206:207], v13 offset:19968
  ds_read_b64_tr_b16 a[208:209], v13 offset:20480
  ds_read_b64_tr_b16 a[210:211], v13 offset:20992
  ds_read_b64_tr_b16 a[212:213], v13 offset:21504
  ds_read_b64_tr_b16 a[214:215], v13 offset:22016
  ds_read_b64_tr_b16 a[216:217], v13 offset:22528
  ds_read_b64_tr_b16 a[218:219], v13 offset:23040
  ds_read_b64_tr_b16 a[220:221], v13 offset:23552
  ds_read_b64_tr_b16 a[222:223], v13 offset:24064
  s_waitcnt lgkmcnt(0)
  s_waitcnt vmcnt(0)
  ds_read_b64_tr_b16 a[224:225], v13 offset:24576
  ds_read_b64_tr_b16 a[226:227], v13 offset:25088
  ds_read_b64_tr_b16 a[228:229], v13 offset:25600
  ds_read_b64_tr_b16 a[230:231], v13 offset:26112
  ds_read_b64_tr_b16 a[232:233], v13 offset:26624
  ds_read_b64_tr_b16 a[234:235], v13 offset:27136
  ds_read_b64_tr_b16 a[236:237], v13 offset:27648
  ds_read_b64_tr_b16 a[238:239], v13 offset:28160
  ds_read_b64_tr_b16 a[240:241], v13 offset:28672
  ds_read_b64_tr_b16 a[242:243], v13 offset:29184
  ds_read_b64_tr_b16 a[244:245], v13 offset:29696
  ds_read_b64_tr_b16 a[246:247], v13 offset:30208
  ds_read_b64_tr_b16 a[248:249], v13 offset:30720
  ds_read_b64_tr_b16 a[250:251], v13 offset:31232
  ds_read_b64_tr_b16 a[252:253], v13 offset:31744
  ds_read_b64_tr_b16 a[254:255], v13 offset:32256
  s_waitcnt lgkmcnt(0)
  s_mov_b32 s12, s92
  s_and_b32 s13, s93, 0xffff
  s_mov_b32 s14, 256
  s_mov_b32 s15, 0x20000
  s_mov_b32 s26, 0
Lwi_81:
  buffer_load_dword v10, off, s[12:15], 0 offset:12 sc1
  s_waitcnt vmcnt(0)
  v_readfirstlane_b32 s29, v10
  s_nop 0
  s_cmp_ge_u32 s29, 4
  s_nop 1
  s_cbranch_scc1 Lwi_82
  s_sleep 2
  s_add_u32 s26, s26, 1
  s_cmp_lt_u32 s26, 0x40000
  s_cbranch_scc1 Lwi_81
  s_branch L_end
Lwi_82:
  s_load_dwordx2 s[12:13], s[0:1], 80
  s_waitcnt lgkmcnt(0)
  s_and_b32 s13, s13, 0xffff
  s_mov_b32 s14, 2097152
  s_mov_b32 s15, 0x20000
  s_barrier
  s_lshl_b32 s29, s21, 16
  v_add_u32 v5, s29, v1
  s_lshl_b32 s29, s21, 12
  v_add_u32 v6, s29, v1
  s_lshl_b32 s29, s21, 11
  v_add_u32 v7, s29, v1
  s_lshl_b32 s29, s20, 11
  s_lshl_b32 s30, s21, 10
  s_add_u32 s29, s29, s30
  v_add_u32 v8, s29, v1
  s_lshl_b32 s29, s20, 6
  s_lshl_b32 s30, s21, 5
  s_add_u32 s29, s29, s30
  v_lshlrev_b32 v9, 10, v2
  v_lshl_add_u32 v9, v3, 4, v9
  v_add_u32 v9, s29, v9
  s_lshl_b32 s53, s46, 15
  s_add_u32 s53, s53, 23986176
  s_cmp_ge_u32 s21, 2
  s_cbranch_scc1 Lnp_83
  v_mov_b32 v20, -1
  v_mov_b32 v21, -1
  v_mov_b32 v22, -1
  v_mov_b32 v23, -1
  buffer_store_dwordx4 v[20:23], v8, s[4:7], s53 offen sc1
  s_nop 1
Lnp_83:
  v_and_b32 v48, 7, v0
  v_lshlrev_b32 v48, 13, v48
  s_lshl_b32 s29, s21, 16
  s_add_u32 s29, s29, 7168
  v_add_u32 v48, s29, v48
  s_mov_b32 s47, s46
  s_nop 0
Lwo_84:
  s_cmp_ge_u32 s47, 128
  s_cbranch_scc1 Lwo_85
  s_lshl_b32 s54, s20, 14
  s_lshl_b32 s29, s21, 12
  s_add_u32 s54, s54, s29
  s_lshl_b32 s29, s47, 18
  s_add_u32 s54, s54, s29
  s_add_u32 s54, s54, 100663296
  v_lshlrev_b32 v14, 7, v2
  s_lshl_b32 s53, s47, 7
  s_add_u32 s53, s53, 12288
  s_mov_b32 s52, 32
  s_mov_b32 s67, s54
  s_mov_b32 s69, 0
  s_and_b32 s29, s47, 63
  s_cmp_lt_u32 s29, 60
  s_cbranch_scc1 Lwo_89
  s_mov_b32 s58, 0
Lwo_88:
  s_mov_b32 s69, 1
  s_lshl_b32 s66, s47, 18
  s_add_u32 s66, s66, 100663296
  buffer_load_dword v10, v48, s[4:7], s66 offen sc1
  s_waitcnt vmcnt(0)
  v_cmp_eq_u32 vcc, -1, v10
  s_cbranch_vccz Lwo_90
  s_add_u32 s58, s58, 1
  s_cmp_lt_u32 s58, 4096
  s_cbranch_scc1 Lwo_88
  s_mov_b32 s69, 0
  s_lshl_b32 s53, s47, 7
  s_add_u32 s53, s53, 12288
  s_mov_b32 s54, s67
Lwo_89:
  s_mov_b32 s26, 0
Lwf_91:
  buffer_load_dword v10, off, s[4:7], s53 sc1
  buffer_load_dword v15, v14, s[4:7], s54 offen sc1
  s_waitcnt vmcnt(1)
  v_readfirstlane_b32 s29, v10
  s_nop 0
  s_cmp_ge_u32 s29, s52
  s_nop 1
  s_cbranch_scc1 Lwf_92
  s_sleep 0
  s_add_u32 s26, s26, 1
  s_cmp_lt_u32 s26, 0x100000
  s_cbranch_scc1 Lwf_91
  s_branch L_end
Lwf_92:
Lwo_90:
  v_mov_b32 v11, 0
  s_lshr_b32 s68, s47, 2
  s_lshl_b32 s57, s47, 15
  s_cmp_ge_u32 s47, 64
  s_cselect_b32 s29, 2097152, 0
  s_add_u32 s57, s57, s29
  s_add_u32 s57, s57, 19922944
  buffer_load_dwordx4 v[52:55], v8, s[4:7], s57 offen sc1
  s_lshl_b32 s53, s47, 18
  s_add_u32 s53, s53, 100663296
  buffer_load_dword v15, v14, s[4:7], s67 offen sc1
  s_add_u32 s54, s53, 0
  buffer_load_dwordx4 v[64:67], v5, s[4:7], s54 offen offset:0 sc1
  buffer_load_dwordx4 v[68:71], v5, s[4:7], s54 offen offset:1024 sc1
  buffer_load_dwordx4 v[72:75], v5, s[4:7], s54 offen offset:2048 sc1
  buffer_load_dwordx4 v[76:79], v5, s[4:7], s54 offen offset:3072 sc1
  s_add_u32 s54, s53, 4096
  buffer_load_dwordx4 v[80:83], v5, s[4:7], s54 offen offset:0 sc1
  buffer_load_dwordx4 v[84:87], v5, s[4:7], s54 offen offset:1024 sc1
  buffer_load_dwordx4 v[88:91], v5, s[4:7], s54 offen offset:2048 sc1
  buffer_load_dwordx4 v[92:95], v5, s[4:7], s54 offen offset:3072 sc1
  s_add_u32 s54, s53, 8192
  buffer_load_dwordx4 v[96:99], v5, s[4:7], s54 offen offset:0 sc1
  buffer_load_dwordx4 v[100:103], v5, s[4:7], s54 offen offset:1024 sc1
  buffer_load_dwordx4 v[104:107], v5, s[4:7], s54 offen offset:2048 sc1
  buffer_load_dwordx4 v[108:111], v5, s[4:7], s54 offen offset:3072 sc1
  s_add_u32 s54, s53, 12288
  buffer_load_dwordx4 v[112:115], v5, s[4:7], s54 offen offset:0 sc1
  buffer_load_dwordx4 v[116:119], v5, s[4:7], s54 offen offset:1024 sc1
  buffer_load_dwordx4 v[120:123], v5, s[4:7], s54 offen offset:2048 sc1
  buffer_load_dwordx4 v[124:127], v5, s[4:7], s54 offen offset:3072 sc1
  s_add_u32 s54, s53, 16384
  buffer_load_dwordx4 v[128:131], v5, s[4:7], s54 offen offset:0 sc1
  buffer_load_dwordx4 v[132:135], v5, s[4:7], s54 offen offset:1024 sc1
  buffer_load_dwordx4 v[136:139], v5, s[4:7], s54 offen offset:2048 sc1
  buffer_load_dwordx4 v[140:143], v5, s[4:7], s54 offen offset:3072 sc1
  s_add_u32 s54, s53, 20480
  buffer_load_dwordx4 v[144:147], v5, s[4:7], s54 offen offset:0 sc1
  buffer_load_dwordx4 v[148:151], v5, s[4:7], s54 offen offset:1024 sc1
  buffer_load_dwordx4 v[152:155], v5, s[4:7], s54 offen offset:2048 sc1
  buffer_load_dwordx4 v[156:159], v5, s[4:7], s54 offen offset:3072 sc1
  s_add_u32 s54, s53, 24576
  buffer_load_dwordx4 v[160:163], v5, s[4:7], s54 offen offset:0 sc1
  buffer_load_dwordx4 v[164:167], v5, s[4:7], s54 offen offset:1024 sc1
  buffer_load_dwordx4 v[168:171], v5, s[4:7], s54 offen offset:2048 sc1
  buffer_load_dwordx4 v[172:175], v5, s[4:7], s54 offen offset:3072 sc1
  s_add_u32 s54, s53, 28672
  buffer_load_dwordx4 v[176:179], v5, s[4:7], s54 offen offset:0 sc1
  buffer_load_dwordx4 v[180:183], v5, s[4:7], s54 offen offset:1024 sc1
  buffer_load_dwordx4 v[184:187], v5, s[4:7], s54 offen offset:2048 sc1
  buffer_load_dwordx4 v[188:191], v5, s[4:7], s54 offen offset:3072 sc1
  s_add_u32 s54, s53, 32768
  buffer_load_dwordx4 v[192:195], v5, s[4:7], s54 offen offset:0 sc1
  buffer_load_dwordx4 v[196:199], v5, s[4:7], s54 offen offset:1024 sc1
  buffer_load_dwordx4 v[200:203], v5, s[4:7], s54 offen offset:2048 sc1
  buffer_load_dwordx4 v[204:207], v5, s[4:7], s54 offen offset:3072 sc1
  s_add_u32 s54, s53, 36864
  buffer_load_dwordx4 v[208:211], v5, s[4:7], s54 offen offset:0 sc1
  buffer_load_dwordx4 v[212:215], v5, s[4:7], s54 offen offset:1024 sc1
  buffer_load_dwordx4 v[216:219], v5, s[4:7], s54 offen offset:2048 sc1
  buffer_load_dwordx4 v[220:223], v5, s[4:7], s54 offen offset:3072 sc1
  s_add_u32 s54, s53, 40960
  buffer_load_dwordx4 v[224:227], v5, s[4:7], s54 offen offset:0 sc1
  buffer_load_dwordx4 v[228:231], v5, s[4:7], s54 offen offset:1024 sc1
  buffer_load_dwordx4 v[232:235], v5, s[4:7], s54 offen offset:2048 sc1
  buffer_load_dwordx4 v[236:239], v5, s[4:7], s54 offen offset:3072 sc1
  s_add_u32 s54, s53, 45056
  buffer_load_dwordx4 v[240:243], v5, s[4:7], s54 offen offset:0 sc1
  buffer_load_dwordx4 v[244:247], v5, s[4:7], s54 offen offset:1024 sc1
  buffer_load_dwordx4 v[248:251], v5, s[4:7], s54 offen offset:2048 sc1
  buffer_load_dwordx4 v[252:255], v5, s[4:7], s54 offen offset:3072 sc1
  s_waitcnt vmcnt(47)
  v_mfma_f32_32x32x16_bf16 v[16:31], a[0:3], v[64:67], 0
  v_max_u32 v11, v11, v64
  s_add_u32 s54, s53, 49152
  buffer_load_dwordx4 v[64:67], v5, s[4:7], s54 offen offset:0 sc1
  s_waitcnt vmcnt(47)
  v_mfma_f32_32x32x16_bf16 v[32:47], a[4:7], v[68:71], 0
  v_max_u32 v11, v11, v68
  buffer_load_dwordx4 v[68:71], v5, s[4:7], s54 offen offset:1024 sc1
  s_waitcnt vmcnt(47)
  v_mfma_f32_32x32x16_bf16 v[16:31], a[8:11], v[72:75], v[16:31]
  v_max_u32 v11, v11, v72
  buffer_load_dwordx4 v[72:75], v5, s[4:7], s54 offen offset:2048 sc1
  s_waitcnt vmcnt(47)
  v_mfma_f32_32x32x16_bf16 v[32:47], a[12:15], v[76:79], v[32:47]
  v_max_u32 v11, v11, v76
  buffer_load_dwordx4 v[76:79], v5, s[4:7], s54 offen offset:3072 sc1
  s_waitcnt vmcnt(47)
  v_mfma_f32_32x32x16_bf16 v[16:31], a[16:19], v[80:83], v[16:31]
  v_max_u32 v11, v11, v80
  s_add_u32 s54, s53, 53248
  buffer_load_dwordx4 v[80:83], v5, s[4:7], s54 offen offset:0 sc1
  s_waitcnt vmcnt(47)
  v_mfma_f32_32x32x16_bf16 v[32:47], a[20:23], v[84:87], v[32:47]
  v_max_u32 v11, v11, v84
  buffer_load_dwordx4 v[84:87], v5, s[4:7], s54 offen offset:1024 sc1
  s_waitcnt vmcnt(47)
  v_mfma_f32_32x32x16_bf16 v[16:31], a[24:27], v[88:91], v[16:31]
  v_max_u32 v11, v11, v88
  buffer_load_dwordx4 v[88:91], v5, s[4:7], s54 offen offset:2048 sc1
  s_waitcnt vmcnt(47)
  v_mfma_f32_32x32x16_bf16 v[32:47], a[28:31], v[92:95], v[32:47]
  v_max_u32 v11, v11, v92
  buffer_load_dwordx4 v[92:95], v5, s[4:7], s54 offen offset:3072 sc1
  s_waitcnt vmcnt(47)
  v_mfma_f32_32x32x16_bf16 v[16:31], a[32:35], v[96:99], v[16:31]
  v_max_u32 v11, v11, v96
  s_add_u32 s54, s53, 57344
  buffer_load_dwordx4 v[96:99], v5, s[4:7], s54 offen offset:0 sc1
  s_waitcnt vmcnt(47)
  v_mfma_f32_32x32x16_bf16 v[32:47], a[36:39], v[100:103], v[32:47]
  v_max_u32 v11, v11, v100
  buffer_load_dwordx4 v[100:103], v5, s[4:7], s54 offen offset:1024 sc1
  s_waitcnt vmcnt(47)
  v_mfma_f32_32x32x16_bf16 v[16:31], a[40:43], v[104:107], v[16:31]
  v_max_u32 v11, v11, v104
  buffer_load_dwordx4 v[104:107], v5, s[4:7], s54 offen offset:2048 sc1
  s_waitcnt vmcnt(47)
  v_mfma_f32_32x32x16_bf16 v[32:47], a[44:47], v[108:111], v[32:47]
  v_max_u32 v11, v11, v108
  buffer_load_dwordx4 v[108:111], v5, s[4:7], s54 offen offset:3072 sc1
  s_waitcnt vmcnt(47)
  v_mfma_f32_32x32x16_bf16 v[16:31], a[48:51], v[112:115], v[16:31]
  v_max_u32 v11, v11, v112
  s_add_u32 s54, s53, 61440
  buffer_load_dwordx4 v[112:115], v5, s[4:7], s54 offen offset:0 sc1
  s_waitcnt vmcnt(47)
  v_mfma_f32_32x32x16_bf16 v[32:47], a[52:55], v[116:119], v[32:47]
  v_max_u32 v11, v11, v116
  buffer_load_dwordx4 v[116:119], v5, s[4:7], s54 offen offset:1024 sc1
  s_waitcnt vmcnt(47)
  v_mfma_f32_32x32x16_bf16 v[16:31], a[56:59], v[120:123], v[16:31]
  v_max_u32 v11, v11, v120
  buffer_load_dwordx4 v[120:123], v5, s[4:7], s54 offen offset:2048 sc1
  s_waitcnt vmcnt(47)
  v_mfma_f32_32x32x16_bf16 v[32:47], a[60:63], v[124:127], v[32:47]
  v_max_u32 v11, v11, v124
  buffer_load_dwordx4 v[124:127], v5, s[4:7], s54 offen offset:3072 sc1
  s_waitcnt vmcnt(47)
  v_mfma_f32_32x32x16_bf16 v[16:31], a[64:67], v[128:131], v[16:31]
  v_max_u32 v11, v11, v128
  s_waitcnt vmcnt(46)
  v_mfma_f32_32x32x16_bf16 v[32:47], a[68:71], v[132:135], v[32:47]
  v_max_u32 v11, v11, v132
  s_waitcnt vmcnt(45)
  v_mfma_f32_32x32x16_bf16 v[16:31], a[72:75], v[136:139], v[16:31]
  v_max_u32 v11, v11, v136
  s_waitcnt vmcnt(44)
  v_mfma_f32_32x32x16_bf16 v[32:47], a[76:79], v[140:143], v[32:47]
  v_max_u32 v11, v11, v140
  s_waitcnt vmcnt(43)
  v_mfma_f32_32x32x16_bf16 v[16:31], a[80:83], v[144:147], v[16:31]
  v_max_u32 v11, v11, v144
  s_waitcnt vmcnt(42)
  v_mfma_f32_32x32x16_bf16 v[32:47], a[84:87], v[148:151], v[32:47]
  v_max_u32 v11, v11, v148
  s_waitcnt vmcnt(41)
  v_mfma_f32_32x32x16_bf16 v[16:31], a[88:91], v[152:155], v[16:31]
  v_max_u32 v11, v11, v152
  s_waitcnt vmcnt(40)
  v_mfma_f32_32x32x16_bf16 v[32:47], a[92:95], v[156:159], v[32:47]
  v_max_u32 v11, v11, v156
  s_waitcnt vmcnt(39)
  v_mfma_f32_32x32x16_bf16 v[16:31], a[96:99], v[160:163], v[16:31]
  v_max_u32 v11, v11, v160
  s_waitcnt vmcnt(38)
  v_mfma_f32_32x32x16_bf16 v[32:47], a[100:103], v[164:167], v[32:47]
  v_max_u32 v11, v11, v164
  s_waitcnt vmcnt(37)
  v_mfma_f32_32x32x16_bf16 v[16:31], a[104:107], v[168:171], v[16:31]
  v_max_u32 v11, v11, v168
  s_waitcnt vmcnt(36)
  v_mfma_f32_32x32x16_bf16 v[32:47], a[108:111], v[172:175], v[32:47]
  v_max_u32 v11, v11, v172
  s_waitcnt vmcnt(35)
  v_mfma_f32_32x32x16_bf16 v[16:31], a[112:115], v[176:179], v[16:31]
  v_max_u32 v11, v11, v176
  s_waitcnt vmcnt(34)
  v_mfma_f32_32x32x16_bf16 v[32:47], a[116:119], v[180:183], v[32:47]
  v_max_u32 v11, v11, v180
  s_waitcnt vmcnt(33)
  v_mfma_f32_32x32x16_bf16 v[16:31], a[120:123], v[184:187], v[16:31]
  v_max_u32 v11, v11, v184
  s_waitcnt vmcnt(32)
  v_mfma_f32_32x32x16_bf16 v[32:47], a[124:127], v[188:191], v[32:47]
  v_max_u32 v11, v11, v188
  s_waitcnt vmcnt(31)
  v_mfma_f32_32x32x16_bf16 v[16:31], a[128:131], v[192:195], v[16:31]
  v_max_u32 v11, v11, v192
  s_waitcnt vmcnt(30)
  v_mfma_f32_32x32x16_bf16 v[32:47], a[132:135], v[196:199], v[32:47]
  v_max_u32 v11, v11, v196
  s_waitcnt vmcnt(29)
  v_mfma_f32_32x32x16_bf16 v[16:31], a[136:139], v[200:203], v[16:31]
  v_max_u32 v11, v11, v200
  s_waitcnt vmcnt(28)
  v_mfma_f32_32x32x16_bf16 v[32:47], a[140:143], v[204:207], v[32:47]
  v_max_u32 v11, v11, v204
  s_waitcnt vmcnt(27)
  v_mfma_f32_32x32x16_bf16 v[16:31], a[144:147], v[208:211], v[16:31]
  v_max_u32 v11, v11, v208
  s_waitcnt vmcnt(26)
  v_mfma_f32_32x32x16_bf16 v[32:47], a[148:151], v[212:215], v[32:47]
  v_max_u32 v11, v11, v212
  s_waitcnt vmcnt(25)
  v_mfma_f32_32x32x16_bf16 v[16:31], a[152:155], v[216:219], v[16:31]
  v_max_u32 v11, v11, v216
  s_waitcnt vmcnt(24)
  v_mfma_f32_32x32x16_bf16 v[32:47], a[156:159], v[220:223], v[32:47]
  v_max_u32 v11, v11, v220
  s_waitcnt vmcnt(23)
  v_mfma_f32_32x32x16_bf16 v[16:31], a[160:163], v[224:227], v[16:31]
  v_max_u32 v11, v11, v224
  s_waitcnt vmcnt(22)
  v_mfma_f32_32x32x16_bf16 v[32:47], a[164:167], v[228:231], v[32:47]
  v_max_u32 v11, v11, v228
  s_waitcnt vmcnt(21)
  v_mfma_f32_32x32x16_bf16 v[16:31], a[168:171], v[232:235], v[16:31]
  v_max_u32 v11, v11, v232
  s_waitcnt vmcnt(20)
  v_mfma_f32_32x32x16_bf16 v[32:47], a[172:175], v[236:239], v[32:47]
  v_max_u32 v11, v11, v236
  s_waitcnt vmcnt(19)
  v_mfma_f32_32x32x16_bf16 v[16:31], a[176:179], v[240:243], v[16:31]
  v_max_u32 v11, v11, v240
  s_waitcnt vmcnt(18)
  v_mfma_f32_32x32x16_bf16 v[32:47], a[180:183], v[244:247], v[32:47]
  v_max_u32 v11, v11, v244
  s_waitcnt vmcnt(17)
  v_mfma_f32_32x32x16_bf16 v[16:31], a[184:187], v[248:251], v[16:31]
  v_max_u32 v11, v11, v248
  s_waitcnt vmcnt(16)
  v_mfma_f32_32x32x16_bf16 v[32:47], a[188:191], v[252:255], v[32:47]
  v_max_u32 v11, v11, v252
  s_waitcnt vmcnt(15)
  v_mfma_f32_32x32x16_bf16 v[16:31], a[192:195], v[64:67], v[16:31]
  v_max_u32 v11, v11, v64
  s_waitcnt vmcnt(14)
  v_mfma_f32_32x32x16_bf16 v[32:47], a[196:199], v[68:71], v[32:47]
  v_max_u32 v11, v11, v68
  s_waitcnt vmcnt(13)
  v_mfma_f32_32x32x16_bf16 v[16:31], a[200:203], v[72:75], v[16:31]
  v_max_u32 v11, v11, v72
  s_waitcnt vmcnt(12)
  v_mfma_f32_32x32x16_bf16 v[32:47], a[204:207], v[76:79], v[32:47]
  v_max_u32 v11, v11, v76
  s_waitcnt vmcnt(11)
  v_mfma_f32_32x32x16_bf16 v[16:31], a[208:211], v[80:83], v[16:31]
  v_max_u32 v11, v11, v80
  s_waitcnt vmcnt(10)
  v_mfma_f32_32x32x16_bf16 v[32:47], a[212:215], v[84:87], v[32:47]
  v_max_u32 v11, v11, v84
  s_waitcnt vmcnt(9)
  v_mfma_f32_32x32x16_bf16 v[16:31], a[216:219], v[88:91], v[16:31]
  v_max_u32 v11, v11, v88
  s_waitcnt vmcnt(8)
  v_mfma_f32_32x32x16_bf16 v[32:47], a[220:223], v[92:95], v[32:47]
  v_max_u32 v11, v11, v92
  s_waitcnt vmcnt(7)
  v_mfma_f32_32x32x16_bf16 v[16:31], a[224:227], v[96:99], v[16:31]
  v_max_u32 v11, v11, v96
  s_waitcnt vmcnt(6)
  v_mfma_f32_32x32x16_bf16 v[32:47], a[228:231], v[100:103], v[32:47]
  v_max_u32 v11, v11, v100
  s_waitcnt vmcnt(5)
  v_mfma_f32_32x32x16_bf16 v[16:31], a[232:235], v[104:107], v[16:31]
  v_max_u32 v11, v11, v104
  s_waitcnt vmcnt(4)
  v_mfma_f32_32x32x16_bf16 v[32:47], a[236:239], v[108:111], v[32:47]
  v_max_u32 v11, v11, v108
  s_waitcnt vmcnt(3)
  v_mfma_f32_32x32x16_bf16 v[16:31], a[240:243], v[112:115], v[16:31]
  v_max_u32 v11, v11, v112
  s_waitcnt vmcnt(2)
  v_mfma_f32_32x32x16_bf16 v[32:47], a[244:247], v[116:119], v[32:47]
  v_max_u32 v11, v11, v116
  s_waitcnt vmcnt(1)
  v_mfma_f32_32x32x16_bf16 v[16:31], a[248:251], v[120:123], v[16:31]
  v_max_u32 v11, v11, v120
  s_waitcnt vmcnt(0)
  v_mfma_f32_32x32x16_bf16 v[32:47], a[252:255], v[124:127], v[32:47]
  v_max_u32 v11, v11, v124
  v_cmp_eq_u32 vcc, -1, v11
  s_nop 8
  s_cbranch_vccz Lwo_93
  s_add_u32 s58, s58, 256
  s_cmp_eq_u32 s69, 1
  s_cbranch_scc1 Lwo_88
Lwo_93:
  v_add_f32 v16, v16, v32
  v_add_f32 v17, v17, v33
  v_add_f32 v18, v18, v34
  v_add_f32 v19, v19, v35
  v_add_f32 v20, v20, v36
  v_add_f32 v21, v21, v37
  v_add_f32 v22, v22, v38
  v_add_f32 v23, v23, v39
  v_add_f32 v24, v24, v40
  v_add_f32 v25, v25, v41
  v_add_f32 v26, v26, v42
  v_add_f32 v27, v27, v43
  v_add_f32 v28, v28, v44
  v_add_f32 v29, v29, v45
  v_add_f32 v30, v30, v46
  v_add_f32 v31, v31, v47
  ds_write_b128 v6, v[16:19] offset:0
  ds_write_b128 v6, v[20:23] offset:1024
  ds_write_b128 v6, v[24:27] offset:2048
  ds_write_b128 v6, v[28:31] offset:3072
  s_waitcnt lgkmcnt(0)
  s_barrier
  s_cmp_ge_u32 s21, 2
  s_cbranch_scc1 Lwo_87
  ds_read_b128 v[64:67], v7 offset:0
  ds_read_b128 v[68:71], v7 offset:1024
  ds_read_b128 v[72:75], v7 offset:4096
  ds_read_b128 v[76:79], v7 offset:5120
  ds_read_b128 v[80:83], v7 offset:8192
  ds_read_b128 v[84:87], v7 offset:9216
  ds_read_b128 v[88:91], v7 offset:12288
  ds_read_b128 v[92:95], v7 offset:13312
  v_lshlrev_b32 v16, 16, v52
  v_and_b32 v17, 0xffff0000, v52
  v_lshlrev_b32 v18, 16, v53
  v_and_b32 v19, 0xffff0000, v53
  v_lshlrev_b32 v20, 16, v54
  v_and_b32 v21, 0xffff0000, v54
  v_lshlrev_b32 v22, 16, v55
  v_and_b32 v23, 0xffff0000, v55
  s_waitcnt lgkmcnt(0)
  v_pk_add_f32 v[64:65], v[64:65], v[72:73]
  v_pk_add_f32 v[80:81], v[80:81], v[88:89]
  v_pk_add_f32 v[64:65], v[64:65], v[80:81]
  v_pk_add_f32 v[16:17], v[16:17], v[64:65]
  v_pk_add_f32 v[66:67], v[66:67], v[74:75]
  v_pk_add_f32 v[82:83], v[82:83], v[90:91]
  v_pk_add_f32 v[66:67], v[66:67], v[82:83]
  v_pk_add_f32 v[18:19], v[18:19], v[66:67]
  v_pk_add_f32 v[68:69], v[68:69], v[76:77]
  v_pk_add_f32 v[84:85], v[84:85], v[92:93]
  v_pk_add_f32 v[68:69], v[68:69], v[84:85]
  v_pk_add_f32 v[20:21], v[20:21], v[68:69]
  v_pk_add_f32 v[70:71], v[70:71], v[78:79]
  v_pk_add_f32 v[86:87], v[86:87], v[94:95]
  v_pk_add_f32 v[70:71], v[70:71], v[86:87]
  v_pk_add_f32 v[22:23], v[22:23], v[70:71]
  v_cvt_pk_bf16_f32 v24, v16, v17
  v_cvt_pk_bf16_f32 v25, v18, v19
  v_cvt_pk_bf16_f32 v26, v20, v21
  v_cvt_pk_bf16_f32 v27, v22, v23
  s_and_b32 s53, s47, 63
  s_lshl_b32 s53, s53, 15
  s_cmp_ge_u32 s47, 64
  s_cbranch_scc1 Lwo_86
  s_add_u32 s66, s53, 22020096
  s_cmp_lt_u32 s47, 62
  s_cbranch_scc1 Lwo_94
  buffer_store_dwordx4 v[24:27], v8, s[4:7], s66 offen
  s_nop 0
  s_branch Lwo_94a
Lwo_94:
  buffer_store_dwordx4 v[24:27], v8, s[4:7], s66 offen sc1
  s_nop 1
Lwo_94a:
  s_cmp_lt_u32 s47, 62
  s_cbranch_scc1 Lwo_94b
  s_waitcnt vmcnt(0)
  s_sleep 40
  buffer_store_dwordx4 v[24:27], v8, s[4:7], s66 offen sc1
  s_nop 1
Lwo_94b:
  s_lshl_b32 s53, s47, 7
  s_add_u32 s53, s53, 28672
  s_waitcnt vmcnt(0)
  v_mov_b32 v10, 1
  s_mov_b64 exec, 1
  buffer_atomic_add v10, off, s[4:7], s53 sc1
  s_mov_b64 exec, -1
  s_branch Lwo_87
Lwo_86:
  v_permlane32_swap_b32 v24, v26
  v_permlane32_swap_b32 v25, v27
  buffer_store_dwordx4 v[24:27], v9, s[12:15], s53 offen sc1
  s_nop 1
Lwo_87:
  s_barrier
  s_add_u32 s47, s47, 4
  s_branch Lwo_84
Lwo_85:
  s_branch L_end
L_qa:
  s_lshl_b32 s20, s46, 4
  s_and_b32 s29, s75, 15
  s_add_u32 s20, s20, s29
  s_lshr_b32 s46, s75, 4
  v_lshlrev_b32 v1, 4, v0
  v_and_b32 v2, 31, v0
  v_lshrrev_b32 v3, 5, v0
  v_bfe_u32 v4, v0, 2, 2
  s_mov_b32 s70, 0x358637bd
  s_mov_b32 s71, 0x358637bd
  s_mov_b32 s73, 0x3fb8aa3b
  s_mov_b32 s72, 0x3fb8aa3b
  s_mov_b32 s59, 0x3b000000
  s_mov_b32 s60, 0x3727c5ac
  s_load_dwordx2 s[8:9], s[0:1], 40
  s_waitcnt lgkmcnt(0)
  s_and_b32 s9, s9, 0xffff
  s_mov_b32 s10, 4194304
  s_mov_b32 s11, 0x20000
  v_mov_b32 v100, 0x3f803f80
  v_mov_b32 v101, 0x3f803f80
  v_mov_b32 v102, 0x3f803f80
  v_mov_b32 v103, 0x3f803f80
  v_lshrrev_b32 v10, 4, v0
  v_and_b32 v11, 15, v0
  v_lshlrev_b32 v12, 2, v10
  v_xor_b32 v11, v11, v12
  v_lshlrev_b32 v11, 4, v11
  v_lshl_add_u32 v10, v10, 13, v11
  s_lshl_b32 s53, s21, 15
  s_lshl_b32 s57, s21, 20
  s_lshl_b32 s29, s20, 8
  s_add_u32 s57, s57, s29
  s_waitcnt vmcnt(0) lgkmcnt(0)
  s_add_u32 m0, s53, 0
  s_add_u32 s54, s57, 0
  buffer_load_dwordx4 v10, s[8:11], s54 offen lds
  s_add_u32 m0, s53, 1024
  s_add_u32 s54, s57, 32768
  buffer_load_dwordx4 v10, s[8:11], s54 offen lds
  s_add_u32 m0, s53, 2048
  s_add_u32 s54, s57, 65536
  buffer_load_dwordx4 v10, s[8:11], s54 offen lds
  s_add_u32 m0, s53, 3072
  s_add_u32 s54, s57, 98304
  buffer_load_dwordx4 v10, s[8:11], s54 offen lds
  s_add_u32 m0, s53, 4096
  s_add_u32 s54, s57, 131072
  buffer_load_dwordx4 v10, s[8:11], s54 offen lds
  s_add_u32 m0, s53, 5120
  s_add_u32 s54, s57, 163840
  buffer_load_dwordx4 v10, s[8:11], s54 offen lds
  s_add_u32 m0, s53, 6144
  s_add_u32 s54, s57, 196608
  buffer_load_dwordx4 v10, s[8:11], s54 offen lds
  s_add_u32 m0, s53, 7168
  s_add_u32 s54, s57, 229376
  buffer_load_dwordx4 v10, s[8:11], s54 offen lds
  s_add_u32 m0, s53, 8192
  s_add_u32 s54, s57, 262144
  buffer_load_dwordx4 v10, s[8:11], s54 offen lds
  s_add_u32 m0, s53, 9216
  s_add_u32 s54, s57, 294912
  buffer_load_dwordx4 v10, s[8:11], s54 offen lds
  s_add_u32 m0, s53, 10240
  s_add_u32 s54, s57, 327680
  buffer_load_dwordx4 v10, s[8:11], s54 offen lds
  s_add_u32 m0, s53, 11264
  s_add_u32 s54, s57, 360448
  buffer_load_dwordx4 v10, s[8:11], s54 offen lds
  s_add_u32 m0, s53, 12288
  s_add_u32 s54, s57, 393216
  buffer_load_dwordx4 v10, s[8:11], s54 offen lds
  s_add_u32 m0, s53, 13312
  s_add_u32 s54, s57, 425984
  buffer_load_dwordx4 v10, s[8:11], s54 offen lds
  s_add_u32 m0, s53, 14336
  s_add_u32 s54, s57, 458752
  buffer_load_dwordx4 v10, s[8:11], s54 offen lds
  s_add_u32 m0, s53, 15360
  s_add_u32 s54, s57, 491520
  buffer_load_dwordx4 v10, s[8:11], s54 offen lds
  s_add_u32 m0, s53, 16384
  s_add_u32 s54, s57, 524288
  buffer_load_dwordx4 v10, s[8:11], s54 offen lds
  s_add_u32 m0, s53, 17408
  s_add_u32 s54, s57, 557056
  buffer_load_dwordx4 v10, s[8:11], s54 offen lds
  s_add_u32 m0, s53, 18432
  s_add_u32 s54, s57, 589824
  buffer_load_dwordx4 v10, s[8:11], s54 offen lds
  s_add_u32 m0, s53, 19456
  s_add_u32 s54, s57, 622592
  buffer_load_dwordx4 v10, s[8:11], s54 offen lds
  s_add_u32 m0, s53, 20480
  s_add_u32 s54, s57, 655360
  buffer_load_dwordx4 v10, s[8:11], s54 offen lds
  s_add_u32 m0, s53, 21504
  s_add_u32 s54, s57, 688128
  buffer_load_dwordx4 v10, s[8:11], s54 offen lds
  s_add_u32 m0, s53, 22528
  s_add_u32 s54, s57, 720896
  buffer_load_dwordx4 v10, s[8:11], s54 offen lds
  s_add_u32 m0, s53, 23552
  s_add_u32 s54, s57, 753664
  buffer_load_dwordx4 v10, s[8:11], s54 offen lds
  s_add_u32 m0, s53, 24576
  s_add_u32 s54, s57, 786432
  buffer_load_dwordx4 v10, s[8:11], s54 offen lds
  s_add_u32 m0, s53, 25600
  s_add_u32 s54, s57, 819200
  buffer_load_dwordx4 v10, s[8:11], s54 offen lds
  s_add_u32 m0, s53, 26624
  s_add_u32 s54, s57, 851968
  buffer_load_dwordx4 v10, s[8:11], s54 offen lds
  s_add_u32 m0, s53, 27648
  s_add_u32 s54, s57, 884736
  buffer_load_dwordx4 v10, s[8:11], s54 offen lds
  s_add_u32 m0, s53, 28672
  s_add_u32 s54, s57, 917504
  buffer_load_dwordx4 v10, s[8:11], s54 offen lds
  s_add_u32 m0, s53, 29696
  s_add_u32 s54, s57, 950272
  buffer_load_dwordx4 v10, s[8:11], s54 offen lds
  s_add_u32 m0, s53, 30720
  s_add_u32 s54, s57, 983040
  buffer_load_dwordx4 v10, s[8:11], s54 offen lds
  s_add_u32 m0, s53, 31744
  s_add_u32 s54, s57, 1015808
  buffer_load_dwordx4 v10, s[8:11], s54 offen lds
  v_lshl_add_u32 v13, v3, 2, v4
  v_lshlrev_b32 v13, 8, v13
  v_bfe_u32 v12, v0, 4, 1
  v_lshl_add_u32 v13, v12, 5, v13
  v_and_b32 v12, 3, v0
  v_lshl_add_u32 v13, v12, 3, v13
  v_lshl_add_u32 v13, v4, 6, v13
  v_add_u32 v13, s53, v13
  v_xor_b32 v14, 64, v13
  v_xor_b32 v15, 128, v13
  v_xor_b32 v16, 192, v13
  v_add_u32 v17, s53, v1
  s_waitcnt vmcnt(28)
  ds_read_b64_tr_b16 v[32:33], v13 offset:0
  ds_read_b64_tr_b16 v[34:35], v13 offset:2048
  ds_read_b64_tr_b16 v[36:37], v14 offset:0
  ds_read_b64_tr_b16 v[38:39], v14 offset:2048
  ds_read_b64_tr_b16 v[40:41], v15 offset:0
  ds_read_b64_tr_b16 v[42:43], v15 offset:2048
  ds_read_b64_tr_b16 v[44:45], v16 offset:0
  ds_read_b64_tr_b16 v[46:47], v16 offset:2048
  s_waitcnt lgkmcnt(0)
  ds_write_b128 v17, v[32:35] offset:0
  ds_write_b128 v17, v[36:39] offset:1024
  ds_write_b128 v17, v[40:43] offset:2048
  ds_write_b128 v17, v[44:47] offset:3072
  s_waitcnt lgkmcnt(0)
  s_waitcnt vmcnt(24)
  ds_read_b64_tr_b16 v[32:33], v13 offset:4096
  ds_read_b64_tr_b16 v[34:35], v13 offset:6144
  ds_read_b64_tr_b16 v[36:37], v14 offset:4096
  ds_read_b64_tr_b16 v[38:39], v14 offset:6144
  ds_read_b64_tr_b16 v[40:41], v15 offset:4096
  ds_read_b64_tr_b16 v[42:43], v15 offset:6144
  ds_read_b64_tr_b16 v[44:45], v16 offset:4096
  ds_read_b64_tr_b16 v[46:47], v16 offset:6144
  s_waitcnt lgkmcnt(0)
  ds_write_b128 v17, v[32:35] offset:4096
  ds_write_b128 v17, v[36:39] offset:5120
  ds_write_b128 v17, v[40:43] offset:6144
  ds_write_b128 v17, v[44:47] offset:7168
  s_waitcnt lgkmcnt(0)
  s_waitcnt vmcnt(20)
  ds_read_b64_tr_b16 v[32:33], v13 offset:8192
  ds_read_b64_tr_b16 v[34:35], v13 offset:10240
  ds_read_b64_tr_b16 v[36:37], v14 offset:8192
  ds_read_b64_tr_b16 v[38:39], v14 offset:10240
  ds_read_b64_tr_b16 v[40:41], v15 offset:8192
  ds_read_b64_tr_b16 v[42:43], v15 offset:10240
  ds_read_b64_tr_b16 v[44:45], v16 offset:8192
  ds_read_b64_tr_b16 v[46:47], v16 offset:10240
  s_waitcnt lgkmcnt(0)
  ds_write_b128 v17, v[32:35] offset:8192
  ds_write_b128 v17, v[36:39] offset:9216
  ds_write_b128 v17, v[40:43] offset:10240
  ds_write_b128 v17, v[44:47] offset:11264
  s_waitcnt lgkmcnt(0)
  s_waitcnt vmcnt(16)
  ds_read_b64_tr_b16 v[32:33], v13 offset:12288
  ds_read_b64_tr_b16 v[34:35], v13 offset:14336
  ds_read_b64_tr_b16 v[36:37], v14 offset:12288
  ds_read_b64_tr_b16 v[38:39], v14 offset:14336
  ds_read_b64_tr_b16 v[40:41], v15 offset:12288
  ds_read_b64_tr_b16 v[42:43], v15 offset:14336
  ds_read_b64_tr_b16 v[44:45], v16 offset:12288
  ds_read_b64_tr_b16 v[46:47], v16 offset:14336
  s_waitcnt lgkmcnt(0)
  ds_write_b128 v17, v[32:35] offset:12288
  ds_write_b128 v17, v[36:39] offset:13312
  ds_write_b128 v17, v[40:43] offset:14336
  ds_write_b128 v17, v[44:47] offset:15360
  s_waitcnt lgkmcnt(0)
  s_waitcnt vmcnt(12)
  ds_read_b64_tr_b16 v[32:33], v13 offset:16384
  ds_read_b64_tr_b16 v[34:35], v13 offset:18432
  ds_read_b64_tr_b16 v[36:37], v14 offset:16384
  ds_read_b64_tr_b16 v[38:39], v14 offset:18432
  ds_read_b64_tr_b16 v[40:41], v15 offset:16384
  ds_read_b64_tr_b16 v[42:43], v15 offset:18432
  ds_read_b64_tr_b16 v[44:45], v16 offset:16384
  ds_read_b64_tr_b16 v[46:47], v16 offset:18432
  s_waitcnt lgkmcnt(0)
  ds_write_b128 v17, v[32:35] offset:16384
  ds_write_b128 v17, v[36:39] offset:17408
  ds_write_b128 v17, v[40:43] offset:18432
  ds_write_b128 v17, v[44:47] offset:19456
  s_waitcnt lgkmcnt(0)
  s_waitcnt vmcnt(8)
  ds_read_b64_tr_b16 v[32:33], v13 offset:20480
  ds_read_b64_tr_b16 v[34:35], v13 offset:22528
  ds_read_b64_tr_b16 v[36:37], v14 offset:20480
  ds_read_b64_tr_b16 v[38:39], v14 offset:22528
  ds_read_b64_tr_b16 v[40:41], v15 offset:20480
  ds_read_b64_tr_b16 v[42:43], v15 offset:22528
  ds_read_b64_tr_b16 v[44:45], v16 offset:20480
  ds_read_b64_tr_b16 v[46:47], v16 offset:22528
  s_waitcnt lgkmcnt(0)
  ds_write_b128 v17, v[32:35] offset:20480
  ds_write_b128 v17, v[36:39] offset:21504
  ds_write_b128 v17, v[40:43] offset:22528
  ds_write_b128 v17, v[44:47] offset:23552
  s_waitcnt lgkmcnt(0)
  s_waitcnt vmcnt(4)
  ds_read_b64_tr_b16 v[32:33], v13 offset:24576
  ds_read_b64_tr_b16 v[34:35], v13 offset:26624
  ds_read_b64_tr_b16 v[36:37], v14 offset:24576
  ds_read_b64_tr_b16 v[38:39], v14 offset:26624
  ds_read_b64_tr_b16 v[40:41], v15 offset:24576
  ds_read_b64_tr_b16 v[42:43], v15 offset:26624
  ds_read_b64_tr_b16 v[44:45], v16 offset:24576
  ds_read_b64_tr_b16 v[46:47], v16 offset:26624
  s_waitcnt lgkmcnt(0)
  ds_write_b128 v17, v[32:35] offset:24576
  ds_write_b128 v17, v[36:39] offset:25600
  ds_write_b128 v17, v[40:43] offset:26624
  ds_write_b128 v17, v[44:47] offset:27648
  s_waitcnt lgkmcnt(0)
  s_waitcnt vmcnt(0)
  ds_read_b64_tr_b16 v[32:33], v13 offset:28672
  ds_read_b64_tr_b16 v[34:35], v13 offset:30720
  ds_read_b64_tr_b16 v[36:37], v14 offset:28672
  ds_read_b64_tr_b16 v[38:39], v14 offset:30720
  ds_read_b64_tr_b16 v[40:41], v15 offset:28672
  ds_read_b64_tr_b16 v[42:43], v15 offset:30720
  ds_read_b64_tr_b16 v[44:45], v16 offset:28672
  ds_read_b64_tr_b16 v[46:47], v16 offset:30720
  s_waitcnt lgkmcnt(0)
  ds_write_b128 v17, v[32:35] offset:28672
  ds_write_b128 v17, v[36:39] offset:29696
  ds_write_b128 v17, v[40:43] offset:30720
  ds_write_b128 v17, v[44:47] offset:31744
  s_waitcnt lgkmcnt(0)
  s_barrier
  v_add_u32 v5, 0x10000, v1
  s_mov_b32 s12, s92
  s_and_b32 s13, s93, 0xffff
  s_mov_b32 s14, 256
  s_mov_b32 s15, 0x20000
  s_mov_b32 s26, 0
Lwi_96:
  buffer_load_dword v10, off, s[12:15], 0 offset:12 sc1
  s_waitcnt vmcnt(0)
  v_readfirstlane_b32 s29, v10
  s_nop 0
  s_cmp_ge_u32 s29, 4
  s_nop 1
  s_cbranch_scc1 Lwi_97
  s_sleep 2
  s_add_u32 s26, s26, 1
  s_cmp_lt_u32 s26, 0x40000
  s_cbranch_scc1 Lwi_96
  s_branch L_end
Lwi_97:
  ds_read_b128 v[16:19], v1 offset:0
  ds_read_b128 v[20:23], v1 offset:1024
  ds_read_b128 v[24:27], v1 offset:2048
  s_waitcnt lgkmcnt(2)
  v_mfma_f32_32x32x16_bf16 a[64:79], v[16:19], v[100:103], 0
  ds_read_b128 v[28:31], v1 offset:3072
  s_waitcnt lgkmcnt(2)
  v_mfma_f32_32x32x16_bf16 a[80:95], v[20:23], v[100:103], 0
  ds_read_b128 v[16:19], v1 offset:4096
  s_waitcnt lgkmcnt(2)
  v_mfma_f32_32x32x16_bf16 a[96:111], v[24:27], v[100:103], 0
  ds_read_b128 v[20:23], v1 offset:5120
  s_waitcnt lgkmcnt(2)
  v_mfma_f32_32x32x16_bf16 a[112:127], v[28:31], v[100:103], 0
  ds_read_b128 v[24:27], v1 offset:6144
  s_waitcnt lgkmcnt(2)
  v_mfma_f32_32x32x16_bf16 a[64:79], v[16:19], v[100:103], a[64:79]
  ds_read_b128 v[28:31], v1 offset:7168
  s_waitcnt lgkmcnt(2)
  v_mfma_f32_32x32x16_bf16 a[80:95], v[20:23], v[100:103], a[80:95]
  ds_read_b128 v[16:19], v1 offset:8192
  s_waitcnt lgkmcnt(2)
  v_mfma_f32_32x32x16_bf16 a[96:111], v[24:27], v[100:103], a[96:111]
  ds_read_b128 v[20:23], v1 offset:9216
  s_waitcnt lgkmcnt(2)
  v_mfma_f32_32x32x16_bf16 a[112:127], v[28:31], v[100:103], a[112:127]
  ds_read_b128 v[24:27], v1 offset:10240
  s_waitcnt lgkmcnt(2)
  v_mfma_f32_32x32x16_bf16 a[64:79], v[16:19], v[100:103], a[64:79]
  ds_read_b128 v[28:31], v1 offset:11264
  s_waitcnt lgkmcnt(2)
  v_mfma_f32_32x32x16_bf16 a[80:95], v[20:23], v[100:103], a[80:95]
  ds_read_b128 v[16:19], v1 offset:12288
  s_waitcnt lgkmcnt(2)
  v_mfma_f32_32x32x16_bf16 a[96:111], v[24:27], v[100:103], a[96:111]
  ds_read_b128 v[20:23], v1 offset:13312
  s_waitcnt lgkmcnt(2)
  v_mfma_f32_32x32x16_bf16 a[112:127], v[28:31], v[100:103], a[112:127]
  ds_read_b128 v[24:27], v1 offset:14336
  s_waitcnt lgkmcnt(2)
  v_mfma_f32_32x32x16_bf16 a[64:79], v[16:19], v[100:103], a[64:79]
  ds_read_b128 v[28:31], v1 offset:15360
  s_waitcnt lgkmcnt(2)
  v_mfma_f32_32x32x16_bf16 a[80:95], v[20:23], v[100:103], a[80:95]
  ds_read_b128 v[16:19], v1 offset:16384
  s_waitcnt lgkmcnt(2)
  v_mfma_f32_32x32x16_bf16 a[96:111], v[24:27], v[100:103], a[96:111]
  ds_read_b128 v[20:23], v1 offset:17408
  s_waitcnt lgkmcnt(2)
  v_mfma_f32_32x32x16_bf16 a[112:127], v[28:31], v[100:103], a[112:127]
  ds_read_b128 v[24:27], v1 offset:18432
  s_waitcnt lgkmcnt(2)
  v_mfma_f32_32x32x16_bf16 a[64:79], v[16:19], v[100:103], a[64:79]
  ds_read_b128 v[28:31], v1 offset:19456
  s_waitcnt lgkmcnt(2)
  v_mfma_f32_32x32x16_bf16 a[80:95], v[20:23], v[100:103], a[80:95]
  ds_read_b128 v[16:19], v1 offset:20480
  s_waitcnt lgkmcnt(2)
  v_mfma_f32_32x32x16_bf16 a[96:111], v[24:27], v[100:103], a[96:111]
  ds_read_b128 v[20:23], v1 offset:21504
  s_waitcnt lgkmcnt(2)
  v_mfma_f32_32x32x16_bf16 a[112:127], v[28:31], v[100:103], a[112:127]
  ds_read_b128 v[24:27], v1 offset:22528
  s_waitcnt lgkmcnt(2)
  v_mfma_f32_32x32x16_bf16 a[64:79], v[16:19], v[100:103], a[64:79]
  ds_read_b128 v[28:31], v1 offset:23552
  s_waitcnt lgkmcnt(2)
  v_mfma_f32_32x32x16_bf16 a[80:95], v[20:23], v[100:103], a[80:95]
  ds_read_b128 v[16:19], v1 offset:24576
  s_waitcnt lgkmcnt(2)
  v_mfma_f32_32x32x16_bf16 a[96:111], v[24:27], v[100:103], a[96:111]
  ds_read_b128 v[20:23], v1 offset:25600
  s_waitcnt lgkmcnt(2)
  v_mfma_f32_32x32x16_bf16 a[112:127], v[28:31], v[100:103], a[112:127]
  ds_read_b128 v[24:27], v1 offset:26624
  s_waitcnt lgkmcnt(2)
  v_mfma_f32_32x32x16_bf16 a[64:79], v[16:19], v[100:103], a[64:79]
  ds_read_b128 v[28:31], v1 offset:27648
  s_waitcnt lgkmcnt(2)
  v_mfma_f32_32x32x16_bf16 a[80:95], v[20:23], v[100:103], a[80:95]
  ds_read_b128 v[16:19], v1 offset:28672
  s_waitcnt lgkmcnt(2)
  v_mfma_f32_32x32x16_bf16 a[96:111], v[24:27], v[100:103], a[96:111]
  ds_read_b128 v[20:23], v1 offset:29696
  s_waitcnt lgkmcnt(2)
  v_mfma_f32_32x32x16_bf16 a[112:127], v[28:31], v[100:103], a[112:127]
  ds_read_b128 v[24:27], v1 offset:30720
  s_waitcnt lgkmcnt(2)
  v_mfma_f32_32x32x16_bf16 a[64:79], v[16:19], v[100:103], a[64:79]
  ds_read_b128 v[28:31], v1 offset:31744
  s_waitcnt lgkmcnt(2)
  v_mfma_f32_32x32x16_bf16 a[80:95], v[20:23], v[100:103], a[80:95]
  ds_read_b128 v[16:19], v1 offset:32768
  s_waitcnt lgkmcnt(2)
  v_mfma_f32_32x32x16_bf16 a[96:111], v[24:27], v[100:103], a[96:111]
  ds_read_b128 v[20:23], v1 offset:33792
  s_waitcnt lgkmcnt(2)
  v_mfma_f32_32x32x16_bf16 a[112:127], v[28:31], v[100:103], a[112:127]
  ds_read_b128 v[24:27], v1 offset:34816
  s_waitcnt lgkmcnt(2)
  v_mfma_f32_32x32x16_bf16 a[64:79], v[16:19], v[100:103], a[64:79]
  ds_read_b128 v[28:31], v1 offset:35840
  s_waitcnt lgkmcnt(2)
  v_mfma_f32_32x32x16_bf16 a[80:95], v[20:23], v[100:103], a[80:95]
  ds_read_b128 v[16:19], v1 offset:36864
  s_waitcnt lgkmcnt(2)
  v_mfma_f32_32x32x16_bf16 a[96:111], v[24:27], v[100:103], a[96:111]
  ds_read_b128 v[20:23], v1 offset:37888
  s_waitcnt lgkmcnt(2)
  v_mfma_f32_32x32x16_bf16 a[112:127], v[28:31], v[100:103], a[112:127]
  ds_read_b128 v[24:27], v1 offset:38912
  s_waitcnt lgkmcnt(2)
  v_mfma_f32_32x32x16_bf16 a[64:79], v[16:19], v[100:103], a[64:79]
  ds_read_b128 v[28:31], v1 offset:39936
  s_waitcnt lgkmcnt(2)
  v_mfma_f32_32x32x16_bf16 a[80:95], v[20:23], v[100:103], a[80:95]
  ds_read_b128 v[16:19], v1 offset:40960
  s_waitcnt lgkmcnt(2)
  v_mfma_f32_32x32x16_bf16 a[96:111], v[24:27], v[100:103], a[96:111]
  ds_read_b128 v[20:23], v1 offset:41984
  s_waitcnt lgkmcnt(2)
  v_mfma_f32_32x32x16_bf16 a[112:127], v[28:31], v[100:103], a[112:127]
  ds_read_b128 v[24:27], v1 offset:43008
  s_waitcnt lgkmcnt(2)
  v_mfma_f32_32x32x16_bf16 a[64:79], v[16:19], v[100:103], a[64:79]
  ds_read_b128 v[28:31], v1 offset:44032
  s_waitcnt lgkmcnt(2)
  v_mfma_f32_32x32x16_bf16 a[80:95], v[20:23], v[100:103], a[80:95]
  ds_read_b128 v[16:19], v1 offset:45056
  s_waitcnt lgkmcnt(2)
  v_mfma_f32_32x32x16_bf16 a[96:111], v[24:27], v[100:103], a[96:111]
  ds_read_b128 v[20:23], v1 offset:46080
  s_waitcnt lgkmcnt(2)
  v_mfma_f32_32x32x16_bf16 a[112:127], v[28:31], v[100:103], a[112:127]
  ds_read_b128 v[24:27], v1 offset:47104
  s_waitcnt lgkmcnt(2)
  v_mfma_f32_32x32x16_bf16 a[64:79], v[16:19], v[100:103], a[64:79]
  ds_read_b128 v[28:31], v1 offset:48128
  s_waitcnt lgkmcnt(2)
  v_mfma_f32_32x32x16_bf16 a[80:95], v[20:23], v[100:103], a[80:95]
  ds_read_b128 v[16:19], v1 offset:49152
  s_waitcnt lgkmcnt(2)
  v_mfma_f32_32x32x16_bf16 a[96:111], v[24:27], v[100:103], a[96:111]
  ds_read_b128 v[20:23], v1 offset:50176
  s_waitcnt lgkmcnt(2)
  v_mfma_f32_32x32x16_bf16 a[112:127], v[28:31], v[100:103], a[112:127]
  ds_read_b128 v[24:27], v1 offset:51200
  s_waitcnt lgkmcnt(2)
  v_mfma_f32_32x32x16_bf16 a[64:79], v[16:19], v[100:103], a[64:79]
  ds_read_b128 v[28:31], v1 offset:52224
  s_waitcnt lgkmcnt(2)
  v_mfma_f32_32x32x16_bf16 a[80:95], v[20:23], v[100:103], a[80:95]
  ds_read_b128 v[16:19], v1 offset:53248
  s_waitcnt lgkmcnt(2)
  v_mfma_f32_32x32x16_bf16 a[96:111], v[24:27], v[100:103], a[96:111]
  ds_read_b128 v[20:23], v1 offset:54272
  s_waitcnt lgkmcnt(2)
  v_mfma_f32_32x32x16_bf16 a[112:127], v[28:31], v[100:103], a[112:127]
  ds_read_b128 v[24:27], v1 offset:55296
  s_waitcnt lgkmcnt(2)
  v_mfma_f32_32x32x16_bf16 a[64:79], v[16:19], v[100:103], a[64:79]
  ds_read_b128 v[28:31], v1 offset:56320
  s_waitcnt lgkmcnt(2)
  v_mfma_f32_32x32x16_bf16 a[80:95], v[20:23], v[100:103], a[80:95]
  ds_read_b128 v[16:19], v1 offset:57344
  s_waitcnt lgkmcnt(2)
  v_mfma_f32_32x32x16_bf16 a[96:111], v[24:27], v[100:103], a[96:111]
  ds_read_b128 v[20:23], v1 offset:58368
  s_waitcnt lgkmcnt(2)
  v_mfma_f32_32x32x16_bf16 a[112:127], v[28:31], v[100:103], a[112:127]
  ds_read_b128 v[24:27], v1 offset:59392
  s_waitcnt lgkmcnt(2)
  v_mfma_f32_32x32x16_bf16 a[64:79], v[16:19], v[100:103], a[64:79]
  ds_read_b128 v[28:31], v1 offset:60416
  s_waitcnt lgkmcnt(2)
  v_mfma_f32_32x32x16_bf16 a[80:95], v[20:23], v[100:103], a[80:95]
  ds_read_b128 v[16:19], v1 offset:61440
  s_waitcnt lgkmcnt(2)
  v_mfma_f32_32x32x16_bf16 a[96:111], v[24:27], v[100:103], a[96:111]
  ds_read_b128 v[20:23], v1 offset:62464
  s_waitcnt lgkmcnt(2)
  v_mfma_f32_32x32x16_bf16 a[112:127], v[28:31], v[100:103], a[112:127]
  ds_read_b128 v[24:27], v1 offset:63488
  s_waitcnt lgkmcnt(2)
  v_mfma_f32_32x32x16_bf16 a[64:79], v[16:19], v[100:103], a[64:79]
  ds_read_b128 v[28:31], v1 offset:64512
  s_waitcnt lgkmcnt(2)
  v_mfma_f32_32x32x16_bf16 a[80:95], v[20:23], v[100:103], a[80:95]
  ds_read_b128 v[16:19], v5 offset:0
  s_waitcnt lgkmcnt(2)
  v_mfma_f32_32x32x16_bf16 a[96:111], v[24:27], v[100:103], a[96:111]
  ds_read_b128 v[20:23], v5 offset:1024
  s_waitcnt lgkmcnt(2)
  v_mfma_f32_32x32x16_bf16 a[112:127], v[28:31], v[100:103], a[112:127]
  ds_read_b128 v[24:27], v5 offset:2048
  s_waitcnt lgkmcnt(2)
  v_mfma_f32_32x32x16_bf16 a[64:79], v[16:19], v[100:103], a[64:79]
  ds_read_b128 v[28:31], v5 offset:3072
  s_waitcnt lgkmcnt(2)
  v_mfma_f32_32x32x16_bf16 a[80:95], v[20:23], v[100:103], a[80:95]
  ds_read_b128 v[16:19], v5 offset:4096
  s_waitcnt lgkmcnt(2)
  v_mfma_f32_32x32x16_bf16 a[96:111], v[24:27], v[100:103], a[96:111]
  ds_read_b128 v[20:23], v5 offset:5120
  s_waitcnt lgkmcnt(2)
  v_mfma_f32_32x32x16_bf16 a[112:127], v[28:31], v[100:103], a[112:127]
  ds_read_b128 v[24:27], v5 offset:6144
  s_waitcnt lgkmcnt(2)
  v_mfma_f32_32x32x16_bf16 a[64:79], v[16:19], v[100:103], a[64:79]
  ds_read_b128 v[28:31], v5 offset:7168
  s_waitcnt lgkmcnt(2)
  v_mfma_f32_32x32x16_bf16 a[80:95], v[20:23], v[100:103], a[80:95]
  ds_read_b128 v[16:19], v5 offset:8192
  s_waitcnt lgkmcnt(2)
  v_mfma_f32_32x32x16_bf16 a[96:111], v[24:27], v[100:103], a[96:111]
  ds_read_b128 v[20:23], v5 offset:9216
  s_waitcnt lgkmcnt(2)
  v_mfma_f32_32x32x16_bf16 a[112:127], v[28:31], v[100:103], a[112:127]
  ds_read_b128 v[24:27], v5 offset:10240
  s_waitcnt lgkmcnt(2)
  v_mfma_f32_32x32x16_bf16 a[64:79], v[16:19], v[100:103], a[64:79]
  ds_read_b128 v[28:31], v5 offset:11264
  s_waitcnt lgkmcnt(2)
  v_mfma_f32_32x32x16_bf16 a[80:95], v[20:23], v[100:103], a[80:95]
  ds_read_b128 v[16:19], v5 offset:12288
  s_waitcnt lgkmcnt(2)
  v_mfma_f32_32x32x16_bf16 a[96:111], v[24:27], v[100:103], a[96:111]
  ds_read_b128 v[20:23], v5 offset:13312
  s_waitcnt lgkmcnt(2)
  v_mfma_f32_32x32x16_bf16 a[112:127], v[28:31], v[100:103], a[112:127]
  ds_read_b128 v[24:27], v5 offset:14336
  s_waitcnt lgkmcnt(2)
  v_mfma_f32_32x32x16_bf16 a[64:79], v[16:19], v[100:103], a[64:79]
  ds_read_b128 v[28:31], v5 offset:15360
  s_waitcnt lgkmcnt(2)
  v_mfma_f32_32x32x16_bf16 a[80:95], v[20:23], v[100:103], a[80:95]
  ds_read_b128 v[16:19], v5 offset:16384
  s_waitcnt lgkmcnt(2)
  v_mfma_f32_32x32x16_bf16 a[96:111], v[24:27], v[100:103], a[96:111]
  ds_read_b128 v[20:23], v5 offset:17408
  s_waitcnt lgkmcnt(2)
  v_mfma_f32_32x32x16_bf16 a[112:127], v[28:31], v[100:103], a[112:127]
  ds_read_b128 v[24:27], v5 offset:18432
  s_waitcnt lgkmcnt(2)
  v_mfma_f32_32x32x16_bf16 a[64:79], v[16:19], v[100:103], a[64:79]
  ds_read_b128 v[28:31], v5 offset:19456
  s_waitcnt lgkmcnt(2)
  v_mfma_f32_32x32x16_bf16 a[80:95], v[20:23], v[100:103], a[80:95]
  ds_read_b128 v[16:19], v5 offset:20480
  s_waitcnt lgkmcnt(2)
  v_mfma_f32_32x32x16_bf16 a[96:111], v[24:27], v[100:103], a[96:111]
  ds_read_b128 v[20:23], v5 offset:21504
  s_waitcnt lgkmcnt(2)
  v_mfma_f32_32x32x16_bf16 a[112:127], v[28:31], v[100:103], a[112:127]
  ds_read_b128 v[24:27], v5 offset:22528
  s_waitcnt lgkmcnt(2)
  v_mfma_f32_32x32x16_bf16 a[64:79], v[16:19], v[100:103], a[64:79]
  ds_read_b128 v[28:31], v5 offset:23552
  s_waitcnt lgkmcnt(2)
  v_mfma_f32_32x32x16_bf16 a[80:95], v[20:23], v[100:103], a[80:95]
  ds_read_b128 v[16:19], v5 offset:24576
  s_waitcnt lgkmcnt(2)
  v_mfma_f32_32x32x16_bf16 a[96:111], v[24:27], v[100:103], a[96:111]
  ds_read_b128 v[20:23], v5 offset:25600
  s_waitcnt lgkmcnt(2)
  v_mfma_f32_32x32x16_bf16 a[112:127], v[28:31], v[100:103], a[112:127]
  ds_read_b128 v[24:27], v5 offset:26624
  s_waitcnt lgkmcnt(2)
  v_mfma_f32_32x32x16_bf16 a[64:79], v[16:19], v[100:103], a[64:79]
  ds_read_b128 v[28:31], v5 offset:27648
  s_waitcnt lgkmcnt(2)
  v_mfma_f32_32x32x16_bf16 a[80:95], v[20:23], v[100:103], a[80:95]
  ds_read_b128 v[16:19], v5 offset:28672
  s_waitcnt lgkmcnt(2)
  v_mfma_f32_32x32x16_bf16 a[96:111], v[24:27], v[100:103], a[96:111]
  ds_read_b128 v[20:23], v5 offset:29696
  s_waitcnt lgkmcnt(2)
  v_mfma_f32_32x32x16_bf16 a[112:127], v[28:31], v[100:103], a[112:127]
  ds_read_b128 v[24:27], v5 offset:30720
  s_waitcnt lgkmcnt(2)
  v_mfma_f32_32x32x16_bf16 a[64:79], v[16:19], v[100:103], a[64:79]
  ds_read_b128 v[28:31], v5 offset:31744
  s_waitcnt lgkmcnt(2)
  v_mfma_f32_32x32x16_bf16 a[80:95], v[20:23], v[100:103], a[80:95]
  ds_read_b128 v[16:19], v5 offset:32768
  s_waitcnt lgkmcnt(2)
  v_mfma_f32_32x32x16_bf16 a[96:111], v[24:27], v[100:103], a[96:111]
  ds_read_b128 v[20:23], v5 offset:33792
  s_waitcnt lgkmcnt(2)
  v_mfma_f32_32x32x16_bf16 a[112:127], v[28:31], v[100:103], a[112:127]
  ds_read_b128 v[24:27], v5 offset:34816
  s_waitcnt lgkmcnt(2)
  v_mfma_f32_32x32x16_bf16 a[64:79], v[16:19], v[100:103], a[64:79]
  ds_read_b128 v[28:31], v5 offset:35840
  s_waitcnt lgkmcnt(2)
  v_mfma_f32_32x32x16_bf16 a[80:95], v[20:23], v[100:103], a[80:95]
  ds_read_b128 v[16:19], v5 offset:36864
  s_waitcnt lgkmcnt(2)
  v_mfma_f32_32x32x16_bf16 a[96:111], v[24:27], v[100:103], a[96:111]
  ds_read_b128 v[20:23], v5 offset:37888
  s_waitcnt lgkmcnt(2)
  v_mfma_f32_32x32x16_bf16 a[112:127], v[28:31], v[100:103], a[112:127]
  ds_read_b128 v[24:27], v5 offset:38912
  s_waitcnt lgkmcnt(2)
  v_mfma_f32_32x32x16_bf16 a[64:79], v[16:19], v[100:103], a[64:79]
  ds_read_b128 v[28:31], v5 offset:39936
  s_waitcnt lgkmcnt(2)
  v_mfma_f32_32x32x16_bf16 a[80:95], v[20:23], v[100:103], a[80:95]
  ds_read_b128 v[16:19], v5 offset:40960
  s_waitcnt lgkmcnt(2)
  v_mfma_f32_32x32x16_bf16 a[96:111], v[24:27], v[100:103], a[96:111]
  ds_read_b128 v[20:23], v5 offset:41984
  s_waitcnt lgkmcnt(2)
  v_mfma_f32_32x32x16_bf16 a[112:127], v[28:31], v[100:103], a[112:127]
  ds_read_b128 v[24:27], v5 offset:43008
  s_waitcnt lgkmcnt(2)
  v_mfma_f32_32x32x16_bf16 a[64:79], v[16:19], v[100:103], a[64:79]
  ds_read_b128 v[28:31], v5 offset:44032
  s_waitcnt lgkmcnt(2)
  v_mfma_f32_32x32x16_bf16 a[80:95], v[20:23], v[100:103], a[80:95]
  ds_read_b128 v[16:19], v5 offset:45056
  s_waitcnt lgkmcnt(2)
  v_mfma_f32_32x32x16_bf16 a[96:111], v[24:27], v[100:103], a[96:111]
  ds_read_b128 v[20:23], v5 offset:46080
  s_waitcnt lgkmcnt(2)
  v_mfma_f32_32x32x16_bf16 a[112:127], v[28:31], v[100:103], a[112:127]
  ds_read_b128 v[24:27], v5 offset:47104
  s_waitcnt lgkmcnt(2)
  v_mfma_f32_32x32x16_bf16 a[64:79], v[16:19], v[100:103], a[64:79]
  ds_read_b128 v[28:31], v5 offset:48128
  s_waitcnt lgkmcnt(2)
  v_mfma_f32_32x32x16_bf16 a[80:95], v[20:23], v[100:103], a[80:95]
  ds_read_b128 v[16:19], v5 offset:49152
  s_waitcnt lgkmcnt(2)
  v_mfma_f32_32x32x16_bf16 a[96:111], v[24:27], v[100:103], a[96:111]
  ds_read_b128 v[20:23], v5 offset:50176
  s_waitcnt lgkmcnt(2)
  v_mfma_f32_32x32x16_bf16 a[112:127], v[28:31], v[100:103], a[112:127]
  ds_read_b128 v[24:27], v5 offset:51200
  s_waitcnt lgkmcnt(2)
  v_mfma_f32_32x32x16_bf16 a[64:79], v[16:19], v[100:103], a[64:79]
  ds_read_b128 v[28:31], v5 offset:52224
  s_waitcnt lgkmcnt(2)
  v_mfma_f32_32x32x16_bf16 a[80:95], v[20:23], v[100:103], a[80:95]
  ds_read_b128 v[16:19], v5 offset:53248
  s_waitcnt lgkmcnt(2)
  v_mfma_f32_32x32x16_bf16 a[96:111], v[24:27], v[100:103], a[96:111]
  ds_read_b128 v[20:23], v5 offset:54272
  s_waitcnt lgkmcnt(2)
  v_mfma_f32_32x32x16_bf16 a[112:127], v[28:31], v[100:103], a[112:127]
  ds_read_b128 v[24:27], v5 offset:55296
  s_waitcnt lgkmcnt(2)
  v_mfma_f32_32x32x16_bf16 a[64:79], v[16:19], v[100:103], a[64:79]
  ds_read_b128 v[28:31], v5 offset:56320
  s_waitcnt lgkmcnt(2)
  v_mfma_f32_32x32x16_bf16 a[80:95], v[20:23], v[100:103], a[80:95]
  ds_read_b128 v[16:19], v5 offset:57344
  s_waitcnt lgkmcnt(2)
  v_mfma_f32_32x32x16_bf16 a[96:111], v[24:27], v[100:103], a[96:111]
  ds_read_b128 v[20:23], v5 offset:58368
  s_waitcnt lgkmcnt(2)
  v_mfma_f32_32x32x16_bf16 a[112:127], v[28:31], v[100:103], a[112:127]
  ds_read_b128 v[24:27], v5 offset:59392
  s_waitcnt lgkmcnt(2)
  v_mfma_f32_32x32x16_bf16 a[64:79], v[16:19], v[100:103], a[64:79]
  ds_read_b128 v[28:31], v5 offset:60416
  s_waitcnt lgkmcnt(2)
  v_mfma_f32_32x32x16_bf16 a[80:95], v[20:23], v[100:103], a[80:95]
  ds_read_b128 v[16:19], v5 offset:61440
  s_waitcnt lgkmcnt(2)
  v_mfma_f32_32x32x16_bf16 a[96:111], v[24:27], v[100:103], a[96:111]
  ds_read_b128 v[20:23], v5 offset:62464
  s_waitcnt lgkmcnt(2)
  v_mfma_f32_32x32x16_bf16 a[112:127], v[28:31], v[100:103], a[112:127]
  ds_read_b128 v[24:27], v5 offset:63488
  s_waitcnt lgkmcnt(2)
  v_mfma_f32_32x32x16_bf16 a[64:79], v[16:19], v[100:103], a[64:79]
  ds_read_b128 v[28:31], v5 offset:64512
  s_waitcnt lgkmcnt(2)
  v_mfma_f32_32x32x16_bf16 a[80:95], v[20:23], v[100:103], a[80:95]
  s_waitcnt lgkmcnt(1)
  v_mfma_f32_32x32x16_bf16 a[96:111], v[24:27], v[100:103], a[96:111]
  s_waitcnt lgkmcnt(0)
  v_mfma_f32_32x32x16_bf16 a[112:127], v[28:31], v[100:103], a[112:127]
  v_lshlrev_b32 v10, 2, v3
  v_sub_u32 v10, v2, v10
  v_mov_b32 v11, 0
  v_mov_b32 v12, 0xff800000
  v_cmp_le_i32 vcc, 0, v10
  s_nop 1
  v_cndmask_b32 v104, v12, v11, vcc
  v_cmp_le_i32 vcc, 1, v10
  s_nop 1
  v_cndmask_b32 v105, v12, v11, vcc
  v_cmp_le_i32 vcc, 2, v10
  s_nop 1
  v_cndmask_b32 v106, v12, v11, vcc
  v_cmp_le_i32 vcc, 3, v10
  s_nop 1
  v_cndmask_b32 v107, v12, v11, vcc
  v_cmp_le_i32 vcc, 8, v10
  s_nop 1
  v_cndmask_b32 v108, v12, v11, vcc
  v_cmp_le_i32 vcc, 9, v10
  s_nop 1
  v_cndmask_b32 v109, v12, v11, vcc
  v_cmp_le_i32 vcc, 10, v10
  s_nop 1
  v_cndmask_b32 v110, v12, v11, vcc
  v_cmp_le_i32 vcc, 11, v10
  s_nop 1
  v_cndmask_b32 v111, v12, v11, vcc
  v_cmp_le_i32 vcc, 16, v10
  s_nop 1
  v_cndmask_b32 v112, v12, v11, vcc
  v_cmp_le_i32 vcc, 17, v10
  s_nop 1
  v_cndmask_b32 v113, v12, v11, vcc
  v_cmp_le_i32 vcc, 18, v10
  s_nop 1
  v_cndmask_b32 v114, v12, v11, vcc
  v_cmp_le_i32 vcc, 19, v10
  s_nop 1
  v_cndmask_b32 v115, v12, v11, vcc
  v_cmp_le_i32 vcc, 24, v10
  s_nop 1
  v_cndmask_b32 v116, v12, v11, vcc
  v_cmp_le_i32 vcc, 25, v10
  s_nop 1
  v_cndmask_b32 v117, v12, v11, vcc
  v_cmp_le_i32 vcc, 26, v10
  s_nop 1
  v_cndmask_b32 v118, v12, v11, vcc
  v_cmp_le_i32 vcc, 27, v10
  s_nop 1
  v_cndmask_b32 v119, v12, v11, vcc
  v_lshrrev_b32 v6, 1, v1
  v_and_b32 v6, 0x80, v6
  v_xor_b32 v6, v6, v1
  v_lshlrev_b32 v7, 4, v2
  v_lshl_add_u32 v7, v3, 7, v7
  v_mov_b32 v10, 0x80000000
  v_cmp_gt_u32 vcc, 8, v2
  s_nop 1
  v_cndmask_b32 v7, v10, v7, vcc
  v_lshlrev_b32 v8, 4, v2
  v_lshl_add_u32 v8, v3, 3, v8
  v_and_b32 v9, 15, v0
  v_lshlrev_b32 v9, 7, v9
  v_bfe_u32 v10, v0, 4, 1
  v_mul_u32_u24 v10, 8454144, v10
  v_add_u32 v9, v9, v10
  s_lshl_b32 s47, s46, 2
  s_add_u32 s47, s47, s21
  s_cmp_lg_u32 s46, 1
  s_cbranch_scc1 Lnp_98
  s_lshl_b32 s53, s20, 13
  s_lshl_b32 s29, s21, 18
  s_add_u32 s53, s53, s29
  v_mov_b32 v16, -1
  v_mov_b32 v17, -1
  v_mov_b32 v18, -1
  v_mov_b32 v19, -1
  s_add_u32 s54, s53, 116391936
  buffer_store_dwordx4 v[16:19], v1, s[4:7], s54 offen offset:0 sc1
  buffer_store_dwordx4 v[16:19], v1, s[4:7], s54 offen offset:1024 sc1
  buffer_store_dwordx4 v[16:19], v1, s[4:7], s54 offen offset:2048 sc1
  buffer_store_dwordx4 v[16:19], v1, s[4:7], s54 offen offset:3072 sc1
  s_add_u32 s54, s53, 116396032
  buffer_store_dwordx4 v[16:19], v1, s[4:7], s54 offen offset:0 sc1
  buffer_store_dwordx4 v[16:19], v1, s[4:7], s54 offen offset:1024 sc1
  buffer_store_dwordx4 v[16:19], v1, s[4:7], s54 offen offset:2048 sc1
  buffer_store_dwordx4 v[16:19], v1, s[4:7], s54 offen offset:3072 sc1
  s_add_u32 s54, s53, 133169152
  buffer_store_dwordx4 v[16:19], v1, s[4:7], s54 offen offset:0 sc1
  buffer_store_dwordx4 v[16:19], v1, s[4:7], s54 offen offset:1024 sc1
  buffer_store_dwordx4 v[16:19], v1, s[4:7], s54 offen offset:2048 sc1
  buffer_store_dwordx4 v[16:19], v1, s[4:7], s54 offen offset:3072 sc1
  s_add_u32 s54, s53, 133173248
  buffer_store_dwordx4 v[16:19], v1, s[4:7], s54 offen offset:0 sc1
  buffer_store_dwordx4 v[16:19], v1, s[4:7], s54 offen offset:1024 sc1
  buffer_store_dwordx4 v[16:19], v1, s[4:7], s54 offen offset:2048 sc1
  buffer_store_dwordx4 v[16:19], v1, s[4:7], s54 offen offset:3072 sc1
  s_nop 1
Lnp_98:
Lqa_99:
  s_cmp_ge_u32 s47, 128
  s_cbranch_scc1 Lqa_100
  s_lshl_b32 s67, s47, 7
  s_add_u32 s67, s67, 38912
  s_mov_b32 s52, 16
  s_mov_b32 s26, 0
Lwf_101:
  buffer_load_dword v10, off, s[4:7], s67 sc1
  s_waitcnt vmcnt(0)
  v_readfirstlane_b32 s29, v10
  s_nop 0
  s_cmp_ge_u32 s29, s52
  s_nop 1
  s_cbranch_scc1 Lwf_102
  s_sleep 0
  s_add_u32 s26, s26, 1
  s_cmp_lt_u32 s26, 0x100000
  s_cbranch_scc1 Lwf_101
  s_branch L_end
Lwf_102:
  s_lshl_b32 s57, s47, 15
  s_cmp_ge_u32 s47, 64
  s_cselect_b32 s29, 2097152, 0
  s_add_u32 s57, s57, s29
  s_add_u32 s57, s57, 19922944
  s_lshr_b32 s53, s47, 6
  s_lshl_b32 s53, s53, 6
  s_add_u32 s53, s53, s47
  s_lshl_b32 s54, s53, 8
  s_add_u32 s54, s54, 30539776
  v_lshlrev_b32 v10, 2, v2
  buffer_load_dword v96, v10, s[4:7], s54 offen sc1
  buffer_load_dword v97, v10, s[4:7], s54 offen offset:128 sc1
  s_add_u32 s54, s57, 0
  buffer_load_dwordx4 v[128:131], v1, s[4:7], s54 offen offset:0 sc1
  buffer_load_dwordx4 v[132:135], v1, s[4:7], s54 offen offset:1024 sc1
  buffer_load_dwordx4 v[136:139], v1, s[4:7], s54 offen offset:2048 sc1
  buffer_load_dwordx4 v[140:143], v1, s[4:7], s54 offen offset:3072 sc1
  s_add_u32 s54, s57, 4096
  buffer_load_dwordx4 v[144:147], v1, s[4:7], s54 offen offset:0 sc1
  buffer_load_dwordx4 v[148:151], v1, s[4:7], s54 offen offset:1024 sc1
  buffer_load_dwordx4 v[152:155], v1, s[4:7], s54 offen offset:2048 sc1
  buffer_load_dwordx4 v[156:159], v1, s[4:7], s54 offen offset:3072 sc1
  s_add_u32 s54, s57, 8192
  buffer_load_dwordx4 v[160:163], v1, s[4:7], s54 offen offset:0 sc1
  buffer_load_dwordx4 v[164:167], v1, s[4:7], s54 offen offset:1024 sc1
  buffer_load_dwordx4 v[168:171], v1, s[4:7], s54 offen offset:2048 sc1
  buffer_load_dwordx4 v[172:175], v1, s[4:7], s54 offen offset:3072 sc1
  s_add_u32 s54, s57, 12288
  buffer_load_dwordx4 v[176:179], v1, s[4:7], s54 offen offset:0 sc1
  buffer_load_dwordx4 v[180:183], v1, s[4:7], s54 offen offset:1024 sc1
  buffer_load_dwordx4 v[184:187], v1, s[4:7], s54 offen offset:2048 sc1
  buffer_load_dwordx4 v[188:191], v1, s[4:7], s54 offen offset:3072 sc1
  s_add_u32 s54, s57, 16384
  buffer_load_dwordx4 v[192:195], v1, s[4:7], s54 offen offset:0 sc1
  buffer_load_dwordx4 v[196:199], v1, s[4:7], s54 offen offset:1024 sc1
  buffer_load_dwordx4 v[200:203], v1, s[4:7], s54 offen offset:2048 sc1
  buffer_load_dwordx4 v[204:207], v1, s[4:7], s54 offen offset:3072 sc1
  s_add_u32 s54, s57, 20480
  buffer_load_dwordx4 v[208:211], v1, s[4:7], s54 offen offset:0 sc1
  buffer_load_dwordx4 v[212:215], v1, s[4:7], s54 offen offset:1024 sc1
  buffer_load_dwordx4 v[216:219], v1, s[4:7], s54 offen offset:2048 sc1
  buffer_load_dwordx4 v[220:223], v1, s[4:7], s54 offen offset:3072 sc1
  s_add_u32 s54, s57, 24576
  buffer_load_dwordx4 v[224:227], v1, s[4:7], s54 offen offset:0 sc1
  buffer_load_dwordx4 v[228:231], v1, s[4:7], s54 offen offset:1024 sc1
  buffer_load_dwordx4 v[232:235], v1, s[4:7], s54 offen offset:2048 sc1
  buffer_load_dwordx4 v[236:239], v1, s[4:7], s54 offen offset:3072 sc1
  s_add_u32 s54, s57, 28672
  buffer_load_dwordx4 v[240:243], v1, s[4:7], s54 offen offset:0 sc1
  buffer_load_dwordx4 v[244:247], v1, s[4:7], s54 offen offset:1024 sc1
  buffer_load_dwordx4 v[248:251], v1, s[4:7], s54 offen offset:2048 sc1
  buffer_load_dwordx4 v[252:255], v1, s[4:7], s54 offen offset:3072 sc1
  ds_read_b128 v[16:19], v1 offset:0
  ds_read_b128 v[20:23], v1 offset:1024
  ds_read_b128 v[24:27], v1 offset:2048
  s_waitcnt vmcnt(31)
  s_waitcnt lgkmcnt(2)
  v_mfma_f32_32x32x16_bf16 a[0:15], v[16:19], v[128:131], 0
  ds_read_b128 v[28:31], v1 offset:3072
  s_waitcnt lgkmcnt(2)
  v_mfma_f32_32x32x16_bf16 a[16:31], v[20:23], v[128:131], 0
  ds_read_b128 v[16:19], v1 offset:4096
  s_waitcnt lgkmcnt(2)
  v_mfma_f32_32x32x16_bf16 a[32:47], v[24:27], v[128:131], 0
  ds_read_b128 v[20:23], v1 offset:5120
  s_waitcnt lgkmcnt(2)
  v_mfma_f32_32x32x16_bf16 a[48:63], v[28:31], v[128:131], 0
  ds_read_b128 v[24:27], v1 offset:6144
  s_waitcnt vmcnt(30)
  s_waitcnt lgkmcnt(2)
  v_mfma_f32_32x32x16_bf16 a[0:15], v[16:19], v[132:135], a[0:15]
  ds_read_b128 v[28:31], v1 offset:7168
  s_waitcnt lgkmcnt(2)
  v_mfma_f32_32x32x16_bf16 a[16:31], v[20:23], v[132:135], a[16:31]
  ds_read_b128 v[16:19], v1 offset:8192
  s_waitcnt lgkmcnt(2)
  v_mfma_f32_32x32x16_bf16 a[32:47], v[24:27], v[132:135], a[32:47]
  ds_read_b128 v[20:23], v1 offset:9216
  s_waitcnt lgkmcnt(2)
  v_mfma_f32_32x32x16_bf16 a[48:63], v[28:31], v[132:135], a[48:63]
  ds_read_b128 v[24:27], v1 offset:10240
  s_waitcnt vmcnt(29)
  s_waitcnt lgkmcnt(2)
  v_mfma_f32_32x32x16_bf16 a[0:15], v[16:19], v[136:139], a[0:15]
  ds_read_b128 v[28:31], v1 offset:11264
  s_waitcnt lgkmcnt(2)
  v_mfma_f32_32x32x16_bf16 a[16:31], v[20:23], v[136:139], a[16:31]
  ds_read_b128 v[16:19], v1 offset:12288
  s_waitcnt lgkmcnt(2)
  v_mfma_f32_32x32x16_bf16 a[32:47], v[24:27], v[136:139], a[32:47]
  ds_read_b128 v[20:23], v1 offset:13312
  s_waitcnt lgkmcnt(2)
  v_mfma_f32_32x32x16_bf16 a[48:63], v[28:31], v[136:139], a[48:63]
  ds_read_b128 v[24:27], v1 offset:14336
  s_waitcnt vmcnt(28)
  s_waitcnt lgkmcnt(2)
  v_mfma_f32_32x32x16_bf16 a[0:15], v[16:19], v[140:143], a[0:15]
  ds_read_b128 v[28:31], v1 offset:15360
  s_waitcnt lgkmcnt(2)
  v_mfma_f32_32x32x16_bf16 a[16:31], v[20:23], v[140:143], a[16:31]
  ds_read_b128 v[16:19], v1 offset:16384
  s_waitcnt lgkmcnt(2)
  v_mfma_f32_32x32x16_bf16 a[32:47], v[24:27], v[140:143], a[32:47]
  ds_read_b128 v[20:23], v1 offset:17408
  s_waitcnt lgkmcnt(2)
  v_mfma_f32_32x32x16_bf16 a[48:63], v[28:31], v[140:143], a[48:63]
  ds_read_b128 v[24:27], v1 offset:18432
  s_waitcnt vmcnt(27)
  s_waitcnt lgkmcnt(2)
  v_mfma_f32_32x32x16_bf16 a[0:15], v[16:19], v[144:147], a[0:15]
  ds_read_b128 v[28:31], v1 offset:19456
  s_waitcnt lgkmcnt(2)
  v_mfma_f32_32x32x16_bf16 a[16:31], v[20:23], v[144:147], a[16:31]
  ds_read_b128 v[16:19], v1 offset:20480
  s_waitcnt lgkmcnt(2)
  v_mfma_f32_32x32x16_bf16 a[32:47], v[24:27], v[144:147], a[32:47]
  ds_read_b128 v[20:23], v1 offset:21504
  s_waitcnt lgkmcnt(2)
  v_mfma_f32_32x32x16_bf16 a[48:63], v[28:31], v[144:147], a[48:63]
  ds_read_b128 v[24:27], v1 offset:22528
  s_waitcnt vmcnt(26)
  s_waitcnt lgkmcnt(2)
  v_mfma_f32_32x32x16_bf16 a[0:15], v[16:19], v[148:151], a[0:15]
  ds_read_b128 v[28:31], v1 offset:23552
  s_waitcnt lgkmcnt(2)
  v_mfma_f32_32x32x16_bf16 a[16:31], v[20:23], v[148:151], a[16:31]
  ds_read_b128 v[16:19], v1 offset:24576
  s_waitcnt lgkmcnt(2)
  v_mfma_f32_32x32x16_bf16 a[32:47], v[24:27], v[148:151], a[32:47]
  ds_read_b128 v[20:23], v1 offset:25600
  s_waitcnt lgkmcnt(2)
  v_mfma_f32_32x32x16_bf16 a[48:63], v[28:31], v[148:151], a[48:63]
  ds_read_b128 v[24:27], v1 offset:26624
  s_waitcnt vmcnt(25)
  s_waitcnt lgkmcnt(2)
  v_mfma_f32_32x32x16_bf16 a[0:15], v[16:19], v[152:155], a[0:15]
  ds_read_b128 v[28:31], v1 offset:27648
  s_waitcnt lgkmcnt(2)
  v_mfma_f32_32x32x16_bf16 a[16:31], v[20:23], v[152:155], a[16:31]
  ds_read_b128 v[16:19], v1 offset:28672
  s_waitcnt lgkmcnt(2)
  v_mfma_f32_32x32x16_bf16 a[32:47], v[24:27], v[152:155], a[32:47]
  ds_read_b128 v[20:23], v1 offset:29696
  s_waitcnt lgkmcnt(2)
  v_mfma_f32_32x32x16_bf16 a[48:63], v[28:31], v[152:155], a[48:63]
  ds_read_b128 v[24:27], v1 offset:30720
  s_waitcnt vmcnt(24)
  s_waitcnt lgkmcnt(2)
  v_mfma_f32_32x32x16_bf16 a[0:15], v[16:19], v[156:159], a[0:15]
  ds_read_b128 v[28:31], v1 offset:31744
  s_waitcnt lgkmcnt(2)
  v_mfma_f32_32x32x16_bf16 a[16:31], v[20:23], v[156:159], a[16:31]
  ds_read_b128 v[16:19], v1 offset:32768
  s_waitcnt lgkmcnt(2)
  v_mfma_f32_32x32x16_bf16 a[32:47], v[24:27], v[156:159], a[32:47]
  ds_read_b128 v[20:23], v1 offset:33792
  s_waitcnt lgkmcnt(2)
  v_mfma_f32_32x32x16_bf16 a[48:63], v[28:31], v[156:159], a[48:63]
  ds_read_b128 v[24:27], v1 offset:34816
  s_waitcnt vmcnt(23)
  s_waitcnt lgkmcnt(2)
  v_mfma_f32_32x32x16_bf16 a[0:15], v[16:19], v[160:163], a[0:15]
  ds_read_b128 v[28:31], v1 offset:35840
  s_waitcnt lgkmcnt(2)
  v_mfma_f32_32x32x16_bf16 a[16:31], v[20:23], v[160:163], a[16:31]
  ds_read_b128 v[16:19], v1 offset:36864
  s_waitcnt lgkmcnt(2)
  v_mfma_f32_32x32x16_bf16 a[32:47], v[24:27], v[160:163], a[32:47]
  ds_read_b128 v[20:23], v1 offset:37888
  s_waitcnt lgkmcnt(2)
  v_mfma_f32_32x32x16_bf16 a[48:63], v[28:31], v[160:163], a[48:63]
  ds_read_b128 v[24:27], v1 offset:38912
  s_waitcnt vmcnt(22)
  s_waitcnt lgkmcnt(2)
  v_mfma_f32_32x32x16_bf16 a[0:15], v[16:19], v[164:167], a[0:15]
  ds_read_b128 v[28:31], v1 offset:39936
  s_waitcnt lgkmcnt(2)
  v_mfma_f32_32x32x16_bf16 a[16:31], v[20:23], v[164:167], a[16:31]
  ds_read_b128 v[16:19], v1 offset:40960
  s_waitcnt lgkmcnt(2)
  v_mfma_f32_32x32x16_bf16 a[32:47], v[24:27], v[164:167], a[32:47]
  ds_read_b128 v[20:23], v1 offset:41984
  s_waitcnt lgkmcnt(2)
  v_mfma_f32_32x32x16_bf16 a[48:63], v[28:31], v[164:167], a[48:63]
  ds_read_b128 v[24:27], v1 offset:43008
  s_waitcnt vmcnt(21)
  s_waitcnt lgkmcnt(2)
  v_mfma_f32_32x32x16_bf16 a[0:15], v[16:19], v[168:171], a[0:15]
  ds_read_b128 v[28:31], v1 offset:44032
  s_waitcnt lgkmcnt(2)
  v_mfma_f32_32x32x16_bf16 a[16:31], v[20:23], v[168:171], a[16:31]
  ds_read_b128 v[16:19], v1 offset:45056
  s_waitcnt lgkmcnt(2)
  v_mfma_f32_32x32x16_bf16 a[32:47], v[24:27], v[168:171], a[32:47]
  ds_read_b128 v[20:23], v1 offset:46080
  s_waitcnt lgkmcnt(2)
  v_mfma_f32_32x32x16_bf16 a[48:63], v[28:31], v[168:171], a[48:63]
  ds_read_b128 v[24:27], v1 offset:47104
  s_waitcnt vmcnt(20)
  s_waitcnt lgkmcnt(2)
  v_mfma_f32_32x32x16_bf16 a[0:15], v[16:19], v[172:175], a[0:15]
  ds_read_b128 v[28:31], v1 offset:48128
  s_waitcnt lgkmcnt(2)
  v_mfma_f32_32x32x16_bf16 a[16:31], v[20:23], v[172:175], a[16:31]
  ds_read_b128 v[16:19], v1 offset:49152
  s_waitcnt lgkmcnt(2)
  v_mfma_f32_32x32x16_bf16 a[32:47], v[24:27], v[172:175], a[32:47]
  ds_read_b128 v[20:23], v1 offset:50176
  s_waitcnt lgkmcnt(2)
  v_mfma_f32_32x32x16_bf16 a[48:63], v[28:31], v[172:175], a[48:63]
  ds_read_b128 v[24:27], v1 offset:51200
  s_waitcnt vmcnt(19)
  s_waitcnt lgkmcnt(2)
  v_mfma_f32_32x32x16_bf16 a[0:15], v[16:19], v[176:179], a[0:15]
  ds_read_b128 v[28:31], v1 offset:52224
  s_waitcnt lgkmcnt(2)
  v_mfma_f32_32x32x16_bf16 a[16:31], v[20:23], v[176:179], a[16:31]
  ds_read_b128 v[16:19], v1 offset:53248
  s_waitcnt lgkmcnt(2)
  v_mfma_f32_32x32x16_bf16 a[32:47], v[24:27], v[176:179], a[32:47]
  ds_read_b128 v[20:23], v1 offset:54272
  s_waitcnt lgkmcnt(2)
  v_mfma_f32_32x32x16_bf16 a[48:63], v[28:31], v[176:179], a[48:63]
  ds_read_b128 v[24:27], v1 offset:55296
  s_waitcnt vmcnt(18)
  s_waitcnt lgkmcnt(2)
  v_mfma_f32_32x32x16_bf16 a[0:15], v[16:19], v[180:183], a[0:15]
  ds_read_b128 v[28:31], v1 offset:56320
  s_waitcnt lgkmcnt(2)
  v_mfma_f32_32x32x16_bf16 a[16:31], v[20:23], v[180:183], a[16:31]
  ds_read_b128 v[16:19], v1 offset:57344
  s_waitcnt lgkmcnt(2)
  v_mfma_f32_32x32x16_bf16 a[32:47], v[24:27], v[180:183], a[32:47]
  ds_read_b128 v[20:23], v1 offset:58368
  s_waitcnt lgkmcnt(2)
  v_mfma_f32_32x32x16_bf16 a[48:63], v[28:31], v[180:183], a[48:63]
  ds_read_b128 v[24:27], v1 offset:59392
  s_waitcnt vmcnt(17)
  s_waitcnt lgkmcnt(2)
  v_mfma_f32_32x32x16_bf16 a[0:15], v[16:19], v[184:187], a[0:15]
  ds_read_b128 v[28:31], v1 offset:60416
  s_waitcnt lgkmcnt(2)
  v_mfma_f32_32x32x16_bf16 a[16:31], v[20:23], v[184:187], a[16:31]
  ds_read_b128 v[16:19], v1 offset:61440
  s_waitcnt lgkmcnt(2)
  v_mfma_f32_32x32x16_bf16 a[32:47], v[24:27], v[184:187], a[32:47]
  ds_read_b128 v[20:23], v1 offset:62464
  s_waitcnt lgkmcnt(2)
  v_mfma_f32_32x32x16_bf16 a[48:63], v[28:31], v[184:187], a[48:63]
  ds_read_b128 v[24:27], v1 offset:63488
  s_waitcnt vmcnt(16)
  s_waitcnt lgkmcnt(2)
  v_mfma_f32_32x32x16_bf16 a[0:15], v[16:19], v[188:191], a[0:15]
  ds_read_b128 v[28:31], v1 offset:64512
  s_waitcnt lgkmcnt(2)
  v_mfma_f32_32x32x16_bf16 a[16:31], v[20:23], v[188:191], a[16:31]
  ds_read_b128 v[16:19], v5 offset:0
  s_waitcnt lgkmcnt(2)
  v_mfma_f32_32x32x16_bf16 a[32:47], v[24:27], v[188:191], a[32:47]
  ds_read_b128 v[20:23], v5 offset:1024
  s_waitcnt lgkmcnt(2)
  v_mfma_f32_32x32x16_bf16 a[48:63], v[28:31], v[188:191], a[48:63]
  ds_read_b128 v[24:27], v5 offset:2048
  s_waitcnt vmcnt(15)
  s_waitcnt lgkmcnt(2)
  v_mfma_f32_32x32x16_bf16 a[0:15], v[16:19], v[192:195], a[0:15]
  ds_read_b128 v[28:31], v5 offset:3072
  s_waitcnt lgkmcnt(2)
  v_mfma_f32_32x32x16_bf16 a[16:31], v[20:23], v[192:195], a[16:31]
  ds_read_b128 v[16:19], v5 offset:4096
  s_waitcnt lgkmcnt(2)
  v_mfma_f32_32x32x16_bf16 a[32:47], v[24:27], v[192:195], a[32:47]
  ds_read_b128 v[20:23], v5 offset:5120
  s_waitcnt lgkmcnt(2)
  v_mfma_f32_32x32x16_bf16 a[48:63], v[28:31], v[192:195], a[48:63]
  ds_read_b128 v[24:27], v5 offset:6144
  s_waitcnt vmcnt(14)
  s_waitcnt lgkmcnt(2)
  v_mfma_f32_32x32x16_bf16 a[0:15], v[16:19], v[196:199], a[0:15]
  ds_read_b128 v[28:31], v5 offset:7168
  s_waitcnt lgkmcnt(2)
  v_mfma_f32_32x32x16_bf16 a[16:31], v[20:23], v[196:199], a[16:31]
  ds_read_b128 v[16:19], v5 offset:8192
  s_waitcnt lgkmcnt(2)
  v_mfma_f32_32x32x16_bf16 a[32:47], v[24:27], v[196:199], a[32:47]
  ds_read_b128 v[20:23], v5 offset:9216
  s_waitcnt lgkmcnt(2)
  v_mfma_f32_32x32x16_bf16 a[48:63], v[28:31], v[196:199], a[48:63]
  ds_read_b128 v[24:27], v5 offset:10240
  s_waitcnt vmcnt(13)
  s_waitcnt lgkmcnt(2)
  v_mfma_f32_32x32x16_bf16 a[0:15], v[16:19], v[200:203], a[0:15]
  ds_read_b128 v[28:31], v5 offset:11264
  s_waitcnt lgkmcnt(2)
  v_mfma_f32_32x32x16_bf16 a[16:31], v[20:23], v[200:203], a[16:31]
  ds_read_b128 v[16:19], v5 offset:12288
  s_waitcnt lgkmcnt(2)
  v_mfma_f32_32x32x16_bf16 a[32:47], v[24:27], v[200:203], a[32:47]
  ds_read_b128 v[20:23], v5 offset:13312
  s_waitcnt lgkmcnt(2)
  v_mfma_f32_32x32x16_bf16 a[48:63], v[28:31], v[200:203], a[48:63]
  ds_read_b128 v[24:27], v5 offset:14336
  s_waitcnt vmcnt(12)
  s_waitcnt lgkmcnt(2)
  v_mfma_f32_32x32x16_bf16 a[0:15], v[16:19], v[204:207], a[0:15]
  ds_read_b128 v[28:31], v5 offset:15360
  s_waitcnt lgkmcnt(2)
  v_mfma_f32_32x32x16_bf16 a[16:31], v[20:23], v[204:207], a[16:31]
  ds_read_b128 v[16:19], v5 offset:16384
  s_waitcnt lgkmcnt(2)
  v_mfma_f32_32x32x16_bf16 a[32:47], v[24:27], v[204:207], a[32:47]
  ds_read_b128 v[20:23], v5 offset:17408
  s_waitcnt lgkmcnt(2)
  v_mfma_f32_32x32x16_bf16 a[48:63], v[28:31], v[204:207], a[48:63]
  ds_read_b128 v[24:27], v5 offset:18432
  s_waitcnt vmcnt(11)
  s_waitcnt lgkmcnt(2)
  v_mfma_f32_32x32x16_bf16 a[0:15], v[16:19], v[208:211], a[0:15]
  ds_read_b128 v[28:31], v5 offset:19456
  s_waitcnt lgkmcnt(2)
  v_mfma_f32_32x32x16_bf16 a[16:31], v[20:23], v[208:211], a[16:31]
  ds_read_b128 v[16:19], v5 offset:20480
  s_waitcnt lgkmcnt(2)
  v_mfma_f32_32x32x16_bf16 a[32:47], v[24:27], v[208:211], a[32:47]
  ds_read_b128 v[20:23], v5 offset:21504
  s_waitcnt lgkmcnt(2)
  v_mfma_f32_32x32x16_bf16 a[48:63], v[28:31], v[208:211], a[48:63]
  ds_read_b128 v[24:27], v5 offset:22528
  s_waitcnt vmcnt(10)
  s_waitcnt lgkmcnt(2)
  v_mfma_f32_32x32x16_bf16 a[0:15], v[16:19], v[212:215], a[0:15]
  ds_read_b128 v[28:31], v5 offset:23552
  s_waitcnt lgkmcnt(2)
  v_mfma_f32_32x32x16_bf16 a[16:31], v[20:23], v[212:215], a[16:31]
  ds_read_b128 v[16:19], v5 offset:24576
  s_waitcnt lgkmcnt(2)
  v_mfma_f32_32x32x16_bf16 a[32:47], v[24:27], v[212:215], a[32:47]
  ds_read_b128 v[20:23], v5 offset:25600
  s_waitcnt lgkmcnt(2)
  v_mfma_f32_32x32x16_bf16 a[48:63], v[28:31], v[212:215], a[48:63]
  ds_read_b128 v[24:27], v5 offset:26624
  s_waitcnt vmcnt(9)
  s_waitcnt lgkmcnt(2)
  v_mfma_f32_32x32x16_bf16 a[0:15], v[16:19], v[216:219], a[0:15]
  ds_read_b128 v[28:31], v5 offset:27648
  s_waitcnt lgkmcnt(2)
  v_mfma_f32_32x32x16_bf16 a[16:31], v[20:23], v[216:219], a[16:31]
  ds_read_b128 v[16:19], v5 offset:28672
  s_waitcnt lgkmcnt(2)
  v_mfma_f32_32x32x16_bf16 a[32:47], v[24:27], v[216:219], a[32:47]
  ds_read_b128 v[20:23], v5 offset:29696
  s_waitcnt lgkmcnt(2)
  v_mfma_f32_32x32x16_bf16 a[48:63], v[28:31], v[216:219], a[48:63]
  ds_read_b128 v[24:27], v5 offset:30720
  s_waitcnt vmcnt(8)
  s_waitcnt lgkmcnt(2)
  v_mfma_f32_32x32x16_bf16 a[0:15], v[16:19], v[220:223], a[0:15]
  ds_read_b128 v[28:31], v5 offset:31744
  s_waitcnt lgkmcnt(2)
  v_mfma_f32_32x32x16_bf16 a[16:31], v[20:23], v[220:223], a[16:31]
  ds_read_b128 v[16:19], v5 offset:32768
  s_waitcnt lgkmcnt(2)
  v_mfma_f32_32x32x16_bf16 a[32:47], v[24:27], v[220:223], a[32:47]
  ds_read_b128 v[20:23], v5 offset:33792
  s_waitcnt lgkmcnt(2)
  v_mfma_f32_32x32x16_bf16 a[48:63], v[28:31], v[220:223], a[48:63]
  ds_read_b128 v[24:27], v5 offset:34816
  s_waitcnt vmcnt(7)
  s_waitcnt lgkmcnt(2)
  v_mfma_f32_32x32x16_bf16 a[0:15], v[16:19], v[224:227], a[0:15]
  ds_read_b128 v[28:31], v5 offset:35840
  s_waitcnt lgkmcnt(2)
  v_mfma_f32_32x32x16_bf16 a[16:31], v[20:23], v[224:227], a[16:31]
  ds_read_b128 v[16:19], v5 offset:36864
  s_waitcnt lgkmcnt(2)
  v_mfma_f32_32x32x16_bf16 a[32:47], v[24:27], v[224:227], a[32:47]
  ds_read_b128 v[20:23], v5 offset:37888
  s_waitcnt lgkmcnt(2)
  v_mfma_f32_32x32x16_bf16 a[48:63], v[28:31], v[224:227], a[48:63]
  ds_read_b128 v[24:27], v5 offset:38912
  s_waitcnt vmcnt(6)
  s_waitcnt lgkmcnt(2)
  v_mfma_f32_32x32x16_bf16 a[0:15], v[16:19], v[228:231], a[0:15]
  ds_read_b128 v[28:31], v5 offset:39936
  s_waitcnt lgkmcnt(2)
  v_mfma_f32_32x32x16_bf16 a[16:31], v[20:23], v[228:231], a[16:31]
  ds_read_b128 v[16:19], v5 offset:40960
  s_waitcnt lgkmcnt(2)
  v_mfma_f32_32x32x16_bf16 a[32:47], v[24:27], v[228:231], a[32:47]
  ds_read_b128 v[20:23], v5 offset:41984
  s_waitcnt lgkmcnt(2)
  v_mfma_f32_32x32x16_bf16 a[48:63], v[28:31], v[228:231], a[48:63]
  ds_read_b128 v[24:27], v5 offset:43008
  s_waitcnt vmcnt(5)
  s_waitcnt lgkmcnt(2)
  v_mfma_f32_32x32x16_bf16 a[0:15], v[16:19], v[232:235], a[0:15]
  ds_read_b128 v[28:31], v5 offset:44032
  s_waitcnt lgkmcnt(2)
  v_mfma_f32_32x32x16_bf16 a[16:31], v[20:23], v[232:235], a[16:31]
  ds_read_b128 v[16:19], v5 offset:45056
  s_waitcnt lgkmcnt(2)
  v_mfma_f32_32x32x16_bf16 a[32:47], v[24:27], v[232:235], a[32:47]
  ds_read_b128 v[20:23], v5 offset:46080
  s_waitcnt lgkmcnt(2)
  v_mfma_f32_32x32x16_bf16 a[48:63], v[28:31], v[232:235], a[48:63]
  ds_read_b128 v[24:27], v5 offset:47104
  s_waitcnt vmcnt(4)
  s_waitcnt lgkmcnt(2)
  v_mfma_f32_32x32x16_bf16 a[0:15], v[16:19], v[236:239], a[0:15]
  ds_read_b128 v[28:31], v5 offset:48128
  s_waitcnt lgkmcnt(2)
  v_mfma_f32_32x32x16_bf16 a[16:31], v[20:23], v[236:239], a[16:31]
  ds_read_b128 v[16:19], v5 offset:49152
  s_waitcnt lgkmcnt(2)
  v_mfma_f32_32x32x16_bf16 a[32:47], v[24:27], v[236:239], a[32:47]
  ds_read_b128 v[20:23], v5 offset:50176
  s_waitcnt lgkmcnt(2)
  v_mfma_f32_32x32x16_bf16 a[48:63], v[28:31], v[236:239], a[48:63]
  ds_read_b128 v[24:27], v5 offset:51200
  s_waitcnt vmcnt(3)
  s_waitcnt lgkmcnt(2)
  v_mfma_f32_32x32x16_bf16 a[0:15], v[16:19], v[240:243], a[0:15]
  ds_read_b128 v[28:31], v5 offset:52224
  s_waitcnt lgkmcnt(2)
  v_mfma_f32_32x32x16_bf16 a[16:31], v[20:23], v[240:243], a[16:31]
  ds_read_b128 v[16:19], v5 offset:53248
  s_waitcnt lgkmcnt(2)
  v_mfma_f32_32x32x16_bf16 a[32:47], v[24:27], v[240:243], a[32:47]
  ds_read_b128 v[20:23], v5 offset:54272
  s_waitcnt lgkmcnt(2)
  v_mfma_f32_32x32x16_bf16 a[48:63], v[28:31], v[240:243], a[48:63]
  ds_read_b128 v[24:27], v5 offset:55296
  s_waitcnt vmcnt(2)
  s_waitcnt lgkmcnt(2)
  v_mfma_f32_32x32x16_bf16 a[0:15], v[16:19], v[244:247], a[0:15]
  ds_read_b128 v[28:31], v5 offset:56320
  s_waitcnt lgkmcnt(2)
  v_mfma_f32_32x32x16_bf16 a[16:31], v[20:23], v[244:247], a[16:31]
  ds_read_b128 v[16:19], v5 offset:57344
  s_waitcnt lgkmcnt(2)
  v_mfma_f32_32x32x16_bf16 a[32:47], v[24:27], v[244:247], a[32:47]
  ds_read_b128 v[20:23], v5 offset:58368
  s_waitcnt lgkmcnt(2)
  v_mfma_f32_32x32x16_bf16 a[48:63], v[28:31], v[244:247], a[48:63]
  ds_read_b128 v[24:27], v5 offset:59392
  s_waitcnt vmcnt(1)
  s_waitcnt lgkmcnt(2)
  v_mfma_f32_32x32x16_bf16 a[0:15], v[16:19], v[248:251], a[0:15]
  ds_read_b128 v[28:31], v5 offset:60416
  s_waitcnt lgkmcnt(2)
  v_mfma_f32_32x32x16_bf16 a[16:31], v[20:23], v[248:251], a[16:31]
  ds_read_b128 v[16:19], v5 offset:61440
  s_waitcnt lgkmcnt(2)
  v_mfma_f32_32x32x16_bf16 a[32:47], v[24:27], v[248:251], a[32:47]
  ds_read_b128 v[20:23], v5 offset:62464
  s_waitcnt lgkmcnt(2)
  v_mfma_f32_32x32x16_bf16 a[48:63], v[28:31], v[248:251], a[48:63]
  ds_read_b128 v[24:27], v5 offset:63488
  s_waitcnt vmcnt(0)
  s_waitcnt lgkmcnt(2)
  v_mfma_f32_32x32x16_bf16 a[0:15], v[16:19], v[252:255], a[0:15]
  ds_read_b128 v[28:31], v5 offset:64512
  s_waitcnt lgkmcnt(2)
  v_mfma_f32_32x32x16_bf16 a[16:31], v[20:23], v[252:255], a[16:31]
  s_waitcnt lgkmcnt(1)
  v_mfma_f32_32x32x16_bf16 a[32:47], v[24:27], v[252:255], a[32:47]
  s_waitcnt lgkmcnt(0)
  v_mfma_f32_32x32x16_bf16 a[48:63], v[28:31], v[252:255], a[48:63]
  v_mul_f32 v96, s59, v96
  v_mul_f32 v97, s59, v97
  v_fma_f32 v97, -v96, v96, v97
  v_max_f32 v97, 0, v97
  v_cvt_pk_bf16_f32 v96, v96, v96
  v_and_b32 v96, 0xffff0000, v96
  v_cvt_pk_bf16_f32 v97, v97, v97
  v_and_b32 v97, 0xffff0000, v97
  v_add_f32 v97, s60, v97
  v_cvt_pk_bf16_f32 v97, v97, v97
  v_and_b32 v97, 0xffff0000, v97
  v_sqrt_f32 v97, v97
  s_nop 0
  v_cvt_pk_bf16_f32 v97, v97, v97
  v_and_b32 v97, 0xffff0000, v97
  v_rcp_f32 v97, v97
  s_nop 0
  v_mul_f32 v96, v96, v97
  v_accvgpr_read_b32 v12, a0
  v_accvgpr_read_b32 v10, a64
  v_mul_f32 v10, v96, v10
  v_fma_f32 v12, v12, v97, -v10
  v_accvgpr_read_b32 v13, a1
  v_accvgpr_read_b32 v10, a65
  v_mul_f32 v10, v96, v10
  v_fma_f32 v13, v13, v97, -v10
  v_cvt_pk_bf16_f32 v128, v12, v13
  v_accvgpr_read_b32 v12, a2
  v_accvgpr_read_b32 v10, a66
  v_mul_f32 v10, v96, v10
  v_fma_f32 v12, v12, v97, -v10
  v_accvgpr_read_b32 v13, a3
  v_accvgpr_read_b32 v10, a67
  v_mul_f32 v10, v96, v10
  v_fma_f32 v13, v13, v97, -v10
  v_cvt_pk_bf16_f32 v129, v12, v13
  v_accvgpr_read_b32 v12, a4
  v_accvgpr_read_b32 v10, a68
  v_mul_f32 v10, v96, v10
  v_fma_f32 v12, v12, v97, -v10
  v_accvgpr_read_b32 v13, a5
  v_accvgpr_read_b32 v10, a69
  v_mul_f32 v10, v96, v10
  v_fma_f32 v13, v13, v97, -v10
  v_cvt_pk_bf16_f32 v130, v12, v13
  v_accvgpr_read_b32 v12, a6
  v_accvgpr_read_b32 v10, a70
  v_mul_f32 v10, v96, v10
  v_fma_f32 v12, v12, v97, -v10
  v_accvgpr_read_b32 v13, a7
  v_accvgpr_read_b32 v10, a71
  v_mul_f32 v10, v96, v10
  v_fma_f32 v13, v13, v97, -v10
  v_cvt_pk_bf16_f32 v131, v12, v13
  v_accvgpr_read_b32 v12, a8
  v_accvgpr_read_b32 v10, a72
  v_mul_f32 v10, v96, v10
  v_fma_f32 v12, v12, v97, -v10
  v_accvgpr_read_b32 v13, a9
  v_accvgpr_read_b32 v10, a73
  v_mul_f32 v10, v96, v10
  v_fma_f32 v13, v13, v97, -v10
  v_cvt_pk_bf16_f32 v132, v12, v13
  v_accvgpr_read_b32 v12, a10
  v_accvgpr_read_b32 v10, a74
  v_mul_f32 v10, v96, v10
  v_fma_f32 v12, v12, v97, -v10
  v_accvgpr_read_b32 v13, a11
  v_accvgpr_read_b32 v10, a75
  v_mul_f32 v10, v96, v10
  v_fma_f32 v13, v13, v97, -v10
  v_cvt_pk_bf16_f32 v133, v12, v13
  v_accvgpr_read_b32 v12, a12
  v_accvgpr_read_b32 v10, a76
  v_mul_f32 v10, v96, v10
  v_fma_f32 v12, v12, v97, -v10
  v_accvgpr_read_b32 v13, a13
  v_accvgpr_read_b32 v10, a77
  v_mul_f32 v10, v96, v10
  v_fma_f32 v13, v13, v97, -v10
  v_cvt_pk_bf16_f32 v134, v12, v13
  v_accvgpr_read_b32 v12, a14
  v_accvgpr_read_b32 v10, a78
  v_mul_f32 v10, v96, v10
  v_fma_f32 v12, v12, v97, -v10
  v_accvgpr_read_b32 v13, a15
  v_accvgpr_read_b32 v10, a79
  v_mul_f32 v10, v96, v10
  v_fma_f32 v13, v13, v97, -v10
  v_cvt_pk_bf16_f32 v135, v12, v13
  v_accvgpr_read_b32 v12, a16
  v_accvgpr_read_b32 v10, a80
  v_mul_f32 v10, v96, v10
  v_fma_f32 v12, v12, v97, -v10
  v_accvgpr_read_b32 v13, a17
  v_accvgpr_read_b32 v10, a81
  v_mul_f32 v10, v96, v10
  v_fma_f32 v13, v13, v97, -v10
  v_cvt_pk_bf16_f32 v136, v12, v13
  v_accvgpr_read_b32 v12, a18
  v_accvgpr_read_b32 v10, a82
  v_mul_f32 v10, v96, v10
  v_fma_f32 v12, v12, v97, -v10
  v_accvgpr_read_b32 v13, a19
  v_accvgpr_read_b32 v10, a83
  v_mul_f32 v10, v96, v10
  v_fma_f32 v13, v13, v97, -v10
  v_cvt_pk_bf16_f32 v137, v12, v13
  v_accvgpr_read_b32 v12, a20
  v_accvgpr_read_b32 v10, a84
  v_mul_f32 v10, v96, v10
  v_fma_f32 v12, v12, v97, -v10
  v_accvgpr_read_b32 v13, a21
  v_accvgpr_read_b32 v10, a85
  v_mul_f32 v10, v96, v10
  v_fma_f32 v13, v13, v97, -v10
  v_cvt_pk_bf16_f32 v138, v12, v13
  v_accvgpr_read_b32 v12, a22
  v_accvgpr_read_b32 v10, a86
  v_mul_f32 v10, v96, v10
  v_fma_f32 v12, v12, v97, -v10
  v_accvgpr_read_b32 v13, a23
  v_accvgpr_read_b32 v10, a87
  v_mul_f32 v10, v96, v10
  v_fma_f32 v13, v13, v97, -v10
  v_cvt_pk_bf16_f32 v139, v12, v13
  v_accvgpr_read_b32 v12, a24
  v_accvgpr_read_b32 v10, a88
  v_mul_f32 v10, v96, v10
  v_fma_f32 v12, v12, v97, -v10
  v_accvgpr_read_b32 v13, a25
  v_accvgpr_read_b32 v10, a89
  v_mul_f32 v10, v96, v10
  v_fma_f32 v13, v13, v97, -v10
  v_cvt_pk_bf16_f32 v140, v12, v13
  v_accvgpr_read_b32 v12, a26
  v_accvgpr_read_b32 v10, a90
  v_mul_f32 v10, v96, v10
  v_fma_f32 v12, v12, v97, -v10
  v_accvgpr_read_b32 v13, a27
  v_accvgpr_read_b32 v10, a91
  v_mul_f32 v10, v96, v10
  v_fma_f32 v13, v13, v97, -v10
  v_cvt_pk_bf16_f32 v141, v12, v13
  v_accvgpr_read_b32 v12, a28
  v_accvgpr_read_b32 v10, a92
  v_mul_f32 v10, v96, v10
  v_fma_f32 v12, v12, v97, -v10
  v_accvgpr_read_b32 v13, a29
  v_accvgpr_read_b32 v10, a93
  v_mul_f32 v10, v96, v10
  v_fma_f32 v13, v13, v97, -v10
  v_cvt_pk_bf16_f32 v142, v12, v13
  v_accvgpr_read_b32 v12, a30
  v_accvgpr_read_b32 v10, a94
  v_mul_f32 v10, v96, v10
  v_fma_f32 v12, v12, v97, -v10
  v_accvgpr_read_b32 v13, a31
  v_accvgpr_read_b32 v10, a95
  v_mul_f32 v10, v96, v10
  v_fma_f32 v13, v13, v97, -v10
  v_cvt_pk_bf16_f32 v143, v12, v13
  v_accvgpr_read_b32 v12, a32
  v_accvgpr_read_b32 v10, a96
  v_mul_f32 v10, v96, v10
  v_fma_f32 v12, v12, v97, -v10
  v_accvgpr_read_b32 v13, a33
  v_accvgpr_read_b32 v10, a97
  v_mul_f32 v10, v96, v10
  v_fma_f32 v13, v13, v97, -v10
  v_cvt_pk_bf16_f32 v144, v12, v13
  v_accvgpr_read_b32 v12, a34
  v_accvgpr_read_b32 v10, a98
  v_mul_f32 v10, v96, v10
  v_fma_f32 v12, v12, v97, -v10
  v_accvgpr_read_b32 v13, a35
  v_accvgpr_read_b32 v10, a99
  v_mul_f32 v10, v96, v10
  v_fma_f32 v13, v13, v97, -v10
  v_cvt_pk_bf16_f32 v145, v12, v13
  v_accvgpr_read_b32 v12, a36
  v_accvgpr_read_b32 v10, a100
  v_mul_f32 v10, v96, v10
  v_fma_f32 v12, v12, v97, -v10
  v_accvgpr_read_b32 v13, a37
  v_accvgpr_read_b32 v10, a101
  v_mul_f32 v10, v96, v10
  v_fma_f32 v13, v13, v97, -v10
  v_cvt_pk_bf16_f32 v146, v12, v13
  v_accvgpr_read_b32 v12, a38
  v_accvgpr_read_b32 v10, a102
  v_mul_f32 v10, v96, v10
  v_fma_f32 v12, v12, v97, -v10
  v_accvgpr_read_b32 v13, a39
  v_accvgpr_read_b32 v10, a103
  v_mul_f32 v10, v96, v10
  v_fma_f32 v13, v13, v97, -v10
  v_cvt_pk_bf16_f32 v147, v12, v13
  v_accvgpr_read_b32 v12, a40
  v_accvgpr_read_b32 v10, a104
  v_mul_f32 v10, v96, v10
  v_fma_f32 v12, v12, v97, -v10
  v_accvgpr_read_b32 v13, a41
  v_accvgpr_read_b32 v10, a105
  v_mul_f32 v10, v96, v10
  v_fma_f32 v13, v13, v97, -v10
  v_cvt_pk_bf16_f32 v148, v12, v13
  v_accvgpr_read_b32 v12, a42
  v_accvgpr_read_b32 v10, a106
  v_mul_f32 v10, v96, v10
  v_fma_f32 v12, v12, v97, -v10
  v_accvgpr_read_b32 v13, a43
  v_accvgpr_read_b32 v10, a107
  v_mul_f32 v10, v96, v10
  v_fma_f32 v13, v13, v97, -v10
  v_cvt_pk_bf16_f32 v149, v12, v13
  v_accvgpr_read_b32 v12, a44
  v_accvgpr_read_b32 v10, a108
  v_mul_f32 v10, v96, v10
  v_fma_f32 v12, v12, v97, -v10
  v_accvgpr_read_b32 v13, a45
  v_accvgpr_read_b32 v10, a109
  v_mul_f32 v10, v96, v10
  v_fma_f32 v13, v13, v97, -v10
  v_cvt_pk_bf16_f32 v150, v12, v13
  v_accvgpr_read_b32 v12, a46
  v_accvgpr_read_b32 v10, a110
  v_mul_f32 v10, v96, v10
  v_fma_f32 v12, v12, v97, -v10
  v_accvgpr_read_b32 v13, a47
  v_accvgpr_read_b32 v10, a111
  v_mul_f32 v10, v96, v10
  v_fma_f32 v13, v13, v97, -v10
  v_cvt_pk_bf16_f32 v151, v12, v13
  v_accvgpr_read_b32 v12, a48
  v_accvgpr_read_b32 v10, a112
  v_mul_f32 v10, v96, v10
  v_fma_f32 v12, v12, v97, -v10
  v_accvgpr_read_b32 v13, a49
  v_accvgpr_read_b32 v10, a113
  v_mul_f32 v10, v96, v10
  v_fma_f32 v13, v13, v97, -v10
  v_cvt_pk_bf16_f32 v152, v12, v13
  v_accvgpr_read_b32 v12, a50
  v_accvgpr_read_b32 v10, a114
  v_mul_f32 v10, v96, v10
  v_fma_f32 v12, v12, v97, -v10
  v_accvgpr_read_b32 v13, a51
  v_accvgpr_read_b32 v10, a115
  v_mul_f32 v10, v96, v10
  v_fma_f32 v13, v13, v97, -v10
  v_cvt_pk_bf16_f32 v153, v12, v13
  v_accvgpr_read_b32 v12, a52
  v_accvgpr_read_b32 v10, a116
  v_mul_f32 v10, v96, v10
  v_fma_f32 v12, v12, v97, -v10
  v_accvgpr_read_b32 v13, a53
  v_accvgpr_read_b32 v10, a117
  v_mul_f32 v10, v96, v10
  v_fma_f32 v13, v13, v97, -v10
  v_cvt_pk_bf16_f32 v154, v12, v13
  v_accvgpr_read_b32 v12, a54
  v_accvgpr_read_b32 v10, a118
  v_mul_f32 v10, v96, v10
  v_fma_f32 v12, v12, v97, -v10
  v_accvgpr_read_b32 v13, a55
  v_accvgpr_read_b32 v10, a119
  v_mul_f32 v10, v96, v10
  v_fma_f32 v13, v13, v97, -v10
  v_cvt_pk_bf16_f32 v155, v12, v13
  v_accvgpr_read_b32 v12, a56
  v_accvgpr_read_b32 v10, a120
  v_mul_f32 v10, v96, v10
  v_fma_f32 v12, v12, v97, -v10
  v_accvgpr_read_b32 v13, a57
  v_accvgpr_read_b32 v10, a121
  v_mul_f32 v10, v96, v10
  v_fma_f32 v13, v13, v97, -v10
  v_cvt_pk_bf16_f32 v156, v12, v13
  v_accvgpr_read_b32 v12, a58
  v_accvgpr_read_b32 v10, a122
  v_mul_f32 v10, v96, v10
  v_fma_f32 v12, v12, v97, -v10
  v_accvgpr_read_b32 v13, a59
  v_accvgpr_read_b32 v10, a123
  v_mul_f32 v10, v96, v10
  v_fma_f32 v13, v13, v97, -v10
  v_cvt_pk_bf16_f32 v157, v12, v13
  v_accvgpr_read_b32 v12, a60
  v_accvgpr_read_b32 v10, a124
  v_mul_f32 v10, v96, v10
  v_fma_f32 v12, v12, v97, -v10
  v_accvgpr_read_b32 v13, a61
  v_accvgpr_read_b32 v10, a125
  v_mul_f32 v10, v96, v10
  v_fma_f32 v13, v13, v97, -v10
  v_cvt_pk_bf16_f32 v158, v12, v13
  v_accvgpr_read_b32 v12, a62
  v_accvgpr_read_b32 v10, a126
  v_mul_f32 v10, v96, v10
  v_fma_f32 v12, v12, v97, -v10
  v_accvgpr_read_b32 v13, a63
  v_accvgpr_read_b32 v10, a127
  v_mul_f32 v10, v96, v10
  v_fma_f32 v13, v13, v97, -v10
  v_cvt_pk_bf16_f32 v159, v12, v13
  s_and_b32 s29, s47, 1
  s_lshl_b32 s53, s20, 1
  s_add_u32 s53, s53, s29
  s_lshl_b32 s53, s53, 7
  s_add_u32 s53, s53, 4096
  s_lshr_b32 s52, s47, 1
  s_add_u32 s52, s52, 1
  s_lshl_b32 s52, s52, 2
  s_mov_b32 s26, 0
Lwf_103:
  buffer_load_dword v10, off, s[4:7], s53 sc1
  s_waitcnt vmcnt(0)
  v_readfirstlane_b32 s29, v10
  s_nop 0
  s_cmp_ge_u32 s29, s52
  s_nop 1
  s_cbranch_scc1 Lwf_104
  s_sleep 0
  s_add_u32 s26, s26, 1
  s_cmp_lt_u32 s26, 0x100000
  s_cbranch_scc1 Lwf_103
  s_branch L_end
Lwf_104:
  s_lshl_b32 s57, s47, 18
  s_lshl_b32 s29, s20, 13
  s_add_u32 s57, s57, s29
  s_add_u32 s54, s57, 33554432
  buffer_load_dwordx4 v[160:163], v6, s[4:7], s54 offen offset:0 sc1
  buffer_load_dwordx4 v[164:167], v6, s[4:7], s54 offen offset:1024 sc1
  buffer_load_dwordx4 v[168:171], v6, s[4:7], s54 offen offset:2048 sc1
  buffer_load_dwordx4 v[172:175], v6, s[4:7], s54 offen offset:3072 sc1
  s_add_u32 s54, s57, 33558528
  buffer_load_dwordx4 v[176:179], v6, s[4:7], s54 offen offset:0 sc1
  buffer_load_dwordx4 v[180:183], v6, s[4:7], s54 offen offset:1024 sc1
  buffer_load_dwordx4 v[184:187], v6, s[4:7], s54 offen offset:2048 sc1
  buffer_load_dwordx4 v[188:191], v6, s[4:7], s54 offen offset:3072 sc1
  s_add_u32 s54, s57, 67108864
  buffer_load_dwordx4 v[192:195], v1, s[4:7], s54 offen offset:0 sc1
  buffer_load_dwordx4 v[196:199], v1, s[4:7], s54 offen offset:1024 sc1
  buffer_load_dwordx4 v[200:203], v1, s[4:7], s54 offen offset:2048 sc1
  buffer_load_dwordx4 v[204:207], v1, s[4:7], s54 offen offset:3072 sc1
  s_add_u32 s54, s57, 67112960
  buffer_load_dwordx4 v[208:211], v1, s[4:7], s54 offen offset:0 sc1
  buffer_load_dwordx4 v[212:215], v1, s[4:7], s54 offen offset:1024 sc1
  buffer_load_dwordx4 v[216:219], v1, s[4:7], s54 offen offset:2048 sc1
  buffer_load_dwordx4 v[220:223], v1, s[4:7], s54 offen offset:3072 sc1
  s_waitcnt vmcnt(15)
  v_mfma_f32_32x32x16_bf16 v[16:31], v[160:163], v[128:131], v[104:119]
  s_waitcnt vmcnt(14)
  v_mfma_f32_32x32x16_bf16 v[16:31], v[164:167], v[132:135], v[16:31]
  s_waitcnt vmcnt(13)
  v_mfma_f32_32x32x16_bf16 v[16:31], v[168:171], v[136:139], v[16:31]
  s_waitcnt vmcnt(12)
  v_mfma_f32_32x32x16_bf16 v[16:31], v[172:175], v[140:143], v[16:31]
  s_waitcnt vmcnt(11)
  v_mfma_f32_32x32x16_bf16 v[16:31], v[176:179], v[144:147], v[16:31]
  s_waitcnt vmcnt(10)
  v_mfma_f32_32x32x16_bf16 v[16:31], v[180:183], v[148:151], v[16:31]
  s_waitcnt vmcnt(9)
  v_mfma_f32_32x32x16_bf16 v[16:31], v[184:187], v[152:155], v[16:31]
  s_waitcnt vmcnt(8)
  v_mfma_f32_32x32x16_bf16 v[16:31], v[188:191], v[156:159], v[16:31]
  s_lshl_b32 s67, s20, 7
  s_add_u32 s67, s67, 0
  s_and_b32 s29, s47, 63
  s_cmp_ge_u32 s29, 56
  s_cselect_b32 s69, 1, 0
  s_cselect_b32 s29, -5, 1
  s_add_u32 s52, s47, s29
  s_mov_b32 s58, 0
  s_nop 3
Lqk_105:
  s_lshr_b32 s54, s57, 2
  s_add_u32 s54, s54, 2162688
  s_mov_b32 s26, 0
Lwf_108:
  buffer_load_dword v10, off, s[4:7], s67 sc1
  s_waitcnt vmcnt(0)
  v_readfirstlane_b32 s29, v10
  s_nop 0
  s_cmp_ge_u32 s29, s52
  s_nop 1
  s_cbranch_scc1 Lwf_109
  s_sleep 0
  s_add_u32 s26, s26, 1
  s_cmp_lt_u32 s26, 0x100000
  s_cbranch_scc1 Lwf_108
  s_branch L_end
Lwf_109:
  s_cmp_eq_u32 s69, 0
  s_cbranch_scc1 Lqk_106
  v_and_b32 v12, 0x600, v9
  v_add_u32 v12, 0, v12
  s_nop 1
Lqk_106w:
  buffer_load_dword v10, v12, s[4:7], s54 offen sc1
  s_add_u32 s58, s58, 1
  s_cmp_gt_u32 s58, 8192
  s_cbranch_scc1 Lqk_106
  s_waitcnt vmcnt(0)
  v_cmp_eq_u32 vcc, -1, v10
  s_cbranch_vccnz Lqk_106w
  s_nop 3
Lqk_106:
  s_lshr_b32 s53, s57, 2
  s_add_u32 s54, s53, 2162688
  s_add_u32 s53, s53, 10616832
  buffer_load_dwordx4 v[224:227], v7, s[4:7], s54 offen offset:0 sc1
  buffer_load_dwordx4 v[228:231], v7, s[4:7], s54 offen offset:256 sc1
  buffer_load_dwordx4 v[232:235], v7, s[4:7], s54 offen offset:512 sc1
  buffer_load_dwordx4 v[236:239], v7, s[4:7], s54 offen offset:768 sc1
  buffer_load_dwordx4 v[240:243], v7, s[4:7], s54 offen offset:1024 sc1
  buffer_load_dwordx4 v[244:247], v7, s[4:7], s54 offen offset:1280 sc1
  buffer_load_dwordx4 v[248:251], v7, s[4:7], s54 offen offset:1536 sc1
  buffer_load_dwordx4 v[252:255], v7, s[4:7], s54 offen offset:1792 sc1
  buffer_load_dwordx2 v[64:65], v8, s[4:7], s53 offen offset:0 sc1
  v_mov_b64 v[66:67], 0
  buffer_load_dwordx2 v[68:69], v8, s[4:7], s53 offen offset:512 sc1
  v_mov_b64 v[70:71], 0
  buffer_load_dwordx2 v[72:73], v8, s[4:7], s53 offen offset:1024 sc1
  v_mov_b64 v[74:75], 0
  buffer_load_dwordx2 v[76:77], v8, s[4:7], s53 offen offset:1536 sc1
  v_mov_b64 v[78:79], 0
  s_cmp_eq_u32 s69, 0
  s_cbranch_scc1 Lqk_107
  s_waitcnt vmcnt(0)
  v_max3_u32 v10, v224, v225, v226
  v_max3_u32 v10, v10, v227, v228
  v_max3_u32 v10, v10, v229, v230
  v_max3_u32 v10, v10, v231, v232
  v_max3_u32 v10, v10, v233, v234
  v_max3_u32 v10, v10, v235, v236
  v_max3_u32 v10, v10, v237, v238
  v_max3_u32 v10, v10, v239, v240
  v_max3_u32 v10, v10, v241, v242
  v_max3_u32 v10, v10, v243, v244
  v_max3_u32 v10, v10, v245, v246
  v_max3_u32 v10, v10, v247, v248
  v_max3_u32 v10, v10, v249, v250
  v_max3_u32 v10, v10, v251, v252
  v_max3_u32 v10, v10, v253, v254
  v_max3_u32 v10, v10, v255, v64
  v_max3_u32 v10, v10, v65, v68
  v_max3_u32 v10, v10, v69, v72
  v_max3_u32 v10, v10, v73, v76
  v_max_u32 v10, v10, v77
  v_cmp_eq_u32 vcc, -1, v10
  s_cbranch_vccz Lqk_107
  s_add_u32 s58, s58, 1
  s_cmp_lt_u32 s58, 8192
  s_cbranch_scc1 Lqk_106w
  s_mov_b32 s69, 0
  s_add_u32 s52, s47, 1
  s_branch Lqk_105
Lqk_107:
  s_waitcnt vmcnt(11)
  v_mfma_f32_32x32x16_bf16 v[32:47], v[224:227], v[128:131], 0
  s_waitcnt vmcnt(10)
  v_mfma_f32_32x32x16_bf16 v[32:47], v[228:231], v[132:135], v[32:47]
  s_waitcnt vmcnt(9)
  v_mfma_f32_32x32x16_bf16 v[32:47], v[232:235], v[136:139], v[32:47]
  s_waitcnt vmcnt(8)
  v_mfma_f32_32x32x16_bf16 v[32:47], v[236:239], v[140:143], v[32:47]
  s_waitcnt vmcnt(7)
  v_mfma_f32_32x32x16_bf16 v[32:47], v[240:243], v[144:147], v[32:47]
  s_waitcnt vmcnt(6)
  v_mfma_f32_32x32x16_bf16 v[32:47], v[244:247], v[148:151], v[32:47]
  s_waitcnt vmcnt(5)
  v_mfma_f32_32x32x16_bf16 v[32:47], v[248:251], v[152:155], v[32:47]
  s_waitcnt vmcnt(4)
  v_mfma_f32_32x32x16_bf16 v[32:47], v[252:255], v[156:159], v[32:47]
  v_max3_f32 v10, v16, v17, v18
  v_max3_f32 v10, v10, v19, v20
  v_max3_f32 v10, v10, v21, v22
  v_max3_f32 v10, v10, v23, v24
  v_max3_f32 v10, v10, v25, v26
  v_max3_f32 v10, v10, v27, v28
  v_max3_f32 v10, v10, v29, v30
  s_nop 4
  v_max3_f32 v10, v10, v31, v32
  v_max3_f32 v10, v10, v33, v34
  v_max_f32 v10, v10, v35
  v_mov_b32 v11, v10
  s_nop 1
  v_permlane32_swap_b32 v10, v11
  v_max_f32 v10, v10, v11
  v_sub_f32 v16, v16, v10
  v_exp_f32 v16, v16
  v_sub_f32 v17, v17, v10
  v_exp_f32 v17, v17
  v_sub_f32 v18, v18, v10
  v_exp_f32 v18, v18
  v_sub_f32 v19, v19, v10
  v_exp_f32 v19, v19
  v_sub_f32 v20, v20, v10
  v_exp_f32 v20, v20
  v_sub_f32 v21, v21, v10
  v_exp_f32 v21, v21
  v_sub_f32 v22, v22, v10
  v_exp_f32 v22, v22
  v_sub_f32 v23, v23, v10
  v_exp_f32 v23, v23
  v_sub_f32 v24, v24, v10
  v_exp_f32 v24, v24
  v_sub_f32 v25, v25, v10
  v_exp_f32 v25, v25
  v_sub_f32 v26, v26, v10
  v_exp_f32 v26, v26
  v_sub_f32 v27, v27, v10
  v_exp_f32 v27, v27
  v_sub_f32 v28, v28, v10
  v_exp_f32 v28, v28
  v_sub_f32 v29, v29, v10
  v_exp_f32 v29, v29
  v_sub_f32 v30, v30, v10
  v_exp_f32 v30, v30
  v_sub_f32 v31, v31, v10
  v_exp_f32 v31, v31
  v_sub_f32 v32, v32, v10
  v_exp_f32 v32, v32
  v_sub_f32 v33, v33, v10
  v_exp_f32 v33, v33
  v_sub_f32 v34, v34, v10
  v_exp_f32 v34, v34
  v_sub_f32 v35, v35, v10
  v_exp_f32 v35, v35
  v_cvt_pk_bf16_f32 v48, v16, v17
  v_cvt_pk_bf16_f32 v49, v18, v19
  v_cvt_pk_bf16_f32 v50, v20, v21
  v_cvt_pk_bf16_f32 v51, v22, v23
  v_cvt_pk_bf16_f32 v52, v24, v25
  v_cvt_pk_bf16_f32 v53, v26, v27
  v_cvt_pk_bf16_f32 v54, v28, v29
  v_cvt_pk_bf16_f32 v55, v30, v31
  v_cvt_pk_bf16_f32 v56, v32, v33
  v_cvt_pk_bf16_f32 v57, v34, v35
  v_mov_b64 v[58:59], 0
  s_waitcnt vmcnt(0)
  v_mfma_f32_32x32x16_bf16 v[16:31], v[100:103], v[48:51], 0
  v_mfma_f32_32x32x16_bf16 v[16:31], v[100:103], v[52:55], v[16:31]
  v_mfma_f32_32x32x16_bf16 v[16:31], v[100:103], v[56:59], v[16:31]
  v_mfma_f32_32x32x16_bf16 a[0:15], v[192:195], v[48:51], 0
  v_mfma_f32_32x32x16_bf16 a[0:15], v[196:199], v[52:55], a[0:15]
  v_mfma_f32_32x32x16_bf16 a[0:15], v[64:67], v[56:59], a[0:15]
  v_mfma_f32_32x32x16_bf16 a[16:31], v[200:203], v[48:51], 0
  v_mfma_f32_32x32x16_bf16 a[16:31], v[204:207], v[52:55], a[16:31]
  v_mfma_f32_32x32x16_bf16 a[16:31], v[68:71], v[56:59], a[16:31]
  v_mfma_f32_32x32x16_bf16 a[32:47], v[208:211], v[48:51], 0
  v_mfma_f32_32x32x16_bf16 a[32:47], v[212:215], v[52:55], a[32:47]
  v_mfma_f32_32x32x16_bf16 a[32:47], v[72:75], v[56:59], a[32:47]
  v_mfma_f32_32x32x16_bf16 a[48:63], v[216:219], v[48:51], 0
  v_mfma_f32_32x32x16_bf16 a[48:63], v[220:223], v[52:55], a[48:63]
  v_mfma_f32_32x32x16_bf16 a[48:63], v[76:79], v[56:59], a[48:63]
  v_rcp_f32 v11, v16
  s_add_u32 s53, s57, 100663296
  s_add_u32 s54, s53, 4096
  v_accvgpr_read_b32 v12, a0
  v_accvgpr_read_b32 v13, a1
  v_mul_f32 v12, v12, v11
  v_mul_f32 v13, v13, v11
  v_cvt_pk_bf16_f32 v160, v12, v13
  v_accvgpr_read_b32 v12, a2
  v_accvgpr_read_b32 v13, a3
  v_mul_f32 v12, v12, v11
  v_mul_f32 v13, v13, v11
  v_cvt_pk_bf16_f32 v161, v12, v13
  v_accvgpr_read_b32 v12, a4
  v_accvgpr_read_b32 v13, a5
  v_mul_f32 v12, v12, v11
  v_mul_f32 v13, v13, v11
  v_cvt_pk_bf16_f32 v162, v12, v13
  v_accvgpr_read_b32 v12, a6
  v_accvgpr_read_b32 v13, a7
  v_mul_f32 v12, v12, v11
  v_mul_f32 v13, v13, v11
  v_cvt_pk_bf16_f32 v163, v12, v13
  buffer_store_dwordx4 v[160:163], v1, s[4:7], s53 offen offset:0 sc1
  v_accvgpr_read_b32 v12, a8
  v_accvgpr_read_b32 v13, a9
  v_mul_f32 v12, v12, v11
  v_mul_f32 v13, v13, v11
  v_cvt_pk_bf16_f32 v164, v12, v13
  v_accvgpr_read_b32 v12, a10
  v_accvgpr_read_b32 v13, a11
  v_mul_f32 v12, v12, v11
  v_mul_f32 v13, v13, v11
  v_cvt_pk_bf16_f32 v165, v12, v13
  v_accvgpr_read_b32 v12, a12
  v_accvgpr_read_b32 v13, a13
  v_mul_f32 v12, v12, v11
  v_mul_f32 v13, v13, v11
  v_cvt_pk_bf16_f32 v166, v12, v13
  v_accvgpr_read_b32 v12, a14
  v_accvgpr_read_b32 v13, a15
  v_mul_f32 v12, v12, v11
  v_mul_f32 v13, v13, v11
  v_cvt_pk_bf16_f32 v167, v12, v13
  buffer_store_dwordx4 v[164:167], v1, s[4:7], s53 offen offset:1024 sc1
  v_accvgpr_read_b32 v12, a16
  v_accvgpr_read_b32 v13, a17
  v_mul_f32 v12, v12, v11
  v_mul_f32 v13, v13, v11
  v_cvt_pk_bf16_f32 v168, v12, v13
  v_accvgpr_read_b32 v12, a18
  v_accvgpr_read_b32 v13, a19
  v_mul_f32 v12, v12, v11
  v_mul_f32 v13, v13, v11
  v_cvt_pk_bf16_f32 v169, v12, v13
  v_accvgpr_read_b32 v12, a20
  v_accvgpr_read_b32 v13, a21
  v_mul_f32 v12, v12, v11
  v_mul_f32 v13, v13, v11
  v_cvt_pk_bf16_f32 v170, v12, v13
  v_accvgpr_read_b32 v12, a22
  v_accvgpr_read_b32 v13, a23
  v_mul_f32 v12, v12, v11
  v_mul_f32 v13, v13, v11
  v_cvt_pk_bf16_f32 v171, v12, v13
  buffer_store_dwordx4 v[168:171], v1, s[4:7], s53 offen offset:2048 sc1
  v_accvgpr_read_b32 v12, a24
  v_accvgpr_read_b32 v13, a25
  v_mul_f32 v12, v12, v11
  v_mul_f32 v13, v13, v11
  v_cvt_pk_bf16_f32 v172, v12, v13
  v_accvgpr_read_b32 v12, a26
  v_accvgpr_read_b32 v13, a27
  v_mul_f32 v12, v12, v11
  v_mul_f32 v13, v13, v11
  v_cvt_pk_bf16_f32 v173, v12, v13
  v_accvgpr_read_b32 v12, a28
  v_accvgpr_read_b32 v13, a29
  v_mul_f32 v12, v12, v11
  v_mul_f32 v13, v13, v11
  v_cvt_pk_bf16_f32 v174, v12, v13
  v_accvgpr_read_b32 v12, a30
  v_accvgpr_read_b32 v13, a31
  v_mul_f32 v12, v12, v11
  v_mul_f32 v13, v13, v11
  v_cvt_pk_bf16_f32 v175, v12, v13
  buffer_store_dwordx4 v[172:175], v1, s[4:7], s53 offen offset:3072 sc1
  v_accvgpr_read_b32 v12, a32
  v_accvgpr_read_b32 v13, a33
  v_mul_f32 v12, v12, v11
  v_mul_f32 v13, v13, v11
  v_cvt_pk_bf16_f32 v176, v12, v13
  v_accvgpr_read_b32 v12, a34
  v_accvgpr_read_b32 v13, a35
  v_mul_f32 v12, v12, v11
  v_mul_f32 v13, v13, v11
  v_cvt_pk_bf16_f32 v177, v12, v13
  v_accvgpr_read_b32 v12, a36
  v_accvgpr_read_b32 v13, a37
  v_mul_f32 v12, v12, v11
  v_mul_f32 v13, v13, v11
  v_cvt_pk_bf16_f32 v178, v12, v13
  v_accvgpr_read_b32 v12, a38
  v_accvgpr_read_b32 v13, a39
  v_mul_f32 v12, v12, v11
  v_mul_f32 v13, v13, v11
  v_cvt_pk_bf16_f32 v179, v12, v13
  buffer_store_dwordx4 v[176:179], v1, s[4:7], s54 offen offset:0 sc1
  v_accvgpr_read_b32 v12, a40
  v_accvgpr_read_b32 v13, a41
  v_mul_f32 v12, v12, v11
  v_mul_f32 v13, v13, v11
  v_cvt_pk_bf16_f32 v180, v12, v13
  v_accvgpr_read_b32 v12, a42
  v_accvgpr_read_b32 v13, a43
  v_mul_f32 v12, v12, v11
  v_mul_f32 v13, v13, v11
  v_cvt_pk_bf16_f32 v181, v12, v13
  v_accvgpr_read_b32 v12, a44
  v_accvgpr_read_b32 v13, a45
  v_mul_f32 v12, v12, v11
  v_mul_f32 v13, v13, v11
  v_cvt_pk_bf16_f32 v182, v12, v13
  v_accvgpr_read_b32 v12, a46
  v_accvgpr_read_b32 v13, a47
  v_mul_f32 v12, v12, v11
  v_mul_f32 v13, v13, v11
  v_cvt_pk_bf16_f32 v183, v12, v13
  buffer_store_dwordx4 v[180:183], v1, s[4:7], s54 offen offset:1024 sc1
  v_accvgpr_read_b32 v12, a48
  v_accvgpr_read_b32 v13, a49
  v_mul_f32 v12, v12, v11
  v_mul_f32 v13, v13, v11
  v_cvt_pk_bf16_f32 v184, v12, v13
  v_accvgpr_read_b32 v12, a50
  v_accvgpr_read_b32 v13, a51
  v_mul_f32 v12, v12, v11
  v_mul_f32 v13, v13, v11
  v_cvt_pk_bf16_f32 v185, v12, v13
  v_accvgpr_read_b32 v12, a52
  v_accvgpr_read_b32 v13, a53
  v_mul_f32 v12, v12, v11
  v_mul_f32 v13, v13, v11
  v_cvt_pk_bf16_f32 v186, v12, v13
  v_accvgpr_read_b32 v12, a54
  v_accvgpr_read_b32 v13, a55
  v_mul_f32 v12, v12, v11
  v_mul_f32 v13, v13, v11
  v_cvt_pk_bf16_f32 v187, v12, v13
  buffer_store_dwordx4 v[184:187], v1, s[4:7], s54 offen offset:2048 sc1
  v_accvgpr_read_b32 v12, a56
  v_accvgpr_read_b32 v13, a57
  v_mul_f32 v12, v12, v11
  v_mul_f32 v13, v13, v11
  v_cvt_pk_bf16_f32 v188, v12, v13
  v_accvgpr_read_b32 v12, a58
  v_accvgpr_read_b32 v13, a59
  v_mul_f32 v12, v12, v11
  v_mul_f32 v13, v13, v11
  v_cvt_pk_bf16_f32 v189, v12, v13
  v_accvgpr_read_b32 v12, a60
  v_accvgpr_read_b32 v13, a61
  v_mul_f32 v12, v12, v11
  v_mul_f32 v13, v13, v11
  v_cvt_pk_bf16_f32 v190, v12, v13
  v_accvgpr_read_b32 v12, a62
  v_accvgpr_read_b32 v13, a63
  v_mul_f32 v12, v12, v11
  v_mul_f32 v13, v13, v11
  v_cvt_pk_bf16_f32 v191, v12, v13
  buffer_store_dwordx4 v[188:191], v1, s[4:7], s54 offen offset:3072 sc1
  s_lshl_b32 s53, s47, 7
  s_add_u32 s53, s53, 12288
  s_waitcnt vmcnt(0)
  v_mov_b32 v10, 1
  s_mov_b64 exec, 1
  buffer_atomic_add v10, off, s[4:7], s53 sc1
  s_mov_b64 exec, -1
  s_add_u32 s47, s47, 8
  s_branch Lqa_99
Lqa_100:
  s_branch L_end
L_a2:
  s_sub_u32 s29, s75, 22
  s_and_b32 s20, s29, 3
  s_lshr_b32 s46, s29, 2
  v_lshlrev_b32 v1, 4, v0
  v_and_b32 v2, 31, v0
  v_lshrrev_b32 v3, 5, v0
  v_bfe_u32 v4, v0, 2, 2
  s_mov_b32 s70, 0x358637bd
  s_mov_b32 s71, 0x358637bd
  s_mov_b32 s73, 0x3fb8aa3b
  s_mov_b32 s72, 0x3fb8aa3b
  s_mov_b32 s59, 0x3b000000
  s_mov_b32 s60, 0x3727c5ac
  v_mov_b32 v100, 0x3f803f80
  v_mov_b32 v101, 0x3f803f80
  v_mov_b32 v102, 0x3f803f80
  v_mov_b32 v103, 0x3f803f80
  v_mov_b32 v5, v1
  s_lshl_b32 s29, s21, 13
  v_add_u32 v6, s29, v1
  s_lshl_b32 s29, s21, 8
  s_add_u32 s29, s29, 67584
  v_lshlrev_b32 v7, 2, v2
  v_add_u32 v7, s29, v7
  v_lshlrev_b32 v8, 4, v3
  v_add_u32 v8, s29, v8
  s_load_dwordx2 s[8:9], s[0:1], 16
  s_waitcnt lgkmcnt(0)
  s_and_b32 s9, s9, 0xffff
  s_mov_b32 s10, 524288
  s_mov_b32 s11, 0x20000
  s_lshl_b32 s57, s20, 8
  s_lshl_b32 s29, s21, 6
  s_add_u32 s57, s57, s29
  v_lshrrev_b32 v10, 2, v0
  s_mov_b32 s29, 1024
  v_mul_lo_u32 v10, v10, s29
  v_and_b32 v12, 3, v0
  v_lshl_add_u32 v10, v12, 4, v10
  v_lshl_add_u32 v13, v3, 2, v4
  v_mul_u32_u24 v13, 64, v13
  v_bfe_u32 v12, v0, 4, 1
  v_lshl_add_u32 v13, v12, 5, v13
  v_and_b32 v12, 3, v0
  v_lshl_add_u32 v13, v12, 3, v13
  s_mul_i32 s83, s21, 32768
  s_add_u32 s83, s83, 0
  v_add_u32 v13, s83, v13
  s_waitcnt lgkmcnt(0)
  s_add_u32 m0, s83, 0
  s_add_u32 s54, s57, 0
  buffer_load_dwordx4 v10, s[8:11], s54 offen lds
  s_add_u32 m0, s83, 1024
  s_add_u32 s54, s57, 16384
  buffer_load_dwordx4 v10, s[8:11], s54 offen lds
  s_add_u32 m0, s83, 2048
  s_add_u32 s54, s57, 32768
  buffer_load_dwordx4 v10, s[8:11], s54 offen lds
  s_add_u32 m0, s83, 3072
  s_add_u32 s54, s57, 49152
  buffer_load_dwordx4 v10, s[8:11], s54 offen lds
  s_add_u32 m0, s83, 4096
  s_add_u32 s54, s57, 65536
  buffer_load_dwordx4 v10, s[8:11], s54 offen lds
  s_add_u32 m0, s83, 5120
  s_add_u32 s54, s57, 81920
  buffer_load_dwordx4 v10, s[8:11], s54 offen lds
  s_add_u32 m0, s83, 6144
  s_add_u32 s54, s57, 98304
  buffer_load_dwordx4 v10, s[8:11], s54 offen lds
  s_add_u32 m0, s83, 7168
  s_add_u32 s54, s57, 114688
  buffer_load_dwordx4 v10, s[8:11], s54 offen lds
  s_add_u32 m0, s83, 8192
  s_add_u32 s54, s57, 131072
  buffer_load_dwordx4 v10, s[8:11], s54 offen lds
  s_add_u32 m0, s83, 9216
  s_add_u32 s54, s57, 147456
  buffer_load_dwordx4 v10, s[8:11], s54 offen lds
  s_add_u32 m0, s83, 10240
  s_add_u32 s54, s57, 163840
  buffer_load_dwordx4 v10, s[8:11], s54 offen lds
  s_add_u32 m0, s83, 11264
  s_add_u32 s54, s57, 180224
  buffer_load_dwordx4 v10, s[8:11], s54 offen lds
  s_add_u32 m0, s83, 12288
  s_add_u32 s54, s57, 196608
  buffer_load_dwordx4 v10, s[8:11], s54 offen lds
  s_add_u32 m0, s83, 13312
  s_add_u32 s54, s57, 212992
  buffer_load_dwordx4 v10, s[8:11], s54 offen lds
  s_add_u32 m0, s83, 14336
  s_add_u32 s54, s57, 229376
  buffer_load_dwordx4 v10, s[8:11], s54 offen lds
  s_add_u32 m0, s83, 15360
  s_add_u32 s54, s57, 245760
  buffer_load_dwordx4 v10, s[8:11], s54 offen lds
  s_add_u32 m0, s83, 16384
  s_add_u32 s54, s57, 262144
  buffer_load_dwordx4 v10, s[8:11], s54 offen lds
  s_add_u32 m0, s83, 17408
  s_add_u32 s54, s57, 278528
  buffer_load_dwordx4 v10, s[8:11], s54 offen lds
  s_add_u32 m0, s83, 18432
  s_add_u32 s54, s57, 294912
  buffer_load_dwordx4 v10, s[8:11], s54 offen lds
  s_add_u32 m0, s83, 19456
  s_add_u32 s54, s57, 311296
  buffer_load_dwordx4 v10, s[8:11], s54 offen lds
  s_add_u32 m0, s83, 20480
  s_add_u32 s54, s57, 327680
  buffer_load_dwordx4 v10, s[8:11], s54 offen lds
  s_add_u32 m0, s83, 21504
  s_add_u32 s54, s57, 344064
  buffer_load_dwordx4 v10, s[8:11], s54 offen lds
  s_add_u32 m0, s83, 22528
  s_add_u32 s54, s57, 360448
  buffer_load_dwordx4 v10, s[8:11], s54 offen lds
  s_add_u32 m0, s83, 23552
  s_add_u32 s54, s57, 376832
  buffer_load_dwordx4 v10, s[8:11], s54 offen lds
  s_add_u32 m0, s83, 24576
  s_add_u32 s54, s57, 393216
  buffer_load_dwordx4 v10, s[8:11], s54 offen lds
  s_add_u32 m0, s83, 25600
  s_add_u32 s54, s57, 409600
  buffer_load_dwordx4 v10, s[8:11], s54 offen lds
  s_add_u32 m0, s83, 26624
  s_add_u32 s54, s57, 425984
  buffer_load_dwordx4 v10, s[8:11], s54 offen lds
  s_add_u32 m0, s83, 27648
  s_add_u32 s54, s57, 442368
  buffer_load_dwordx4 v10, s[8:11], s54 offen lds
  s_add_u32 m0, s83, 28672
  s_add_u32 s54, s57, 458752
  buffer_load_dwordx4 v10, s[8:11], s54 offen lds
  s_add_u32 m0, s83, 29696
  s_add_u32 s54, s57, 475136
  buffer_load_dwordx4 v10, s[8:11], s54 offen lds
  s_add_u32 m0, s83, 30720
  s_add_u32 s54, s57, 491520
  buffer_load_dwordx4 v10, s[8:11], s54 offen lds
  s_add_u32 m0, s83, 31744
  s_add_u32 s54, s57, 507904
  buffer_load_dwordx4 v10, s[8:11], s54 offen lds
  s_waitcnt vmcnt(24)
  ds_read_b64_tr_b16 a[0:1], v13 offset:0
  ds_read_b64_tr_b16 a[2:3], v13 offset:512
  ds_read_b64_tr_b16 a[4:5], v13 offset:1024
  ds_read_b64_tr_b16 a[6:7], v13 offset:1536
  ds_read_b64_tr_b16 a[8:9], v13 offset:2048
  ds_read_b64_tr_b16 a[10:11], v13 offset:2560
  ds_read_b64_tr_b16 a[12:13], v13 offset:3072
  ds_read_b64_tr_b16 a[14:15], v13 offset:3584
  ds_read_b64_tr_b16 a[16:17], v13 offset:4096
  ds_read_b64_tr_b16 a[18:19], v13 offset:4608
  ds_read_b64_tr_b16 a[20:21], v13 offset:5120
  ds_read_b64_tr_b16 a[22:23], v13 offset:5632
  ds_read_b64_tr_b16 a[24:25], v13 offset:6144
  ds_read_b64_tr_b16 a[26:27], v13 offset:6656
  ds_read_b64_tr_b16 a[28:29], v13 offset:7168
  ds_read_b64_tr_b16 a[30:31], v13 offset:7680
  s_waitcnt lgkmcnt(0)
  s_waitcnt vmcnt(16)
  ds_read_b64_tr_b16 a[32:33], v13 offset:8192
  ds_read_b64_tr_b16 a[34:35], v13 offset:8704
  ds_read_b64_tr_b16 a[36:37], v13 offset:9216
  ds_read_b64_tr_b16 a[38:39], v13 offset:9728
  ds_read_b64_tr_b16 a[40:41], v13 offset:10240
  ds_read_b64_tr_b16 a[42:43], v13 offset:10752
  ds_read_b64_tr_b16 a[44:45], v13 offset:11264
  ds_read_b64_tr_b16 a[46:47], v13 offset:11776
  ds_read_b64_tr_b16 a[48:49], v13 offset:12288
  ds_read_b64_tr_b16 a[50:51], v13 offset:12800
  ds_read_b64_tr_b16 a[52:53], v13 offset:13312
  ds_read_b64_tr_b16 a[54:55], v13 offset:13824
  ds_read_b64_tr_b16 a[56:57], v13 offset:14336
  ds_read_b64_tr_b16 a[58:59], v13 offset:14848
  ds_read_b64_tr_b16 a[60:61], v13 offset:15360
  ds_read_b64_tr_b16 a[62:63], v13 offset:15872
  s_waitcnt lgkmcnt(0)
  s_waitcnt vmcnt(8)
  ds_read_b64_tr_b16 a[64:65], v13 offset:16384
  ds_read_b64_tr_b16 a[66:67], v13 offset:16896
  ds_read_b64_tr_b16 a[68:69], v13 offset:17408
  ds_read_b64_tr_b16 a[70:71], v13 offset:17920
  ds_read_b64_tr_b16 a[72:73], v13 offset:18432
  ds_read_b64_tr_b16 a[74:75], v13 offset:18944
  ds_read_b64_tr_b16 a[76:77], v13 offset:19456
  ds_read_b64_tr_b16 a[78:79], v13 offset:19968
  ds_read_b64_tr_b16 a[80:81], v13 offset:20480
  ds_read_b64_tr_b16 a[82:83], v13 offset:20992
  ds_read_b64_tr_b16 a[84:85], v13 offset:21504
  ds_read_b64_tr_b16 a[86:87], v13 offset:22016
  ds_read_b64_tr_b16 a[88:89], v13 offset:22528
  ds_read_b64_tr_b16 a[90:91], v13 offset:23040
  ds_read_b64_tr_b16 a[92:93], v13 offset:23552
  ds_read_b64_tr_b16 a[94:95], v13 offset:24064
  s_waitcnt lgkmcnt(0)
  s_waitcnt vmcnt(0)
  ds_read_b64_tr_b16 a[96:97], v13 offset:24576
  ds_read_b64_tr_b16 a[98:99], v13 offset:25088
  ds_read_b64_tr_b16 a[100:101], v13 offset:25600
  ds_read_b64_tr_b16 a[102:103], v13 offset:26112
  ds_read_b64_tr_b16 a[104:105], v13 offset:26624
  ds_read_b64_tr_b16 a[106:107], v13 offset:27136
  ds_read_b64_tr_b16 a[108:109], v13 offset:27648
  ds_read_b64_tr_b16 a[110:111], v13 offset:28160
  ds_read_b64_tr_b16 a[112:113], v13 offset:28672
  ds_read_b64_tr_b16 a[114:115], v13 offset:29184
  ds_read_b64_tr_b16 a[116:117], v13 offset:29696
  ds_read_b64_tr_b16 a[118:119], v13 offset:30208
  ds_read_b64_tr_b16 a[120:121], v13 offset:30720
  ds_read_b64_tr_b16 a[122:123], v13 offset:31232
  ds_read_b64_tr_b16 a[124:125], v13 offset:31744
  ds_read_b64_tr_b16 a[126:127], v13 offset:32256
  s_waitcnt lgkmcnt(0)
  s_barrier
  s_mov_b32 s12, s92
  s_and_b32 s13, s93, 0xffff
  s_mov_b32 s14, 256
  s_mov_b32 s15, 0x20000
  s_mov_b32 s26, 0
Lwi_111:
  buffer_load_dword v10, off, s[12:15], 0 offset:12 sc1
  s_waitcnt vmcnt(0)
  v_readfirstlane_b32 s29, v10
  s_nop 0
  s_cmp_ge_u32 s29, 4
  s_nop 1
  s_cbranch_scc1 Lwi_112
  s_sleep 2
  s_add_u32 s26, s26, 1
  s_cmp_lt_u32 s26, 0x40000
  s_cbranch_scc1 Lwi_111
  s_branch L_end
Lwi_112:
  s_mov_b32 s12, s86
  s_and_b32 s13, s87, 0xffff
  s_mov_b32 s14, 2097152
  s_mov_b32 s15, 0x20000
  v_lshlrev_b32 v98, 10, v2
  v_lshl_add_u32 v98, v3, 3, v98
  v_add_u32 v98, s57, v98
  s_lshl_b32 s29, s57, 5
  v_add_u32 v99, s29, v1
  v_add_u32 v120, 0, v98
  v_add_u32 v121, 16, v98
  v_add_u32 v122, 32, v98
  v_add_u32 v123, 48, v98
  s_cmp_gt_u32 s46, 1
  s_cbranch_scc1 Lnp_113
  s_lshl_b32 s53, s46, 15
  s_add_u32 s53, s53, 24117248
  v_mov_b32 v104, -1
  v_mov_b32 v105, -1
  v_mov_b32 v106, -1
  v_mov_b32 v107, -1
  buffer_store_dwordx4 v[104:107], v99, s[4:7], s53 offen offset:0 sc1
  buffer_store_dwordx4 v[104:107], v99, s[4:7], s53 offen offset:1024 sc1
  s_sub_u32 s53, s53, 4194304
  buffer_store_dwordx4 v[104:107], v99, s[4:7], s53 offen offset:0 sc1
  buffer_store_dwordx4 v[104:107], v99, s[4:7], s53 offen offset:1024 sc1
  s_mov_b32 s53, 56832
  s_waitcnt vmcnt(0)
  v_mov_b32 v10, 1
  s_mov_b64 exec, 1
  buffer_atomic_add v10, off, s[4:7], s53 sc1
  s_mov_b64 exec, -1
Lnp_113:
  s_mov_b32 s81, 0
  s_mov_b32 s80, 199
La2l_115:
  s_lshl_b32 s76, s81, 21
  s_add_u32 s76, s76, 26214400
  s_lshl_b32 s77, s81, 16
  s_add_u32 s77, s77, 30408704
  s_mul_i32 s78, s81, 4194304
  s_add_u32 s78, s78, 19922944
  s_mov_b32 s47, s46
  s_lshl_b32 s67, s81, 2
  s_add_u32 s67, s67, s46
  s_lshl_b32 s67, s67, 7
  s_add_u32 s67, s67, 55296
  s_mov_b32 s52, 8
  s_mov_b32 s26, 0
Lwf_116:
  buffer_load_dword v10, off, s[4:7], s67 sc1
  s_waitcnt vmcnt(0)
  v_readfirstlane_b32 s29, v10
  s_nop 0
  s_cmp_ge_u32 s29, s52
  s_nop 1
  s_cbranch_scc1 Lwf_117
  s_sleep 0
  s_add_u32 s26, s26, 1
  s_cmp_lt_u32 s26, 0x100000
  s_cbranch_scc1 Lwf_116
  s_branch L_end
Lwf_117:
  s_lshl_b32 s53, s47, 15
  s_add_u32 s53, s53, s76
  s_add_u32 s54, s53, 4096
  buffer_load_dwordx4 v[224:227], v6, s[4:7], s53 offen offset:0 sc1
  buffer_load_dwordx4 v[228:231], v6, s[4:7], s53 offen offset:1024 sc1
  buffer_load_dwordx4 v[232:235], v6, s[4:7], s53 offen offset:2048 sc1
  buffer_load_dwordx4 v[236:239], v6, s[4:7], s53 offen offset:3072 sc1
  buffer_load_dwordx4 v[240:243], v6, s[4:7], s54 offen offset:0 sc1
  buffer_load_dwordx4 v[244:247], v6, s[4:7], s54 offen offset:1024 sc1
  buffer_load_dwordx4 v[248:251], v6, s[4:7], s54 offen offset:2048 sc1
  buffer_load_dwordx4 v[252:255], v6, s[4:7], s54 offen offset:3072 sc1
  v_and_b32 v12, 7, v0
  v_sub_u32 v13, s80, v12
  v_lshrrev_b32 v13, 3, v13
  v_lshlrev_b32 v12, 7, v12
  s_lshl_b32 s53, s81, 10
  s_add_u32 s53, s53, 36864
  s_mov_b32 s26, 0
Lw8_118:
  buffer_load_dword v10, v12, s[4:7], s53 offen sc1
  s_waitcnt vmcnt(0)
  v_cmp_lt_u32 vcc, v10, v13
  s_cbranch_vccz Lw8_119
  s_add_u32 s26, s26, 1
  s_cmp_lt_u32 s26, 0x100000
  s_cbranch_scc1 Lw8_118
  s_branch L_end
Lw8_119:
  s_lshl_b32 s79, s81, 1
  v_lshl_add_u32 v11, v3, 5, v2
  v_lshlrev_b32 v11, 5, v11
  v_lshlrev_b32 v12, 4, v3
  v_cmp_gt_u32 vcc, 16, v2
  v_add_u32 v13, 0, v11
  v_add_u32 v14, 512, v12
  v_cndmask_b32 v124, v14, v13, vcc
  v_add_u32 v13, 16, v11
  v_add_u32 v14, 544, v12
  v_cndmask_b32 v125, v14, v13, vcc
  v_add_u32 v13, 2048, v11
  v_add_u32 v14, 576, v12
  v_cndmask_b32 v126, v14, v13, vcc
  v_add_u32 v13, 2064, v11
  v_add_u32 v14, 608, v12
  v_cndmask_b32 v127, v14, v13, vcc
  s_lshl_b32 s53, s21, 14
  s_add_u32 s66, s53, 30801920
  s_add_u32 s53, s53, s77
  s_add_u32 s54, s53, 0
  buffer_load_dwordx4 v[160:163], v124, s[4:7], s54 offen sc1
  buffer_load_dwordx4 v[164:167], v125, s[4:7], s54 offen sc1
  buffer_load_dwordx4 v[168:171], v126, s[4:7], s54 offen sc1
  buffer_load_dwordx4 v[172:175], v127, s[4:7], s54 offen sc1
  s_add_u32 s54, s53, 4096
  buffer_load_dwordx4 v[176:179], v124, s[4:7], s54 offen sc1
  buffer_load_dwordx4 v[180:183], v125, s[4:7], s54 offen sc1
  buffer_load_dwordx4 v[184:187], v126, s[4:7], s54 offen sc1
  buffer_load_dwordx4 v[188:191], v127, s[4:7], s54 offen sc1
  s_add_u32 s54, s53, 8192
  buffer_load_dwordx4 v[192:195], v124, s[4:7], s54 offen sc1
  buffer_load_dwordx4 v[196:199], v125, s[4:7], s54 offen sc1
  buffer_load_dwordx4 v[200:203], v126, s[4:7], s54 offen sc1
  buffer_load_dwordx4 v[204:207], v127, s[4:7], s54 offen sc1
  s_add_u32 s54, s53, 12288
  buffer_load_dwordx4 v[208:211], v124, s[4:7], s54 offen sc1
  buffer_load_dwordx4 v[212:215], v125, s[4:7], s54 offen sc1
  buffer_load_dwordx4 v[216:219], v126, s[4:7], s54 offen sc1
  buffer_load_dwordx4 v[220:223], v127, s[4:7], s54 offen sc1
  s_cmp_eq_u32 s81, 0
  s_cbranch_scc1 Lz_120
  s_mov_b32 s58, 0
  v_and_b32 v12, 3, v0
  v_lshlrev_b32 v12, 12, v12
  s_add_u32 s48, s66, 3*65536
  s_nop 0
Lz_121:
  buffer_load_dword v10, v12, s[4:7], s66 offen sc1
  s_add_u32 s58, s58, 1
  s_cmp_gt_u32 s58, 0x8000
  s_cbranch_scc1 Lz_121f
  s_waitcnt vmcnt(0)
  v_cmp_eq_u32 vcc, -1, v10
  s_cbranch_vccnz Lz_121
  s_add_u32 s54, s66, 0
  buffer_load_dwordx4 v[16:19], v124, s[4:7], s54 offen sc1
  buffer_load_dwordx4 v[20:23], v125, s[4:7], s54 offen sc1
  buffer_load_dwordx4 v[24:27], v126, s[4:7], s54 offen sc1
  buffer_load_dwordx4 v[28:31], v127, s[4:7], s54 offen sc1
  s_add_u32 s54, s66, 4096
  buffer_load_dwordx4 v[32:35], v124, s[4:7], s54 offen sc1
  buffer_load_dwordx4 v[36:39], v125, s[4:7], s54 offen sc1
  buffer_load_dwordx4 v[40:43], v126, s[4:7], s54 offen sc1
  buffer_load_dwordx4 v[44:47], v127, s[4:7], s54 offen sc1
  s_add_u32 s54, s66, 8192
  buffer_load_dwordx4 v[48:51], v124, s[4:7], s54 offen sc1
  buffer_load_dwordx4 v[52:55], v125, s[4:7], s54 offen sc1
  buffer_load_dwordx4 v[56:59], v126, s[4:7], s54 offen sc1
  buffer_load_dwordx4 v[60:63], v127, s[4:7], s54 offen sc1
  s_add_u32 s54, s66, 12288
  buffer_load_dwordx4 v[64:67], v124, s[4:7], s54 offen sc1
  buffer_load_dwordx4 v[68:71], v125, s[4:7], s54 offen sc1
  buffer_load_dwordx4 v[72:75], v126, s[4:7], s54 offen sc1
  buffer_load_dwordx4 v[76:79], v127, s[4:7], s54 offen sc1
  s_waitcnt vmcnt(0)
  v_max3_u32 v10, v16, v17, v18
  v_max3_u32 v10, v10, v19, v20
  v_max3_u32 v10, v10, v21, v22
  v_max3_u32 v10, v10, v23, v24
  v_max3_u32 v10, v10, v25, v26
  v_max3_u32 v10, v10, v27, v28
  v_max3_u32 v10, v10, v29, v30
  v_max3_u32 v10, v10, v31, v32
  v_max3_u32 v10, v10, v33, v34
  v_max3_u32 v10, v10, v35, v36
  v_max3_u32 v10, v10, v37, v38
  v_max3_u32 v10, v10, v39, v40
  v_max3_u32 v10, v10, v41, v42
  v_max3_u32 v10, v10, v43, v44
  v_max3_u32 v10, v10, v45, v46
  v_max3_u32 v10, v10, v47, v48
  v_max3_u32 v10, v10, v49, v50
  v_max3_u32 v10, v10, v51, v52
  v_max3_u32 v10, v10, v53, v54
  v_max3_u32 v10, v10, v55, v56
  v_max3_u32 v10, v10, v57, v58
  v_max3_u32 v10, v10, v59, v60
  v_max3_u32 v10, v10, v61, v62
  v_max3_u32 v10, v10, v63, v64
  v_max3_u32 v10, v10, v65, v66
  v_max3_u32 v10, v10, v67, v68
  v_max3_u32 v10, v10, v69, v70
  v_max3_u32 v10, v10, v71, v72
  v_max3_u32 v10, v10, v73, v74
  v_max3_u32 v10, v10, v75, v76
  v_max3_u32 v10, v10, v77, v78
  v_max_u32 v10, v10, v79
  v_cmp_eq_u32 vcc, -1, v10
  s_cbranch_vccz Lz_122
  s_sleep 4
  s_branch Lz_121
  s_nop 1
Lz_121f:
  s_mov_b32 s67, 56576
  s_mov_b32 s52, 64
  s_mov_b32 s26, 0
Lwf_123:
  buffer_load_dword v10, off, s[4:7], s67 sc1
  s_waitcnt vmcnt(0)
  v_readfirstlane_b32 s29, v10
  s_nop 0
  s_cmp_ge_u32 s29, s52
  s_nop 1
  s_cbranch_scc1 Lwf_124
  s_sleep 0
  s_add_u32 s26, s26, 1
  s_cmp_lt_u32 s26, 0x100000
  s_cbranch_scc1 Lwf_123
  s_branch L_end
Lwf_124:
  s_add_u32 s54, s66, 0
  buffer_load_dwordx4 v[16:19], v124, s[4:7], s54 offen sc1
  buffer_load_dwordx4 v[20:23], v125, s[4:7], s54 offen sc1
  buffer_load_dwordx4 v[24:27], v126, s[4:7], s54 offen sc1
  buffer_load_dwordx4 v[28:31], v127, s[4:7], s54 offen sc1
  s_add_u32 s54, s66, 4096
  buffer_load_dwordx4 v[32:35], v124, s[4:7], s54 offen sc1
  buffer_load_dwordx4 v[36:39], v125, s[4:7], s54 offen sc1
  buffer_load_dwordx4 v[40:43], v126, s[4:7], s54 offen sc1
  buffer_load_dwordx4 v[44:47], v127, s[4:7], s54 offen sc1
  s_add_u32 s54, s66, 8192
  buffer_load_dwordx4 v[48:51], v124, s[4:7], s54 offen sc1
  buffer_load_dwordx4 v[52:55], v125, s[4:7], s54 offen sc1
  buffer_load_dwordx4 v[56:59], v126, s[4:7], s54 offen sc1
  buffer_load_dwordx4 v[60:63], v127, s[4:7], s54 offen sc1
  s_add_u32 s54, s66, 12288
  buffer_load_dwordx4 v[64:67], v124, s[4:7], s54 offen sc1
  buffer_load_dwordx4 v[68:71], v125, s[4:7], s54 offen sc1
  buffer_load_dwordx4 v[72:75], v126, s[4:7], s54 offen sc1
  buffer_load_dwordx4 v[76:79], v127, s[4:7], s54 offen sc1
  s_waitcnt vmcnt(0)
Lz_122:
  v_pk_add_f32 v[160:161], v[160:161], v[16:17]
  v_pk_add_f32 v[162:163], v[162:163], v[18:19]
  v_pk_add_f32 v[164:165], v[164:165], v[20:21]
  v_pk_add_f32 v[166:167], v[166:167], v[22:23]
  v_pk_add_f32 v[168:169], v[168:169], v[24:25]
  v_pk_add_f32 v[170:171], v[170:171], v[26:27]
  v_pk_add_f32 v[172:173], v[172:173], v[28:29]
  v_pk_add_f32 v[174:175], v[174:175], v[30:31]
  v_pk_add_f32 v[176:177], v[176:177], v[32:33]
  v_pk_add_f32 v[178:179], v[178:179], v[34:35]
  v_pk_add_f32 v[180:181], v[180:181], v[36:37]
  v_pk_add_f32 v[182:183], v[182:183], v[38:39]
  v_pk_add_f32 v[184:185], v[184:185], v[40:41]
  v_pk_add_f32 v[186:187], v[186:187], v[42:43]
  v_pk_add_f32 v[188:189], v[188:189], v[44:45]
  v_pk_add_f32 v[190:191], v[190:191], v[46:47]
  v_pk_add_f32 v[192:193], v[192:193], v[48:49]
  v_pk_add_f32 v[194:195], v[194:195], v[50:51]
  v_pk_add_f32 v[196:197], v[196:197], v[52:53]
  v_pk_add_f32 v[198:199], v[198:199], v[54:55]
  v_pk_add_f32 v[200:201], v[200:201], v[56:57]
  v_pk_add_f32 v[202:203], v[202:203], v[58:59]
  v_pk_add_f32 v[204:205], v[204:205], v[60:61]
  v_pk_add_f32 v[206:207], v[206:207], v[62:63]
  v_pk_add_f32 v[208:209], v[208:209], v[64:65]
  v_pk_add_f32 v[210:211], v[210:211], v[66:67]
  v_pk_add_f32 v[212:213], v[212:213], v[68:69]
  v_pk_add_f32 v[214:215], v[214:215], v[70:71]
  v_pk_add_f32 v[216:217], v[216:217], v[72:73]
  v_pk_add_f32 v[218:219], v[218:219], v[74:75]
  v_pk_add_f32 v[220:221], v[220:221], v[76:77]
  v_pk_add_f32 v[222:223], v[222:223], v[78:79]
  s_add_u32 s66, s66, 65536
  s_cmp_le_u32 s66, s48
  s_cbranch_scc1 Lz_121
Lz_120:
  s_waitcnt vmcnt(0)
  v_cvt_pk_bf16_f32 v128, v160, v161
  v_cvt_pk_bf16_f32 v129, v162, v163
  v_cvt_pk_bf16_f32 v130, v164, v165
  v_cvt_pk_bf16_f32 v131, v166, v167
  v_cvt_pk_bf16_f32 v132, v168, v169
  v_cvt_pk_bf16_f32 v133, v170, v171
  v_cvt_pk_bf16_f32 v134, v172, v173
  v_cvt_pk_bf16_f32 v135, v174, v175
  v_cvt_pk_bf16_f32 v136, v176, v177
  v_cvt_pk_bf16_f32 v137, v178, v179
  v_cvt_pk_bf16_f32 v138, v180, v181
  v_cvt_pk_bf16_f32 v139, v182, v183
  v_cvt_pk_bf16_f32 v140, v184, v185
  v_cvt_pk_bf16_f32 v141, v186, v187
  v_cvt_pk_bf16_f32 v142, v188, v189
  v_cvt_pk_bf16_f32 v143, v190, v191
  v_cvt_pk_bf16_f32 v144, v192, v193
  v_cvt_pk_bf16_f32 v145, v194, v195
  v_cvt_pk_bf16_f32 v146, v196, v197
  v_cvt_pk_bf16_f32 v147, v198, v199
  v_cvt_pk_bf16_f32 v148, v200, v201
  v_cvt_pk_bf16_f32 v149, v202, v203
  v_cvt_pk_bf16_f32 v150, v204, v205
  v_cvt_pk_bf16_f32 v151, v206, v207
  v_cvt_pk_bf16_f32 v152, v208, v209
  v_cvt_pk_bf16_f32 v153, v210, v211
  v_cvt_pk_bf16_f32 v154, v212, v213
  v_cvt_pk_bf16_f32 v155, v214, v215
  v_cvt_pk_bf16_f32 v156, v216, v217
  v_cvt_pk_bf16_f32 v157, v218, v219
  v_cvt_pk_bf16_f32 v158, v220, v221
  v_cvt_pk_bf16_f32 v159, v222, v223
  s_mov_b32 s69, s81
  s_nop 0
La2_125:
  s_lshl_b32 s57, s47, 15
  buffer_load_dwordx2 v[104:105], v120, s[12:15], s57 offen sc1
  buffer_load_dwordx2 v[106:107], v121, s[12:15], s57 offen sc1
  buffer_load_dwordx2 v[108:109], v122, s[12:15], s57 offen sc1
  buffer_load_dwordx2 v[110:111], v123, s[12:15], s57 offen sc1
  s_waitcnt vmcnt(4)
  v_mfma_f32_32x32x16_bf16 v[160:175], v[128:131], v[224:227], 0
  v_mfma_f32_32x32x16_bf16 v[176:191], v[132:135], v[228:231], 0
  v_mfma_f32_32x32x16_bf16 v[192:207], v[136:139], v[232:235], 0
  v_mfma_f32_32x32x16_bf16 v[208:223], v[140:143], v[236:239], 0
  s_nop 8
  v_add_f32 v10, s70, v168
  v_rcp_f32 v10, v10
  s_nop 0
  v_pk_mul_f32 v[160:161], v[160:161], v[10:11] op_sel_hi:[1,0]
  v_pk_mul_f32 v[162:163], v[162:163], v[10:11] op_sel_hi:[1,0]
  v_pk_mul_f32 v[164:165], v[164:165], v[10:11] op_sel_hi:[1,0]
  v_pk_mul_f32 v[166:167], v[166:167], v[10:11] op_sel_hi:[1,0]
  v_cvt_pk_bf16_f32 v168, v160, v161
  v_cvt_pk_bf16_f32 v169, v162, v163
  v_cvt_pk_bf16_f32 v170, v164, v165
  v_cvt_pk_bf16_f32 v171, v166, v167
  ds_write_b128 v6, v[168:171] offset:0
  v_add_f32 v10, s70, v184
  v_rcp_f32 v10, v10
  s_nop 0
  v_pk_mul_f32 v[176:177], v[176:177], v[10:11] op_sel_hi:[1,0]
  v_pk_mul_f32 v[178:179], v[178:179], v[10:11] op_sel_hi:[1,0]
  v_pk_mul_f32 v[180:181], v[180:181], v[10:11] op_sel_hi:[1,0]
  v_pk_mul_f32 v[182:183], v[182:183], v[10:11] op_sel_hi:[1,0]
  v_cvt_pk_bf16_f32 v184, v176, v177
  v_cvt_pk_bf16_f32 v185, v178, v179
  v_cvt_pk_bf16_f32 v186, v180, v181
  v_cvt_pk_bf16_f32 v187, v182, v183
  ds_write_b128 v6, v[184:187] offset:1024
  v_add_f32 v10, s70, v200
  v_rcp_f32 v10, v10
  s_nop 0
  v_pk_mul_f32 v[192:193], v[192:193], v[10:11] op_sel_hi:[1,0]
  v_pk_mul_f32 v[194:195], v[194:195], v[10:11] op_sel_hi:[1,0]
  v_pk_mul_f32 v[196:197], v[196:197], v[10:11] op_sel_hi:[1,0]
  v_pk_mul_f32 v[198:199], v[198:199], v[10:11] op_sel_hi:[1,0]
  v_cvt_pk_bf16_f32 v200, v192, v193
  v_cvt_pk_bf16_f32 v201, v194, v195
  v_cvt_pk_bf16_f32 v202, v196, v197
  v_cvt_pk_bf16_f32 v203, v198, v199
  ds_write_b128 v6, v[200:203] offset:2048
  v_add_f32 v10, s70, v216
  v_rcp_f32 v10, v10
  s_nop 0
  v_pk_mul_f32 v[208:209], v[208:209], v[10:11] op_sel_hi:[1,0]
  v_pk_mul_f32 v[210:211], v[210:211], v[10:11] op_sel_hi:[1,0]
  v_pk_mul_f32 v[212:213], v[212:213], v[10:11] op_sel_hi:[1,0]
  v_pk_mul_f32 v[214:215], v[214:215], v[10:11] op_sel_hi:[1,0]
  v_cvt_pk_bf16_f32 v216, v208, v209
  v_cvt_pk_bf16_f32 v217, v210, v211
  v_cvt_pk_bf16_f32 v218, v212, v213
  v_cvt_pk_bf16_f32 v219, v214, v215
  ds_write_b128 v6, v[216:219] offset:3072
  v_mfma_f32_32x32x16_bf16 v[160:175], v[144:147], v[240:243], 0
  v_mfma_f32_32x32x16_bf16 v[176:191], v[148:151], v[244:247], 0
  v_mfma_f32_32x32x16_bf16 v[192:207], v[152:155], v[248:251], 0
  v_mfma_f32_32x32x16_bf16 v[208:223], v[156:159], v[252:255], 0
  s_add_u32 s66, s47, 2
  s_min_u32 s67, s66, 63
  s_cmp_eq_u32 s69, 1
  s_nop 7
  s_cbranch_scc1 Lnq_126
  s_lshl_b32 s53, s67, 15
  s_add_u32 s53, s53, s76
  s_add_u32 s54, s53, 4096
  buffer_load_dwordx4 v[224:227], v6, s[4:7], s53 offen offset:0 sc1
  buffer_load_dwordx4 v[228:231], v6, s[4:7], s53 offen offset:1024 sc1
  buffer_load_dwordx4 v[232:235], v6, s[4:7], s53 offen offset:2048 sc1
  buffer_load_dwordx4 v[236:239], v6, s[4:7], s53 offen offset:3072 sc1
  buffer_load_dwordx4 v[240:243], v6, s[4:7], s54 offen offset:0 sc1
  buffer_load_dwordx4 v[244:247], v6, s[4:7], s54 offen offset:1024 sc1
  buffer_load_dwordx4 v[248:251], v6, s[4:7], s54 offen offset:2048 sc1
  buffer_load_dwordx4 v[252:255], v6, s[4:7], s54 offen offset:3072 sc1
Lnq_126:
  v_add_f32 v10, s70, v168
  v_rcp_f32 v10, v10
  s_nop 0
  v_pk_mul_f32 v[160:161], v[160:161], v[10:11] op_sel_hi:[1,0]
  v_pk_mul_f32 v[162:163], v[162:163], v[10:11] op_sel_hi:[1,0]
  v_pk_mul_f32 v[164:165], v[164:165], v[10:11] op_sel_hi:[1,0]
  v_pk_mul_f32 v[166:167], v[166:167], v[10:11] op_sel_hi:[1,0]
  v_cvt_pk_bf16_f32 v168, v160, v161
  v_cvt_pk_bf16_f32 v169, v162, v163
  v_cvt_pk_bf16_f32 v170, v164, v165
  v_cvt_pk_bf16_f32 v171, v166, v167
  ds_write_b128 v6, v[168:171] offset:4096
  v_add_f32 v10, s70, v184
  v_rcp_f32 v10, v10
  s_nop 0
  v_pk_mul_f32 v[176:177], v[176:177], v[10:11] op_sel_hi:[1,0]
  v_pk_mul_f32 v[178:179], v[178:179], v[10:11] op_sel_hi:[1,0]
  v_pk_mul_f32 v[180:181], v[180:181], v[10:11] op_sel_hi:[1,0]
  v_pk_mul_f32 v[182:183], v[182:183], v[10:11] op_sel_hi:[1,0]
  v_cvt_pk_bf16_f32 v184, v176, v177
  v_cvt_pk_bf16_f32 v185, v178, v179
  v_cvt_pk_bf16_f32 v186, v180, v181
  v_cvt_pk_bf16_f32 v187, v182, v183
  ds_write_b128 v6, v[184:187] offset:5120
  v_add_f32 v10, s70, v200
  v_rcp_f32 v10, v10
  s_nop 0
  v_pk_mul_f32 v[192:193], v[192:193], v[10:11] op_sel_hi:[1,0]
  v_pk_mul_f32 v[194:195], v[194:195], v[10:11] op_sel_hi:[1,0]
  v_pk_mul_f32 v[196:197], v[196:197], v[10:11] op_sel_hi:[1,0]
  v_pk_mul_f32 v[198:199], v[198:199], v[10:11] op_sel_hi:[1,0]
  v_cvt_pk_bf16_f32 v200, v192, v193
  v_cvt_pk_bf16_f32 v201, v194, v195
  v_cvt_pk_bf16_f32 v202, v196, v197
  v_cvt_pk_bf16_f32 v203, v198, v199
  ds_write_b128 v6, v[200:203] offset:6144
  v_add_f32 v10, s70, v216
  v_rcp_f32 v10, v10
  s_nop 0
  v_pk_mul_f32 v[208:209], v[208:209], v[10:11] op_sel_hi:[1,0]
  v_pk_mul_f32 v[210:211], v[210:211], v[10:11] op_sel_hi:[1,0]
  v_pk_mul_f32 v[212:213], v[212:213], v[10:11] op_sel_hi:[1,0]
  v_pk_mul_f32 v[214:215], v[214:215], v[10:11] op_sel_hi:[1,0]
  v_cvt_pk_bf16_f32 v216, v208, v209
  v_cvt_pk_bf16_f32 v217, v210, v211
  v_cvt_pk_bf16_f32 v218, v212, v213
  v_cvt_pk_bf16_f32 v219, v214, v215
  ds_write_b128 v6, v[216:219] offset:7168
  s_waitcnt lgkmcnt(0)
  s_barrier
  s_mov_b32 s51, 0
  v_add_u32 v9, s51, v5
  ds_read_b128 v[80:83], v9 offset:0
  ds_read_b128 v[84:87], v9 offset:1024
  ds_read_b128 v[88:91], v9 offset:2048
  s_waitcnt lgkmcnt(2)
  v_mfma_f32_32x32x16_bf16 v[16:31], a[0:3], v[80:83], 0
  ds_read_b128 v[92:95], v9 offset:3072
  s_waitcnt lgkmcnt(2)
  v_mfma_f32_32x32x16_bf16 v[16:31], a[4:7], v[84:87], v[16:31]
  ds_read_b128 v[80:83], v9 offset:4096
  s_waitcnt lgkmcnt(2)
  v_mfma_f32_32x32x16_bf16 v[16:31], a[8:11], v[88:91], v[16:31]
  ds_read_b128 v[84:87], v9 offset:5120
  s_waitcnt lgkmcnt(2)
  v_mfma_f32_32x32x16_bf16 v[16:31], a[12:15], v[92:95], v[16:31]
  ds_read_b128 v[88:91], v9 offset:6144
  s_waitcnt lgkmcnt(2)
  v_mfma_f32_32x32x16_bf16 v[16:31], a[16:19], v[80:83], v[16:31]
  ds_read_b128 v[92:95], v9 offset:7168
  s_waitcnt lgkmcnt(2)
  v_mfma_f32_32x32x16_bf16 v[16:31], a[20:23], v[84:87], v[16:31]
  ds_read_b128 v[80:83], v9 offset:8192
  s_waitcnt lgkmcnt(2)
  v_mfma_f32_32x32x16_bf16 v[16:31], a[24:27], v[88:91], v[16:31]
  ds_read_b128 v[84:87], v9 offset:9216
  s_waitcnt lgkmcnt(2)
  v_mfma_f32_32x32x16_bf16 v[16:31], a[28:31], v[92:95], v[16:31]
  ds_read_b128 v[88:91], v9 offset:10240
  s_waitcnt lgkmcnt(2)
  v_mfma_f32_32x32x16_bf16 v[16:31], a[32:35], v[80:83], v[16:31]
  ds_read_b128 v[92:95], v9 offset:11264
  s_waitcnt lgkmcnt(2)
  v_mfma_f32_32x32x16_bf16 v[16:31], a[36:39], v[84:87], v[16:31]
  ds_read_b128 v[80:83], v9 offset:12288
  s_waitcnt lgkmcnt(2)
  v_mfma_f32_32x32x16_bf16 v[16:31], a[40:43], v[88:91], v[16:31]
  ds_read_b128 v[84:87], v9 offset:13312
  s_waitcnt lgkmcnt(2)
  v_mfma_f32_32x32x16_bf16 v[16:31], a[44:47], v[92:95], v[16:31]
  ds_read_b128 v[88:91], v9 offset:14336
  s_waitcnt lgkmcnt(2)
  v_mfma_f32_32x32x16_bf16 v[16:31], a[48:51], v[80:83], v[16:31]
  ds_read_b128 v[92:95], v9 offset:15360
  s_waitcnt lgkmcnt(2)
  v_mfma_f32_32x32x16_bf16 v[16:31], a[52:55], v[84:87], v[16:31]
  ds_read_b128 v[80:83], v9 offset:16384
  s_waitcnt lgkmcnt(2)
  v_mfma_f32_32x32x16_bf16 v[16:31], a[56:59], v[88:91], v[16:31]
  ds_read_b128 v[84:87], v9 offset:17408
  s_waitcnt lgkmcnt(2)
  v_mfma_f32_32x32x16_bf16 v[16:31], a[60:63], v[92:95], v[16:31]
  ds_read_b128 v[88:91], v9 offset:18432
  s_waitcnt lgkmcnt(2)
  v_mfma_f32_32x32x16_bf16 v[16:31], a[64:67], v[80:83], v[16:31]
  ds_read_b128 v[92:95], v9 offset:19456
  s_waitcnt lgkmcnt(2)
  v_mfma_f32_32x32x16_bf16 v[16:31], a[68:71], v[84:87], v[16:31]
  ds_read_b128 v[80:83], v9 offset:20480
  s_waitcnt lgkmcnt(2)
  v_mfma_f32_32x32x16_bf16 v[16:31], a[72:75], v[88:91], v[16:31]
  ds_read_b128 v[84:87], v9 offset:21504
  s_waitcnt lgkmcnt(2)
  v_mfma_f32_32x32x16_bf16 v[16:31], a[76:79], v[92:95], v[16:31]
  ds_read_b128 v[88:91], v9 offset:22528
  s_waitcnt lgkmcnt(2)
  v_mfma_f32_32x32x16_bf16 v[16:31], a[80:83], v[80:83], v[16:31]
  ds_read_b128 v[92:95], v9 offset:23552
  s_waitcnt lgkmcnt(2)
  v_mfma_f32_32x32x16_bf16 v[16:31], a[84:87], v[84:87], v[16:31]
  ds_read_b128 v[80:83], v9 offset:24576
  s_waitcnt lgkmcnt(2)
  v_mfma_f32_32x32x16_bf16 v[16:31], a[88:91], v[88:91], v[16:31]
  ds_read_b128 v[84:87], v9 offset:25600
  s_waitcnt lgkmcnt(2)
  v_mfma_f32_32x32x16_bf16 v[16:31], a[92:95], v[92:95], v[16:31]
  ds_read_b128 v[88:91], v9 offset:26624
  s_waitcnt lgkmcnt(2)
  v_mfma_f32_32x32x16_bf16 v[16:31], a[96:99], v[80:83], v[16:31]
  ds_read_b128 v[92:95], v9 offset:27648
  s_waitcnt lgkmcnt(2)
  v_mfma_f32_32x32x16_bf16 v[16:31], a[100:103], v[84:87], v[16:31]
  ds_read_b128 v[80:83], v9 offset:28672
  s_waitcnt lgkmcnt(2)
  v_mfma_f32_32x32x16_bf16 v[16:31], a[104:107], v[88:91], v[16:31]
  ds_read_b128 v[84:87], v9 offset:29696
  s_waitcnt lgkmcnt(2)
  v_mfma_f32_32x32x16_bf16 v[16:31], a[108:111], v[92:95], v[16:31]
  ds_read_b128 v[88:91], v9 offset:30720
  s_waitcnt lgkmcnt(2)
  v_mfma_f32_32x32x16_bf16 v[16:31], a[112:115], v[80:83], v[16:31]
  ds_read_b128 v[92:95], v9 offset:31744
  s_waitcnt lgkmcnt(2)
  v_mfma_f32_32x32x16_bf16 v[16:31], a[116:119], v[84:87], v[16:31]
  s_waitcnt lgkmcnt(1)
  v_mfma_f32_32x32x16_bf16 v[16:31], a[120:123], v[88:91], v[16:31]
  s_waitcnt lgkmcnt(0)
  v_mfma_f32_32x32x16_bf16 v[16:31], a[124:127], v[92:95], v[16:31]
  s_waitcnt vmcnt(0)
  v_lshlrev_b32 v10, 16, v104
  v_and_b32 v11, 0xffff0000, v104
  s_nop 8
  v_add_f32 v16, v16, v10
  v_add_f32 v17, v17, v11
  v_lshlrev_b32 v10, 16, v105
  v_and_b32 v11, 0xffff0000, v105
  v_add_f32 v18, v18, v10
  v_add_f32 v19, v19, v11
  v_lshlrev_b32 v10, 16, v106
  v_and_b32 v11, 0xffff0000, v106
  v_add_f32 v20, v20, v10
  v_add_f32 v21, v21, v11
  v_lshlrev_b32 v10, 16, v107
  v_and_b32 v11, 0xffff0000, v107
  v_add_f32 v22, v22, v10
  v_add_f32 v23, v23, v11
  v_lshlrev_b32 v10, 16, v108
  v_and_b32 v11, 0xffff0000, v108
  v_add_f32 v24, v24, v10
  v_add_f32 v25, v25, v11
  v_lshlrev_b32 v10, 16, v109
  v_and_b32 v11, 0xffff0000, v109
  v_add_f32 v26, v26, v10
  v_add_f32 v27, v27, v11
  v_lshlrev_b32 v10, 16, v110
  v_and_b32 v11, 0xffff0000, v110
  v_add_f32 v28, v28, v10
  v_add_f32 v29, v29, v11
  v_lshlrev_b32 v10, 16, v111
  v_and_b32 v11, 0xffff0000, v111
  v_add_f32 v30, v30, v10
  v_add_f32 v31, v31, v11
  v_cvt_pk_bf16_f32 v112, v16, v17
  v_cvt_pk_bf16_f32 v113, v18, v19
  v_cvt_pk_bf16_f32 v114, v20, v21
  v_cvt_pk_bf16_f32 v115, v22, v23
  v_cvt_pk_bf16_f32 v116, v24, v25
  v_cvt_pk_bf16_f32 v117, v26, v27
  v_cvt_pk_bf16_f32 v118, v28, v29
  v_cvt_pk_bf16_f32 v119, v30, v31
  s_add_u32 s53, s57, s78
  buffer_store_dwordx4 v[112:115], v99, s[4:7], s53 offen offset:0 sc1
  buffer_store_dwordx4 v[116:119], v99, s[4:7], s53 offen offset:1024 sc1
  s_lshl_b32 s53, s81, 7
  s_add_u32 s53, s53, s47
  v_mov_b32 v10, v16
  v_mul_f32 v11, v16, v16
  v_add_f32 v10, v10, v17
  v_fmac_f32 v11, v17, v17
  v_add_f32 v10, v10, v18
  v_fmac_f32 v11, v18, v18
  v_add_f32 v10, v10, v19
  v_fmac_f32 v11, v19, v19
  v_add_f32 v10, v10, v20
  v_fmac_f32 v11, v20, v20
  v_add_f32 v10, v10, v21
  v_fmac_f32 v11, v21, v21
  v_add_f32 v10, v10, v22
  v_fmac_f32 v11, v22, v22
  v_add_f32 v10, v10, v23
  v_fmac_f32 v11, v23, v23
  v_add_f32 v10, v10, v24
  v_fmac_f32 v11, v24, v24
  v_add_f32 v10, v10, v25
  v_fmac_f32 v11, v25, v25
  v_add_f32 v10, v10, v26
  v_fmac_f32 v11, v26, v26
  v_add_f32 v10, v10, v27
  v_fmac_f32 v11, v27, v27
  v_add_f32 v10, v10, v28
  v_fmac_f32 v11, v28, v28
  v_add_f32 v10, v10, v29
  v_fmac_f32 v11, v29, v29
  v_add_f32 v10, v10, v30
  v_fmac_f32 v11, v30, v30
  v_add_f32 v10, v10, v31
  v_fmac_f32 v11, v31, v31
  s_nop 1
  v_permlane32_swap_b32 v10, v11
  v_add_f32 v10, v10, v11
  v_lshlrev_b32 v11, 2, v0
  s_lshl_b32 s54, s53, 8
  s_add_u32 s54, s54, 30539776
  buffer_atomic_add_f32 v10, v11, s[4:7], s54 offen
  s_lshl_b32 s53, s81, 6
  s_add_u32 s53, s53, s47
  s_lshl_b32 s53, s53, 7
  s_add_u32 s53, s53, 38912
  s_waitcnt vmcnt(0)
  v_mov_b32 v10, 1
  s_mov_b64 exec, 1
  buffer_atomic_add v10, off, s[4:7], s53 sc1
  s_mov_b64 exec, -1
  s_cmp_eq_u32 s69, 0
  s_cbranch_scc1 Lnq_128
  s_mov_b32 s69, 0
  s_mov_b32 s67, 56704
  s_mov_b32 s52, 8
  s_mov_b32 s26, 0
Lwf_129:
  buffer_load_dword v10, off, s[4:7], s67 sc1
  s_waitcnt vmcnt(0)
  v_readfirstlane_b32 s29, v10
  s_nop 0
  s_cmp_ge_u32 s29, s52
  s_nop 1
  s_cbranch_scc1 Lwf_130
  s_sleep 0
  s_add_u32 s26, s26, 1
  s_cmp_lt_u32 s26, 0x100000
  s_cbranch_scc1 Lwf_129
  s_branch L_end
Lwf_130:
  s_lshl_b32 s53, s66, 15
  s_add_u32 s53, s53, s76
  s_add_u32 s54, s53, 4096
  buffer_load_dwordx4 v[224:227], v6, s[4:7], s53 offen offset:0 sc1
  buffer_load_dwordx4 v[228:231], v6, s[4:7], s53 offen offset:1024 sc1
  buffer_load_dwordx4 v[232:235], v6, s[4:7], s53 offen offset:2048 sc1
  buffer_load_dwordx4 v[236:239], v6, s[4:7], s53 offen offset:3072 sc1
  buffer_load_dwordx4 v[240:243], v6, s[4:7], s54 offen offset:0 sc1
  buffer_load_dwordx4 v[244:247], v6, s[4:7], s54 offen offset:1024 sc1
  buffer_load_dwordx4 v[248:251], v6, s[4:7], s54 offen offset:2048 sc1
  buffer_load_dwordx4 v[252:255], v6, s[4:7], s54 offen offset:3072 sc1
Lnq_128:
  s_barrier
  s_mov_b32 s47, s66
  s_cmp_lt_u32 s47, 64
  s_cbranch_scc1 La2_125
  v_add_u32 v120, 0, v99
  v_add_u32 v121, 8, v99
  v_add_u32 v122, 1024, v99
  v_add_u32 v123, 1032, v99
  s_add_u32 s12, s4, 22020096
  s_addc_u32 s13, s5, 0
  s_mov_b32 s80, 23
  s_add_u32 s81, s81, 1
  s_cmp_lt_u32 s81, 2
  s_cbranch_scc1 La2l_115
  s_branch L_end
L_kv:
  s_sub_u32 s20, s74, 1
  s_lshl_b32 s20, s20, 4
  s_and_b32 s29, s75, 15
  s_add_u32 s20, s20, s29
  s_lshr_b32 s46, s75, 4
  v_lshlrev_b32 v1, 4, v0
  v_and_b32 v2, 31, v0
  v_lshrrev_b32 v3, 5, v0
  v_bfe_u32 v4, v0, 2, 2
  s_mov_b32 s70, 0x358637bd
  s_mov_b32 s71, 0x358637bd
  s_mov_b32 s73, 0x3fb8aa3b
  s_mov_b32 s72, 0x3fb8aa3b
  s_mov_b32 s59, 0x3b000000
  s_mov_b32 s60, 0x3727c5ac
  v_mov_b32 v100, 0x3f803f80
  v_mov_b32 v101, 0x3f803f80
  v_mov_b32 v102, 0x3f803f80
  v_mov_b32 v103, 0x3f803f80
  v_mov_b32 v5, v1
  s_lshl_b32 s29, s21, 13
  v_add_u32 v6, s29, v1
  s_lshl_b32 s29, s21, 8
  s_add_u32 s29, s29, 67584
  v_lshlrev_b32 v7, 2, v2
  v_add_u32 v7, s29, v7
  v_lshlrev_b32 v8, 4, v3
  v_add_u32 v8, s29, v8
  s_mov_b32 s8, s88
  s_and_b32 s9, s89, 0xffff
  s_mov_b32 s10, 4194304
  s_mov_b32 s11, 0x20000
  s_load_dwordx2 s[12:13], s[0:1], 56
  s_waitcnt lgkmcnt(0)
  s_and_b32 s13, s13, 0xffff
  s_mov_b32 s14, 4194304
  s_mov_b32 s15, 0x20000
  s_cmp_lt_u32 s21, 2
  s_cselect_b32 s8, s8, s12
  s_cselect_b32 s9, s9, s13
  s_lshl_b32 s57, s20, 8
  s_and_b32 s29, s21, 1
  s_lshl_b32 s29, s29, 7
  s_add_u32 s57, s57, s29
  s_add_u32 s52, s57, 64
  v_lshrrev_b32 v10, 3, v0
  v_and_b32 v11, 7, v0
  v_bfe_u32 v12, v0, 4, 1
  v_lshlrev_b32 v12, 2, v12
  v_xor_b32 v11, v11, v12
  s_mov_b32 s29, 8192
  v_mul_lo_u32 v10, v10, s29
  v_and_b32 v12, 3, v11
  v_lshl_add_u32 v10, v12, 4, v10
  s_sub_u32 s29, s52, s57
  v_lshrrev_b32 v12, 2, v11
  v_mul_lo_u32 v12, v12, s29
  v_add_u32 v10, v10, v12
  v_lshl_add_u32 v13, v3, 2, v4
  v_mul_u32_u24 v13, 128, v13
  v_bfe_u32 v12, v0, 4, 1
  v_lshl_add_u32 v13, v12, 5, v13
  v_and_b32 v12, 3, v0
  v_lshl_add_u32 v13, v12, 3, v13
  s_mul_i32 s83, s21, 32768
  s_add_u32 s83, s83, 0
  v_add_u32 v13, s83, v13
  v_bfe_u32 v12, v0, 3, 1
  v_lshlrev_b32 v12, 6, v12
  v_xor_b32 v13, v13, v12
  v_xor_b32 v14, 64, v13
  s_waitcnt lgkmcnt(0)
  s_add_u32 m0, s83, 0
  s_add_u32 s54, s57, 0
  buffer_load_dwordx4 v10, s[8:11], s54 offen lds
  s_add_u32 m0, s83, 1024
  s_add_u32 s54, s57, 65536
  buffer_load_dwordx4 v10, s[8:11], s54 offen lds
  s_add_u32 m0, s83, 2048
  s_add_u32 s54, s57, 131072
  buffer_load_dwordx4 v10, s[8:11], s54 offen lds
  s_add_u32 m0, s83, 3072
  s_add_u32 s54, s57, 196608
  buffer_load_dwordx4 v10, s[8:11], s54 offen lds
  s_add_u32 m0, s83, 4096
  s_add_u32 s54, s57, 262144
  buffer_load_dwordx4 v10, s[8:11], s54 offen lds
  s_add_u32 m0, s83, 5120
  s_add_u32 s54, s57, 327680
  buffer_load_dwordx4 v10, s[8:11], s54 offen lds
  s_add_u32 m0, s83, 6144
  s_add_u32 s54, s57, 393216
  buffer_load_dwordx4 v10, s[8:11], s54 offen lds
  s_add_u32 m0, s83, 7168
  s_add_u32 s54, s57, 458752
  buffer_load_dwordx4 v10, s[8:11], s54 offen lds
  s_add_u32 m0, s83, 8192
  s_add_u32 s54, s57, 524288
  buffer_load_dwordx4 v10, s[8:11], s54 offen lds
  s_add_u32 m0, s83, 9216
  s_add_u32 s54, s57, 589824
  buffer_load_dwordx4 v10, s[8:11], s54 offen lds
  s_add_u32 m0, s83, 10240
  s_add_u32 s54, s57, 655360
  buffer_load_dwordx4 v10, s[8:11], s54 offen lds
  s_add_u32 m0, s83, 11264
  s_add_u32 s54, s57, 720896
  buffer_load_dwordx4 v10, s[8:11], s54 offen lds
  s_add_u32 m0, s83, 12288
  s_add_u32 s54, s57, 786432
  buffer_load_dwordx4 v10, s[8:11], s54 offen lds
  s_add_u32 m0, s83, 13312
  s_add_u32 s54, s57, 851968
  buffer_load_dwordx4 v10, s[8:11], s54 offen lds
  s_add_u32 m0, s83, 14336
  s_add_u32 s54, s57, 917504
  buffer_load_dwordx4 v10, s[8:11], s54 offen lds
  s_add_u32 m0, s83, 15360
  s_add_u32 s54, s57, 983040
  buffer_load_dwordx4 v10, s[8:11], s54 offen lds
  s_add_u32 m0, s83, 16384
  s_add_u32 s54, s57, 1048576
  buffer_load_dwordx4 v10, s[8:11], s54 offen lds
  s_add_u32 m0, s83, 17408
  s_add_u32 s54, s57, 1114112
  buffer_load_dwordx4 v10, s[8:11], s54 offen lds
  s_add_u32 m0, s83, 18432
  s_add_u32 s54, s57, 1179648
  buffer_load_dwordx4 v10, s[8:11], s54 offen lds
  s_add_u32 m0, s83, 19456
  s_add_u32 s54, s57, 1245184
  buffer_load_dwordx4 v10, s[8:11], s54 offen lds
  s_add_u32 m0, s83, 20480
  s_add_u32 s54, s57, 1310720
  buffer_load_dwordx4 v10, s[8:11], s54 offen lds
  s_add_u32 m0, s83, 21504
  s_add_u32 s54, s57, 1376256
  buffer_load_dwordx4 v10, s[8:11], s54 offen lds
  s_add_u32 m0, s83, 22528
  s_add_u32 s54, s57, 1441792
  buffer_load_dwordx4 v10, s[8:11], s54 offen lds
  s_add_u32 m0, s83, 23552
  s_add_u32 s54, s57, 1507328
  buffer_load_dwordx4 v10, s[8:11], s54 offen lds
  s_add_u32 m0, s83, 24576
  s_add_u32 s54, s57, 1572864
  buffer_load_dwordx4 v10, s[8:11], s54 offen lds
  s_add_u32 m0, s83, 25600
  s_add_u32 s54, s57, 1638400
  buffer_load_dwordx4 v10, s[8:11], s54 offen lds
  s_add_u32 m0, s83, 26624
  s_add_u32 s54, s57, 1703936
  buffer_load_dwordx4 v10, s[8:11], s54 offen lds
  s_add_u32 m0, s83, 27648
  s_add_u32 s54, s57, 1769472
  buffer_load_dwordx4 v10, s[8:11], s54 offen lds
  s_add_u32 m0, s83, 28672
  s_add_u32 s54, s57, 1835008
  buffer_load_dwordx4 v10, s[8:11], s54 offen lds
  s_add_u32 m0, s83, 29696
  s_add_u32 s54, s57, 1900544
  buffer_load_dwordx4 v10, s[8:11], s54 offen lds
  s_add_u32 m0, s83, 30720
  s_add_u32 s54, s57, 1966080
  buffer_load_dwordx4 v10, s[8:11], s54 offen lds
  s_add_u32 m0, s83, 31744
  s_add_u32 s54, s57, 2031616
  buffer_load_dwordx4 v10, s[8:11], s54 offen lds
  s_waitcnt vmcnt(24)
  ds_read_b64_tr_b16 a[0:1], v13 offset:0
  ds_read_b64_tr_b16 a[2:3], v13 offset:1024
  ds_read_b64_tr_b16 a[4:5], v14 offset:0
  ds_read_b64_tr_b16 a[6:7], v14 offset:1024
  ds_read_b64_tr_b16 a[8:9], v13 offset:2048
  ds_read_b64_tr_b16 a[10:11], v13 offset:3072
  ds_read_b64_tr_b16 a[12:13], v14 offset:2048
  ds_read_b64_tr_b16 a[14:15], v14 offset:3072
  ds_read_b64_tr_b16 a[16:17], v13 offset:4096
  ds_read_b64_tr_b16 a[18:19], v13 offset:5120
  ds_read_b64_tr_b16 a[20:21], v14 offset:4096
  ds_read_b64_tr_b16 a[22:23], v14 offset:5120
  ds_read_b64_tr_b16 a[24:25], v13 offset:6144
  ds_read_b64_tr_b16 a[26:27], v13 offset:7168
  ds_read_b64_tr_b16 a[28:29], v14 offset:6144
  ds_read_b64_tr_b16 a[30:31], v14 offset:7168
  s_waitcnt lgkmcnt(0)
  s_add_u32 m0, s83, 0
  s_add_u32 s54, s57, 2097152
  buffer_load_dwordx4 v10, s[8:11], s54 offen lds
  s_add_u32 m0, s83, 1024
  s_add_u32 s54, s57, 2162688
  buffer_load_dwordx4 v10, s[8:11], s54 offen lds
  s_add_u32 m0, s83, 2048
  s_add_u32 s54, s57, 2228224
  buffer_load_dwordx4 v10, s[8:11], s54 offen lds
  s_add_u32 m0, s83, 3072
  s_add_u32 s54, s57, 2293760
  buffer_load_dwordx4 v10, s[8:11], s54 offen lds
  s_add_u32 m0, s83, 4096
  s_add_u32 s54, s57, 2359296
  buffer_load_dwordx4 v10, s[8:11], s54 offen lds
  s_add_u32 m0, s83, 5120
  s_add_u32 s54, s57, 2424832
  buffer_load_dwordx4 v10, s[8:11], s54 offen lds
  s_add_u32 m0, s83, 6144
  s_add_u32 s54, s57, 2490368
  buffer_load_dwordx4 v10, s[8:11], s54 offen lds
  s_add_u32 m0, s83, 7168
  s_add_u32 s54, s57, 2555904
  buffer_load_dwordx4 v10, s[8:11], s54 offen lds
  s_cmp_lt_u32 s21, 2
  s_cbranch_scc0 Lws_133
  v_mfma_f32_32x32x16_bf16 v[48:63], a[0:3], v[100:103], 0
  v_mfma_f32_32x32x16_bf16 v[64:79], a[4:7], v[100:103], 0
  v_mfma_f32_32x32x16_bf16 v[48:63], a[8:11], v[100:103], v[48:63]
  v_mfma_f32_32x32x16_bf16 v[64:79], a[12:15], v[100:103], v[64:79]
  v_mfma_f32_32x32x16_bf16 v[48:63], a[16:19], v[100:103], v[48:63]
  v_mfma_f32_32x32x16_bf16 v[64:79], a[20:23], v[100:103], v[64:79]
  v_mfma_f32_32x32x16_bf16 v[48:63], a[24:27], v[100:103], v[48:63]
  v_mfma_f32_32x32x16_bf16 v[64:79], a[28:31], v[100:103], v[64:79]
  s_nop 10
  s_branch Lws_134
Lws_133:
  v_mfma_f32_32x32x16_bf16 v[48:63], v[100:103], a[0:3], 0
  v_mfma_f32_32x32x16_bf16 v[64:79], v[100:103], a[4:7], 0
  v_mfma_f32_32x32x16_bf16 v[48:63], v[100:103], a[8:11], v[48:63]
  v_mfma_f32_32x32x16_bf16 v[64:79], v[100:103], a[12:15], v[64:79]
  v_mfma_f32_32x32x16_bf16 v[48:63], v[100:103], a[16:19], v[48:63]
  v_mfma_f32_32x32x16_bf16 v[64:79], v[100:103], a[20:23], v[64:79]
  v_mfma_f32_32x32x16_bf16 v[48:63], v[100:103], a[24:27], v[48:63]
  v_mfma_f32_32x32x16_bf16 v[64:79], v[100:103], a[28:31], v[64:79]
  s_nop 11
Lws_134:
  s_waitcnt vmcnt(24)
  ds_read_b64_tr_b16 a[32:33], v13 offset:8192
  ds_read_b64_tr_b16 a[34:35], v13 offset:9216
  ds_read_b64_tr_b16 a[36:37], v14 offset:8192
  ds_read_b64_tr_b16 a[38:39], v14 offset:9216
  ds_read_b64_tr_b16 a[40:41], v13 offset:10240
  ds_read_b64_tr_b16 a[42:43], v13 offset:11264
  ds_read_b64_tr_b16 a[44:45], v14 offset:10240
  ds_read_b64_tr_b16 a[46:47], v14 offset:11264
  ds_read_b64_tr_b16 a[48:49], v13 offset:12288
  ds_read_b64_tr_b16 a[50:51], v13 offset:13312
  ds_read_b64_tr_b16 a[52:53], v14 offset:12288
  ds_read_b64_tr_b16 a[54:55], v14 offset:13312
  ds_read_b64_tr_b16 a[56:57], v13 offset:14336
  ds_read_b64_tr_b16 a[58:59], v13 offset:15360
  ds_read_b64_tr_b16 a[60:61], v14 offset:14336
  ds_read_b64_tr_b16 a[62:63], v14 offset:15360
  s_waitcnt lgkmcnt(0)
  s_add_u32 m0, s83, 8192
  s_add_u32 s54, s57, 2621440
  buffer_load_dwordx4 v10, s[8:11], s54 offen lds
  s_add_u32 m0, s83, 9216
  s_add_u32 s54, s57, 2686976
  buffer_load_dwordx4 v10, s[8:11], s54 offen lds
  s_add_u32 m0, s83, 10240
  s_add_u32 s54, s57, 2752512
  buffer_load_dwordx4 v10, s[8:11], s54 offen lds
  s_add_u32 m0, s83, 11264
  s_add_u32 s54, s57, 2818048
  buffer_load_dwordx4 v10, s[8:11], s54 offen lds
  s_add_u32 m0, s83, 12288
  s_add_u32 s54, s57, 2883584
  buffer_load_dwordx4 v10, s[8:11], s54 offen lds
  s_add_u32 m0, s83, 13312
  s_add_u32 s54, s57, 2949120
  buffer_load_dwordx4 v10, s[8:11], s54 offen lds
  s_add_u32 m0, s83, 14336
  s_add_u32 s54, s57, 3014656
  buffer_load_dwordx4 v10, s[8:11], s54 offen lds
  s_add_u32 m0, s83, 15360
  s_add_u32 s54, s57, 3080192
  buffer_load_dwordx4 v10, s[8:11], s54 offen lds
  s_cmp_lt_u32 s21, 2
  s_cbranch_scc0 Lws_135
  v_mfma_f32_32x32x16_bf16 v[48:63], a[32:35], v[100:103], v[48:63]
  v_mfma_f32_32x32x16_bf16 v[64:79], a[36:39], v[100:103], v[64:79]
  v_mfma_f32_32x32x16_bf16 v[48:63], a[40:43], v[100:103], v[48:63]
  v_mfma_f32_32x32x16_bf16 v[64:79], a[44:47], v[100:103], v[64:79]
  v_mfma_f32_32x32x16_bf16 v[48:63], a[48:51], v[100:103], v[48:63]
  v_mfma_f32_32x32x16_bf16 v[64:79], a[52:55], v[100:103], v[64:79]
  v_mfma_f32_32x32x16_bf16 v[48:63], a[56:59], v[100:103], v[48:63]
  v_mfma_f32_32x32x16_bf16 v[64:79], a[60:63], v[100:103], v[64:79]
  s_nop 10
  s_branch Lws_136
Lws_135:
  v_mfma_f32_32x32x16_bf16 v[48:63], v[100:103], a[32:35], v[48:63]
  v_mfma_f32_32x32x16_bf16 v[64:79], v[100:103], a[36:39], v[64:79]
  v_mfma_f32_32x32x16_bf16 v[48:63], v[100:103], a[40:43], v[48:63]
  v_mfma_f32_32x32x16_bf16 v[64:79], v[100:103], a[44:47], v[64:79]
  v_mfma_f32_32x32x16_bf16 v[48:63], v[100:103], a[48:51], v[48:63]
  v_mfma_f32_32x32x16_bf16 v[64:79], v[100:103], a[52:55], v[64:79]
  v_mfma_f32_32x32x16_bf16 v[48:63], v[100:103], a[56:59], v[48:63]
  v_mfma_f32_32x32x16_bf16 v[64:79], v[100:103], a[60:63], v[64:79]
  s_nop 11
Lws_136:
  s_waitcnt vmcnt(24)
  ds_read_b64_tr_b16 a[64:65], v13 offset:16384
  ds_read_b64_tr_b16 a[66:67], v13 offset:17408
  ds_read_b64_tr_b16 a[68:69], v14 offset:16384
  ds_read_b64_tr_b16 a[70:71], v14 offset:17408
  ds_read_b64_tr_b16 a[72:73], v13 offset:18432
  ds_read_b64_tr_b16 a[74:75], v13 offset:19456
  ds_read_b64_tr_b16 a[76:77], v14 offset:18432
  ds_read_b64_tr_b16 a[78:79], v14 offset:19456
  ds_read_b64_tr_b16 a[80:81], v13 offset:20480
  ds_read_b64_tr_b16 a[82:83], v13 offset:21504
  ds_read_b64_tr_b16 a[84:85], v14 offset:20480
  ds_read_b64_tr_b16 a[86:87], v14 offset:21504
  ds_read_b64_tr_b16 a[88:89], v13 offset:22528
  ds_read_b64_tr_b16 a[90:91], v13 offset:23552
  ds_read_b64_tr_b16 a[92:93], v14 offset:22528
  ds_read_b64_tr_b16 a[94:95], v14 offset:23552
  s_waitcnt lgkmcnt(0)
  s_add_u32 m0, s83, 16384
  s_add_u32 s54, s57, 3145728
  buffer_load_dwordx4 v10, s[8:11], s54 offen lds
  s_add_u32 m0, s83, 17408
  s_add_u32 s54, s57, 3211264
  buffer_load_dwordx4 v10, s[8:11], s54 offen lds
  s_add_u32 m0, s83, 18432
  s_add_u32 s54, s57, 3276800
  buffer_load_dwordx4 v10, s[8:11], s54 offen lds
  s_add_u32 m0, s83, 19456
  s_add_u32 s54, s57, 3342336
  buffer_load_dwordx4 v10, s[8:11], s54 offen lds
  s_add_u32 m0, s83, 20480
  s_add_u32 s54, s57, 3407872
  buffer_load_dwordx4 v10, s[8:11], s54 offen lds
  s_add_u32 m0, s83, 21504
  s_add_u32 s54, s57, 3473408
  buffer_load_dwordx4 v10, s[8:11], s54 offen lds
  s_add_u32 m0, s83, 22528
  s_add_u32 s54, s57, 3538944
  buffer_load_dwordx4 v10, s[8:11], s54 offen lds
  s_add_u32 m0, s83, 23552
  s_add_u32 s54, s57, 3604480
  buffer_load_dwordx4 v10, s[8:11], s54 offen lds
  s_cmp_lt_u32 s21, 2
  s_cbranch_scc0 Lws_137
  v_mfma_f32_32x32x16_bf16 v[48:63], a[64:67], v[100:103], v[48:63]
  v_mfma_f32_32x32x16_bf16 v[64:79], a[68:71], v[100:103], v[64:79]
  v_mfma_f32_32x32x16_bf16 v[48:63], a[72:75], v[100:103], v[48:63]
  v_mfma_f32_32x32x16_bf16 v[64:79], a[76:79], v[100:103], v[64:79]
  v_mfma_f32_32x32x16_bf16 v[48:63], a[80:83], v[100:103], v[48:63]
  v_mfma_f32_32x32x16_bf16 v[64:79], a[84:87], v[100:103], v[64:79]
  v_mfma_f32_32x32x16_bf16 v[48:63], a[88:91], v[100:103], v[48:63]
  v_mfma_f32_32x32x16_bf16 v[64:79], a[92:95], v[100:103], v[64:79]
  s_nop 10
  s_branch Lws_138
Lws_137:
  v_mfma_f32_32x32x16_bf16 v[48:63], v[100:103], a[64:67], v[48:63]
  v_mfma_f32_32x32x16_bf16 v[64:79], v[100:103], a[68:71], v[64:79]
  v_mfma_f32_32x32x16_bf16 v[48:63], v[100:103], a[72:75], v[48:63]
  v_mfma_f32_32x32x16_bf16 v[64:79], v[100:103], a[76:79], v[64:79]
  v_mfma_f32_32x32x16_bf16 v[48:63], v[100:103], a[80:83], v[48:63]
  v_mfma_f32_32x32x16_bf16 v[64:79], v[100:103], a[84:87], v[64:79]
  v_mfma_f32_32x32x16_bf16 v[48:63], v[100:103], a[88:91], v[48:63]
  v_mfma_f32_32x32x16_bf16 v[64:79], v[100:103], a[92:95], v[64:79]
  s_nop 11
Lws_138:
  s_waitcnt vmcnt(24)
  ds_read_b64_tr_b16 a[96:97], v13 offset:24576
  ds_read_b64_tr_b16 a[98:99], v13 offset:25600
  ds_read_b64_tr_b16 a[100:101], v14 offset:24576
  ds_read_b64_tr_b16 a[102:103], v14 offset:25600
  ds_read_b64_tr_b16 a[104:105], v13 offset:26624
  ds_read_b64_tr_b16 a[106:107], v13 offset:27648
  ds_read_b64_tr_b16 a[108:109], v14 offset:26624
  ds_read_b64_tr_b16 a[110:111], v14 offset:27648
  ds_read_b64_tr_b16 a[112:113], v13 offset:28672
  ds_read_b64_tr_b16 a[114:115], v13 offset:29696
  ds_read_b64_tr_b16 a[116:117], v14 offset:28672
  ds_read_b64_tr_b16 a[118:119], v14 offset:29696
  ds_read_b64_tr_b16 a[120:121], v13 offset:30720
  ds_read_b64_tr_b16 a[122:123], v13 offset:31744
  ds_read_b64_tr_b16 a[124:125], v14 offset:30720
  ds_read_b64_tr_b16 a[126:127], v14 offset:31744
  s_waitcnt lgkmcnt(0)
  s_add_u32 m0, s83, 24576
  s_add_u32 s54, s57, 3670016
  buffer_load_dwordx4 v10, s[8:11], s54 offen lds
  s_add_u32 m0, s83, 25600
  s_add_u32 s54, s57, 3735552
  buffer_load_dwordx4 v10, s[8:11], s54 offen lds
  s_add_u32 m0, s83, 26624
  s_add_u32 s54, s57, 3801088
  buffer_load_dwordx4 v10, s[8:11], s54 offen lds
  s_add_u32 m0, s83, 27648
  s_add_u32 s54, s57, 3866624
  buffer_load_dwordx4 v10, s[8:11], s54 offen lds
  s_add_u32 m0, s83, 28672
  s_add_u32 s54, s57, 3932160
  buffer_load_dwordx4 v10, s[8:11], s54 offen lds
  s_add_u32 m0, s83, 29696
  s_add_u32 s54, s57, 3997696
  buffer_load_dwordx4 v10, s[8:11], s54 offen lds
  s_add_u32 m0, s83, 30720
  s_add_u32 s54, s57, 4063232
  buffer_load_dwordx4 v10, s[8:11], s54 offen lds
  s_add_u32 m0, s83, 31744
  s_add_u32 s54, s57, 4128768
  buffer_load_dwordx4 v10, s[8:11], s54 offen lds
  s_cmp_lt_u32 s21, 2
  s_cbranch_scc0 Lws_139
  v_mfma_f32_32x32x16_bf16 v[48:63], a[96:99], v[100:103], v[48:63]
  v_mfma_f32_32x32x16_bf16 v[64:79], a[100:103], v[100:103], v[64:79]
  v_mfma_f32_32x32x16_bf16 v[48:63], a[104:107], v[100:103], v[48:63]
  v_mfma_f32_32x32x16_bf16 v[64:79], a[108:111], v[100:103], v[64:79]
  v_mfma_f32_32x32x16_bf16 v[48:63], a[112:115], v[100:103], v[48:63]
  v_mfma_f32_32x32x16_bf16 v[64:79], a[116:119], v[100:103], v[64:79]
  v_mfma_f32_32x32x16_bf16 v[48:63], a[120:123], v[100:103], v[48:63]
  v_mfma_f32_32x32x16_bf16 v[64:79], a[124:127], v[100:103], v[64:79]
  s_nop 10
  s_branch Lws_140
Lws_139:
  v_mfma_f32_32x32x16_bf16 v[48:63], v[100:103], a[96:99], v[48:63]
  v_mfma_f32_32x32x16_bf16 v[64:79], v[100:103], a[100:103], v[64:79]
  v_mfma_f32_32x32x16_bf16 v[48:63], v[100:103], a[104:107], v[48:63]
  v_mfma_f32_32x32x16_bf16 v[64:79], v[100:103], a[108:111], v[64:79]
  v_mfma_f32_32x32x16_bf16 v[48:63], v[100:103], a[112:115], v[48:63]
  v_mfma_f32_32x32x16_bf16 v[64:79], v[100:103], a[116:119], v[64:79]
  v_mfma_f32_32x32x16_bf16 v[48:63], v[100:103], a[120:123], v[48:63]
  v_mfma_f32_32x32x16_bf16 v[64:79], v[100:103], a[124:127], v[64:79]
  s_nop 11
Lws_140:
  s_waitcnt vmcnt(24)
  ds_read_b64_tr_b16 a[128:129], v13 offset:0
  ds_read_b64_tr_b16 a[130:131], v13 offset:1024
  ds_read_b64_tr_b16 a[132:133], v14 offset:0
  ds_read_b64_tr_b16 a[134:135], v14 offset:1024
  ds_read_b64_tr_b16 a[136:137], v13 offset:2048
  ds_read_b64_tr_b16 a[138:139], v13 offset:3072
  ds_read_b64_tr_b16 a[140:141], v14 offset:2048
  ds_read_b64_tr_b16 a[142:143], v14 offset:3072
  ds_read_b64_tr_b16 a[144:145], v13 offset:4096
  ds_read_b64_tr_b16 a[146:147], v13 offset:5120
  ds_read_b64_tr_b16 a[148:149], v14 offset:4096
  ds_read_b64_tr_b16 a[150:151], v14 offset:5120
  ds_read_b64_tr_b16 a[152:153], v13 offset:6144
  ds_read_b64_tr_b16 a[154:155], v13 offset:7168
  ds_read_b64_tr_b16 a[156:157], v14 offset:6144
  ds_read_b64_tr_b16 a[158:159], v14 offset:7168
  s_waitcnt lgkmcnt(0)
  s_cmp_lt_u32 s21, 2
  s_cbranch_scc0 Lws_141
  v_mfma_f32_32x32x16_bf16 v[48:63], a[128:131], v[100:103], v[48:63]
  v_mfma_f32_32x32x16_bf16 v[64:79], a[132:135], v[100:103], v[64:79]
  v_mfma_f32_32x32x16_bf16 v[48:63], a[136:139], v[100:103], v[48:63]
  v_mfma_f32_32x32x16_bf16 v[64:79], a[140:143], v[100:103], v[64:79]
  v_mfma_f32_32x32x16_bf16 v[48:63], a[144:147], v[100:103], v[48:63]
  v_mfma_f32_32x32x16_bf16 v[64:79], a[148:151], v[100:103], v[64:79]
  v_mfma_f32_32x32x16_bf16 v[48:63], a[152:155], v[100:103], v[48:63]
  v_mfma_f32_32x32x16_bf16 v[64:79], a[156:159], v[100:103], v[64:79]
  s_nop 10
  s_branch Lws_142
Lws_141:
  v_mfma_f32_32x32x16_bf16 v[48:63], v[100:103], a[128:131], v[48:63]
  v_mfma_f32_32x32x16_bf16 v[64:79], v[100:103], a[132:135], v[64:79]
  v_mfma_f32_32x32x16_bf16 v[48:63], v[100:103], a[136:139], v[48:63]
  v_mfma_f32_32x32x16_bf16 v[64:79], v[100:103], a[140:143], v[64:79]
  v_mfma_f32_32x32x16_bf16 v[48:63], v[100:103], a[144:147], v[48:63]
  v_mfma_f32_32x32x16_bf16 v[64:79], v[100:103], a[148:151], v[64:79]
  v_mfma_f32_32x32x16_bf16 v[48:63], v[100:103], a[152:155], v[48:63]
  v_mfma_f32_32x32x16_bf16 v[64:79], v[100:103], a[156:159], v[64:79]
  s_nop 11
Lws_142:
  s_waitcnt vmcnt(16)
  ds_read_b64_tr_b16 a[160:161], v13 offset:8192
  ds_read_b64_tr_b16 a[162:163], v13 offset:9216
  ds_read_b64_tr_b16 a[164:165], v14 offset:8192
  ds_read_b64_tr_b16 a[166:167], v14 offset:9216
  ds_read_b64_tr_b16 a[168:169], v13 offset:10240
  ds_read_b64_tr_b16 a[170:171], v13 offset:11264
  ds_read_b64_tr_b16 a[172:173], v14 offset:10240
  ds_read_b64_tr_b16 a[174:175], v14 offset:11264
  ds_read_b64_tr_b16 a[176:177], v13 offset:12288
  ds_read_b64_tr_b16 a[178:179], v13 offset:13312
  ds_read_b64_tr_b16 a[180:181], v14 offset:12288
  ds_read_b64_tr_b16 a[182:183], v14 offset:13312
  ds_read_b64_tr_b16 a[184:185], v13 offset:14336
  ds_read_b64_tr_b16 a[186:187], v13 offset:15360
  ds_read_b64_tr_b16 a[188:189], v14 offset:14336
  ds_read_b64_tr_b16 a[190:191], v14 offset:15360
  s_waitcnt lgkmcnt(0)
  s_cmp_lt_u32 s21, 2
  s_cbranch_scc0 Lws_143
  v_mfma_f32_32x32x16_bf16 v[48:63], a[160:163], v[100:103], v[48:63]
  v_mfma_f32_32x32x16_bf16 v[64:79], a[164:167], v[100:103], v[64:79]
  v_mfma_f32_32x32x16_bf16 v[48:63], a[168:171], v[100:103], v[48:63]
  v_mfma_f32_32x32x16_bf16 v[64:79], a[172:175], v[100:103], v[64:79]
  v_mfma_f32_32x32x16_bf16 v[48:63], a[176:179], v[100:103], v[48:63]
  v_mfma_f32_32x32x16_bf16 v[64:79], a[180:183], v[100:103], v[64:79]
  v_mfma_f32_32x32x16_bf16 v[48:63], a[184:187], v[100:103], v[48:63]
  v_mfma_f32_32x32x16_bf16 v[64:79], a[188:191], v[100:103], v[64:79]
  s_nop 10
  s_branch Lws_144
Lws_143:
  v_mfma_f32_32x32x16_bf16 v[48:63], v[100:103], a[160:163], v[48:63]
  v_mfma_f32_32x32x16_bf16 v[64:79], v[100:103], a[164:167], v[64:79]
  v_mfma_f32_32x32x16_bf16 v[48:63], v[100:103], a[168:171], v[48:63]
  v_mfma_f32_32x32x16_bf16 v[64:79], v[100:103], a[172:175], v[64:79]
  v_mfma_f32_32x32x16_bf16 v[48:63], v[100:103], a[176:179], v[48:63]
  v_mfma_f32_32x32x16_bf16 v[64:79], v[100:103], a[180:183], v[64:79]
  v_mfma_f32_32x32x16_bf16 v[48:63], v[100:103], a[184:187], v[48:63]
  v_mfma_f32_32x32x16_bf16 v[64:79], v[100:103], a[188:191], v[64:79]
  s_nop 11
Lws_144:
  s_waitcnt vmcnt(8)
  ds_read_b64_tr_b16 a[192:193], v13 offset:16384
  ds_read_b64_tr_b16 a[194:195], v13 offset:17408
  ds_read_b64_tr_b16 a[196:197], v14 offset:16384
  ds_read_b64_tr_b16 a[198:199], v14 offset:17408
  ds_read_b64_tr_b16 a[200:201], v13 offset:18432
  ds_read_b64_tr_b16 a[202:203], v13 offset:19456
  ds_read_b64_tr_b16 a[204:205], v14 offset:18432
  ds_read_b64_tr_b16 a[206:207], v14 offset:19456
  ds_read_b64_tr_b16 a[208:209], v13 offset:20480
  ds_read_b64_tr_b16 a[210:211], v13 offset:21504
  ds_read_b64_tr_b16 a[212:213], v14 offset:20480
  ds_read_b64_tr_b16 a[214:215], v14 offset:21504
  ds_read_b64_tr_b16 a[216:217], v13 offset:22528
  ds_read_b64_tr_b16 a[218:219], v13 offset:23552
  ds_read_b64_tr_b16 a[220:221], v14 offset:22528
  ds_read_b64_tr_b16 a[222:223], v14 offset:23552
  s_waitcnt lgkmcnt(0)
  s_cmp_lt_u32 s21, 2
  s_cbranch_scc0 Lws_145
  v_mfma_f32_32x32x16_bf16 v[48:63], a[192:195], v[100:103], v[48:63]
  v_mfma_f32_32x32x16_bf16 v[64:79], a[196:199], v[100:103], v[64:79]
  v_mfma_f32_32x32x16_bf16 v[48:63], a[200:203], v[100:103], v[48:63]
  v_mfma_f32_32x32x16_bf16 v[64:79], a[204:207], v[100:103], v[64:79]
  v_mfma_f32_32x32x16_bf16 v[48:63], a[208:211], v[100:103], v[48:63]
  v_mfma_f32_32x32x16_bf16 v[64:79], a[212:215], v[100:103], v[64:79]
  v_mfma_f32_32x32x16_bf16 v[48:63], a[216:219], v[100:103], v[48:63]
  v_mfma_f32_32x32x16_bf16 v[64:79], a[220:223], v[100:103], v[64:79]
  s_nop 10
  s_branch Lws_146
Lws_145:
  v_mfma_f32_32x32x16_bf16 v[48:63], v[100:103], a[192:195], v[48:63]
  v_mfma_f32_32x32x16_bf16 v[64:79], v[100:103], a[196:199], v[64:79]
  v_mfma_f32_32x32x16_bf16 v[48:63], v[100:103], a[200:203], v[48:63]
  v_mfma_f32_32x32x16_bf16 v[64:79], v[100:103], a[204:207], v[64:79]
  v_mfma_f32_32x32x16_bf16 v[48:63], v[100:103], a[208:211], v[48:63]
  v_mfma_f32_32x32x16_bf16 v[64:79], v[100:103], a[212:215], v[64:79]
  v_mfma_f32_32x32x16_bf16 v[48:63], v[100:103], a[216:219], v[48:63]
  v_mfma_f32_32x32x16_bf16 v[64:79], v[100:103], a[220:223], v[64:79]
  s_nop 11
Lws_146:
  s_waitcnt vmcnt(0)
  ds_read_b64_tr_b16 a[224:225], v13 offset:24576
  ds_read_b64_tr_b16 a[226:227], v13 offset:25600
  ds_read_b64_tr_b16 a[228:229], v14 offset:24576
  ds_read_b64_tr_b16 a[230:231], v14 offset:25600
  ds_read_b64_tr_b16 a[232:233], v13 offset:26624
  ds_read_b64_tr_b16 a[234:235], v13 offset:27648
  ds_read_b64_tr_b16 a[236:237], v14 offset:26624
  ds_read_b64_tr_b16 a[238:239], v14 offset:27648
  ds_read_b64_tr_b16 a[240:241], v13 offset:28672
  ds_read_b64_tr_b16 a[242:243], v13 offset:29696
  ds_read_b64_tr_b16 a[244:245], v14 offset:28672
  ds_read_b64_tr_b16 a[246:247], v14 offset:29696
  ds_read_b64_tr_b16 a[248:249], v13 offset:30720
  ds_read_b64_tr_b16 a[250:251], v13 offset:31744
  ds_read_b64_tr_b16 a[252:253], v14 offset:30720
  ds_read_b64_tr_b16 a[254:255], v14 offset:31744
  s_waitcnt lgkmcnt(0)
  s_cmp_lt_u32 s21, 2
  s_cbranch_scc0 Lws_147
  v_mfma_f32_32x32x16_bf16 v[48:63], a[224:227], v[100:103], v[48:63]
  v_mfma_f32_32x32x16_bf16 v[64:79], a[228:231], v[100:103], v[64:79]
  v_mfma_f32_32x32x16_bf16 v[48:63], a[232:235], v[100:103], v[48:63]
  v_mfma_f32_32x32x16_bf16 v[64:79], a[236:239], v[100:103], v[64:79]
  v_mfma_f32_32x32x16_bf16 v[48:63], a[240:243], v[100:103], v[48:63]
  v_mfma_f32_32x32x16_bf16 v[64:79], a[244:247], v[100:103], v[64:79]
  v_mfma_f32_32x32x16_bf16 v[48:63], a[248:251], v[100:103], v[48:63]
  v_mfma_f32_32x32x16_bf16 v[64:79], a[252:255], v[100:103], v[64:79]
  s_nop 10
  s_branch Lws_148
Lws_147:
  v_mfma_f32_32x32x16_bf16 v[48:63], v[100:103], a[224:227], v[48:63]
  v_mfma_f32_32x32x16_bf16 v[64:79], v[100:103], a[228:231], v[64:79]
  v_mfma_f32_32x32x16_bf16 v[48:63], v[100:103], a[232:235], v[48:63]
  v_mfma_f32_32x32x16_bf16 v[64:79], v[100:103], a[236:239], v[64:79]
  v_mfma_f32_32x32x16_bf16 v[48:63], v[100:103], a[240:243], v[48:63]
  v_mfma_f32_32x32x16_bf16 v[64:79], v[100:103], a[244:247], v[64:79]
  v_mfma_f32_32x32x16_bf16 v[48:63], v[100:103], a[248:251], v[48:63]
  v_mfma_f32_32x32x16_bf16 v[64:79], v[100:103], a[252:255], v[64:79]
  s_nop 11
Lws_148:
  s_mov_b32 s12, s92
  s_and_b32 s13, s93, 0xffff
  s_mov_b32 s14, 256
  s_mov_b32 s15, 0x20000
  s_mov_b32 s26, 0
Lwi_149:
  buffer_load_dword v10, off, s[12:15], 0 offset:12 sc1
  s_waitcnt vmcnt(0)
  v_readfirstlane_b32 s29, v10
  s_nop 0
  s_cmp_ge_u32 s29, 4
  s_nop 1
  s_cbranch_scc1 Lwi_150
  s_sleep 2
  s_add_u32 s26, s26, 1
  s_cmp_lt_u32 s26, 0x40000
  s_cbranch_scc1 Lwi_149
  s_branch L_end
Lwi_150:
  s_barrier
  s_mov_b32 s47, s46
  s_mov_b32 s48, 128
  s_mov_b32 s49, 2
  s_lshl_b32 s29, s20, 13
  s_and_b32 s30, s21, 1
  s_lshl_b32 s30, s30, 12
  s_add_u32 s29, s29, s30
  v_add_u32 v98, s29, v1
  s_cmp_ge_u32 s21, 2
  s_cbranch_scc1 Lkv_131
  v_lshrrev_b32 v10, 1, v98
  v_and_b32 v10, 0x80, v10
  v_xor_b32 v98, v98, v10
  s_cmp_lg_u32 s46, 0
  s_cbranch_scc1 Lnp_151
  s_mov_b32 s53, 50331648
  v_mov_b32 v104, -1
  v_mov_b32 v105, -1
  v_mov_b32 v106, -1
  v_mov_b32 v107, -1
  buffer_store_dwordx4 v[104:107], v98, s[4:7], s53 offen offset:0 sc1
  buffer_store_dwordx4 v[104:107], v98, s[4:7], s53 offen offset:1024 sc1
  buffer_store_dwordx4 v[104:107], v98, s[4:7], s53 offen offset:2048 sc1
  buffer_store_dwordx4 v[104:107], v98, s[4:7], s53 offen offset:3072 sc1
  s_mov_b32 s53, 33554432
  buffer_store_dwordx4 v[104:107], v98, s[4:7], s53 offen offset:0 sc1
  buffer_store_dwordx4 v[104:107], v98, s[4:7], s53 offen offset:1024 sc1
  buffer_store_dwordx4 v[104:107], v98, s[4:7], s53 offen offset:2048 sc1
  buffer_store_dwordx4 v[104:107], v98, s[4:7], s53 offen offset:3072 sc1
  s_lshl_b32 s53, s20, 7
  s_add_u32 s53, s53, 56960
  s_waitcnt vmcnt(0)
  v_mov_b32 v10, 1
  s_mov_b64 exec, 1
  buffer_atomic_add v10, off, s[4:7], s53 sc1
  s_mov_b64 exec, -1
Lnp_151:
  s_mov_b32 s67, 56832
  s_mov_b32 s52, 32
  s_mov_b32 s26, 0
Lwf_153:
  buffer_load_dword v10, off, s[4:7], s67 sc1
  s_waitcnt vmcnt(0)
  v_readfirstlane_b32 s29, v10
  s_nop 0
  s_cmp_ge_u32 s29, s52
  s_nop 1
  s_cbranch_scc1 Lwf_154
  s_sleep 0
  s_add_u32 s26, s26, 1
  s_cmp_lt_u32 s26, 0x100000
  s_cbranch_scc1 Lwf_153
  s_branch L_end
Lwf_154:
  s_mov_b32 s69, 0
  s_mov_b32 s51, 0
  s_mov_b32 s61, 0
  s_branch Lsl_159
Lsl_155:
  s_add_u32 s66, s47, s49
  s_sub_u32 s53, s48, 1
  s_min_u32 s53, s53, s66
  s_lshl_b32 s67, s53, 7
  s_add_u32 s67, s67, 38912
  s_mov_b32 s52, 16
  buffer_load_dword v11, off, s[4:7], s67 sc1
  s_waitcnt vmcnt(0)
  v_readfirstlane_b32 s58, v11
  s_barrier
  s_cmp_eq_u32 s61, 0
  s_nop 1
  s_cbranch_scc1 Lsl_160
  v_mov_b32 v10, 1
  s_mov_b64 exec, 1
  buffer_atomic_add v10, off, s[4:7], s61 sc1
  s_mov_b64 exec, -1
Lsl_160:
  s_xor_b32 s53, s51, 33280
  s_cmp_ge_u32 s58, s52
  s_cselect_b32 s58, 1, 0
  s_cmp_lt_u32 s66, s48
  s_cselect_b32 s58, s58, 0
  s_cmp_eq_u32 s58, 0
  s_cbranch_scc1 Lsl_158
  s_mov_b32 s67, s53
  s_lshl_b32 s57, s66, 15
  s_cmp_ge_u32 s66, 64
  s_cselect_b32 s29, 2097152, 0
  s_add_u32 s57, s57, s29
  s_add_u32 s57, s57, 19922944
  s_mul_i32 s53, s21, 8192
  s_add_u32 s53, s53, s67
  s_add_u32 m0, s53, 0
  s_add_u32 s54, s57, 0
  buffer_load_dwordx4 v6, s[4:7], s54 offen sc1 lds
  s_add_u32 m0, s53, 1024
  s_add_u32 s54, s57, 1024
  buffer_load_dwordx4 v6, s[4:7], s54 offen sc1 lds
  s_add_u32 m0, s53, 2048
  s_add_u32 s54, s57, 2048
  buffer_load_dwordx4 v6, s[4:7], s54 offen sc1 lds
  s_add_u32 m0, s53, 3072
  s_add_u32 s54, s57, 3072
  buffer_load_dwordx4 v6, s[4:7], s54 offen sc1 lds
  s_add_u32 m0, s53, 4096
  s_add_u32 s54, s57, 4096
  buffer_load_dwordx4 v6, s[4:7], s54 offen sc1 lds
  s_add_u32 m0, s53, 5120
  s_add_u32 s54, s57, 5120
  buffer_load_dwordx4 v6, s[4:7], s54 offen sc1 lds
  s_add_u32 m0, s53, 6144
  s_add_u32 s54, s57, 6144
  buffer_load_dwordx4 v6, s[4:7], s54 offen sc1 lds
  s_add_u32 m0, s53, 7168
  s_add_u32 s54, s57, 7168
  buffer_load_dwordx4 v6, s[4:7], s54 offen sc1 lds
Lsl_158:
  s_and_b32 s29, s47, 62
  s_cmp_eq_u32 s29, 0
  s_cbranch_scc1 Lst_161
  s_lshr_b32 s53, s47, 6
  s_lshl_b32 s53, s53, 6
  s_add_u32 s53, s53, s47
  s_lshl_b32 s54, s53, 8
  s_add_u32 s54, s54, 30539776
  v_lshlrev_b32 v10, 2, v2
  buffer_load_dword v96, v10, s[4:7], s54 offen sc1
  buffer_load_dword v97, v10, s[4:7], s54 offen offset:128 sc1
  s_branch Lst_162
Lst_161:
  s_mul_i32 s53, s21, 8192
  s_add_u32 s53, s53, s51
  v_add_u32 v9, s53, v5
  v_mov_b32 v96, 0
  v_mov_b32 v97, 0
  ds_read_b128 v[104:107], v9 offset:0
  ds_read_b128 v[108:111], v9 offset:1024
  ds_read_b128 v[112:115], v9 offset:2048
  ds_read_b128 v[116:119], v9 offset:3072
  ds_read_b128 v[120:123], v9 offset:4096
  ds_read_b128 v[124:127], v9 offset:5120
  ds_read_b128 v[128:131], v9 offset:6144
  ds_read_b128 v[132:135], v9 offset:7168
  s_waitcnt lgkmcnt(7)
  v_dot2c_f32_bf16 v96, v104, v100
  v_dot2c_f32_bf16 v97, v104, v104
  v_dot2c_f32_bf16 v96, v105, v100
  v_dot2c_f32_bf16 v97, v105, v105
  v_dot2c_f32_bf16 v96, v106, v100
  v_dot2c_f32_bf16 v97, v106, v106
  v_dot2c_f32_bf16 v96, v107, v100
  v_dot2c_f32_bf16 v97, v107, v107
  s_waitcnt lgkmcnt(6)
  v_dot2c_f32_bf16 v96, v108, v100
  v_dot2c_f32_bf16 v97, v108, v108
  v_dot2c_f32_bf16 v96, v109, v100
  v_dot2c_f32_bf16 v97, v109, v109
  v_dot2c_f32_bf16 v96, v110, v100
  v_dot2c_f32_bf16 v97, v110, v110
  v_dot2c_f32_bf16 v96, v111, v100
  v_dot2c_f32_bf16 v97, v111, v111
  s_waitcnt lgkmcnt(5)
  v_dot2c_f32_bf16 v96, v112, v100
  v_dot2c_f32_bf16 v97, v112, v112
  v_dot2c_f32_bf16 v96, v113, v100
  v_dot2c_f32_bf16 v97, v113, v113
  v_dot2c_f32_bf16 v96, v114, v100
  v_dot2c_f32_bf16 v97, v114, v114
  v_dot2c_f32_bf16 v96, v115, v100
  v_dot2c_f32_bf16 v97, v115, v115
  s_waitcnt lgkmcnt(4)
  v_dot2c_f32_bf16 v96, v116, v100
  v_dot2c_f32_bf16 v97, v116, v116
  v_dot2c_f32_bf16 v96, v117, v100
  v_dot2c_f32_bf16 v97, v117, v117
  v_dot2c_f32_bf16 v96, v118, v100
  v_dot2c_f32_bf16 v97, v118, v118
  v_dot2c_f32_bf16 v96, v119, v100
  v_dot2c_f32_bf16 v97, v119, v119
  s_waitcnt lgkmcnt(3)
  v_dot2c_f32_bf16 v96, v120, v100
  v_dot2c_f32_bf16 v97, v120, v120
  v_dot2c_f32_bf16 v96, v121, v100
  v_dot2c_f32_bf16 v97, v121, v121
  v_dot2c_f32_bf16 v96, v122, v100
  v_dot2c_f32_bf16 v97, v122, v122
  v_dot2c_f32_bf16 v96, v123, v100
  v_dot2c_f32_bf16 v97, v123, v123
  s_waitcnt lgkmcnt(2)
  v_dot2c_f32_bf16 v96, v124, v100
  v_dot2c_f32_bf16 v97, v124, v124
  v_dot2c_f32_bf16 v96, v125, v100
  v_dot2c_f32_bf16 v97, v125, v125
  v_dot2c_f32_bf16 v96, v126, v100
  v_dot2c_f32_bf16 v97, v126, v126
  v_dot2c_f32_bf16 v96, v127, v100
  v_dot2c_f32_bf16 v97, v127, v127
  s_waitcnt lgkmcnt(1)
  v_dot2c_f32_bf16 v96, v128, v100
  v_dot2c_f32_bf16 v97, v128, v128
  v_dot2c_f32_bf16 v96, v129, v100
  v_dot2c_f32_bf16 v97, v129, v129
  v_dot2c_f32_bf16 v96, v130, v100
  v_dot2c_f32_bf16 v97, v130, v130
  v_dot2c_f32_bf16 v96, v131, v100
  v_dot2c_f32_bf16 v97, v131, v131
  s_waitcnt lgkmcnt(0)
  v_dot2c_f32_bf16 v96, v132, v100
  v_dot2c_f32_bf16 v97, v132, v132
  v_dot2c_f32_bf16 v96, v133, v100
  v_dot2c_f32_bf16 v97, v133, v133
  v_dot2c_f32_bf16 v96, v134, v100
  v_dot2c_f32_bf16 v97, v134, v134
  v_dot2c_f32_bf16 v96, v135, v100
  v_dot2c_f32_bf16 v97, v135, v135
  s_nop 2
  v_permlane32_swap_b32 v96, v97
  v_add_f32 v96, v96, v97
  v_lshlrev_b32 v10, 2, v0
  s_lshl_b32 s53, s21, 8
  s_add_u32 s53, s53, 68608
  v_add_u32 v10, s53, v10
  ds_write_b32 v10, v96
  s_nop 0
Lst_162:
  v_add_u32 v9, s51, v5
  ds_read_b128 v[80:83], v9 offset:0
  ds_read_b128 v[84:87], v9 offset:1024
  ds_read_b128 v[88:91], v9 offset:2048
  s_waitcnt lgkmcnt(2)
  v_mfma_f32_32x32x16_bf16 v[16:31], a[0:3], v[80:83], 0
  ds_read_b128 v[92:95], v9 offset:3072
  v_mfma_f32_32x32x16_bf16 v[32:47], a[4:7], v[80:83], 0
  s_waitcnt lgkmcnt(2)
  v_mfma_f32_32x32x16_bf16 v[16:31], a[8:11], v[84:87], v[16:31]
  ds_read_b128 v[80:83], v9 offset:4096
  v_mfma_f32_32x32x16_bf16 v[32:47], a[12:15], v[84:87], v[32:47]
  s_waitcnt lgkmcnt(2)
  v_mfma_f32_32x32x16_bf16 v[16:31], a[16:19], v[88:91], v[16:31]
  ds_read_b128 v[84:87], v9 offset:5120
  v_mfma_f32_32x32x16_bf16 v[32:47], a[20:23], v[88:91], v[32:47]
  s_waitcnt lgkmcnt(2)
  v_mfma_f32_32x32x16_bf16 v[16:31], a[24:27], v[92:95], v[16:31]
  ds_read_b128 v[88:91], v9 offset:6144
  v_mfma_f32_32x32x16_bf16 v[32:47], a[28:31], v[92:95], v[32:47]
  s_waitcnt lgkmcnt(2)
  v_mfma_f32_32x32x16_bf16 v[16:31], a[32:35], v[80:83], v[16:31]
  ds_read_b128 v[92:95], v9 offset:7168
  v_mfma_f32_32x32x16_bf16 v[32:47], a[36:39], v[80:83], v[32:47]
  s_waitcnt lgkmcnt(2)
  v_mfma_f32_32x32x16_bf16 v[16:31], a[40:43], v[84:87], v[16:31]
  ds_read_b128 v[80:83], v9 offset:8192
  v_mfma_f32_32x32x16_bf16 v[32:47], a[44:47], v[84:87], v[32:47]
  s_waitcnt lgkmcnt(2)
  v_mfma_f32_32x32x16_bf16 v[16:31], a[48:51], v[88:91], v[16:31]
  ds_read_b128 v[84:87], v9 offset:9216
  v_mfma_f32_32x32x16_bf16 v[32:47], a[52:55], v[88:91], v[32:47]
  s_waitcnt lgkmcnt(2)
  v_mfma_f32_32x32x16_bf16 v[16:31], a[56:59], v[92:95], v[16:31]
  ds_read_b128 v[88:91], v9 offset:10240
  v_mfma_f32_32x32x16_bf16 v[32:47], a[60:63], v[92:95], v[32:47]
  s_waitcnt lgkmcnt(2)
  v_mfma_f32_32x32x16_bf16 v[16:31], a[64:67], v[80:83], v[16:31]
  ds_read_b128 v[92:95], v9 offset:11264
  v_mfma_f32_32x32x16_bf16 v[32:47], a[68:71], v[80:83], v[32:47]
  s_waitcnt lgkmcnt(2)
  v_mfma_f32_32x32x16_bf16 v[16:31], a[72:75], v[84:87], v[16:31]
  ds_read_b128 v[80:83], v9 offset:12288
  v_mfma_f32_32x32x16_bf16 v[32:47], a[76:79], v[84:87], v[32:47]
  s_waitcnt lgkmcnt(2)
  v_mfma_f32_32x32x16_bf16 v[16:31], a[80:83], v[88:91], v[16:31]
  ds_read_b128 v[84:87], v9 offset:13312
  v_mfma_f32_32x32x16_bf16 v[32:47], a[84:87], v[88:91], v[32:47]
  s_waitcnt lgkmcnt(2)
  v_mfma_f32_32x32x16_bf16 v[16:31], a[88:91], v[92:95], v[16:31]
  ds_read_b128 v[88:91], v9 offset:14336
  v_mfma_f32_32x32x16_bf16 v[32:47], a[92:95], v[92:95], v[32:47]
  s_waitcnt lgkmcnt(2)
  v_mfma_f32_32x32x16_bf16 v[16:31], a[96:99], v[80:83], v[16:31]
  ds_read_b128 v[92:95], v9 offset:15360
  v_mfma_f32_32x32x16_bf16 v[32:47], a[100:103], v[80:83], v[32:47]
  s_waitcnt lgkmcnt(2)
  v_mfma_f32_32x32x16_bf16 v[16:31], a[104:107], v[84:87], v[16:31]
  ds_read_b128 v[80:83], v9 offset:16384
  v_mfma_f32_32x32x16_bf16 v[32:47], a[108:111], v[84:87], v[32:47]
  s_waitcnt lgkmcnt(2)
  v_mfma_f32_32x32x16_bf16 v[16:31], a[112:115], v[88:91], v[16:31]
  ds_read_b128 v[84:87], v9 offset:17408
  v_mfma_f32_32x32x16_bf16 v[32:47], a[116:119], v[88:91], v[32:47]
  s_waitcnt lgkmcnt(2)
  v_mfma_f32_32x32x16_bf16 v[16:31], a[120:123], v[92:95], v[16:31]
  ds_read_b128 v[88:91], v9 offset:18432
  v_mfma_f32_32x32x16_bf16 v[32:47], a[124:127], v[92:95], v[32:47]
  s_waitcnt lgkmcnt(2)
  v_mfma_f32_32x32x16_bf16 v[16:31], a[128:131], v[80:83], v[16:31]
  ds_read_b128 v[92:95], v9 offset:19456
  v_mfma_f32_32x32x16_bf16 v[32:47], a[132:135], v[80:83], v[32:47]
  s_waitcnt lgkmcnt(2)
  v_mfma_f32_32x32x16_bf16 v[16:31], a[136:139], v[84:87], v[16:31]
  ds_read_b128 v[80:83], v9 offset:20480
  v_mfma_f32_32x32x16_bf16 v[32:47], a[140:143], v[84:87], v[32:47]
  s_waitcnt lgkmcnt(2)
  v_mfma_f32_32x32x16_bf16 v[16:31], a[144:147], v[88:91], v[16:31]
  ds_read_b128 v[84:87], v9 offset:21504
  v_mfma_f32_32x32x16_bf16 v[32:47], a[148:151], v[88:91], v[32:47]
  s_waitcnt lgkmcnt(2)
  v_mfma_f32_32x32x16_bf16 v[16:31], a[152:155], v[92:95], v[16:31]
  ds_read_b128 v[88:91], v9 offset:22528
  v_mfma_f32_32x32x16_bf16 v[32:47], a[156:159], v[92:95], v[32:47]
  s_waitcnt lgkmcnt(2)
  v_mfma_f32_32x32x16_bf16 v[16:31], a[160:163], v[80:83], v[16:31]
  ds_read_b128 v[92:95], v9 offset:23552
  v_mfma_f32_32x32x16_bf16 v[32:47], a[164:167], v[80:83], v[32:47]
  s_waitcnt lgkmcnt(2)
  v_mfma_f32_32x32x16_bf16 v[16:31], a[168:171], v[84:87], v[16:31]
  ds_read_b128 v[80:83], v9 offset:24576
  v_mfma_f32_32x32x16_bf16 v[32:47], a[172:175], v[84:87], v[32:47]
  s_waitcnt lgkmcnt(2)
  v_mfma_f32_32x32x16_bf16 v[16:31], a[176:179], v[88:91], v[16:31]
  ds_read_b128 v[84:87], v9 offset:25600
  v_mfma_f32_32x32x16_bf16 v[32:47], a[180:183], v[88:91], v[32:47]
  s_waitcnt lgkmcnt(2)
  v_mfma_f32_32x32x16_bf16 v[16:31], a[184:187], v[92:95], v[16:31]
  ds_read_b128 v[88:91], v9 offset:26624
  v_mfma_f32_32x32x16_bf16 v[32:47], a[188:191], v[92:95], v[32:47]
  s_waitcnt lgkmcnt(2)
  v_mfma_f32_32x32x16_bf16 v[16:31], a[192:195], v[80:83], v[16:31]
  ds_read_b128 v[92:95], v9 offset:27648
  v_mfma_f32_32x32x16_bf16 v[32:47], a[196:199], v[80:83], v[32:47]
  s_waitcnt lgkmcnt(2)
  v_mfma_f32_32x32x16_bf16 v[16:31], a[200:203], v[84:87], v[16:31]
  ds_read_b128 v[80:83], v9 offset:28672
  v_mfma_f32_32x32x16_bf16 v[32:47], a[204:207], v[84:87], v[32:47]
  s_waitcnt lgkmcnt(2)
  v_mfma_f32_32x32x16_bf16 v[16:31], a[208:211], v[88:91], v[16:31]
  ds_read_b128 v[84:87], v9 offset:29696
  v_mfma_f32_32x32x16_bf16 v[32:47], a[212:215], v[88:91], v[32:47]
  s_waitcnt lgkmcnt(2)
  v_mfma_f32_32x32x16_bf16 v[16:31], a[216:219], v[92:95], v[16:31]
  ds_read_b128 v[88:91], v9 offset:30720
  v_mfma_f32_32x32x16_bf16 v[32:47], a[220:223], v[92:95], v[32:47]
  s_waitcnt lgkmcnt(2)
  v_mfma_f32_32x32x16_bf16 v[16:31], a[224:227], v[80:83], v[16:31]
  ds_read_b128 v[92:95], v9 offset:31744
  v_mfma_f32_32x32x16_bf16 v[32:47], a[228:231], v[80:83], v[32:47]
  s_waitcnt lgkmcnt(2)
  v_mfma_f32_32x32x16_bf16 v[16:31], a[232:235], v[84:87], v[16:31]
  v_mfma_f32_32x32x16_bf16 v[32:47], a[236:239], v[84:87], v[32:47]
  s_waitcnt lgkmcnt(1)
  v_mfma_f32_32x32x16_bf16 v[16:31], a[240:243], v[88:91], v[16:31]
  v_mfma_f32_32x32x16_bf16 v[32:47], a[244:247], v[88:91], v[32:47]
  s_waitcnt lgkmcnt(0)
  v_mfma_f32_32x32x16_bf16 v[16:31], a[248:251], v[92:95], v[16:31]
  v_mfma_f32_32x32x16_bf16 v[32:47], a[252:255], v[92:95], v[32:47]
  s_and_b32 s29, s47, 62
  s_cmp_eq_u32 s29, 0
  s_nop 8
  s_cbranch_scc0 Lst_163
  s_barrier
  v_lshlrev_b32 v10, 2, v2
  v_add_u32 v10, 68608, v10
  ds_read2_b32 v[104:105], v10 offset0:0 offset1:32
  ds_read2_b32 v[106:107], v10 offset0:64 offset1:96
  ds_read2_b32 v[108:109], v10 offset0:128 offset1:160
  ds_read2_b32 v[110:111], v10 offset0:192 offset1:224
  s_waitcnt lgkmcnt(0)
  v_pk_add_f32 v[104:105], v[104:105], v[106:107]
  v_pk_add_f32 v[108:109], v[108:109], v[110:111]
  v_pk_add_f32 v[96:97], v[104:105], v[108:109]
  s_nop 0
  s_branch Lst_164
Lst_163:
  s_waitcnt vmcnt(0)
Lst_164:
  v_mul_f32 v96, s59, v96
  v_mul_f32 v97, s59, v97
  v_fma_f32 v97, -v96, v96, v97
  v_max_f32 v97, 0, v97
  v_cvt_pk_bf16_f32 v96, v96, v96
  v_and_b32 v96, 0xffff0000, v96
  v_cvt_pk_bf16_f32 v97, v97, v97
  v_and_b32 v97, 0xffff0000, v97
  v_add_f32 v97, s60, v97
  v_cvt_pk_bf16_f32 v97, v97, v97
  v_and_b32 v97, 0xffff0000, v97
  v_sqrt_f32 v97, v97
  s_nop 0
  v_cvt_pk_bf16_f32 v97, v97, v97
  v_and_b32 v97, 0xffff0000, v97
  v_rcp_f32 v97, v97
  s_nop 0
  v_mul_f32 v97, 0x3e0293ee, v97
  v_mul_f32 v96, v96, v97
  v_pk_mul_f32 v[10:11], v[48:49], v[96:97] op_sel_hi:[1,0]
  v_pk_fma_f32 v[16:17], v[16:17], v[96:97], v[10:11] op_sel:[0,1,0] op_sel_hi:[1,1,1] neg_lo:[0,0,1] neg_hi:[0,0,1]
  v_pk_mul_f32 v[10:11], v[50:51], v[96:97] op_sel_hi:[1,0]
  v_pk_fma_f32 v[18:19], v[18:19], v[96:97], v[10:11] op_sel:[0,1,0] op_sel_hi:[1,1,1] neg_lo:[0,0,1] neg_hi:[0,0,1]
  v_pk_mul_f32 v[10:11], v[52:53], v[96:97] op_sel_hi:[1,0]
  v_pk_fma_f32 v[20:21], v[20:21], v[96:97], v[10:11] op_sel:[0,1,0] op_sel_hi:[1,1,1] neg_lo:[0,0,1] neg_hi:[0,0,1]
  v_pk_mul_f32 v[10:11], v[54:55], v[96:97] op_sel_hi:[1,0]
  v_pk_fma_f32 v[22:23], v[22:23], v[96:97], v[10:11] op_sel:[0,1,0] op_sel_hi:[1,1,1] neg_lo:[0,0,1] neg_hi:[0,0,1]
  v_pk_mul_f32 v[10:11], v[56:57], v[96:97] op_sel_hi:[1,0]
  v_pk_fma_f32 v[24:25], v[24:25], v[96:97], v[10:11] op_sel:[0,1,0] op_sel_hi:[1,1,1] neg_lo:[0,0,1] neg_hi:[0,0,1]
  v_pk_mul_f32 v[10:11], v[58:59], v[96:97] op_sel_hi:[1,0]
  v_pk_fma_f32 v[26:27], v[26:27], v[96:97], v[10:11] op_sel:[0,1,0] op_sel_hi:[1,1,1] neg_lo:[0,0,1] neg_hi:[0,0,1]
  v_pk_mul_f32 v[10:11], v[60:61], v[96:97] op_sel_hi:[1,0]
  v_pk_fma_f32 v[28:29], v[28:29], v[96:97], v[10:11] op_sel:[0,1,0] op_sel_hi:[1,1,1] neg_lo:[0,0,1] neg_hi:[0,0,1]
  v_pk_mul_f32 v[10:11], v[62:63], v[96:97] op_sel_hi:[1,0]
  v_pk_fma_f32 v[30:31], v[30:31], v[96:97], v[10:11] op_sel:[0,1,0] op_sel_hi:[1,1,1] neg_lo:[0,0,1] neg_hi:[0,0,1]
  v_pk_mul_f32 v[10:11], v[64:65], v[96:97] op_sel_hi:[1,0]
  v_pk_fma_f32 v[32:33], v[32:33], v[96:97], v[10:11] op_sel:[0,1,0] op_sel_hi:[1,1,1] neg_lo:[0,0,1] neg_hi:[0,0,1]
  v_pk_mul_f32 v[10:11], v[66:67], v[96:97] op_sel_hi:[1,0]
  v_pk_fma_f32 v[34:35], v[34:35], v[96:97], v[10:11] op_sel:[0,1,0] op_sel_hi:[1,1,1] neg_lo:[0,0,1] neg_hi:[0,0,1]
  v_pk_mul_f32 v[10:11], v[68:69], v[96:97] op_sel_hi:[1,0]
  v_pk_fma_f32 v[36:37], v[36:37], v[96:97], v[10:11] op_sel:[0,1,0] op_sel_hi:[1,1,1] neg_lo:[0,0,1] neg_hi:[0,0,1]
  v_pk_mul_f32 v[10:11], v[70:71], v[96:97] op_sel_hi:[1,0]
  v_pk_fma_f32 v[38:39], v[38:39], v[96:97], v[10:11] op_sel:[0,1,0] op_sel_hi:[1,1,1] neg_lo:[0,0,1] neg_hi:[0,0,1]
  v_pk_mul_f32 v[10:11], v[72:73], v[96:97] op_sel_hi:[1,0]
  v_pk_fma_f32 v[40:41], v[40:41], v[96:97], v[10:11] op_sel:[0,1,0] op_sel_hi:[1,1,1] neg_lo:[0,0,1] neg_hi:[0,0,1]
  v_pk_mul_f32 v[10:11], v[74:75], v[96:97] op_sel_hi:[1,0]
  v_pk_fma_f32 v[42:43], v[42:43], v[96:97], v[10:11] op_sel:[0,1,0] op_sel_hi:[1,1,1] neg_lo:[0,0,1] neg_hi:[0,0,1]
  v_pk_mul_f32 v[10:11], v[76:77], v[96:97] op_sel_hi:[1,0]
  v_pk_fma_f32 v[44:45], v[44:45], v[96:97], v[10:11] op_sel:[0,1,0] op_sel_hi:[1,1,1] neg_lo:[0,0,1] neg_hi:[0,0,1]
  v_pk_mul_f32 v[10:11], v[78:79], v[96:97] op_sel_hi:[1,0]
  v_pk_fma_f32 v[46:47], v[46:47], v[96:97], v[10:11] op_sel:[0,1,0] op_sel_hi:[1,1,1] neg_lo:[0,0,1] neg_hi:[0,0,1]
  v_cvt_pk_bf16_f32 v104, v16, v17
  v_cvt_pk_bf16_f32 v105, v18, v19
  v_cvt_pk_bf16_f32 v106, v20, v21
  v_cvt_pk_bf16_f32 v107, v22, v23
  v_cvt_pk_bf16_f32 v108, v24, v25
  v_cvt_pk_bf16_f32 v109, v26, v27
  v_cvt_pk_bf16_f32 v110, v28, v29
  v_cvt_pk_bf16_f32 v111, v30, v31
  v_cvt_pk_bf16_f32 v112, v32, v33
  v_cvt_pk_bf16_f32 v113, v34, v35
  v_cvt_pk_bf16_f32 v114, v36, v37
  v_cvt_pk_bf16_f32 v115, v38, v39
  v_cvt_pk_bf16_f32 v116, v40, v41
  v_cvt_pk_bf16_f32 v117, v42, v43
  v_cvt_pk_bf16_f32 v118, v44, v45
  v_cvt_pk_bf16_f32 v119, v46, v47
  s_lshl_b32 s53, s47, 18
  s_add_u32 s53, s53, 33554432
  buffer_store_dwordx4 v[104:107], v98, s[4:7], s53 offen offset:0 sc1
  buffer_store_dwordx4 v[108:111], v98, s[4:7], s53 offen offset:1024 sc1
  buffer_store_dwordx4 v[112:115], v98, s[4:7], s53 offen offset:2048 sc1
  buffer_store_dwordx4 v[116:119], v98, s[4:7], s53 offen offset:3072 sc1
  s_lshl_b32 s61, s20, 1
  s_add_u32 s61, s61, s46
  s_lshl_b32 s61, s61, 7
  s_add_u32 s61, s61, 4096
  s_mov_b32 s68, s47
  s_xor_b32 s51, s51, 33280
  s_mov_b32 s47, s66
  s_cmp_eq_u32 s58, 1
  s_cbranch_scc1 Lsl_155
  s_waitcnt vmcnt(0)
  v_mov_b32 v10, 1
  s_mov_b64 exec, 1
  buffer_atomic_add v10, off, s[4:7], s61 sc1
  s_mov_b64 exec, -1
  s_mov_b32 s61, 0
Lsl_159:
  s_cmp_ge_u32 s47, s48
  s_cbranch_scc1 Lsl_157
  s_lshl_b32 s57, s47, 15
  s_cmp_ge_u32 s47, 64
  s_cselect_b32 s29, 2097152, 0
  s_add_u32 s57, s57, s29
  s_add_u32 s57, s57, 19922944
  s_and_b32 s29, s47, 62
  s_cmp_eq_u32 s29, 0
  s_cbranch_scc0 Lsp_166
  s_mov_b32 s69, 1
  s_mov_b32 s26, 0
  s_mul_i32 s29, s21, 8192
  s_add_u32 s29, s29, s51
  v_add_u32 v12, s29, v1
  v_and_b32 v13, 7, v0
  v_lshlrev_b32 v13, 10, v13
  s_lshl_b32 s29, s21, 13
  v_add_u32 v13, s29, v13
  s_nop 1
Lsp_165:
  buffer_load_dword v10, v13, s[4:7], s57 offen offset:0 sc1
  s_add_u32 s26, s26, 1
  s_cmp_gt_u32 s26, 8192
  s_cbranch_scc1 Lsp_166x
  s_waitcnt vmcnt(0)
  v_cmp_eq_u32 vcc, -1, v10
  s_cbranch_vccnz Lsp_165
  s_mul_i32 s53, s21, 8192
  s_add_u32 s53, s53, s51
  s_add_u32 m0, s53, 0
  s_add_u32 s54, s57, 0
  buffer_load_dwordx4 v6, s[4:7], s54 offen sc1 lds
  s_add_u32 m0, s53, 1024
  s_add_u32 s54, s57, 1024
  buffer_load_dwordx4 v6, s[4:7], s54 offen sc1 lds
  s_add_u32 m0, s53, 2048
  s_add_u32 s54, s57, 2048
  buffer_load_dwordx4 v6, s[4:7], s54 offen sc1 lds
  s_add_u32 m0, s53, 3072
  s_add_u32 s54, s57, 3072
  buffer_load_dwordx4 v6, s[4:7], s54 offen sc1 lds
  s_add_u32 m0, s53, 4096
  s_add_u32 s54, s57, 4096
  buffer_load_dwordx4 v6, s[4:7], s54 offen sc1 lds
  s_add_u32 m0, s53, 5120
  s_add_u32 s54, s57, 5120
  buffer_load_dwordx4 v6, s[4:7], s54 offen sc1 lds
  s_add_u32 m0, s53, 6144
  s_add_u32 s54, s57, 6144
  buffer_load_dwordx4 v6, s[4:7], s54 offen sc1 lds
  s_add_u32 m0, s53, 7168
  s_add_u32 s54, s57, 7168
  buffer_load_dwordx4 v6, s[4:7], s54 offen sc1 lds
  s_waitcnt vmcnt(0)
  ds_read_b128 v[104:107], v12 offset:0
  ds_read_b128 v[108:111], v12 offset:1024
  ds_read_b128 v[112:115], v12 offset:2048
  ds_read_b128 v[116:119], v12 offset:3072
  ds_read_b128 v[120:123], v12 offset:4096
  ds_read_b128 v[124:127], v12 offset:5120
  ds_read_b128 v[128:131], v12 offset:6144
  ds_read_b128 v[132:135], v12 offset:7168
  s_waitcnt lgkmcnt(0)
  v_max3_u32 v10, v104, v105, v106
  v_max3_u32 v10, v10, v107, v108
  v_max3_u32 v10, v10, v109, v110
  v_max3_u32 v10, v10, v111, v112
  v_max3_u32 v10, v10, v113, v114
  v_max3_u32 v10, v10, v115, v116
  v_max3_u32 v10, v10, v117, v118
  v_max3_u32 v10, v10, v119, v120
  v_max3_u32 v10, v10, v121, v122
  v_max3_u32 v10, v10, v123, v124
  v_max3_u32 v10, v10, v125, v126
  v_max3_u32 v10, v10, v127, v128
  v_max3_u32 v10, v10, v129, v130
  v_max3_u32 v10, v10, v131, v132
  v_max3_u32 v10, v10, v133, v134
  v_max_u32 v10, v10, v135
  v_cmp_eq_u32 vcc, -1, v10
  s_cbranch_vccz Lsl_155
  s_sleep 4
  s_branch Lsp_165
  s_nop 1
Lsp_166x:
  s_mov_b32 s69, 0
Lsp_166:
  v_lshlrev_b32 v12, 7, v0
  s_lshl_b32 s29, s21, 13
  v_add_u32 v12, s29, v12
  s_lshl_b32 s67, s47, 7
  s_add_u32 s67, s67, 38912
  s_mov_b32 s52, 16
  s_mov_b32 s26, 0
Lwf_167:
  buffer_load_dword v10, off, s[4:7], s67 sc1
  buffer_load_dword v13, v12, s[4:7], s57 offen sc1
  s_waitcnt vmcnt(1)
  v_readfirstlane_b32 s29, v10
  s_nop 0
  s_cmp_ge_u32 s29, s52
  s_nop 1
  s_cbranch_scc1 Lwf_168
  s_sleep 0
  s_add_u32 s26, s26, 1
  s_cmp_lt_u32 s26, 0x100000
  s_cbranch_scc1 Lwf_167
  s_branch L_end
Lwf_168:
  s_mul_i32 s53, s21, 8192
  s_add_u32 s53, s53, s51
  s_add_u32 m0, s53, 0
  s_add_u32 s54, s57, 0
  buffer_load_dwordx4 v6, s[4:7], s54 offen sc1 lds
  s_add_u32 m0, s53, 1024
  s_add_u32 s54, s57, 1024
  buffer_load_dwordx4 v6, s[4:7], s54 offen sc1 lds
  s_add_u32 m0, s53, 2048
  s_add_u32 s54, s57, 2048
  buffer_load_dwordx4 v6, s[4:7], s54 offen sc1 lds
  s_add_u32 m0, s53, 3072
  s_add_u32 s54, s57, 3072
  buffer_load_dwordx4 v6, s[4:7], s54 offen sc1 lds
  s_add_u32 m0, s53, 4096
  s_add_u32 s54, s57, 4096
  buffer_load_dwordx4 v6, s[4:7], s54 offen sc1 lds
  s_add_u32 m0, s53, 5120
  s_add_u32 s54, s57, 5120
  buffer_load_dwordx4 v6, s[4:7], s54 offen sc1 lds
  s_add_u32 m0, s53, 6144
  s_add_u32 s54, s57, 6144
  buffer_load_dwordx4 v6, s[4:7], s54 offen sc1 lds
  s_add_u32 m0, s53, 7168
  s_add_u32 s54, s57, 7168
  buffer_load_dwordx4 v6, s[4:7], s54 offen sc1 lds
  s_branch Lsl_155
Lsl_157:
  s_branch Lkv_132
Lkv_131:
  s_cmp_lg_u32 s46, 0
  s_cbranch_scc1 Lnp_169
  s_mov_b32 s53, 83886080
  v_mov_b32 v104, -1
  v_mov_b32 v105, -1
  v_mov_b32 v106, -1
  v_mov_b32 v107, -1
  buffer_store_dwordx4 v[104:107], v98, s[4:7], s53 offen offset:0 sc1
  buffer_store_dwordx4 v[104:107], v98, s[4:7], s53 offen offset:1024 sc1
  buffer_store_dwordx4 v[104:107], v98, s[4:7], s53 offen offset:2048 sc1
  buffer_store_dwordx4 v[104:107], v98, s[4:7], s53 offen offset:3072 sc1
  s_mov_b32 s53, 67108864
  buffer_store_dwordx4 v[104:107], v98, s[4:7], s53 offen offset:0 sc1
  buffer_store_dwordx4 v[104:107], v98, s[4:7], s53 offen offset:1024 sc1
  buffer_store_dwordx4 v[104:107], v98, s[4:7], s53 offen offset:2048 sc1
  buffer_store_dwordx4 v[104:107], v98, s[4:7], s53 offen offset:3072 sc1
  s_lshl_b32 s53, s20, 7
  s_add_u32 s53, s53, 56960
  s_waitcnt vmcnt(0)
  v_mov_b32 v10, 1
  s_mov_b64 exec, 1
  buffer_atomic_add v10, off, s[4:7], s53 sc1
  s_mov_b64 exec, -1
Lnp_169:
  s_mov_b32 s67, 56832
  s_mov_b32 s52, 32
  s_mov_b32 s26, 0
Lwf_171:
  buffer_load_dword v10, off, s[4:7], s67 sc1
  s_waitcnt vmcnt(0)
  v_readfirstlane_b32 s29, v10
  s_nop 0
  s_cmp_ge_u32 s29, s52
  s_nop 1
  s_cbranch_scc1 Lwf_172
  s_sleep 0
  s_add_u32 s26, s26, 1
  s_cmp_lt_u32 s26, 0x100000
  s_cbranch_scc1 Lwf_171
  s_branch L_end
Lwf_172:
  s_mov_b32 s69, 0
  s_mov_b32 s51, 0
  s_mov_b32 s61, 0
  s_branch Lsl_177
Lsl_173:
  s_add_u32 s66, s47, s49
  s_sub_u32 s53, s48, 1
  s_min_u32 s53, s53, s66
  s_lshl_b32 s67, s53, 7
  s_add_u32 s67, s67, 38912
  s_mov_b32 s52, 16
  buffer_load_dword v11, off, s[4:7], s67 sc1
  s_waitcnt vmcnt(0)
  v_readfirstlane_b32 s58, v11
  s_barrier
  s_cmp_eq_u32 s61, 0
  s_nop 1
  s_cbranch_scc1 Lsl_178
  v_mov_b32 v10, 1
  s_mov_b64 exec, 1
  buffer_atomic_add v10, off, s[4:7], s61 sc1
  s_mov_b64 exec, -1
Lsl_178:
  s_xor_b32 s53, s51, 33280
  s_cmp_ge_u32 s58, s52
  s_cselect_b32 s58, 1, 0
  s_cmp_lt_u32 s66, s48
  s_cselect_b32 s58, s58, 0
  s_cmp_eq_u32 s58, 0
  s_cbranch_scc1 Lsl_176
  s_mov_b32 s67, s53
  s_lshl_b32 s57, s66, 15
  s_cmp_ge_u32 s66, 64
  s_cselect_b32 s29, 2097152, 0
  s_add_u32 s57, s57, s29
  s_add_u32 s57, s57, 19922944
  s_mul_i32 s53, s21, 8192
  s_add_u32 s53, s53, s67
  s_add_u32 m0, s53, 0
  s_add_u32 s54, s57, 0
  buffer_load_dwordx4 v6, s[4:7], s54 offen sc1 lds
  s_add_u32 m0, s53, 1024
  s_add_u32 s54, s57, 1024
  buffer_load_dwordx4 v6, s[4:7], s54 offen sc1 lds
  s_add_u32 m0, s53, 2048
  s_add_u32 s54, s57, 2048
  buffer_load_dwordx4 v6, s[4:7], s54 offen sc1 lds
  s_add_u32 m0, s53, 3072
  s_add_u32 s54, s57, 3072
  buffer_load_dwordx4 v6, s[4:7], s54 offen sc1 lds
  s_add_u32 m0, s53, 4096
  s_add_u32 s54, s57, 4096
  buffer_load_dwordx4 v6, s[4:7], s54 offen sc1 lds
  s_add_u32 m0, s53, 5120
  s_add_u32 s54, s57, 5120
  buffer_load_dwordx4 v6, s[4:7], s54 offen sc1 lds
  s_add_u32 m0, s53, 6144
  s_add_u32 s54, s57, 6144
  buffer_load_dwordx4 v6, s[4:7], s54 offen sc1 lds
  s_add_u32 m0, s53, 7168
  s_add_u32 s54, s57, 7168
  buffer_load_dwordx4 v6, s[4:7], s54 offen sc1 lds
Lsl_176:
  s_and_b32 s29, s47, 62
  s_cmp_eq_u32 s29, 0
  s_cbranch_scc1 Lst_179
  s_lshr_b32 s53, s47, 6
  s_lshl_b32 s53, s53, 6
  s_add_u32 s53, s53, s47
  s_lshl_b32 s54, s53, 8
  s_add_u32 s54, s54, 30539776
  v_lshlrev_b32 v10, 2, v2
  buffer_load_dword v96, v10, s[4:7], s54 offen sc1
  buffer_load_dword v97, v10, s[4:7], s54 offen offset:128 sc1
  s_branch Lst_180
Lst_179:
  s_mul_i32 s53, s21, 8192
  s_add_u32 s53, s53, s51
  v_add_u32 v9, s53, v5
  v_mov_b32 v96, 0
  v_mov_b32 v97, 0
  ds_read_b128 v[104:107], v9 offset:0
  ds_read_b128 v[108:111], v9 offset:1024
  ds_read_b128 v[112:115], v9 offset:2048
  ds_read_b128 v[116:119], v9 offset:3072
  ds_read_b128 v[120:123], v9 offset:4096
  ds_read_b128 v[124:127], v9 offset:5120
  ds_read_b128 v[128:131], v9 offset:6144
  ds_read_b128 v[132:135], v9 offset:7168
  s_waitcnt lgkmcnt(7)
  v_dot2c_f32_bf16 v96, v104, v100
  v_dot2c_f32_bf16 v97, v104, v104
  v_dot2c_f32_bf16 v96, v105, v100
  v_dot2c_f32_bf16 v97, v105, v105
  v_dot2c_f32_bf16 v96, v106, v100
  v_dot2c_f32_bf16 v97, v106, v106
  v_dot2c_f32_bf16 v96, v107, v100
  v_dot2c_f32_bf16 v97, v107, v107
  s_waitcnt lgkmcnt(6)
  v_dot2c_f32_bf16 v96, v108, v100
  v_dot2c_f32_bf16 v97, v108, v108
  v_dot2c_f32_bf16 v96, v109, v100
  v_dot2c_f32_bf16 v97, v109, v109
  v_dot2c_f32_bf16 v96, v110, v100
  v_dot2c_f32_bf16 v97, v110, v110
  v_dot2c_f32_bf16 v96, v111, v100
  v_dot2c_f32_bf16 v97, v111, v111
  s_waitcnt lgkmcnt(5)
  v_dot2c_f32_bf16 v96, v112, v100
  v_dot2c_f32_bf16 v97, v112, v112
  v_dot2c_f32_bf16 v96, v113, v100
  v_dot2c_f32_bf16 v97, v113, v113
  v_dot2c_f32_bf16 v96, v114, v100
  v_dot2c_f32_bf16 v97, v114, v114
  v_dot2c_f32_bf16 v96, v115, v100
  v_dot2c_f32_bf16 v97, v115, v115
  s_waitcnt lgkmcnt(4)
  v_dot2c_f32_bf16 v96, v116, v100
  v_dot2c_f32_bf16 v97, v116, v116
  v_dot2c_f32_bf16 v96, v117, v100
  v_dot2c_f32_bf16 v97, v117, v117
  v_dot2c_f32_bf16 v96, v118, v100
  v_dot2c_f32_bf16 v97, v118, v118
  v_dot2c_f32_bf16 v96, v119, v100
  v_dot2c_f32_bf16 v97, v119, v119
  s_waitcnt lgkmcnt(3)
  v_dot2c_f32_bf16 v96, v120, v100
  v_dot2c_f32_bf16 v97, v120, v120
  v_dot2c_f32_bf16 v96, v121, v100
  v_dot2c_f32_bf16 v97, v121, v121
  v_dot2c_f32_bf16 v96, v122, v100
  v_dot2c_f32_bf16 v97, v122, v122
  v_dot2c_f32_bf16 v96, v123, v100
  v_dot2c_f32_bf16 v97, v123, v123
  s_waitcnt lgkmcnt(2)
  v_dot2c_f32_bf16 v96, v124, v100
  v_dot2c_f32_bf16 v97, v124, v124
  v_dot2c_f32_bf16 v96, v125, v100
  v_dot2c_f32_bf16 v97, v125, v125
  v_dot2c_f32_bf16 v96, v126, v100
  v_dot2c_f32_bf16 v97, v126, v126
  v_dot2c_f32_bf16 v96, v127, v100
  v_dot2c_f32_bf16 v97, v127, v127
  s_waitcnt lgkmcnt(1)
  v_dot2c_f32_bf16 v96, v128, v100
  v_dot2c_f32_bf16 v97, v128, v128
  v_dot2c_f32_bf16 v96, v129, v100
  v_dot2c_f32_bf16 v97, v129, v129
  v_dot2c_f32_bf16 v96, v130, v100
  v_dot2c_f32_bf16 v97, v130, v130
  v_dot2c_f32_bf16 v96, v131, v100
  v_dot2c_f32_bf16 v97, v131, v131
  s_waitcnt lgkmcnt(0)
  v_dot2c_f32_bf16 v96, v132, v100
  v_dot2c_f32_bf16 v97, v132, v132
  v_dot2c_f32_bf16 v96, v133, v100
  v_dot2c_f32_bf16 v97, v133, v133
  v_dot2c_f32_bf16 v96, v134, v100
  v_dot2c_f32_bf16 v97, v134, v134
  v_dot2c_f32_bf16 v96, v135, v100
  v_dot2c_f32_bf16 v97, v135, v135
  s_nop 2
  v_permlane32_swap_b32 v96, v97
  v_add_f32 v96, v96, v97
  v_lshlrev_b32 v10, 2, v0
  s_lshl_b32 s53, s21, 8
  s_add_u32 s53, s53, 68608
  v_add_u32 v10, s53, v10
  ds_write_b32 v10, v96
  s_nop 0
Lst_180:
  v_add_u32 v9, s51, v5
  ds_read_b128 v[80:83], v9 offset:0
  ds_read_b128 v[84:87], v9 offset:1024
  ds_read_b128 v[88:91], v9 offset:2048
  s_waitcnt lgkmcnt(2)
  v_mfma_f32_32x32x16_bf16 v[16:31], v[80:83], a[0:3], 0
  ds_read_b128 v[92:95], v9 offset:3072
  v_mfma_f32_32x32x16_bf16 v[32:47], v[80:83], a[4:7], 0
  s_waitcnt lgkmcnt(2)
  v_mfma_f32_32x32x16_bf16 v[16:31], v[84:87], a[8:11], v[16:31]
  ds_read_b128 v[80:83], v9 offset:4096
  v_mfma_f32_32x32x16_bf16 v[32:47], v[84:87], a[12:15], v[32:47]
  s_waitcnt lgkmcnt(2)
  v_mfma_f32_32x32x16_bf16 v[16:31], v[88:91], a[16:19], v[16:31]
  ds_read_b128 v[84:87], v9 offset:5120
  v_mfma_f32_32x32x16_bf16 v[32:47], v[88:91], a[20:23], v[32:47]
  s_waitcnt lgkmcnt(2)
  v_mfma_f32_32x32x16_bf16 v[16:31], v[92:95], a[24:27], v[16:31]
  ds_read_b128 v[88:91], v9 offset:6144
  v_mfma_f32_32x32x16_bf16 v[32:47], v[92:95], a[28:31], v[32:47]
  s_waitcnt lgkmcnt(2)
  v_mfma_f32_32x32x16_bf16 v[16:31], v[80:83], a[32:35], v[16:31]
  ds_read_b128 v[92:95], v9 offset:7168
  v_mfma_f32_32x32x16_bf16 v[32:47], v[80:83], a[36:39], v[32:47]
  s_waitcnt lgkmcnt(2)
  v_mfma_f32_32x32x16_bf16 v[16:31], v[84:87], a[40:43], v[16:31]
  ds_read_b128 v[80:83], v9 offset:8192
  v_mfma_f32_32x32x16_bf16 v[32:47], v[84:87], a[44:47], v[32:47]
  s_waitcnt lgkmcnt(2)
  v_mfma_f32_32x32x16_bf16 v[16:31], v[88:91], a[48:51], v[16:31]
  ds_read_b128 v[84:87], v9 offset:9216
  v_mfma_f32_32x32x16_bf16 v[32:47], v[88:91], a[52:55], v[32:47]
  s_waitcnt lgkmcnt(2)
  v_mfma_f32_32x32x16_bf16 v[16:31], v[92:95], a[56:59], v[16:31]
  ds_read_b128 v[88:91], v9 offset:10240
  v_mfma_f32_32x32x16_bf16 v[32:47], v[92:95], a[60:63], v[32:47]
  s_waitcnt lgkmcnt(2)
  v_mfma_f32_32x32x16_bf16 v[16:31], v[80:83], a[64:67], v[16:31]
  ds_read_b128 v[92:95], v9 offset:11264
  v_mfma_f32_32x32x16_bf16 v[32:47], v[80:83], a[68:71], v[32:47]
  s_waitcnt lgkmcnt(2)
  v_mfma_f32_32x32x16_bf16 v[16:31], v[84:87], a[72:75], v[16:31]
  ds_read_b128 v[80:83], v9 offset:12288
  v_mfma_f32_32x32x16_bf16 v[32:47], v[84:87], a[76:79], v[32:47]
  s_waitcnt lgkmcnt(2)
  v_mfma_f32_32x32x16_bf16 v[16:31], v[88:91], a[80:83], v[16:31]
  ds_read_b128 v[84:87], v9 offset:13312
  v_mfma_f32_32x32x16_bf16 v[32:47], v[88:91], a[84:87], v[32:47]
  s_waitcnt lgkmcnt(2)
  v_mfma_f32_32x32x16_bf16 v[16:31], v[92:95], a[88:91], v[16:31]
  ds_read_b128 v[88:91], v9 offset:14336
  v_mfma_f32_32x32x16_bf16 v[32:47], v[92:95], a[92:95], v[32:47]
  s_waitcnt lgkmcnt(2)
  v_mfma_f32_32x32x16_bf16 v[16:31], v[80:83], a[96:99], v[16:31]
  ds_read_b128 v[92:95], v9 offset:15360
  v_mfma_f32_32x32x16_bf16 v[32:47], v[80:83], a[100:103], v[32:47]
  s_waitcnt lgkmcnt(2)
  v_mfma_f32_32x32x16_bf16 v[16:31], v[84:87], a[104:107], v[16:31]
  ds_read_b128 v[80:83], v9 offset:16384
  v_mfma_f32_32x32x16_bf16 v[32:47], v[84:87], a[108:111], v[32:47]
  s_waitcnt lgkmcnt(2)
  v_mfma_f32_32x32x16_bf16 v[16:31], v[88:91], a[112:115], v[16:31]
  ds_read_b128 v[84:87], v9 offset:17408
  v_mfma_f32_32x32x16_bf16 v[32:47], v[88:91], a[116:119], v[32:47]
  s_waitcnt lgkmcnt(2)
  v_mfma_f32_32x32x16_bf16 v[16:31], v[92:95], a[120:123], v[16:31]
  ds_read_b128 v[88:91], v9 offset:18432
  v_mfma_f32_32x32x16_bf16 v[32:47], v[92:95], a[124:127], v[32:47]
  s_waitcnt lgkmcnt(2)
  v_mfma_f32_32x32x16_bf16 v[16:31], v[80:83], a[128:131], v[16:31]
  ds_read_b128 v[92:95], v9 offset:19456
  v_mfma_f32_32x32x16_bf16 v[32:47], v[80:83], a[132:135], v[32:47]
  s_waitcnt lgkmcnt(2)
  v_mfma_f32_32x32x16_bf16 v[16:31], v[84:87], a[136:139], v[16:31]
  ds_read_b128 v[80:83], v9 offset:20480
  v_mfma_f32_32x32x16_bf16 v[32:47], v[84:87], a[140:143], v[32:47]
  s_waitcnt lgkmcnt(2)
  v_mfma_f32_32x32x16_bf16 v[16:31], v[88:91], a[144:147], v[16:31]
  ds_read_b128 v[84:87], v9 offset:21504
  v_mfma_f32_32x32x16_bf16 v[32:47], v[88:91], a[148:151], v[32:47]
  s_waitcnt lgkmcnt(2)
  v_mfma_f32_32x32x16_bf16 v[16:31], v[92:95], a[152:155], v[16:31]
  ds_read_b128 v[88:91], v9 offset:22528
  v_mfma_f32_32x32x16_bf16 v[32:47], v[92:95], a[156:159], v[32:47]
  s_waitcnt lgkmcnt(2)
  v_mfma_f32_32x32x16_bf16 v[16:31], v[80:83], a[160:163], v[16:31]
  ds_read_b128 v[92:95], v9 offset:23552
  v_mfma_f32_32x32x16_bf16 v[32:47], v[80:83], a[164:167], v[32:47]
  s_waitcnt lgkmcnt(2)
  v_mfma_f32_32x32x16_bf16 v[16:31], v[84:87], a[168:171], v[16:31]
  ds_read_b128 v[80:83], v9 offset:24576
  v_mfma_f32_32x32x16_bf16 v[32:47], v[84:87], a[172:175], v[32:47]
  s_waitcnt lgkmcnt(2)
  v_mfma_f32_32x32x16_bf16 v[16:31], v[88:91], a[176:179], v[16:31]
  ds_read_b128 v[84:87], v9 offset:25600
  v_mfma_f32_32x32x16_bf16 v[32:47], v[88:91], a[180:183], v[32:47]
  s_waitcnt lgkmcnt(2)
  v_mfma_f32_32x32x16_bf16 v[16:31], v[92:95], a[184:187], v[16:31]
  ds_read_b128 v[88:91], v9 offset:26624
  v_mfma_f32_32x32x16_bf16 v[32:47], v[92:95], a[188:191], v[32:47]
  s_waitcnt lgkmcnt(2)
  v_mfma_f32_32x32x16_bf16 v[16:31], v[80:83], a[192:195], v[16:31]
  ds_read_b128 v[92:95], v9 offset:27648
  v_mfma_f32_32x32x16_bf16 v[32:47], v[80:83], a[196:199], v[32:47]
  s_waitcnt lgkmcnt(2)
  v_mfma_f32_32x32x16_bf16 v[16:31], v[84:87], a[200:203], v[16:31]
  ds_read_b128 v[80:83], v9 offset:28672
  v_mfma_f32_32x32x16_bf16 v[32:47], v[84:87], a[204:207], v[32:47]
  s_waitcnt lgkmcnt(2)
  v_mfma_f32_32x32x16_bf16 v[16:31], v[88:91], a[208:211], v[16:31]
  ds_read_b128 v[84:87], v9 offset:29696
  v_mfma_f32_32x32x16_bf16 v[32:47], v[88:91], a[212:215], v[32:47]
  s_waitcnt lgkmcnt(2)
  v_mfma_f32_32x32x16_bf16 v[16:31], v[92:95], a[216:219], v[16:31]
  ds_read_b128 v[88:91], v9 offset:30720
  v_mfma_f32_32x32x16_bf16 v[32:47], v[92:95], a[220:223], v[32:47]
  s_waitcnt lgkmcnt(2)
  v_mfma_f32_32x32x16_bf16 v[16:31], v[80:83], a[224:227], v[16:31]
  ds_read_b128 v[92:95], v9 offset:31744
  v_mfma_f32_32x32x16_bf16 v[32:47], v[80:83], a[228:231], v[32:47]
  s_waitcnt lgkmcnt(2)
  v_mfma_f32_32x32x16_bf16 v[16:31], v[84:87], a[232:235], v[16:31]
  v_mfma_f32_32x32x16_bf16 v[32:47], v[84:87], a[236:239], v[32:47]
  s_waitcnt lgkmcnt(1)
  v_mfma_f32_32x32x16_bf16 v[16:31], v[88:91], a[240:243], v[16:31]
  v_mfma_f32_32x32x16_bf16 v[32:47], v[88:91], a[244:247], v[32:47]
  s_waitcnt lgkmcnt(0)
  v_mfma_f32_32x32x16_bf16 v[16:31], v[92:95], a[248:251], v[16:31]
  v_mfma_f32_32x32x16_bf16 v[32:47], v[92:95], a[252:255], v[32:47]
  s_and_b32 s29, s47, 62
  s_cmp_eq_u32 s29, 0
  s_nop 8
  s_cbranch_scc0 Lst_181
  s_barrier
  v_lshlrev_b32 v10, 2, v2
  v_add_u32 v10, 68608, v10
  ds_read2_b32 v[104:105], v10 offset0:0 offset1:32
  ds_read2_b32 v[106:107], v10 offset0:64 offset1:96
  ds_read2_b32 v[108:109], v10 offset0:128 offset1:160
  ds_read2_b32 v[110:111], v10 offset0:192 offset1:224
  s_waitcnt lgkmcnt(0)
  v_pk_add_f32 v[104:105], v[104:105], v[106:107]
  v_pk_add_f32 v[108:109], v[108:109], v[110:111]
  v_pk_add_f32 v[96:97], v[104:105], v[108:109]
  s_nop 0
  s_branch Lst_182
Lst_181:
  s_waitcnt vmcnt(0)
Lst_182:
  v_mul_f32 v96, s59, v96
  v_mul_f32 v97, s59, v97
  v_fma_f32 v97, -v96, v96, v97
  v_max_f32 v97, 0, v97
  v_cvt_pk_bf16_f32 v96, v96, v96
  v_and_b32 v96, 0xffff0000, v96
  v_cvt_pk_bf16_f32 v97, v97, v97
  v_and_b32 v97, 0xffff0000, v97
  v_add_f32 v97, s60, v97
  v_cvt_pk_bf16_f32 v97, v97, v97
  v_and_b32 v97, 0xffff0000, v97
  v_sqrt_f32 v97, v97
  s_nop 0
  v_cvt_pk_bf16_f32 v97, v97, v97
  v_and_b32 v97, 0xffff0000, v97
  v_rcp_f32 v97, v97
  s_nop 0
  v_mul_f32 v96, v96, v97
  ds_write2_b32 v7, v96, v97 offset0:0 offset1:32
  s_waitcnt lgkmcnt(0)
  ds_read_b128 v[104:107], v8 offset:0
  ds_read_b128 v[120:123], v8 offset:128
  ds_read_b128 v[108:111], v8 offset:32
  ds_read_b128 v[124:127], v8 offset:160
  ds_read_b128 v[112:115], v8 offset:64
  ds_read_b128 v[128:131], v8 offset:192
  ds_read_b128 v[116:119], v8 offset:96
  ds_read_b128 v[132:135], v8 offset:224
  s_waitcnt lgkmcnt(0)
  v_pk_mul_f32 v[10:11], v[104:105], v[48:49]
  v_pk_fma_f32 v[16:17], v[16:17], v[120:121], v[10:11] neg_lo:[0,0,1] neg_hi:[0,0,1]
  v_pk_mul_f32 v[10:11], v[106:107], v[48:49]
  v_pk_fma_f32 v[18:19], v[18:19], v[122:123], v[10:11] neg_lo:[0,0,1] neg_hi:[0,0,1]
  v_pk_mul_f32 v[10:11], v[108:109], v[48:49]
  v_pk_fma_f32 v[20:21], v[20:21], v[124:125], v[10:11] neg_lo:[0,0,1] neg_hi:[0,0,1]
  v_pk_mul_f32 v[10:11], v[110:111], v[48:49]
  v_pk_fma_f32 v[22:23], v[22:23], v[126:127], v[10:11] neg_lo:[0,0,1] neg_hi:[0,0,1]
  v_pk_mul_f32 v[10:11], v[112:113], v[48:49]
  v_pk_fma_f32 v[24:25], v[24:25], v[128:129], v[10:11] neg_lo:[0,0,1] neg_hi:[0,0,1]
  v_pk_mul_f32 v[10:11], v[114:115], v[48:49]
  v_pk_fma_f32 v[26:27], v[26:27], v[130:131], v[10:11] neg_lo:[0,0,1] neg_hi:[0,0,1]
  v_pk_mul_f32 v[10:11], v[116:117], v[48:49]
  v_pk_fma_f32 v[28:29], v[28:29], v[132:133], v[10:11] neg_lo:[0,0,1] neg_hi:[0,0,1]
  v_pk_mul_f32 v[10:11], v[118:119], v[48:49]
  v_pk_fma_f32 v[30:31], v[30:31], v[134:135], v[10:11] neg_lo:[0,0,1] neg_hi:[0,0,1]
  v_pk_mul_f32 v[10:11], v[104:105], v[64:65]
  v_pk_fma_f32 v[32:33], v[32:33], v[120:121], v[10:11] neg_lo:[0,0,1] neg_hi:[0,0,1]
  v_pk_mul_f32 v[10:11], v[106:107], v[64:65]
  v_pk_fma_f32 v[34:35], v[34:35], v[122:123], v[10:11] neg_lo:[0,0,1] neg_hi:[0,0,1]
  v_pk_mul_f32 v[10:11], v[108:109], v[64:65]
  v_pk_fma_f32 v[36:37], v[36:37], v[124:125], v[10:11] neg_lo:[0,0,1] neg_hi:[0,0,1]
  v_pk_mul_f32 v[10:11], v[110:111], v[64:65]
  v_pk_fma_f32 v[38:39], v[38:39], v[126:127], v[10:11] neg_lo:[0,0,1] neg_hi:[0,0,1]
  v_pk_mul_f32 v[10:11], v[112:113], v[64:65]
  v_pk_fma_f32 v[40:41], v[40:41], v[128:129], v[10:11] neg_lo:[0,0,1] neg_hi:[0,0,1]
  v_pk_mul_f32 v[10:11], v[114:115], v[64:65]
  v_pk_fma_f32 v[42:43], v[42:43], v[130:131], v[10:11] neg_lo:[0,0,1] neg_hi:[0,0,1]
  v_pk_mul_f32 v[10:11], v[116:117], v[64:65]
  v_pk_fma_f32 v[44:45], v[44:45], v[132:133], v[10:11] neg_lo:[0,0,1] neg_hi:[0,0,1]
  v_pk_mul_f32 v[10:11], v[118:119], v[64:65]
  v_pk_fma_f32 v[46:47], v[46:47], v[134:135], v[10:11] neg_lo:[0,0,1] neg_hi:[0,0,1]
  v_cvt_pk_bf16_f32 v104, v16, v17
  v_cvt_pk_bf16_f32 v105, v18, v19
  v_cvt_pk_bf16_f32 v106, v20, v21
  v_cvt_pk_bf16_f32 v107, v22, v23
  v_cvt_pk_bf16_f32 v108, v24, v25
  v_cvt_pk_bf16_f32 v109, v26, v27
  v_cvt_pk_bf16_f32 v110, v28, v29
  v_cvt_pk_bf16_f32 v111, v30, v31
  v_cvt_pk_bf16_f32 v112, v32, v33
  v_cvt_pk_bf16_f32 v113, v34, v35
  v_cvt_pk_bf16_f32 v114, v36, v37
  v_cvt_pk_bf16_f32 v115, v38, v39
  v_cvt_pk_bf16_f32 v116, v40, v41
  v_cvt_pk_bf16_f32 v117, v42, v43
  v_cvt_pk_bf16_f32 v118, v44, v45
  v_cvt_pk_bf16_f32 v119, v46, v47
  s_lshl_b32 s53, s47, 18
  s_add_u32 s53, s53, 67108864
  buffer_store_dwordx4 v[104:107], v98, s[4:7], s53 offen offset:0 sc1
  buffer_store_dwordx4 v[108:111], v98, s[4:7], s53 offen offset:1024 sc1
  buffer_store_dwordx4 v[112:115], v98, s[4:7], s53 offen offset:2048 sc1
  buffer_store_dwordx4 v[116:119], v98, s[4:7], s53 offen offset:3072 sc1
  s_lshl_b32 s61, s20, 1
  s_add_u32 s61, s61, s46
  s_lshl_b32 s61, s61, 7
  s_add_u32 s61, s61, 4096
  s_mov_b32 s68, s47
  s_xor_b32 s51, s51, 33280
  s_mov_b32 s47, s66
  s_cmp_eq_u32 s58, 1
  s_cbranch_scc1 Lsl_173
  s_waitcnt vmcnt(0)
  v_mov_b32 v10, 1
  s_mov_b64 exec, 1
  buffer_atomic_add v10, off, s[4:7], s61 sc1
  s_mov_b64 exec, -1
  s_mov_b32 s61, 0
Lsl_177:
  s_cmp_ge_u32 s47, s48
  s_cbranch_scc1 Lsl_175
  s_lshl_b32 s57, s47, 15
  s_cmp_ge_u32 s47, 64
  s_cselect_b32 s29, 2097152, 0
  s_add_u32 s57, s57, s29
  s_add_u32 s57, s57, 19922944
  s_and_b32 s29, s47, 62
  s_cmp_eq_u32 s29, 0
  s_cbranch_scc0 Lsp_184
  s_mov_b32 s69, 1
  s_mov_b32 s26, 0
  s_mul_i32 s29, s21, 8192
  s_add_u32 s29, s29, s51
  v_add_u32 v12, s29, v1
  v_and_b32 v13, 7, v0
  v_lshlrev_b32 v13, 10, v13
  s_lshl_b32 s29, s21, 13
  v_add_u32 v13, s29, v13
  s_nop 1
Lsp_183:
  buffer_load_dword v10, v13, s[4:7], s57 offen offset:0 sc1
  s_add_u32 s26, s26, 1
  s_cmp_gt_u32 s26, 8192
  s_cbranch_scc1 Lsp_184x
  s_waitcnt vmcnt(0)
  v_cmp_eq_u32 vcc, -1, v10
  s_cbranch_vccnz Lsp_183
  s_mul_i32 s53, s21, 8192
  s_add_u32 s53, s53, s51
  s_add_u32 m0, s53, 0
  s_add_u32 s54, s57, 0
  buffer_load_dwordx4 v6, s[4:7], s54 offen sc1 lds
  s_add_u32 m0, s53, 1024
  s_add_u32 s54, s57, 1024
  buffer_load_dwordx4 v6, s[4:7], s54 offen sc1 lds
  s_add_u32 m0, s53, 2048
  s_add_u32 s54, s57, 2048
  buffer_load_dwordx4 v6, s[4:7], s54 offen sc1 lds
  s_add_u32 m0, s53, 3072
  s_add_u32 s54, s57, 3072
  buffer_load_dwordx4 v6, s[4:7], s54 offen sc1 lds
  s_add_u32 m0, s53, 4096
  s_add_u32 s54, s57, 4096
  buffer_load_dwordx4 v6, s[4:7], s54 offen sc1 lds
  s_add_u32 m0, s53, 5120
  s_add_u32 s54, s57, 5120
  buffer_load_dwordx4 v6, s[4:7], s54 offen sc1 lds
  s_add_u32 m0, s53, 6144
  s_add_u32 s54, s57, 6144
  buffer_load_dwordx4 v6, s[4:7], s54 offen sc1 lds
  s_add_u32 m0, s53, 7168
  s_add_u32 s54, s57, 7168
  buffer_load_dwordx4 v6, s[4:7], s54 offen sc1 lds
  s_waitcnt vmcnt(0)
  ds_read_b128 v[104:107], v12 offset:0
  ds_read_b128 v[108:111], v12 offset:1024
  ds_read_b128 v[112:115], v12 offset:2048
  ds_read_b128 v[116:119], v12 offset:3072
  ds_read_b128 v[120:123], v12 offset:4096
  ds_read_b128 v[124:127], v12 offset:5120
  ds_read_b128 v[128:131], v12 offset:6144
  ds_read_b128 v[132:135], v12 offset:7168
  s_waitcnt lgkmcnt(0)
  v_max3_u32 v10, v104, v105, v106
  v_max3_u32 v10, v10, v107, v108
  v_max3_u32 v10, v10, v109, v110
  v_max3_u32 v10, v10, v111, v112
  v_max3_u32 v10, v10, v113, v114
  v_max3_u32 v10, v10, v115, v116
  v_max3_u32 v10, v10, v117, v118
  v_max3_u32 v10, v10, v119, v120
  v_max3_u32 v10, v10, v121, v122
  v_max3_u32 v10, v10, v123, v124
  v_max3_u32 v10, v10, v125, v126
  v_max3_u32 v10, v10, v127, v128
  v_max3_u32 v10, v10, v129, v130
  v_max3_u32 v10, v10, v131, v132
  v_max3_u32 v10, v10, v133, v134
  v_max_u32 v10, v10, v135
  v_cmp_eq_u32 vcc, -1, v10
  s_cbranch_vccz Lsl_173
  s_sleep 4
  s_branch Lsp_183
  s_nop 1
Lsp_184x:
  s_mov_b32 s69, 0
Lsp_184:
  v_lshlrev_b32 v12, 7, v0
  s_lshl_b32 s29, s21, 13
  v_add_u32 v12, s29, v12
  s_lshl_b32 s67, s47, 7
  s_add_u32 s67, s67, 38912
  s_mov_b32 s52, 16
  s_mov_b32 s26, 0
Lwf_185:
  buffer_load_dword v10, off, s[4:7], s67 sc1
  buffer_load_dword v13, v12, s[4:7], s57 offen sc1
  s_waitcnt vmcnt(1)
  v_readfirstlane_b32 s29, v10
  s_nop 0
  s_cmp_ge_u32 s29, s52
  s_nop 1
  s_cbranch_scc1 Lwf_186
  s_sleep 0
  s_add_u32 s26, s26, 1
  s_cmp_lt_u32 s26, 0x100000
  s_cbranch_scc1 Lwf_185
  s_branch L_end
Lwf_186:
  s_mul_i32 s53, s21, 8192
  s_add_u32 s53, s53, s51
  s_add_u32 m0, s53, 0
  s_add_u32 s54, s57, 0
  buffer_load_dwordx4 v6, s[4:7], s54 offen sc1 lds
  s_add_u32 m0, s53, 1024
  s_add_u32 s54, s57, 1024
  buffer_load_dwordx4 v6, s[4:7], s54 offen sc1 lds
  s_add_u32 m0, s53, 2048
  s_add_u32 s54, s57, 2048
  buffer_load_dwordx4 v6, s[4:7], s54 offen sc1 lds
  s_add_u32 m0, s53, 3072
  s_add_u32 s54, s57, 3072
  buffer_load_dwordx4 v6, s[4:7], s54 offen sc1 lds
  s_add_u32 m0, s53, 4096
  s_add_u32 s54, s57, 4096
  buffer_load_dwordx4 v6, s[4:7], s54 offen sc1 lds
  s_add_u32 m0, s53, 5120
  s_add_u32 s54, s57, 5120
  buffer_load_dwordx4 v6, s[4:7], s54 offen sc1 lds
  s_add_u32 m0, s53, 6144
  s_add_u32 s54, s57, 6144
  buffer_load_dwordx4 v6, s[4:7], s54 offen sc1 lds
  s_add_u32 m0, s53, 7168
  s_add_u32 s54, s57, 7168
  buffer_load_dwordx4 v6, s[4:7], s54 offen sc1 lds
  s_branch Lsl_173
Lsl_175:
  s_branch Lkv_132
Lkv_132:
  s_branch L_end
L_chain:
  v_and_b32 v1, 15, v0
  v_lshrrev_b32 v2, 4, v0
  v_lshrrev_b32 v3, 5, v0
  v_and_b32 v4, 1, v2
  v_bfe_u32 v5, v1, 1, 1
  v_lshrrev_b32 v6, 2, v1
  v_and_b32 v8, 1, v1
  v_lshl_add_u32 v6, v6, 1, v8
  v_lshlrev_b32 v7, 4, v0
  v_lshlrev_b32 v8, 1, v2
  v_xor_b32 v8, v8, v1
  v_lshlrev_b32 v8, 4, v8
  v_lshl_add_u32 v10, v2, 13, v8
  v_xor_b32 v11, 0x80, v10
  s_mov_b32 s8, s88
  s_and_b32 s9, s89, 0xffff
  s_mov_b32 s10, 4194304
  s_mov_b32 s11, 0x20000
  s_lshl_b32 s29, s20, 8
  s_lshl_b32 s30, s21, 17
  s_add_u32 s29, s29, s30
  s_add_u32 s29, s29, 0
  s_lshl_b32 s30, s21, 12
  s_add_u32 m0, s30, 0
  s_nop 0
  buffer_load_dwordx4 v10, s[8:11], s29 offen lds
  s_lshl_b32 s29, s20, 8
  s_lshl_b32 s30, s21, 17
  s_add_u32 s29, s29, s30
  s_add_u32 s29, s29, 32768
  s_lshl_b32 s30, s21, 12
  s_add_u32 m0, s30, 1024
  s_nop 0
  buffer_load_dwordx4 v11, s[8:11], s29 offen lds
  s_lshl_b32 s29, s20, 8
  s_lshl_b32 s30, s21, 17
  s_add_u32 s29, s29, s30
  s_add_u32 s29, s29, 65536
  s_lshl_b32 s30, s21, 12
  s_add_u32 m0, s30, 2048
  s_nop 0
  buffer_load_dwordx4 v10, s[8:11], s29 offen lds
  s_lshl_b32 s29, s20, 8
  s_lshl_b32 s30, s21, 17
  s_add_u32 s29, s29, s30
  s_add_u32 s29, s29, 98304
  s_lshl_b32 s30, s21, 12
  s_add_u32 m0, s30, 3072
  s_nop 0
  buffer_load_dwordx4 v11, s[8:11], s29 offen lds
  s_lshl_b32 s29, s20, 8
  s_lshl_b32 s30, s21, 17
  s_add_u32 s29, s29, s30
  s_add_u32 s29, s29, 524288
  s_lshl_b32 s30, s21, 12
  s_add_u32 m0, s30, 16384
  s_nop 0
  buffer_load_dwordx4 v10, s[8:11], s29 offen lds
  s_lshl_b32 s29, s20, 8
  s_lshl_b32 s30, s21, 17
  s_add_u32 s29, s29, s30
  s_add_u32 s29, s29, 557056
  s_lshl_b32 s30, s21, 12
  s_add_u32 m0, s30, 17408
  s_nop 0
  buffer_load_dwordx4 v11, s[8:11], s29 offen lds
  s_lshl_b32 s29, s20, 8
  s_lshl_b32 s30, s21, 17
  s_add_u32 s29, s29, s30
  s_add_u32 s29, s29, 589824
  s_lshl_b32 s30, s21, 12
  s_add_u32 m0, s30, 18432
  s_nop 0
  buffer_load_dwordx4 v10, s[8:11], s29 offen lds
  s_lshl_b32 s29, s20, 8
  s_lshl_b32 s30, s21, 17
  s_add_u32 s29, s29, s30
  s_add_u32 s29, s29, 622592
  s_lshl_b32 s30, s21, 12
  s_add_u32 m0, s30, 19456
  s_nop 0
  buffer_load_dwordx4 v11, s[8:11], s29 offen lds
  s_lshl_b32 s29, s20, 8
  s_lshl_b32 s30, s21, 17
  s_add_u32 s29, s29, s30
  s_add_u32 s29, s29, 1048576
  s_lshl_b32 s30, s21, 12
  s_add_u32 m0, s30, 32768
  s_nop 0
  buffer_load_dwordx4 v10, s[8:11], s29 offen lds
  s_lshl_b32 s29, s20, 8
  s_lshl_b32 s30, s21, 17
  s_add_u32 s29, s29, s30
  s_add_u32 s29, s29, 1081344
  s_lshl_b32 s30, s21, 12
  s_add_u32 m0, s30, 33792
  s_nop 0
  buffer_load_dwordx4 v11, s[8:11], s29 offen lds
  s_lshl_b32 s29, s20, 8
  s_lshl_b32 s30, s21, 17
  s_add_u32 s29, s29, s30
  s_add_u32 s29, s29, 1114112
  s_lshl_b32 s30, s21, 12
  s_add_u32 m0, s30, 34816
  s_nop 0
  buffer_load_dwordx4 v10, s[8:11], s29 offen lds
  s_lshl_b32 s29, s20, 8
  s_lshl_b32 s30, s21, 17
  s_add_u32 s29, s29, s30
  s_add_u32 s29, s29, 1146880
  s_lshl_b32 s30, s21, 12
  s_add_u32 m0, s30, 35840
  s_nop 0
  buffer_load_dwordx4 v11, s[8:11], s29 offen lds
  s_lshl_b32 s29, s20, 8
  s_lshl_b32 s30, s21, 17
  s_add_u32 s29, s29, s30
  s_add_u32 s29, s29, 1572864
  s_lshl_b32 s30, s21, 12
  s_add_u32 m0, s30, 49152
  s_nop 0
  buffer_load_dwordx4 v10, s[8:11], s29 offen lds
  s_lshl_b32 s29, s20, 8
  s_lshl_b32 s30, s21, 17
  s_add_u32 s29, s29, s30
  s_add_u32 s29, s29, 1605632
  s_lshl_b32 s30, s21, 12
  s_add_u32 m0, s30, 50176
  s_nop 0
  buffer_load_dwordx4 v11, s[8:11], s29 offen lds
  s_lshl_b32 s29, s20, 8
  s_lshl_b32 s30, s21, 17
  s_add_u32 s29, s29, s30
  s_add_u32 s29, s29, 1638400
  s_lshl_b32 s30, s21, 12
  s_add_u32 m0, s30, 51200
  s_nop 0
  buffer_load_dwordx4 v10, s[8:11], s29 offen lds
  s_lshl_b32 s29, s20, 8
  s_lshl_b32 s30, s21, 17
  s_add_u32 s29, s29, s30
  s_add_u32 s29, s29, 1671168
  s_lshl_b32 s30, s21, 12
  s_add_u32 m0, s30, 52224
  s_nop 0
  buffer_load_dwordx4 v11, s[8:11], s29 offen lds
  s_lshl_b32 s29, s20, 8
  s_lshl_b32 s30, s21, 17
  s_add_u32 s29, s29, s30
  s_add_u32 s29, s29, 2097152
  s_lshl_b32 s30, s21, 12
  s_add_u32 m0, s30, 65536
  s_nop 0
  buffer_load_dwordx4 v10, s[8:11], s29 offen lds
  s_lshl_b32 s29, s20, 8
  s_lshl_b32 s30, s21, 17
  s_add_u32 s29, s29, s30
  s_add_u32 s29, s29, 2129920
  s_lshl_b32 s30, s21, 12
  s_add_u32 m0, s30, 66560
  s_nop 0
  buffer_load_dwordx4 v11, s[8:11], s29 offen lds
  s_lshl_b32 s29, s20, 8
  s_lshl_b32 s30, s21, 17
  s_add_u32 s29, s29, s30
  s_add_u32 s29, s29, 2162688
  s_lshl_b32 s30, s21, 12
  s_add_u32 m0, s30, 67584
  s_nop 0
  buffer_load_dwordx4 v10, s[8:11], s29 offen lds
  s_lshl_b32 s29, s20, 8
  s_lshl_b32 s30, s21, 17
  s_add_u32 s29, s29, s30
  s_add_u32 s29, s29, 2195456
  s_lshl_b32 s30, s21, 12
  s_add_u32 m0, s30, 68608
  s_nop 0
  buffer_load_dwordx4 v11, s[8:11], s29 offen lds
  s_lshl_b32 s29, s20, 8
  s_lshl_b32 s30, s21, 17
  s_add_u32 s29, s29, s30
  s_add_u32 s29, s29, 2621440
  s_lshl_b32 s30, s21, 12
  s_add_u32 m0, s30, 81920
  s_nop 0
  buffer_load_dwordx4 v10, s[8:11], s29 offen lds
  s_lshl_b32 s29, s20, 8
  s_lshl_b32 s30, s21, 17
  s_add_u32 s29, s29, s30
  s_add_u32 s29, s29, 2654208
  s_lshl_b32 s30, s21, 12
  s_add_u32 m0, s30, 82944
  s_nop 0
  buffer_load_dwordx4 v11, s[8:11], s29 offen lds
  s_lshl_b32 s29, s20, 8
  s_lshl_b32 s30, s21, 17
  s_add_u32 s29, s29, s30
  s_add_u32 s29, s29, 2686976
  s_lshl_b32 s30, s21, 12
  s_add_u32 m0, s30, 83968
  s_nop 0
  buffer_load_dwordx4 v10, s[8:11], s29 offen lds
  s_lshl_b32 s29, s20, 8
  s_lshl_b32 s30, s21, 17
  s_add_u32 s29, s29, s30
  s_add_u32 s29, s29, 2719744
  s_lshl_b32 s30, s21, 12
  s_add_u32 m0, s30, 84992
  s_nop 0
  buffer_load_dwordx4 v11, s[8:11], s29 offen lds
  s_lshl_b32 s29, s20, 8
  s_lshl_b32 s30, s21, 17
  s_add_u32 s29, s29, s30
  s_add_u32 s29, s29, 3145728
  s_lshl_b32 s30, s21, 12
  s_add_u32 m0, s30, 98304
  s_nop 0
  buffer_load_dwordx4 v10, s[8:11], s29 offen lds
  s_lshl_b32 s29, s20, 8
  s_lshl_b32 s30, s21, 17
  s_add_u32 s29, s29, s30
  s_add_u32 s29, s29, 3178496
  s_lshl_b32 s30, s21, 12
  s_add_u32 m0, s30, 99328
  s_nop 0
  buffer_load_dwordx4 v11, s[8:11], s29 offen lds
  s_lshl_b32 s29, s20, 8
  s_lshl_b32 s30, s21, 17
  s_add_u32 s29, s29, s30
  s_add_u32 s29, s29, 3211264
  s_lshl_b32 s30, s21, 12
  s_add_u32 m0, s30, 100352
  s_nop 0
  buffer_load_dwordx4 v10, s[8:11], s29 offen lds
  s_lshl_b32 s29, s20, 8
  s_lshl_b32 s30, s21, 17
  s_add_u32 s29, s29, s30
  s_add_u32 s29, s29, 3244032
  s_lshl_b32 s30, s21, 12
  s_add_u32 m0, s30, 101376
  s_nop 0
  buffer_load_dwordx4 v11, s[8:11], s29 offen lds
  s_lshl_b32 s29, s20, 8
  s_lshl_b32 s30, s21, 17
  s_add_u32 s29, s29, s30
  s_add_u32 s29, s29, 3670016
  s_lshl_b32 s30, s21, 12
  s_add_u32 m0, s30, 114688
  s_nop 0
  buffer_load_dwordx4 v10, s[8:11], s29 offen lds
  s_lshl_b32 s29, s20, 8
  s_lshl_b32 s30, s21, 17
  s_add_u32 s29, s29, s30
  s_add_u32 s29, s29, 3702784
  s_lshl_b32 s30, s21, 12
  s_add_u32 m0, s30, 115712
  s_nop 0
  buffer_load_dwordx4 v11, s[8:11], s29 offen lds
  s_lshl_b32 s29, s20, 8
  s_lshl_b32 s30, s21, 17
  s_add_u32 s29, s29, s30
  s_add_u32 s29, s29, 3735552
  s_lshl_b32 s30, s21, 12
  s_add_u32 m0, s30, 116736
  s_nop 0
  buffer_load_dwordx4 v10, s[8:11], s29 offen lds
  s_lshl_b32 s29, s20, 8
  s_lshl_b32 s30, s21, 17
  s_add_u32 s29, s29, s30
  s_add_u32 s29, s29, 3768320
  s_lshl_b32 s30, s21, 12
  s_add_u32 m0, s30, 117760
  s_nop 0
  buffer_load_dwordx4 v11, s[8:11], s29 offen lds
  s_load_dwordx2 s[12:13], s[0:1], 64
  s_load_dwordx2 s[16:17], s[0:1], 56
  s_load_dwordx2 s[56:57], s[0:1], 40
  s_load_dwordx2 s[60:61], s[0:1], 32
  s_waitcnt lgkmcnt(0)
  s_and_b32 s13, s13, 0xffff
  s_mov_b32 s14, 4194304
  s_mov_b32 s15, 0x20000
  s_and_b32 s17, s17, 0xffff
  s_mov_b32 s18, 4194304
  s_mov_b32 s19, 0x20000
  s_and_b32 s57, s57, 0xffff
  s_mov_b32 s58, 4194304
  s_mov_b32 s59, 0x20000
  s_and_b32 s61, s61, 0xffff
  s_mov_b32 s62, 8192
  s_mov_b32 s63, 0x20000
  s_lshl_b32 s29, s20, 5
  v_lshlrev_b32 v86, 10, v6
  v_lshl_add_u32 v86, v5, 4, v86
  v_add_u32 v86, s29, v86
  buffer_load_dwordx4 v[88:91], v86, s[60:63], 0 offen
  v_mov_b32 v8, 0x4444
  v_mov_b32 v9, 0xeeee
  v_cmp_eq_u32 vcc, 1, v5
  s_nop 1
  v_cndmask_b32 v108, v8, v9, vcc
  v_mov_b32 v104, 0x3f803f80
  v_mov_b32 v105, 0x3f803f80
  v_mov_b32 v106, 0x3f803f80
  v_mov_b32 v107, 0x3f803f80
  s_lshl_b32 s29, s21, 16
  s_lshl_b32 s30, s20, 8
  s_add_u32 s29, s29, s30
  s_add_u32 s29, s29, 65536
  v_lshrrev_b32 v8, 2, v1
  v_lshlrev_b32 v8, 13, v8
  v_and_b32 v9, 3, v1
  v_lshl_add_u32 v9, v2, 2, v9
  v_lshl_add_u32 v8, v9, 4, v8
  v_add_u32 v109, s29, v8
  v_add_u32 v113, 131072, v7
  s_lshl_b32 s29, s21, 12
  v_add_u32 v114, s29, v7
  v_add_u32 v115, 0x10000, v114
  v_lshrrev_b32 v8, 2, v1
  v_xor_b32 v8, v8, v2
  v_lshlrev_b32 v8, 3, v8
  v_lshl_add_u32 v8, v1, 5, v8
  s_lshl_b32 s29, s21, 10
  s_add_u32 s29, s29, 155648
  v_add_u32 v116, s29, v8
  v_lshrrev_b32 v8, 2, v1
  v_lshl_add_u32 v8, v4, 2, v8
  v_lshl_add_u32 v8, v3, 4, v8
  v_lshlrev_b32 v8, 5, v8
  v_and_b32 v9, 3, v1
  v_xor_b32 v9, v9, v4
  v_lshl_add_u32 v8, v9, 3, v8
  v_add_u32 v117, 155648, v8
  v_lshrrev_b32 v8, 2, v1
  v_lshl_add_u32 v8, v4, 2, v8
  v_lshl_add_u32 v8, v3, 4, v8
  v_lshlrev_b32 v8, 4, v8
  v_and_b32 v9, 1, v1
  v_lshl_add_u32 v8, v9, 3, v8
  v_add_u32 v118, 159744, v8
  v_mov_b32 v9, 196608
  v_cmp_eq_u32 vcc, 1, v5
  s_nop 1
  v_cndmask_b32 v118, v118, v9, vcc
  v_lshrrev_b32 v8, 3, v1
  v_mul_u32_u24 v8, 24, v8
  v_and_b32 v9, 7, v1
  v_add_u32 v8, v8, v9
  v_lshlrev_b32 v8, 4, v8
  v_lshl_add_u32 v8, v2, 9, v8
  v_add_u32 v119, 139264, v8
  v_lshlrev_b32 v8, 4, v1
  v_lshl_add_u32 v8, v2, 9, v8
  s_lshl_b32 s29, s21, 11
  s_add_u32 s29, s29, 147456
  v_add_u32 v120, s29, v8
  s_lshl_b32 s29, s21, 9
  s_add_u32 s29, s29, 159744
  v_lshrrev_b32 v8, 1, v1
  v_lshlrev_b32 v8, 2, v8
  v_lshl_add_u32 v8, v3, 1, v8
  v_and_b32 v9, 1, v1
  v_add_u32 v8, v8, v9
  v_lshlrev_b32 v8, 4, v8
  v_lshl_add_u32 v8, v4, 3, v8
  v_add_u32 v8, s29, v8
  v_mov_b32 v9, 196608
  v_cmp_lt_u32 vcc, 7, v1
  s_nop 1
  v_cndmask_b32 v121, v8, v9, vcc
  s_lshl_b32 s29, s21, 9
  s_add_u32 s29, s29, 161792
  v_lshlrev_b32 v8, 4, v1
  v_lshl_add_u32 v8, v2, 2, v8
  v_add_u32 v122, s29, v8
  v_mov_b32 v9, 0
  v_mov_b32 v8, 0x3f80
  v_cmp_eq_u32 vcc, 0, v1
  s_nop 1
  v_cndmask_b32 v96, v9, v8, vcc
  v_mov_b32 v8, 0x3f800000
  v_cmp_eq_u32 vcc, 1, v1
  s_nop 1
  v_cndmask_b32 v96, v96, v8, vcc
  v_mov_b32 v8, 0x3f80
  v_cmp_eq_u32 vcc, 2, v1
  s_nop 1
  v_cndmask_b32 v97, v9, v8, vcc
  v_mov_b32 v8, 0x3f800000
  v_cmp_eq_u32 vcc, 3, v1
  s_nop 1
  v_cndmask_b32 v97, v97, v8, vcc
  v_mov_b32 v8, 0x3f80
  v_cmp_eq_u32 vcc, 4, v1
  s_nop 1
  v_cndmask_b32 v98, v9, v8, vcc
  v_mov_b32 v8, 0x3f800000
  v_cmp_eq_u32 vcc, 5, v1
  s_nop 1
  v_cndmask_b32 v98, v98, v8, vcc
  v_mov_b32 v8, 0x3f80
  v_cmp_eq_u32 vcc, 6, v1
  s_nop 1
  v_cndmask_b32 v99, v9, v8, vcc
  v_mov_b32 v8, 0x3f800000
  v_cmp_eq_u32 vcc, 7, v1
  s_nop 1
  v_cndmask_b32 v99, v99, v8, vcc
  s_lshl_b32 s29, s20, 13
  s_and_b32 s30, s21, 1
  s_lshl_b32 s30, s30, 7
  s_add_u32 s29, s29, s30
  s_add_u32 s29, s29, 65536
  v_lshrrev_b32 v8, 3, v1
  v_lshl_add_u32 v8, v8, 2, v2
  v_lshlrev_b32 v8, 8, v8
  v_and_b32 v9, 7, v1
  v_lshl_add_u32 v8, v9, 4, v8
  v_add_u32 v110, s29, v8
  v_bfe_u32 v8, v1, 2, 1
  v_lshlrev_b32 v8, 1, v8
  v_lshl_add_u32 v8, v4, 2, v8
  v_and_b32 v9, 1, v1
  v_add_u32 v8, v8, v9
  v_lshlrev_b32 v8, 4, v8
  v_lshl_add_u32 v8, v5, 3, v8
  v_lshl_add_u32 v8, v3, 2, v8
  s_lshl_b32 s29, s20, 8
  s_add_u32 s29, s29, s30
  v_add_u32 v8, s29, v8
  v_mov_b32 v9, 0x80000000
  v_cmp_lt_u32 vcc, 7, v1
  s_nop 1
  v_cndmask_b32 v111, v8, v9, vcc
  s_lshl_b32 s29, s20, 11
  s_lshl_b32 s30, s21, 9
  s_add_u32 s29, s29, s30
  s_add_u32 s30, s29, 2097152
  v_lshlrev_b32 v8, 4, v6
  v_lshl_add_u32 v8, v2, 7, v8
  v_add_u32 v8, s30, v8
  v_mul_u32_u24 v124, 8454144, v5
  v_add_u32 v124, v124, v8
  s_lshl_b32 s3, s20, 11
  s_add_u32 s3, s3, 10389504
  s_lshl_b32 s29, s21, 11
  v_add_u32 v112, s29, v7
  s_add_u32 s39, s29, 139264
  s_add_u32 s40, s29, 147456
  s_lshl_b32 s43, s21, 10
  s_lshl_b32 s29, s20, 13
  v_lshlrev_b32 v8, 7, v0
  v_add_u32 v123, s29, v8
  s_mov_b32 s42, 0x40000
  s_mul_i32 s41, s21, 33554432
  s_add_u32 s41, s41, 33816576
  s_add_u32 s37, s29, 33554432
  s_add_u32 s38, s29, 67108864
  s_cmp_lt_u32 s21, 2
  s_cbranch_scc1 Lt_193
  s_lshl_b32 s29, s20, 8
  v_lshlrev_b32 v8, 7, v0
  v_add_u32 v8, s29, v8
  s_xor_b32 s29, s21, 3
  s_lshl_b32 s29, s29, 1
  v_cmp_gt_u32 vcc, s29, v0
  s_nop 1
  v_cndmask_b32 v123, v9, v8, vcc
  s_mov_b32 s41, 1064960
  s_mov_b32 s42, 8192
Lt_193:
  s_lshl_b32 s29, s20, 7
  s_add_u32 s36, s29, 0
  s_mov_b32 s31, 32768
  s_mov_b32 s32, 4096
  v_add_u32 v8, s43, v113
  v_mov_b64 v[100:101], 0
  v_mov_b64 v[102:103], 0
  ds_write_b128 v8, v[100:103] offset:24576
  s_mov_b32 s44, 0x3e0293ee
  s_mov_b32 s45, 0x3e0293ee
  v_and_b32 v12, 31, v0
  v_xor_b32 v12, v12, v3
  v_lshlrev_b32 v12, 4, v12
  v_lshl_add_u32 v12, v3, 10, v12
  v_xor_b32 v13, 0x80, v12
  v_lshrrev_b32 v8, 2, v1
  v_lshl_add_u32 v8, v4, 2, v8
  v_lshl_add_u32 v9, v3, 4, v8
  s_lshl_b32 s29, s21, 2
  v_add_u32 v22, s29, v5
  v_lshlrev_b32 v23, 1, v8
  v_xor_b32 v22, v22, v23
  v_lshlrev_b32 v22, 4, v22
  v_lshl_add_u32 v22, v9, 8, v22
  v_and_b32 v23, 1, v1
  v_lshl_add_u32 v16, v23, 3, v22
  v_xor_b32 v17, 32, v16
  v_add_u32 v18, 0x10000, v16
  v_add_u32 v19, 0x10000, v17
  v_and_b32 v22, 2, v8
  v_lshlrev_b32 v22, 2, v22
  v_and_b32 v20, 1, v8
  v_or_b32 v22, v22, v20
  s_and_b32 s29, s21, 1
  s_lshl_b32 s29, s29, 4
  v_and_b32 v20, 3, v1
  v_lshlrev_b32 v20, 1, v20
  v_add_u32 v20, s29, v20
  v_xor_b32 v20, v20, v22
  v_lshlrev_b32 v20, 4, v20
  v_lshl_add_u32 v20, v9, 9, v20
  v_and_b32 v21, 31, v0
  v_lshrrev_b32 v23, 1, v21
  v_lshlrev_b32 v23, 13, v23
  v_and_b32 v22, 1, v0
  v_lshl_add_u32 v23, v22, 7, v23
  v_lshlrev_b32 v21, 7, v21
  v_mov_b32 v80, 1
  v_mov_b32 v81, 1
  v_mov_b32 v82, 1
  v_mov_b32 v83, 1
  buffer_store_dwordx4 v[80:83], v109, s[4:7], 0 offen sc1
  buffer_store_dwordx4 v[80:83], v109, s[4:7], s31 offen sc1
  v_mov_b32 v92, -1
  v_mov_b32 v93, -1
  v_mov_b32 v94, -1
  v_mov_b32 v95, -1
  s_lshl_b32 s29, s20, 8
  s_lshl_b32 s30, s21, 18
  s_add_u32 s29, s29, s30
  s_add_u32 s29, s29, 1048576
  v_lshlrev_b32 v87, 13, v2
  v_lshl_add_u32 v87, v1, 4, v87
  v_add_u32 v87, s29, v87
  s_mov_b32 s29, 32768
  buffer_store_dwordx4 v[92:95], v87, s[4:7], s29 offen sc1
  s_mov_b32 s29, 65536
  buffer_store_dwordx4 v[92:95], v87, s[4:7], s29 offen sc1
  s_mov_b32 s29, 98304
  buffer_store_dwordx4 v[92:95], v87, s[4:7], s29 offen sc1
  s_mov_b32 s29, 131072
  buffer_store_dwordx4 v[92:95], v87, s[4:7], s29 offen sc1
  s_mov_b32 s29, 163840
  buffer_store_dwordx4 v[92:95], v87, s[4:7], s29 offen sc1
  s_mov_b32 s29, 196608
  buffer_store_dwordx4 v[92:95], v87, s[4:7], s29 offen sc1
  s_mov_b32 s29, 229376
  buffer_store_dwordx4 v[92:95], v87, s[4:7], s29 offen sc1
  s_and_b32 s29, s21, 1
  s_lshl_b32 s29, s29, 4
  s_xor_b32 s29, s29, 16
  s_mov_b32 s30, 3735552
  buffer_store_dwordx4 v[92:95], v124, s[4:7], s30 offen sc1
  s_mov_b32 s30, 3801088
  buffer_store_dwordx4 v[92:95], v124, s[4:7], s30 offen sc1
  s_mov_b32 s30, 3866624
  buffer_store_dwordx4 v[92:95], v124, s[4:7], s30 offen sc1
  s_mov_b32 s30, 3932160
  buffer_store_dwordx4 v[92:95], v124, s[4:7], s30 offen sc1
  s_mov_b32 s30, 3997696
  buffer_store_dwordx4 v[92:95], v124, s[4:7], s30 offen sc1
  s_mov_b32 s30, 4063232
  buffer_store_dwordx4 v[92:95], v124, s[4:7], s30 offen sc1
  s_mov_b32 s30, 4128768
  buffer_store_dwordx4 v[92:95], v124, s[4:7], s30 offen sc1
  s_mov_b32 s30, 4194304
  buffer_store_dwordx4 v[92:95], v124, s[4:7], s30 offen sc1
  s_mov_b32 s30, 7929856
  buffer_store_dwordx4 v[92:95], v124, s[4:7], s30 offen sc1
  s_mov_b32 s30, 7995392
  buffer_store_dwordx4 v[92:95], v124, s[4:7], s30 offen sc1
  s_mov_b32 s30, 8060928
  buffer_store_dwordx4 v[92:95], v124, s[4:7], s30 offen sc1
  s_mov_b32 s30, 8126464
  buffer_store_dwordx4 v[92:95], v124, s[4:7], s30 offen sc1
  s_mov_b32 s30, 8192000
  buffer_store_dwordx4 v[92:95], v124, s[4:7], s30 offen sc1
  s_mov_b32 s30, 8257536
  buffer_store_dwordx4 v[92:95], v124, s[4:7], s30 offen sc1
  s_mov_b32 s30, 8323072
  buffer_store_dwordx4 v[92:95], v124, s[4:7], s30 offen sc1
  s_mov_b32 s30, 8388608
  buffer_store_dwordx4 v[92:95], v124, s[4:7], s30 offen sc1
  s_waitcnt vmcnt(54)
  s_barrier
  s_waitcnt lgkmcnt(0)
  ds_read_b64_tr_b16 v[24:25], v16 offset:0
  ds_read_b64_tr_b16 v[26:27], v16 offset:2048
  ds_read_b64_tr_b16 v[28:29], v16 offset:8192
  ds_read_b64_tr_b16 v[30:31], v16 offset:10240
  ds_read_b64_tr_b16 v[32:33], v17 offset:0
  ds_read_b64_tr_b16 v[34:35], v17 offset:2048
  ds_read_b64_tr_b16 v[36:37], v17 offset:8192
  ds_read_b64_tr_b16 v[38:39], v17 offset:10240
  s_waitcnt lgkmcnt(0)
  v_accvgpr_write_b32 a0, v24
  v_accvgpr_write_b32 a1, v26
  v_accvgpr_write_b32 a2, v25
  v_accvgpr_write_b32 a3, v27
  v_accvgpr_write_b32 a4, v28
  v_accvgpr_write_b32 a5, v30
  v_accvgpr_write_b32 a6, v29
  v_accvgpr_write_b32 a7, v31
  v_accvgpr_write_b32 a8, v32
  v_accvgpr_write_b32 a9, v34
  v_accvgpr_write_b32 a10, v33
  v_accvgpr_write_b32 a11, v35
  v_accvgpr_write_b32 a12, v36
  v_accvgpr_write_b32 a13, v38
  v_accvgpr_write_b32 a14, v37
  v_accvgpr_write_b32 a15, v39
  s_waitcnt vmcnt(50)
  s_barrier
  s_lshl_b32 s29, s20, 17
  s_lshl_b32 s30, s21, 13
  s_add_u32 s29, s29, s30
  s_add_u32 s29, s29, 0
  s_lshl_b32 s30, s21, 12
  s_add_u32 m0, s30, 0
  s_nop 0
  buffer_load_dwordx4 v12, s[12:15], s29 offen lds
  s_lshl_b32 s29, s20, 17
  s_lshl_b32 s30, s21, 13
  s_add_u32 s29, s29, s30
  s_add_u32 s29, s29, 2048
  s_lshl_b32 s30, s21, 12
  s_add_u32 m0, s30, 1024
  s_nop 0
  buffer_load_dwordx4 v13, s[12:15], s29 offen lds
  s_lshl_b32 s29, s20, 17
  s_lshl_b32 s30, s21, 13
  s_add_u32 s29, s29, s30
  s_add_u32 s29, s29, 4096
  s_lshl_b32 s30, s21, 12
  s_add_u32 m0, s30, 2048
  s_nop 0
  buffer_load_dwordx4 v12, s[12:15], s29 offen lds
  s_lshl_b32 s29, s20, 17
  s_lshl_b32 s30, s21, 13
  s_add_u32 s29, s29, s30
  s_add_u32 s29, s29, 6144
  s_lshl_b32 s30, s21, 12
  s_add_u32 m0, s30, 3072
  s_nop 0
  buffer_load_dwordx4 v13, s[12:15], s29 offen lds
  s_waitcnt lgkmcnt(0)
  ds_read_b64_tr_b16 v[24:25], v16 offset:16384
  ds_read_b64_tr_b16 v[26:27], v16 offset:18432
  ds_read_b64_tr_b16 v[28:29], v16 offset:24576
  ds_read_b64_tr_b16 v[30:31], v16 offset:26624
  ds_read_b64_tr_b16 v[32:33], v17 offset:16384
  ds_read_b64_tr_b16 v[34:35], v17 offset:18432
  ds_read_b64_tr_b16 v[36:37], v17 offset:24576
  ds_read_b64_tr_b16 v[38:39], v17 offset:26624
  s_waitcnt lgkmcnt(0)
  v_accvgpr_write_b32 a16, v24
  v_accvgpr_write_b32 a17, v26
  v_accvgpr_write_b32 a18, v25
  v_accvgpr_write_b32 a19, v27
  v_accvgpr_write_b32 a20, v28
  v_accvgpr_write_b32 a21, v30
  v_accvgpr_write_b32 a22, v29
  v_accvgpr_write_b32 a23, v31
  v_accvgpr_write_b32 a24, v32
  v_accvgpr_write_b32 a25, v34
  v_accvgpr_write_b32 a26, v33
  v_accvgpr_write_b32 a27, v35
  v_accvgpr_write_b32 a28, v36
  v_accvgpr_write_b32 a29, v38
  v_accvgpr_write_b32 a30, v37
  v_accvgpr_write_b32 a31, v39
  s_waitcnt vmcnt(50)
  s_barrier
  s_lshl_b32 s29, s20, 17
  s_lshl_b32 s30, s21, 13
  s_add_u32 s29, s29, s30
  s_add_u32 s29, s29, 512
  s_lshl_b32 s30, s21, 12
  s_add_u32 m0, s30, 16384
  s_nop 0
  buffer_load_dwordx4 v12, s[12:15], s29 offen lds
  s_lshl_b32 s29, s20, 17
  s_lshl_b32 s30, s21, 13
  s_add_u32 s29, s29, s30
  s_add_u32 s29, s29, 2560
  s_lshl_b32 s30, s21, 12
  s_add_u32 m0, s30, 17408
  s_nop 0
  buffer_load_dwordx4 v13, s[12:15], s29 offen lds
  s_lshl_b32 s29, s20, 17
  s_lshl_b32 s30, s21, 13
  s_add_u32 s29, s29, s30
  s_add_u32 s29, s29, 4608
  s_lshl_b32 s30, s21, 12
  s_add_u32 m0, s30, 18432
  s_nop 0
  buffer_load_dwordx4 v12, s[12:15], s29 offen lds
  s_lshl_b32 s29, s20, 17
  s_lshl_b32 s30, s21, 13
  s_add_u32 s29, s29, s30
  s_add_u32 s29, s29, 6656
  s_lshl_b32 s30, s21, 12
  s_add_u32 m0, s30, 19456
  s_nop 0
  buffer_load_dwordx4 v13, s[12:15], s29 offen lds
  s_waitcnt lgkmcnt(0)
  ds_read_b64_tr_b16 v[24:25], v16 offset:32768
  ds_read_b64_tr_b16 v[26:27], v16 offset:34816
  ds_read_b64_tr_b16 v[28:29], v16 offset:40960
  ds_read_b64_tr_b16 v[30:31], v16 offset:43008
  ds_read_b64_tr_b16 v[32:33], v17 offset:32768
  ds_read_b64_tr_b16 v[34:35], v17 offset:34816
  ds_read_b64_tr_b16 v[36:37], v17 offset:40960
  ds_read_b64_tr_b16 v[38:39], v17 offset:43008
  s_waitcnt lgkmcnt(0)
  v_accvgpr_write_b32 a32, v24
  v_accvgpr_write_b32 a33, v26
  v_accvgpr_write_b32 a34, v25
  v_accvgpr_write_b32 a35, v27
  v_accvgpr_write_b32 a36, v28
  v_accvgpr_write_b32 a37, v30
  v_accvgpr_write_b32 a38, v29
  v_accvgpr_write_b32 a39, v31
  v_accvgpr_write_b32 a40, v32
  v_accvgpr_write_b32 a41, v34
  v_accvgpr_write_b32 a42, v33
  v_accvgpr_write_b32 a43, v35
  v_accvgpr_write_b32 a44, v36
  v_accvgpr_write_b32 a45, v38
  v_accvgpr_write_b32 a46, v37
  v_accvgpr_write_b32 a47, v39
  s_waitcnt vmcnt(50)
  s_barrier
  s_lshl_b32 s29, s20, 17
  s_lshl_b32 s30, s21, 13
  s_add_u32 s29, s29, s30
  s_add_u32 s29, s29, 32768
  s_lshl_b32 s30, s21, 12
  s_add_u32 m0, s30, 32768
  s_nop 0
  buffer_load_dwordx4 v12, s[12:15], s29 offen lds
  s_lshl_b32 s29, s20, 17
  s_lshl_b32 s30, s21, 13
  s_add_u32 s29, s29, s30
  s_add_u32 s29, s29, 34816
  s_lshl_b32 s30, s21, 12
  s_add_u32 m0, s30, 33792
  s_nop 0
  buffer_load_dwordx4 v13, s[12:15], s29 offen lds
  s_lshl_b32 s29, s20, 17
  s_lshl_b32 s30, s21, 13
  s_add_u32 s29, s29, s30
  s_add_u32 s29, s29, 36864
  s_lshl_b32 s30, s21, 12
  s_add_u32 m0, s30, 34816
  s_nop 0
  buffer_load_dwordx4 v12, s[12:15], s29 offen lds
  s_lshl_b32 s29, s20, 17
  s_lshl_b32 s30, s21, 13
  s_add_u32 s29, s29, s30
  s_add_u32 s29, s29, 38912
  s_lshl_b32 s30, s21, 12
  s_add_u32 m0, s30, 35840
  s_nop 0
  buffer_load_dwordx4 v13, s[12:15], s29 offen lds
  s_waitcnt lgkmcnt(0)
  ds_read_b64_tr_b16 v[24:25], v16 offset:49152
  ds_read_b64_tr_b16 v[26:27], v16 offset:51200
  ds_read_b64_tr_b16 v[28:29], v16 offset:57344
  ds_read_b64_tr_b16 v[30:31], v16 offset:59392
  ds_read_b64_tr_b16 v[32:33], v17 offset:49152
  ds_read_b64_tr_b16 v[34:35], v17 offset:51200
  ds_read_b64_tr_b16 v[36:37], v17 offset:57344
  ds_read_b64_tr_b16 v[38:39], v17 offset:59392
  s_waitcnt lgkmcnt(0)
  v_accvgpr_write_b32 a48, v24
  v_accvgpr_write_b32 a49, v26
  v_accvgpr_write_b32 a50, v25
  v_accvgpr_write_b32 a51, v27
  v_accvgpr_write_b32 a52, v28
  v_accvgpr_write_b32 a53, v30
  v_accvgpr_write_b32 a54, v29
  v_accvgpr_write_b32 a55, v31
  v_accvgpr_write_b32 a56, v32
  v_accvgpr_write_b32 a57, v34
  v_accvgpr_write_b32 a58, v33
  v_accvgpr_write_b32 a59, v35
  v_accvgpr_write_b32 a60, v36
  v_accvgpr_write_b32 a61, v38
  v_accvgpr_write_b32 a62, v37
  v_accvgpr_write_b32 a63, v39
  s_waitcnt vmcnt(50)
  s_barrier
  s_lshl_b32 s29, s20, 17
  s_lshl_b32 s30, s21, 13
  s_add_u32 s29, s29, s30
  s_add_u32 s29, s29, 33280
  s_lshl_b32 s30, s21, 12
  s_add_u32 m0, s30, 49152
  s_nop 0
  buffer_load_dwordx4 v12, s[12:15], s29 offen lds
  s_lshl_b32 s29, s20, 17
  s_lshl_b32 s30, s21, 13
  s_add_u32 s29, s29, s30
  s_add_u32 s29, s29, 35328
  s_lshl_b32 s30, s21, 12
  s_add_u32 m0, s30, 50176
  s_nop 0
  buffer_load_dwordx4 v13, s[12:15], s29 offen lds
  s_lshl_b32 s29, s20, 17
  s_lshl_b32 s30, s21, 13
  s_add_u32 s29, s29, s30
  s_add_u32 s29, s29, 37376
  s_lshl_b32 s30, s21, 12
  s_add_u32 m0, s30, 51200
  s_nop 0
  buffer_load_dwordx4 v12, s[12:15], s29 offen lds
  s_lshl_b32 s29, s20, 17
  s_lshl_b32 s30, s21, 13
  s_add_u32 s29, s29, s30
  s_add_u32 s29, s29, 39424
  s_lshl_b32 s30, s21, 12
  s_add_u32 m0, s30, 52224
  s_nop 0
  buffer_load_dwordx4 v13, s[12:15], s29 offen lds
  s_waitcnt lgkmcnt(0)
  ds_read_b64_tr_b16 v[24:25], v18 offset:0
  ds_read_b64_tr_b16 v[26:27], v18 offset:2048
  ds_read_b64_tr_b16 v[28:29], v18 offset:8192
  ds_read_b64_tr_b16 v[30:31], v18 offset:10240
  ds_read_b64_tr_b16 v[32:33], v19 offset:0
  ds_read_b64_tr_b16 v[34:35], v19 offset:2048
  ds_read_b64_tr_b16 v[36:37], v19 offset:8192
  ds_read_b64_tr_b16 v[38:39], v19 offset:10240
  s_waitcnt lgkmcnt(0)
  v_accvgpr_write_b32 a64, v24
  v_accvgpr_write_b32 a65, v26
  v_accvgpr_write_b32 a66, v25
  v_accvgpr_write_b32 a67, v27
  v_accvgpr_write_b32 a68, v28
  v_accvgpr_write_b32 a69, v30
  v_accvgpr_write_b32 a70, v29
  v_accvgpr_write_b32 a71, v31
  v_accvgpr_write_b32 a72, v32
  v_accvgpr_write_b32 a73, v34
  v_accvgpr_write_b32 a74, v33
  v_accvgpr_write_b32 a75, v35
  v_accvgpr_write_b32 a76, v36
  v_accvgpr_write_b32 a77, v38
  v_accvgpr_write_b32 a78, v37
  v_accvgpr_write_b32 a79, v39
  s_waitcnt vmcnt(50)
  s_barrier
  s_lshl_b32 s29, s20, 17
  s_lshl_b32 s30, s21, 13
  s_add_u32 s29, s29, s30
  s_add_u32 s29, s29, 65536
  s_lshl_b32 s30, s21, 12
  s_add_u32 m0, s30, 65536
  s_nop 0
  buffer_load_dwordx4 v12, s[12:15], s29 offen lds
  s_lshl_b32 s29, s20, 17
  s_lshl_b32 s30, s21, 13
  s_add_u32 s29, s29, s30
  s_add_u32 s29, s29, 67584
  s_lshl_b32 s30, s21, 12
  s_add_u32 m0, s30, 66560
  s_nop 0
  buffer_load_dwordx4 v13, s[12:15], s29 offen lds
  s_lshl_b32 s29, s20, 17
  s_lshl_b32 s30, s21, 13
  s_add_u32 s29, s29, s30
  s_add_u32 s29, s29, 69632
  s_lshl_b32 s30, s21, 12
  s_add_u32 m0, s30, 67584
  s_nop 0
  buffer_load_dwordx4 v12, s[12:15], s29 offen lds
  s_lshl_b32 s29, s20, 17
  s_lshl_b32 s30, s21, 13
  s_add_u32 s29, s29, s30
  s_add_u32 s29, s29, 71680
  s_lshl_b32 s30, s21, 12
  s_add_u32 m0, s30, 68608
  s_nop 0
  buffer_load_dwordx4 v13, s[12:15], s29 offen lds
  s_waitcnt lgkmcnt(0)
  ds_read_b64_tr_b16 v[24:25], v18 offset:16384
  ds_read_b64_tr_b16 v[26:27], v18 offset:18432
  ds_read_b64_tr_b16 v[28:29], v18 offset:24576
  ds_read_b64_tr_b16 v[30:31], v18 offset:26624
  ds_read_b64_tr_b16 v[32:33], v19 offset:16384
  ds_read_b64_tr_b16 v[34:35], v19 offset:18432
  ds_read_b64_tr_b16 v[36:37], v19 offset:24576
  ds_read_b64_tr_b16 v[38:39], v19 offset:26624
  s_waitcnt lgkmcnt(0)
  v_accvgpr_write_b32 a80, v24
  v_accvgpr_write_b32 a81, v26
  v_accvgpr_write_b32 a82, v25
  v_accvgpr_write_b32 a83, v27
  v_accvgpr_write_b32 a84, v28
  v_accvgpr_write_b32 a85, v30
  v_accvgpr_write_b32 a86, v29
  v_accvgpr_write_b32 a87, v31
  v_accvgpr_write_b32 a88, v32
  v_accvgpr_write_b32 a89, v34
  v_accvgpr_write_b32 a90, v33
  v_accvgpr_write_b32 a91, v35
  v_accvgpr_write_b32 a92, v36
  v_accvgpr_write_b32 a93, v38
  v_accvgpr_write_b32 a94, v37
  v_accvgpr_write_b32 a95, v39
  s_waitcnt vmcnt(50)
  s_barrier
  s_lshl_b32 s29, s20, 17
  s_lshl_b32 s30, s21, 13
  s_add_u32 s29, s29, s30
  s_add_u32 s29, s29, 66048
  s_lshl_b32 s30, s21, 12
  s_add_u32 m0, s30, 81920
  s_nop 0
  buffer_load_dwordx4 v12, s[12:15], s29 offen lds
  s_lshl_b32 s29, s20, 17
  s_lshl_b32 s30, s21, 13
  s_add_u32 s29, s29, s30
  s_add_u32 s29, s29, 68096
  s_lshl_b32 s30, s21, 12
  s_add_u32 m0, s30, 82944
  s_nop 0
  buffer_load_dwordx4 v13, s[12:15], s29 offen lds
  s_lshl_b32 s29, s20, 17
  s_lshl_b32 s30, s21, 13
  s_add_u32 s29, s29, s30
  s_add_u32 s29, s29, 70144
  s_lshl_b32 s30, s21, 12
  s_add_u32 m0, s30, 83968
  s_nop 0
  buffer_load_dwordx4 v12, s[12:15], s29 offen lds
  s_lshl_b32 s29, s20, 17
  s_lshl_b32 s30, s21, 13
  s_add_u32 s29, s29, s30
  s_add_u32 s29, s29, 72192
  s_lshl_b32 s30, s21, 12
  s_add_u32 m0, s30, 84992
  s_nop 0
  buffer_load_dwordx4 v13, s[12:15], s29 offen lds
  s_waitcnt lgkmcnt(0)
  ds_read_b64_tr_b16 v[24:25], v18 offset:32768
  ds_read_b64_tr_b16 v[26:27], v18 offset:34816
  ds_read_b64_tr_b16 v[28:29], v18 offset:40960
  ds_read_b64_tr_b16 v[30:31], v18 offset:43008
  ds_read_b64_tr_b16 v[32:33], v19 offset:32768
  ds_read_b64_tr_b16 v[34:35], v19 offset:34816
  ds_read_b64_tr_b16 v[36:37], v19 offset:40960
  ds_read_b64_tr_b16 v[38:39], v19 offset:43008
  s_waitcnt lgkmcnt(0)
  v_accvgpr_write_b32 a96, v24
  v_accvgpr_write_b32 a97, v26
  v_accvgpr_write_b32 a98, v25
  v_accvgpr_write_b32 a99, v27
  v_accvgpr_write_b32 a100, v28
  v_accvgpr_write_b32 a101, v30
  v_accvgpr_write_b32 a102, v29
  v_accvgpr_write_b32 a103, v31
  v_accvgpr_write_b32 a104, v32
  v_accvgpr_write_b32 a105, v34
  v_accvgpr_write_b32 a106, v33
  v_accvgpr_write_b32 a107, v35
  v_accvgpr_write_b32 a108, v36
  v_accvgpr_write_b32 a109, v38
  v_accvgpr_write_b32 a110, v37
  v_accvgpr_write_b32 a111, v39
  s_waitcnt vmcnt(50)
  s_barrier
  s_and_b32 s29, s21, 1
  s_lshl_b32 s29, s29, 4
  s_xor_b32 s29, s29, 16
  s_waitcnt vmcnt(49)
  v_cmp_gt_u32 vcc, s29, v0
  s_nop 1
  v_cndmask_b32 v88, v92, v88, vcc
  v_cndmask_b32 v89, v93, v89, vcc
  v_cndmask_b32 v90, v94, v90, vcc
  v_cndmask_b32 v91, v95, v91, vcc
  buffer_store_dwordx4 v[88:91], v87, s[4:7], 0 offen sc1
  s_lshl_b32 s29, s20, 17
  s_lshl_b32 s30, s21, 13
  s_add_u32 s29, s29, s30
  s_add_u32 s29, s29, 98304
  s_lshl_b32 s30, s21, 12
  s_add_u32 m0, s30, 98304
  s_nop 0
  buffer_load_dwordx4 v12, s[12:15], s29 offen lds
  s_lshl_b32 s29, s20, 17
  s_lshl_b32 s30, s21, 13
  s_add_u32 s29, s29, s30
  s_add_u32 s29, s29, 100352
  s_lshl_b32 s30, s21, 12
  s_add_u32 m0, s30, 99328
  s_nop 0
  buffer_load_dwordx4 v13, s[12:15], s29 offen lds
  s_lshl_b32 s29, s20, 17
  s_lshl_b32 s30, s21, 13
  s_add_u32 s29, s29, s30
  s_add_u32 s29, s29, 102400
  s_lshl_b32 s30, s21, 12
  s_add_u32 m0, s30, 100352
  s_nop 0
  buffer_load_dwordx4 v12, s[12:15], s29 offen lds
  s_lshl_b32 s29, s20, 17
  s_lshl_b32 s30, s21, 13
  s_add_u32 s29, s29, s30
  s_add_u32 s29, s29, 104448
  s_lshl_b32 s30, s21, 12
  s_add_u32 m0, s30, 101376
  s_nop 0
  buffer_load_dwordx4 v13, s[12:15], s29 offen lds
  s_waitcnt lgkmcnt(0)
  ds_read_b64_tr_b16 v[24:25], v18 offset:49152
  ds_read_b64_tr_b16 v[26:27], v18 offset:51200
  ds_read_b64_tr_b16 v[28:29], v18 offset:57344
  ds_read_b64_tr_b16 v[30:31], v18 offset:59392
  ds_read_b64_tr_b16 v[32:33], v19 offset:49152
  ds_read_b64_tr_b16 v[34:35], v19 offset:51200
  ds_read_b64_tr_b16 v[36:37], v19 offset:57344
  ds_read_b64_tr_b16 v[38:39], v19 offset:59392
  s_waitcnt lgkmcnt(0)
  v_accvgpr_write_b32 a112, v24
  v_accvgpr_write_b32 a113, v26
  v_accvgpr_write_b32 a114, v25
  v_accvgpr_write_b32 a115, v27
  v_accvgpr_write_b32 a116, v28
  v_accvgpr_write_b32 a117, v30
  v_accvgpr_write_b32 a118, v29
  v_accvgpr_write_b32 a119, v31
  v_accvgpr_write_b32 a120, v32
  v_accvgpr_write_b32 a121, v34
  v_accvgpr_write_b32 a122, v33
  v_accvgpr_write_b32 a123, v35
  v_accvgpr_write_b32 a124, v36
  v_accvgpr_write_b32 a125, v38
  v_accvgpr_write_b32 a126, v37
  v_accvgpr_write_b32 a127, v39
  s_waitcnt vmcnt(25)
  s_barrier
  s_lshl_b32 s29, s20, 17
  s_lshl_b32 s30, s21, 13
  s_add_u32 s29, s29, s30
  s_add_u32 s29, s29, 98816
  s_lshl_b32 s30, s21, 12
  s_add_u32 m0, s30, 114688
  s_nop 0
  buffer_load_dwordx4 v12, s[12:15], s29 offen lds
  s_lshl_b32 s29, s20, 17
  s_lshl_b32 s30, s21, 13
  s_add_u32 s29, s29, s30
  s_add_u32 s29, s29, 100864
  s_lshl_b32 s30, s21, 12
  s_add_u32 m0, s30, 115712
  s_nop 0
  buffer_load_dwordx4 v13, s[12:15], s29 offen lds
  s_lshl_b32 s29, s20, 17
  s_lshl_b32 s30, s21, 13
  s_add_u32 s29, s29, s30
  s_add_u32 s29, s29, 102912
  s_lshl_b32 s30, s21, 12
  s_add_u32 m0, s30, 116736
  s_nop 0
  buffer_load_dwordx4 v12, s[12:15], s29 offen lds
  s_lshl_b32 s29, s20, 17
  s_lshl_b32 s30, s21, 13
  s_add_u32 s29, s29, s30
  s_add_u32 s29, s29, 104960
  s_lshl_b32 s30, s21, 12
  s_add_u32 m0, s30, 117760
  s_nop 0
  buffer_load_dwordx4 v13, s[12:15], s29 offen lds
  s_lshr_b32 s29, s21, 1
  s_cmp_lg_u32 s29, 0
  s_cbranch_scc1 Lwo_194
  v_xor_b32 v22, 0, v20
  v_add_u32 v22, 0, v22
  ds_read_b64_tr_b16 v[24:25], v22 offset:0
  ds_read_b64_tr_b16 v[26:27], v22 offset:4096
  v_xor_b32 v22, 0, v20
  v_add_u32 v22, 8, v22
  ds_read_b64_tr_b16 v[32:33], v22 offset:0
  ds_read_b64_tr_b16 v[34:35], v22 offset:4096
  v_xor_b32 v22, 16, v20
  v_add_u32 v22, 0, v22
  ds_read_b64_tr_b16 v[40:41], v22 offset:0
  ds_read_b64_tr_b16 v[42:43], v22 offset:4096
  v_xor_b32 v22, 16, v20
  v_add_u32 v22, 8, v22
  ds_read_b64_tr_b16 v[48:49], v22 offset:0
  ds_read_b64_tr_b16 v[50:51], v22 offset:4096
  s_waitcnt lgkmcnt(0)
  v_accvgpr_write_b32 a168, v24
  v_accvgpr_write_b32 a169, v26
  v_accvgpr_write_b32 a170, v25
  v_accvgpr_write_b32 a171, v27
  v_accvgpr_write_b32 a184, v32
  v_accvgpr_write_b32 a185, v34
  v_accvgpr_write_b32 a186, v33
  v_accvgpr_write_b32 a187, v35
  v_accvgpr_write_b32 a200, v40
  v_accvgpr_write_b32 a201, v42
  v_accvgpr_write_b32 a202, v41
  v_accvgpr_write_b32 a203, v43
  v_accvgpr_write_b32 a216, v48
  v_accvgpr_write_b32 a217, v50
  v_accvgpr_write_b32 a218, v49
  v_accvgpr_write_b32 a219, v51
  v_xor_b32 v22, 128, v20
  v_add_u32 v22, 0, v22
  ds_read_b64_tr_b16 v[24:25], v22 offset:0
  ds_read_b64_tr_b16 v[26:27], v22 offset:4096
  v_xor_b32 v22, 128, v20
  v_add_u32 v22, 8, v22
  ds_read_b64_tr_b16 v[32:33], v22 offset:0
  ds_read_b64_tr_b16 v[34:35], v22 offset:4096
  v_xor_b32 v22, 144, v20
  v_add_u32 v22, 0, v22
  ds_read_b64_tr_b16 v[40:41], v22 offset:0
  ds_read_b64_tr_b16 v[42:43], v22 offset:4096
  v_xor_b32 v22, 144, v20
  v_add_u32 v22, 8, v22
  ds_read_b64_tr_b16 v[48:49], v22 offset:0
  ds_read_b64_tr_b16 v[50:51], v22 offset:4096
  s_waitcnt lgkmcnt(0)
  v_accvgpr_write_b32 a232, v24
  v_accvgpr_write_b32 a233, v26
  v_accvgpr_write_b32 a234, v25
  v_accvgpr_write_b32 a235, v27
  v_accvgpr_write_b32 a248, v32
  v_accvgpr_write_b32 a249, v34
  v_accvgpr_write_b32 a250, v33
  v_accvgpr_write_b32 a251, v35
  v_mov_b32 v64, v40
  v_mov_b32 v65, v42
  v_mov_b32 v66, v41
  v_mov_b32 v67, v43
  v_mov_b32 v80, v48
  v_mov_b32 v81, v50
  v_mov_b32 v82, v49
  v_mov_b32 v83, v51
  s_nop 1
Lwo_194:
  s_waitcnt vmcnt(25)
  s_barrier
  s_lshl_b32 s29, s20, 8
  s_lshl_b32 s30, s21, 17
  s_add_u32 s29, s29, s30
  s_add_u32 s29, s29, 0
  s_lshl_b32 s30, s21, 12
  s_add_u32 m0, s30, 0
  s_nop 0
  buffer_load_dwordx4 v10, s[16:19], s29 offen lds
  s_lshl_b32 s29, s20, 8
  s_lshl_b32 s30, s21, 17
  s_add_u32 s29, s29, s30
  s_add_u32 s29, s29, 32768
  s_lshl_b32 s30, s21, 12
  s_add_u32 m0, s30, 1024
  s_nop 0
  buffer_load_dwordx4 v11, s[16:19], s29 offen lds
  s_lshl_b32 s29, s20, 8
  s_lshl_b32 s30, s21, 17
  s_add_u32 s29, s29, s30
  s_add_u32 s29, s29, 65536
  s_lshl_b32 s30, s21, 12
  s_add_u32 m0, s30, 2048
  s_nop 0
  buffer_load_dwordx4 v10, s[16:19], s29 offen lds
  s_lshl_b32 s29, s20, 8
  s_lshl_b32 s30, s21, 17
  s_add_u32 s29, s29, s30
  s_add_u32 s29, s29, 98304
  s_lshl_b32 s30, s21, 12
  s_add_u32 m0, s30, 3072
  s_nop 0
  buffer_load_dwordx4 v11, s[16:19], s29 offen lds
  s_lshr_b32 s29, s21, 1
  s_cmp_lg_u32 s29, 1
  s_cbranch_scc1 Lwo_195
  v_xor_b32 v22, 0, v20
  v_add_u32 v22, 16384, v22
  ds_read_b64_tr_b16 v[24:25], v22 offset:0
  ds_read_b64_tr_b16 v[26:27], v22 offset:4096
  v_xor_b32 v22, 0, v20
  v_add_u32 v22, 16392, v22
  ds_read_b64_tr_b16 v[32:33], v22 offset:0
  ds_read_b64_tr_b16 v[34:35], v22 offset:4096
  v_xor_b32 v22, 16, v20
  v_add_u32 v22, 16384, v22
  ds_read_b64_tr_b16 v[40:41], v22 offset:0
  ds_read_b64_tr_b16 v[42:43], v22 offset:4096
  v_xor_b32 v22, 16, v20
  v_add_u32 v22, 16392, v22
  ds_read_b64_tr_b16 v[48:49], v22 offset:0
  ds_read_b64_tr_b16 v[50:51], v22 offset:4096
  s_waitcnt lgkmcnt(0)
  v_accvgpr_write_b32 a168, v24
  v_accvgpr_write_b32 a169, v26
  v_accvgpr_write_b32 a170, v25
  v_accvgpr_write_b32 a171, v27
  v_accvgpr_write_b32 a184, v32
  v_accvgpr_write_b32 a185, v34
  v_accvgpr_write_b32 a186, v33
  v_accvgpr_write_b32 a187, v35
  v_accvgpr_write_b32 a200, v40
  v_accvgpr_write_b32 a201, v42
  v_accvgpr_write_b32 a202, v41
  v_accvgpr_write_b32 a203, v43
  v_accvgpr_write_b32 a216, v48
  v_accvgpr_write_b32 a217, v50
  v_accvgpr_write_b32 a218, v49
  v_accvgpr_write_b32 a219, v51
  v_xor_b32 v22, 128, v20
  v_add_u32 v22, 16384, v22
  ds_read_b64_tr_b16 v[24:25], v22 offset:0
  ds_read_b64_tr_b16 v[26:27], v22 offset:4096
  v_xor_b32 v22, 128, v20
  v_add_u32 v22, 16392, v22
  ds_read_b64_tr_b16 v[32:33], v22 offset:0
  ds_read_b64_tr_b16 v[34:35], v22 offset:4096
  v_xor_b32 v22, 144, v20
  v_add_u32 v22, 16384, v22
  ds_read_b64_tr_b16 v[40:41], v22 offset:0
  ds_read_b64_tr_b16 v[42:43], v22 offset:4096
  v_xor_b32 v22, 144, v20
  v_add_u32 v22, 16392, v22
  ds_read_b64_tr_b16 v[48:49], v22 offset:0
  ds_read_b64_tr_b16 v[50:51], v22 offset:4096
  s_waitcnt lgkmcnt(0)
  v_accvgpr_write_b32 a232, v24
  v_accvgpr_write_b32 a233, v26
  v_accvgpr_write_b32 a234, v25
  v_accvgpr_write_b32 a235, v27
  v_accvgpr_write_b32 a248, v32
  v_accvgpr_write_b32 a249, v34
  v_accvgpr_write_b32 a250, v33
  v_accvgpr_write_b32 a251, v35
  v_mov_b32 v64, v40
  v_mov_b32 v65, v42
  v_mov_b32 v66, v41
  v_mov_b32 v67, v43
  v_mov_b32 v80, v48
  v_mov_b32 v81, v50
  v_mov_b32 v82, v49
  v_mov_b32 v83, v51
  s_nop 1
Lwo_195:
  s_waitcnt vmcnt(25)
  s_barrier
  s_lshl_b32 s29, s20, 8
  s_lshl_b32 s30, s21, 17
  s_add_u32 s29, s29, s30
  s_add_u32 s29, s29, 524288
  s_lshl_b32 s30, s21, 12
  s_add_u32 m0, s30, 16384
  s_nop 0
  buffer_load_dwordx4 v10, s[16:19], s29 offen lds
  s_lshl_b32 s29, s20, 8
  s_lshl_b32 s30, s21, 17
  s_add_u32 s29, s29, s30
  s_add_u32 s29, s29, 557056
  s_lshl_b32 s30, s21, 12
  s_add_u32 m0, s30, 17408
  s_nop 0
  buffer_load_dwordx4 v11, s[16:19], s29 offen lds
  s_lshl_b32 s29, s20, 8
  s_lshl_b32 s30, s21, 17
  s_add_u32 s29, s29, s30
  s_add_u32 s29, s29, 589824
  s_lshl_b32 s30, s21, 12
  s_add_u32 m0, s30, 18432
  s_nop 0
  buffer_load_dwordx4 v10, s[16:19], s29 offen lds
  s_lshl_b32 s29, s20, 8
  s_lshl_b32 s30, s21, 17
  s_add_u32 s29, s29, s30
  s_add_u32 s29, s29, 622592
  s_lshl_b32 s30, s21, 12
  s_add_u32 m0, s30, 19456
  s_nop 0
  buffer_load_dwordx4 v11, s[16:19], s29 offen lds
  s_lshr_b32 s29, s21, 1
  s_cmp_lg_u32 s29, 0
  s_cbranch_scc1 Lwo_196
  v_xor_b32 v22, 0, v20
  v_add_u32 v22, 32768, v22
  ds_read_b64_tr_b16 v[28:29], v22 offset:0
  ds_read_b64_tr_b16 v[30:31], v22 offset:4096
  v_xor_b32 v22, 0, v20
  v_add_u32 v22, 32776, v22
  ds_read_b64_tr_b16 v[36:37], v22 offset:0
  ds_read_b64_tr_b16 v[38:39], v22 offset:4096
  v_xor_b32 v22, 16, v20
  v_add_u32 v22, 32768, v22
  ds_read_b64_tr_b16 v[44:45], v22 offset:0
  ds_read_b64_tr_b16 v[46:47], v22 offset:4096
  v_xor_b32 v22, 16, v20
  v_add_u32 v22, 32776, v22
  ds_read_b64_tr_b16 v[52:53], v22 offset:0
  ds_read_b64_tr_b16 v[54:55], v22 offset:4096
  s_waitcnt lgkmcnt(0)
  v_accvgpr_write_b32 a172, v28
  v_accvgpr_write_b32 a173, v30
  v_accvgpr_write_b32 a174, v29
  v_accvgpr_write_b32 a175, v31
  v_accvgpr_write_b32 a188, v36
  v_accvgpr_write_b32 a189, v38
  v_accvgpr_write_b32 a190, v37
  v_accvgpr_write_b32 a191, v39
  v_accvgpr_write_b32 a204, v44
  v_accvgpr_write_b32 a205, v46
  v_accvgpr_write_b32 a206, v45
  v_accvgpr_write_b32 a207, v47
  v_accvgpr_write_b32 a220, v52
  v_accvgpr_write_b32 a221, v54
  v_accvgpr_write_b32 a222, v53
  v_accvgpr_write_b32 a223, v55
  v_xor_b32 v22, 128, v20
  v_add_u32 v22, 32768, v22
  ds_read_b64_tr_b16 v[28:29], v22 offset:0
  ds_read_b64_tr_b16 v[30:31], v22 offset:4096
  v_xor_b32 v22, 128, v20
  v_add_u32 v22, 32776, v22
  ds_read_b64_tr_b16 v[36:37], v22 offset:0
  ds_read_b64_tr_b16 v[38:39], v22 offset:4096
  v_xor_b32 v22, 144, v20
  v_add_u32 v22, 32768, v22
  ds_read_b64_tr_b16 v[44:45], v22 offset:0
  ds_read_b64_tr_b16 v[46:47], v22 offset:4096
  v_xor_b32 v22, 144, v20
  v_add_u32 v22, 32776, v22
  ds_read_b64_tr_b16 v[52:53], v22 offset:0
  ds_read_b64_tr_b16 v[54:55], v22 offset:4096
  s_waitcnt lgkmcnt(0)
  v_accvgpr_write_b32 a236, v28
  v_accvgpr_write_b32 a237, v30
  v_accvgpr_write_b32 a238, v29
  v_accvgpr_write_b32 a239, v31
  v_accvgpr_write_b32 a252, v36
  v_accvgpr_write_b32 a253, v38
  v_accvgpr_write_b32 a254, v37
  v_accvgpr_write_b32 a255, v39
  v_mov_b32 v68, v44
  v_mov_b32 v69, v46
  v_mov_b32 v70, v45
  v_mov_b32 v71, v47
  v_mov_b32 v84, v52
  v_mov_b32 v85, v54
  v_mov_b32 v86, v53
  v_mov_b32 v87, v55
  s_nop 1
Lwo_196:
  s_waitcnt vmcnt(25)
  s_barrier
  s_lshl_b32 s29, s20, 8
  s_lshl_b32 s30, s21, 17
  s_add_u32 s29, s29, s30
  s_add_u32 s29, s29, 1048576
  s_lshl_b32 s30, s21, 12
  s_add_u32 m0, s30, 32768
  s_nop 0
  buffer_load_dwordx4 v10, s[16:19], s29 offen lds
  s_lshl_b32 s29, s20, 8
  s_lshl_b32 s30, s21, 17
  s_add_u32 s29, s29, s30
  s_add_u32 s29, s29, 1081344
  s_lshl_b32 s30, s21, 12
  s_add_u32 m0, s30, 33792
  s_nop 0
  buffer_load_dwordx4 v11, s[16:19], s29 offen lds
  s_lshl_b32 s29, s20, 8
  s_lshl_b32 s30, s21, 17
  s_add_u32 s29, s29, s30
  s_add_u32 s29, s29, 1114112
  s_lshl_b32 s30, s21, 12
  s_add_u32 m0, s30, 34816
  s_nop 0
  buffer_load_dwordx4 v10, s[16:19], s29 offen lds
  s_lshl_b32 s29, s20, 8
  s_lshl_b32 s30, s21, 17
  s_add_u32 s29, s29, s30
  s_add_u32 s29, s29, 1146880
  s_lshl_b32 s30, s21, 12
  s_add_u32 m0, s30, 35840
  s_nop 0
  buffer_load_dwordx4 v11, s[16:19], s29 offen lds
  s_lshr_b32 s29, s21, 1
  s_cmp_lg_u32 s29, 1
  s_cbranch_scc1 Lwo_197
  v_xor_b32 v22, 0, v20
  v_add_u32 v22, 49152, v22
  ds_read_b64_tr_b16 v[28:29], v22 offset:0
  ds_read_b64_tr_b16 v[30:31], v22 offset:4096
  v_xor_b32 v22, 0, v20
  v_add_u32 v22, 49160, v22
  ds_read_b64_tr_b16 v[36:37], v22 offset:0
  ds_read_b64_tr_b16 v[38:39], v22 offset:4096
  v_xor_b32 v22, 16, v20
  v_add_u32 v22, 49152, v22
  ds_read_b64_tr_b16 v[44:45], v22 offset:0
  ds_read_b64_tr_b16 v[46:47], v22 offset:4096
  v_xor_b32 v22, 16, v20
  v_add_u32 v22, 49160, v22
  ds_read_b64_tr_b16 v[52:53], v22 offset:0
  ds_read_b64_tr_b16 v[54:55], v22 offset:4096
  s_waitcnt lgkmcnt(0)
  v_accvgpr_write_b32 a172, v28
  v_accvgpr_write_b32 a173, v30
  v_accvgpr_write_b32 a174, v29
  v_accvgpr_write_b32 a175, v31
  v_accvgpr_write_b32 a188, v36
  v_accvgpr_write_b32 a189, v38
  v_accvgpr_write_b32 a190, v37
  v_accvgpr_write_b32 a191, v39
  v_accvgpr_write_b32 a204, v44
  v_accvgpr_write_b32 a205, v46
  v_accvgpr_write_b32 a206, v45
  v_accvgpr_write_b32 a207, v47
  v_accvgpr_write_b32 a220, v52
  v_accvgpr_write_b32 a221, v54
  v_accvgpr_write_b32 a222, v53
  v_accvgpr_write_b32 a223, v55
  v_xor_b32 v22, 128, v20
  v_add_u32 v22, 49152, v22
  ds_read_b64_tr_b16 v[28:29], v22 offset:0
  ds_read_b64_tr_b16 v[30:31], v22 offset:4096
  v_xor_b32 v22, 128, v20
  v_add_u32 v22, 49160, v22
  ds_read_b64_tr_b16 v[36:37], v22 offset:0
  ds_read_b64_tr_b16 v[38:39], v22 offset:4096
  v_xor_b32 v22, 144, v20
  v_add_u32 v22, 49152, v22
  ds_read_b64_tr_b16 v[44:45], v22 offset:0
  ds_read_b64_tr_b16 v[46:47], v22 offset:4096
  v_xor_b32 v22, 144, v20
  v_add_u32 v22, 49160, v22
  ds_read_b64_tr_b16 v[52:53], v22 offset:0
  ds_read_b64_tr_b16 v[54:55], v22 offset:4096
  s_waitcnt lgkmcnt(0)
  v_accvgpr_write_b32 a236, v28
  v_accvgpr_write_b32 a237, v30
  v_accvgpr_write_b32 a238, v29
  v_accvgpr_write_b32 a239, v31
  v_accvgpr_write_b32 a252, v36
  v_accvgpr_write_b32 a253, v38
  v_accvgpr_write_b32 a254, v37
  v_accvgpr_write_b32 a255, v39
  v_mov_b32 v68, v44
  v_mov_b32 v69, v46
  v_mov_b32 v70, v45
  v_mov_b32 v71, v47
  v_mov_b32 v84, v52
  v_mov_b32 v85, v54
  v_mov_b32 v86, v53
  v_mov_b32 v87, v55
  s_nop 1
Lwo_197:
  s_waitcnt vmcnt(25)
  s_barrier
  s_lshl_b32 s29, s20, 8
  s_lshl_b32 s30, s21, 17
  s_add_u32 s29, s29, s30
  s_add_u32 s29, s29, 1572864
  s_lshl_b32 s30, s21, 12
  s_add_u32 m0, s30, 49152
  s_nop 0
  buffer_load_dwordx4 v10, s[16:19], s29 offen lds
  s_lshl_b32 s29, s20, 8
  s_lshl_b32 s30, s21, 17
  s_add_u32 s29, s29, s30
  s_add_u32 s29, s29, 1605632
  s_lshl_b32 s30, s21, 12
  s_add_u32 m0, s30, 50176
  s_nop 0
  buffer_load_dwordx4 v11, s[16:19], s29 offen lds
  s_lshl_b32 s29, s20, 8
  s_lshl_b32 s30, s21, 17
  s_add_u32 s29, s29, s30
  s_add_u32 s29, s29, 1638400
  s_lshl_b32 s30, s21, 12
  s_add_u32 m0, s30, 51200
  s_nop 0
  buffer_load_dwordx4 v10, s[16:19], s29 offen lds
  s_lshl_b32 s29, s20, 8
  s_lshl_b32 s30, s21, 17
  s_add_u32 s29, s29, s30
  s_add_u32 s29, s29, 1671168
  s_lshl_b32 s30, s21, 12
  s_add_u32 m0, s30, 52224
  s_nop 0
  buffer_load_dwordx4 v11, s[16:19], s29 offen lds
  s_lshr_b32 s29, s21, 1
  s_cmp_lg_u32 s29, 0
  s_cbranch_scc1 Lwo_198
  v_xor_b32 v22, 0, v20
  v_add_u32 v22, 65536, v22
  ds_read_b64_tr_b16 v[24:25], v22 offset:0
  ds_read_b64_tr_b16 v[26:27], v22 offset:4096
  v_xor_b32 v22, 0, v20
  v_add_u32 v22, 65544, v22
  ds_read_b64_tr_b16 v[32:33], v22 offset:0
  ds_read_b64_tr_b16 v[34:35], v22 offset:4096
  v_xor_b32 v22, 16, v20
  v_add_u32 v22, 65536, v22
  ds_read_b64_tr_b16 v[40:41], v22 offset:0
  ds_read_b64_tr_b16 v[42:43], v22 offset:4096
  v_xor_b32 v22, 16, v20
  v_add_u32 v22, 65544, v22
  ds_read_b64_tr_b16 v[48:49], v22 offset:0
  ds_read_b64_tr_b16 v[50:51], v22 offset:4096
  s_waitcnt lgkmcnt(0)
  v_accvgpr_write_b32 a176, v24
  v_accvgpr_write_b32 a177, v26
  v_accvgpr_write_b32 a178, v25
  v_accvgpr_write_b32 a179, v27
  v_accvgpr_write_b32 a192, v32
  v_accvgpr_write_b32 a193, v34
  v_accvgpr_write_b32 a194, v33
  v_accvgpr_write_b32 a195, v35
  v_accvgpr_write_b32 a208, v40
  v_accvgpr_write_b32 a209, v42
  v_accvgpr_write_b32 a210, v41
  v_accvgpr_write_b32 a211, v43
  v_accvgpr_write_b32 a224, v48
  v_accvgpr_write_b32 a225, v50
  v_accvgpr_write_b32 a226, v49
  v_accvgpr_write_b32 a227, v51
  v_xor_b32 v22, 128, v20
  v_add_u32 v22, 65536, v22
  ds_read_b64_tr_b16 v[24:25], v22 offset:0
  ds_read_b64_tr_b16 v[26:27], v22 offset:4096
  v_xor_b32 v22, 128, v20
  v_add_u32 v22, 65544, v22
  ds_read_b64_tr_b16 v[32:33], v22 offset:0
  ds_read_b64_tr_b16 v[34:35], v22 offset:4096
  v_xor_b32 v22, 144, v20
  v_add_u32 v22, 65536, v22
  ds_read_b64_tr_b16 v[40:41], v22 offset:0
  ds_read_b64_tr_b16 v[42:43], v22 offset:4096
  v_xor_b32 v22, 144, v20
  v_add_u32 v22, 65544, v22
  ds_read_b64_tr_b16 v[48:49], v22 offset:0
  ds_read_b64_tr_b16 v[50:51], v22 offset:4096
  s_waitcnt lgkmcnt(0)
  v_accvgpr_write_b32 a240, v24
  v_accvgpr_write_b32 a241, v26
  v_accvgpr_write_b32 a242, v25
  v_accvgpr_write_b32 a243, v27
  v_mov_b32 v56, v32
  v_mov_b32 v57, v34
  v_mov_b32 v58, v33
  v_mov_b32 v59, v35
  v_mov_b32 v72, v40
  v_mov_b32 v73, v42
  v_mov_b32 v74, v41
  v_mov_b32 v75, v43
  v_mov_b32 v88, v48
  v_mov_b32 v89, v50
  v_mov_b32 v90, v49
  v_mov_b32 v91, v51
  s_nop 1
Lwo_198:
  s_waitcnt vmcnt(25)
  s_barrier
  s_lshl_b32 s29, s20, 8
  s_lshl_b32 s30, s21, 17
  s_add_u32 s29, s29, s30
  s_add_u32 s29, s29, 2097152
  s_lshl_b32 s30, s21, 12
  s_add_u32 m0, s30, 65536
  s_nop 0
  buffer_load_dwordx4 v10, s[16:19], s29 offen lds
  s_lshl_b32 s29, s20, 8
  s_lshl_b32 s30, s21, 17
  s_add_u32 s29, s29, s30
  s_add_u32 s29, s29, 2129920
  s_lshl_b32 s30, s21, 12
  s_add_u32 m0, s30, 66560
  s_nop 0
  buffer_load_dwordx4 v11, s[16:19], s29 offen lds
  s_lshl_b32 s29, s20, 8
  s_lshl_b32 s30, s21, 17
  s_add_u32 s29, s29, s30
  s_add_u32 s29, s29, 2162688
  s_lshl_b32 s30, s21, 12
  s_add_u32 m0, s30, 67584
  s_nop 0
  buffer_load_dwordx4 v10, s[16:19], s29 offen lds
  s_lshl_b32 s29, s20, 8
  s_lshl_b32 s30, s21, 17
  s_add_u32 s29, s29, s30
  s_add_u32 s29, s29, 2195456
  s_lshl_b32 s30, s21, 12
  s_add_u32 m0, s30, 68608
  s_nop 0
  buffer_load_dwordx4 v11, s[16:19], s29 offen lds
  s_lshr_b32 s29, s21, 1
  s_cmp_lg_u32 s29, 1
  s_cbranch_scc1 Lwo_199
  v_xor_b32 v22, 0, v20
  v_add_u32 v22, 81920, v22
  ds_read_b64_tr_b16 v[24:25], v22 offset:0
  ds_read_b64_tr_b16 v[26:27], v22 offset:4096
  v_xor_b32 v22, 0, v20
  v_add_u32 v22, 81928, v22
  ds_read_b64_tr_b16 v[32:33], v22 offset:0
  ds_read_b64_tr_b16 v[34:35], v22 offset:4096
  v_xor_b32 v22, 16, v20
  v_add_u32 v22, 81920, v22
  ds_read_b64_tr_b16 v[40:41], v22 offset:0
  ds_read_b64_tr_b16 v[42:43], v22 offset:4096
  v_xor_b32 v22, 16, v20
  v_add_u32 v22, 81928, v22
  ds_read_b64_tr_b16 v[48:49], v22 offset:0
  ds_read_b64_tr_b16 v[50:51], v22 offset:4096
  s_waitcnt lgkmcnt(0)
  v_accvgpr_write_b32 a176, v24
  v_accvgpr_write_b32 a177, v26
  v_accvgpr_write_b32 a178, v25
  v_accvgpr_write_b32 a179, v27
  v_accvgpr_write_b32 a192, v32
  v_accvgpr_write_b32 a193, v34
  v_accvgpr_write_b32 a194, v33
  v_accvgpr_write_b32 a195, v35
  v_accvgpr_write_b32 a208, v40
  v_accvgpr_write_b32 a209, v42
  v_accvgpr_write_b32 a210, v41
  v_accvgpr_write_b32 a211, v43
  v_accvgpr_write_b32 a224, v48
  v_accvgpr_write_b32 a225, v50
  v_accvgpr_write_b32 a226, v49
  v_accvgpr_write_b32 a227, v51
  v_xor_b32 v22, 128, v20
  v_add_u32 v22, 81920, v22
  ds_read_b64_tr_b16 v[24:25], v22 offset:0
  ds_read_b64_tr_b16 v[26:27], v22 offset:4096
  v_xor_b32 v22, 128, v20
  v_add_u32 v22, 81928, v22
  ds_read_b64_tr_b16 v[32:33], v22 offset:0
  ds_read_b64_tr_b16 v[34:35], v22 offset:4096
  v_xor_b32 v22, 144, v20
  v_add_u32 v22, 81920, v22
  ds_read_b64_tr_b16 v[40:41], v22 offset:0
  ds_read_b64_tr_b16 v[42:43], v22 offset:4096
  v_xor_b32 v22, 144, v20
  v_add_u32 v22, 81928, v22
  ds_read_b64_tr_b16 v[48:49], v22 offset:0
  ds_read_b64_tr_b16 v[50:51], v22 offset:4096
  s_waitcnt lgkmcnt(0)
  v_accvgpr_write_b32 a240, v24
  v_accvgpr_write_b32 a241, v26
  v_accvgpr_write_b32 a242, v25
  v_accvgpr_write_b32 a243, v27
  v_mov_b32 v56, v32
  v_mov_b32 v57, v34
  v_mov_b32 v58, v33
  v_mov_b32 v59, v35
  v_mov_b32 v72, v40
  v_mov_b32 v73, v42
  v_mov_b32 v74, v41
  v_mov_b32 v75, v43
  v_mov_b32 v88, v48
  v_mov_b32 v89, v50
  v_mov_b32 v90, v49
  v_mov_b32 v91, v51
  s_nop 1
Lwo_199:
  s_waitcnt vmcnt(24)
  s_barrier
  s_lshl_b32 s29, s20, 8
  s_lshl_b32 s30, s21, 17
  s_add_u32 s29, s29, s30
  s_add_u32 s29, s29, 2621440
  s_lshl_b32 s30, s21, 12
  s_add_u32 m0, s30, 81920
  s_nop 0
  buffer_load_dwordx4 v10, s[16:19], s29 offen lds
  s_lshl_b32 s29, s20, 8
  s_lshl_b32 s30, s21, 17
  s_add_u32 s29, s29, s30
  s_add_u32 s29, s29, 2654208
  s_lshl_b32 s30, s21, 12
  s_add_u32 m0, s30, 82944
  s_nop 0
  buffer_load_dwordx4 v11, s[16:19], s29 offen lds
  s_lshl_b32 s29, s20, 8
  s_lshl_b32 s30, s21, 17
  s_add_u32 s29, s29, s30
  s_add_u32 s29, s29, 2686976
  s_lshl_b32 s30, s21, 12
  s_add_u32 m0, s30, 83968
  s_nop 0
  buffer_load_dwordx4 v10, s[16:19], s29 offen lds
  s_lshl_b32 s29, s20, 8
  s_lshl_b32 s30, s21, 17
  s_add_u32 s29, s29, s30
  s_add_u32 s29, s29, 2719744
  s_lshl_b32 s30, s21, 12
  s_add_u32 m0, s30, 84992
  s_nop 0
  buffer_load_dwordx4 v11, s[16:19], s29 offen lds
  s_lshr_b32 s29, s21, 1
  s_cmp_lg_u32 s29, 0
  s_cbranch_scc1 Lwo_200
  v_xor_b32 v22, 0, v20
  v_add_u32 v22, 98304, v22
  ds_read_b64_tr_b16 v[28:29], v22 offset:0
  ds_read_b64_tr_b16 v[30:31], v22 offset:4096
  v_xor_b32 v22, 0, v20
  v_add_u32 v22, 98312, v22
  ds_read_b64_tr_b16 v[36:37], v22 offset:0
  ds_read_b64_tr_b16 v[38:39], v22 offset:4096
  v_xor_b32 v22, 16, v20
  v_add_u32 v22, 98304, v22
  ds_read_b64_tr_b16 v[44:45], v22 offset:0
  ds_read_b64_tr_b16 v[46:47], v22 offset:4096
  v_xor_b32 v22, 16, v20
  v_add_u32 v22, 98312, v22
  ds_read_b64_tr_b16 v[52:53], v22 offset:0
  ds_read_b64_tr_b16 v[54:55], v22 offset:4096
  s_waitcnt lgkmcnt(0)
  v_accvgpr_write_b32 a180, v28
  v_accvgpr_write_b32 a181, v30
  v_accvgpr_write_b32 a182, v29
  v_accvgpr_write_b32 a183, v31
  v_accvgpr_write_b32 a196, v36
  v_accvgpr_write_b32 a197, v38
  v_accvgpr_write_b32 a198, v37
  v_accvgpr_write_b32 a199, v39
  v_accvgpr_write_b32 a212, v44
  v_accvgpr_write_b32 a213, v46
  v_accvgpr_write_b32 a214, v45
  v_accvgpr_write_b32 a215, v47
  v_accvgpr_write_b32 a228, v52
  v_accvgpr_write_b32 a229, v54
  v_accvgpr_write_b32 a230, v53
  v_accvgpr_write_b32 a231, v55
  v_xor_b32 v22, 128, v20
  v_add_u32 v22, 98304, v22
  ds_read_b64_tr_b16 v[28:29], v22 offset:0
  ds_read_b64_tr_b16 v[30:31], v22 offset:4096
  v_xor_b32 v22, 128, v20
  v_add_u32 v22, 98312, v22
  ds_read_b64_tr_b16 v[36:37], v22 offset:0
  ds_read_b64_tr_b16 v[38:39], v22 offset:4096
  v_xor_b32 v22, 144, v20
  v_add_u32 v22, 98304, v22
  ds_read_b64_tr_b16 v[44:45], v22 offset:0
  ds_read_b64_tr_b16 v[46:47], v22 offset:4096
  v_xor_b32 v22, 144, v20
  v_add_u32 v22, 98312, v22
  ds_read_b64_tr_b16 v[52:53], v22 offset:0
  ds_read_b64_tr_b16 v[54:55], v22 offset:4096
  s_waitcnt lgkmcnt(0)
  v_accvgpr_write_b32 a244, v28
  v_accvgpr_write_b32 a245, v30
  v_accvgpr_write_b32 a246, v29
  v_accvgpr_write_b32 a247, v31
  v_mov_b32 v60, v36
  v_mov_b32 v61, v38
  v_mov_b32 v62, v37
  v_mov_b32 v63, v39
  v_mov_b32 v76, v44
  v_mov_b32 v77, v46
  v_mov_b32 v78, v45
  v_mov_b32 v79, v47
  v_mov_b32 v92, v52
  v_mov_b32 v93, v54
  v_mov_b32 v94, v53
  v_mov_b32 v95, v55
  s_nop 1
Lwo_200:
  s_waitcnt vmcnt(24)
  s_barrier
  s_lshl_b32 s29, s20, 8
  s_lshl_b32 s30, s21, 17
  s_add_u32 s29, s29, s30
  s_add_u32 s29, s29, 3145728
  s_lshl_b32 s30, s21, 12
  s_add_u32 m0, s30, 98304
  s_nop 0
  buffer_load_dwordx4 v10, s[16:19], s29 offen lds
  s_lshl_b32 s29, s20, 8
  s_lshl_b32 s30, s21, 17
  s_add_u32 s29, s29, s30
  s_add_u32 s29, s29, 3178496
  s_lshl_b32 s30, s21, 12
  s_add_u32 m0, s30, 99328
  s_nop 0
  buffer_load_dwordx4 v11, s[16:19], s29 offen lds
  s_lshl_b32 s29, s20, 8
  s_lshl_b32 s30, s21, 17
  s_add_u32 s29, s29, s30
  s_add_u32 s29, s29, 3211264
  s_lshl_b32 s30, s21, 12
  s_add_u32 m0, s30, 100352
  s_nop 0
  buffer_load_dwordx4 v10, s[16:19], s29 offen lds
  s_lshl_b32 s29, s20, 8
  s_lshl_b32 s30, s21, 17
  s_add_u32 s29, s29, s30
  s_add_u32 s29, s29, 3244032
  s_lshl_b32 s30, s21, 12
  s_add_u32 m0, s30, 101376
  s_nop 0
  buffer_load_dwordx4 v11, s[16:19], s29 offen lds
  s_lshr_b32 s29, s21, 1
  s_cmp_lg_u32 s29, 1
  s_cbranch_scc1 Lwo_201
  v_xor_b32 v22, 0, v20
  v_add_u32 v22, 114688, v22
  ds_read_b64_tr_b16 v[28:29], v22 offset:0
  ds_read_b64_tr_b16 v[30:31], v22 offset:4096
  v_xor_b32 v22, 0, v20
  v_add_u32 v22, 114696, v22
  ds_read_b64_tr_b16 v[36:37], v22 offset:0
  ds_read_b64_tr_b16 v[38:39], v22 offset:4096
  v_xor_b32 v22, 16, v20
  v_add_u32 v22, 114688, v22
  ds_read_b64_tr_b16 v[44:45], v22 offset:0
  ds_read_b64_tr_b16 v[46:47], v22 offset:4096
  v_xor_b32 v22, 16, v20
  v_add_u32 v22, 114696, v22
  ds_read_b64_tr_b16 v[52:53], v22 offset:0
  ds_read_b64_tr_b16 v[54:55], v22 offset:4096
  s_waitcnt lgkmcnt(0)
  v_accvgpr_write_b32 a180, v28
  v_accvgpr_write_b32 a181, v30
  v_accvgpr_write_b32 a182, v29
  v_accvgpr_write_b32 a183, v31
  v_accvgpr_write_b32 a196, v36
  v_accvgpr_write_b32 a197, v38
  v_accvgpr_write_b32 a198, v37
  v_accvgpr_write_b32 a199, v39
  v_accvgpr_write_b32 a212, v44
  v_accvgpr_write_b32 a213, v46
  v_accvgpr_write_b32 a214, v45
  v_accvgpr_write_b32 a215, v47
  v_accvgpr_write_b32 a228, v52
  v_accvgpr_write_b32 a229, v54
  v_accvgpr_write_b32 a230, v53
  v_accvgpr_write_b32 a231, v55
  v_xor_b32 v22, 128, v20
  v_add_u32 v22, 114688, v22
  ds_read_b64_tr_b16 v[28:29], v22 offset:0
  ds_read_b64_tr_b16 v[30:31], v22 offset:4096
  v_xor_b32 v22, 128, v20
  v_add_u32 v22, 114696, v22
  ds_read_b64_tr_b16 v[36:37], v22 offset:0
  ds_read_b64_tr_b16 v[38:39], v22 offset:4096
  v_xor_b32 v22, 144, v20
  v_add_u32 v22, 114688, v22
  ds_read_b64_tr_b16 v[44:45], v22 offset:0
  ds_read_b64_tr_b16 v[46:47], v22 offset:4096
  v_xor_b32 v22, 144, v20
  v_add_u32 v22, 114696, v22
  ds_read_b64_tr_b16 v[52:53], v22 offset:0
  ds_read_b64_tr_b16 v[54:55], v22 offset:4096
  s_waitcnt lgkmcnt(0)
  v_accvgpr_write_b32 a244, v28
  v_accvgpr_write_b32 a245, v30
  v_accvgpr_write_b32 a246, v29
  v_accvgpr_write_b32 a247, v31
  v_mov_b32 v60, v36
  v_mov_b32 v61, v38
  v_mov_b32 v62, v37
  v_mov_b32 v63, v39
  v_mov_b32 v76, v44
  v_mov_b32 v77, v46
  v_mov_b32 v78, v45
  v_mov_b32 v79, v47
  v_mov_b32 v92, v52
  v_mov_b32 v93, v54
  v_mov_b32 v94, v53
  v_mov_b32 v95, v55
  s_nop 1
Lwo_201:
  s_waitcnt vmcnt(24)
  s_barrier
  s_lshl_b32 s29, s20, 8
  s_lshl_b32 s30, s21, 17
  s_add_u32 s29, s29, s30
  s_add_u32 s29, s29, 3670016
  s_lshl_b32 s30, s21, 12
  s_add_u32 m0, s30, 114688
  s_nop 0
  buffer_load_dwordx4 v10, s[16:19], s29 offen lds
  s_lshl_b32 s29, s20, 8
  s_lshl_b32 s30, s21, 17
  s_add_u32 s29, s29, s30
  s_add_u32 s29, s29, 3702784
  s_lshl_b32 s30, s21, 12
  s_add_u32 m0, s30, 115712
  s_nop 0
  buffer_load_dwordx4 v11, s[16:19], s29 offen lds
  s_lshl_b32 s29, s20, 8
  s_lshl_b32 s30, s21, 17
  s_add_u32 s29, s29, s30
  s_add_u32 s29, s29, 3735552
  s_lshl_b32 s30, s21, 12
  s_add_u32 m0, s30, 116736
  s_nop 0
  buffer_load_dwordx4 v10, s[16:19], s29 offen lds
  s_lshl_b32 s29, s20, 8
  s_lshl_b32 s30, s21, 17
  s_add_u32 s29, s29, s30
  s_add_u32 s29, s29, 3768320
  s_lshl_b32 s30, s21, 12
  s_add_u32 m0, s30, 117760
  s_nop 0
  buffer_load_dwordx4 v11, s[16:19], s29 offen lds
  s_waitcnt lgkmcnt(0)
  ds_read_b64_tr_b16 v[24:25], v16 offset:0
  ds_read_b64_tr_b16 v[26:27], v16 offset:2048
  ds_read_b64_tr_b16 v[28:29], v16 offset:8192
  ds_read_b64_tr_b16 v[30:31], v16 offset:10240
  ds_read_b64_tr_b16 v[32:33], v17 offset:0
  ds_read_b64_tr_b16 v[34:35], v17 offset:2048
  ds_read_b64_tr_b16 v[36:37], v17 offset:8192
  ds_read_b64_tr_b16 v[38:39], v17 offset:10240
  s_waitcnt lgkmcnt(0)
  v_mov_b32 v128, v24
  v_mov_b32 v129, v26
  v_mov_b32 v130, v25
  v_mov_b32 v131, v27
  v_mov_b32 v132, v28
  v_mov_b32 v133, v30
  v_mov_b32 v134, v29
  v_mov_b32 v135, v31
  v_mov_b32 v136, v32
  v_mov_b32 v137, v34
  v_mov_b32 v138, v33
  v_mov_b32 v139, v35
  v_mov_b32 v140, v36
  v_mov_b32 v141, v38
  v_mov_b32 v142, v37
  v_mov_b32 v143, v39
  s_waitcnt vmcnt(24)
  s_barrier
  s_mov_b32 s60, s92
  s_and_b32 s61, s93, 0xffff
  s_mov_b32 s62, 256
  s_mov_b32 s63, 0x20000
  v_mov_b32 v127, 1
  s_cmp_eq_u32 s21, 0
  s_cselect_b32 s29, 4, 256
  v_mov_b32 v126, s29
  s_mov_b64 exec, 1
  buffer_atomic_add v127, v126, s[60:63], 0 offen sc1
  s_mov_b64 exec, -1
  v_bfe_u32 v126, v10, 6, 2
  v_lshl_add_u32 v126, v126, 1, 0
  v_and_b32 v126, 7, v126
  v_lshl_add_u32 v126, v126, 19, v10
  s_lshl_b32 s29, s20, 8
  s_lshl_b32 s30, s21, 17
  s_add_u32 s29, s29, s30
  s_add_u32 s29, s29, 0
  s_lshl_b32 s30, s21, 12
  s_add_u32 m0, s30, 0
  s_nop 0
  buffer_load_dwordx4 v126, s[56:59], s29 offen lds
  v_bfe_u32 v127, v11, 6, 2
  v_lshl_add_u32 v127, v127, 1, 0
  v_and_b32 v127, 7, v127
  v_lshl_add_u32 v127, v127, 19, v11
  s_lshl_b32 s29, s20, 8
  s_lshl_b32 s30, s21, 17
  s_add_u32 s29, s29, s30
  s_add_u32 s29, s29, 32768
  s_lshl_b32 s30, s21, 12
  s_add_u32 m0, s30, 1024
  s_nop 0
  buffer_load_dwordx4 v127, s[56:59], s29 offen lds
  s_lshl_b32 s29, s20, 8
  s_lshl_b32 s30, s21, 17
  s_add_u32 s29, s29, s30
  s_add_u32 s29, s29, 65536
  s_lshl_b32 s30, s21, 12
  s_add_u32 m0, s30, 2048
  s_nop 0
  buffer_load_dwordx4 v126, s[56:59], s29 offen lds
  s_lshl_b32 s29, s20, 8
  s_lshl_b32 s30, s21, 17
  s_add_u32 s29, s29, s30
  s_add_u32 s29, s29, 98304
  s_lshl_b32 s30, s21, 12
  s_add_u32 m0, s30, 3072
  s_nop 0
  buffer_load_dwordx4 v127, s[56:59], s29 offen lds
  s_waitcnt lgkmcnt(0)
  ds_read_b64_tr_b16 v[24:25], v16 offset:16384
  ds_read_b64_tr_b16 v[26:27], v16 offset:18432
  ds_read_b64_tr_b16 v[28:29], v16 offset:24576
  ds_read_b64_tr_b16 v[30:31], v16 offset:26624
  ds_read_b64_tr_b16 v[32:33], v17 offset:16384
  ds_read_b64_tr_b16 v[34:35], v17 offset:18432
  ds_read_b64_tr_b16 v[36:37], v17 offset:24576
  ds_read_b64_tr_b16 v[38:39], v17 offset:26624
  s_waitcnt lgkmcnt(0)
  v_mov_b32 v144, v24
  v_mov_b32 v145, v26
  v_mov_b32 v146, v25
  v_mov_b32 v147, v27
  v_mov_b32 v148, v28
  v_mov_b32 v149, v30
  v_mov_b32 v150, v29
  v_mov_b32 v151, v31
  v_mov_b32 v152, v32
  v_mov_b32 v153, v34
  v_mov_b32 v154, v33
  v_mov_b32 v155, v35
  v_mov_b32 v156, v36
  v_mov_b32 v157, v38
  v_mov_b32 v158, v37
  v_mov_b32 v159, v39
  s_waitcnt vmcnt(25)
  s_barrier
  v_bfe_u32 v126, v10, 6, 2
  v_lshl_add_u32 v126, v126, 1, 1
  v_and_b32 v126, 7, v126
  v_lshl_add_u32 v126, v126, 19, v10
  s_lshl_b32 s29, s20, 8
  s_lshl_b32 s30, s21, 17
  s_add_u32 s29, s29, s30
  s_add_u32 s29, s29, 0
  s_lshl_b32 s30, s21, 12
  s_add_u32 m0, s30, 16384
  s_nop 0
  buffer_load_dwordx4 v126, s[56:59], s29 offen lds
  v_bfe_u32 v127, v11, 6, 2
  v_lshl_add_u32 v127, v127, 1, 1
  v_and_b32 v127, 7, v127
  v_lshl_add_u32 v127, v127, 19, v11
  s_lshl_b32 s29, s20, 8
  s_lshl_b32 s30, s21, 17
  s_add_u32 s29, s29, s30
  s_add_u32 s29, s29, 32768
  s_lshl_b32 s30, s21, 12
  s_add_u32 m0, s30, 17408
  s_nop 0
  buffer_load_dwordx4 v127, s[56:59], s29 offen lds
  s_lshl_b32 s29, s20, 8
  s_lshl_b32 s30, s21, 17
  s_add_u32 s29, s29, s30
  s_add_u32 s29, s29, 65536
  s_lshl_b32 s30, s21, 12
  s_add_u32 m0, s30, 18432
  s_nop 0
  buffer_load_dwordx4 v126, s[56:59], s29 offen lds
  s_lshl_b32 s29, s20, 8
  s_lshl_b32 s30, s21, 17
  s_add_u32 s29, s29, s30
  s_add_u32 s29, s29, 98304
  s_lshl_b32 s30, s21, 12
  s_add_u32 m0, s30, 19456
  s_nop 0
  buffer_load_dwordx4 v127, s[56:59], s29 offen lds
  s_waitcnt lgkmcnt(0)
  ds_read_b64_tr_b16 v[24:25], v16 offset:32768
  ds_read_b64_tr_b16 v[26:27], v16 offset:34816
  ds_read_b64_tr_b16 v[28:29], v16 offset:40960
  ds_read_b64_tr_b16 v[30:31], v16 offset:43008
  ds_read_b64_tr_b16 v[32:33], v17 offset:32768
  ds_read_b64_tr_b16 v[34:35], v17 offset:34816
  ds_read_b64_tr_b16 v[36:37], v17 offset:40960
  ds_read_b64_tr_b16 v[38:39], v17 offset:43008
  s_waitcnt lgkmcnt(0)
  v_mov_b32 v160, v24
  v_mov_b32 v161, v26
  v_mov_b32 v162, v25
  v_mov_b32 v163, v27
  v_mov_b32 v164, v28
  v_mov_b32 v165, v30
  v_mov_b32 v166, v29
  v_mov_b32 v167, v31
  v_mov_b32 v168, v32
  v_mov_b32 v169, v34
  v_mov_b32 v170, v33
  v_mov_b32 v171, v35
  v_mov_b32 v172, v36
  v_mov_b32 v173, v38
  v_mov_b32 v174, v37
  v_mov_b32 v175, v39
  s_waitcnt vmcnt(25)
  s_barrier
  v_bfe_u32 v126, v10, 6, 2
  v_lshl_add_u32 v126, v126, 1, 2
  v_and_b32 v126, 7, v126
  v_lshl_add_u32 v126, v126, 19, v10
  s_lshl_b32 s29, s20, 8
  s_lshl_b32 s30, s21, 17
  s_add_u32 s29, s29, s30
  s_add_u32 s29, s29, 0
  s_lshl_b32 s30, s21, 12
  s_add_u32 m0, s30, 32768
  s_nop 0
  buffer_load_dwordx4 v126, s[56:59], s29 offen lds
  v_bfe_u32 v127, v11, 6, 2
  v_lshl_add_u32 v127, v127, 1, 2
  v_and_b32 v127, 7, v127
  v_lshl_add_u32 v127, v127, 19, v11
  s_lshl_b32 s29, s20, 8
  s_lshl_b32 s30, s21, 17
  s_add_u32 s29, s29, s30
  s_add_u32 s29, s29, 32768
  s_lshl_b32 s30, s21, 12
  s_add_u32 m0, s30, 33792
  s_nop 0
  buffer_load_dwordx4 v127, s[56:59], s29 offen lds
  s_lshl_b32 s29, s20, 8
  s_lshl_b32 s30, s21, 17
  s_add_u32 s29, s29, s30
  s_add_u32 s29, s29, 65536
  s_lshl_b32 s30, s21, 12
  s_add_u32 m0, s30, 34816
  s_nop 0
  buffer_load_dwordx4 v126, s[56:59], s29 offen lds
  s_lshl_b32 s29, s20, 8
  s_lshl_b32 s30, s21, 17
  s_add_u32 s29, s29, s30
  s_add_u32 s29, s29, 98304
  s_lshl_b32 s30, s21, 12
  s_add_u32 m0, s30, 35840
  s_nop 0
  buffer_load_dwordx4 v127, s[56:59], s29 offen lds
  s_waitcnt lgkmcnt(0)
  ds_read_b64_tr_b16 v[24:25], v16 offset:49152
  ds_read_b64_tr_b16 v[26:27], v16 offset:51200
  ds_read_b64_tr_b16 v[28:29], v16 offset:57344
  ds_read_b64_tr_b16 v[30:31], v16 offset:59392
  ds_read_b64_tr_b16 v[32:33], v17 offset:49152
  ds_read_b64_tr_b16 v[34:35], v17 offset:51200
  ds_read_b64_tr_b16 v[36:37], v17 offset:57344
  ds_read_b64_tr_b16 v[38:39], v17 offset:59392
  s_waitcnt lgkmcnt(0)
  v_mov_b32 v176, v24
  v_mov_b32 v177, v26
  v_mov_b32 v178, v25
  v_mov_b32 v179, v27
  v_mov_b32 v180, v28
  v_mov_b32 v181, v30
  v_mov_b32 v182, v29
  v_mov_b32 v183, v31
  v_mov_b32 v184, v32
  v_mov_b32 v185, v34
  v_mov_b32 v186, v33
  v_mov_b32 v187, v35
  v_mov_b32 v188, v36
  v_mov_b32 v189, v38
  v_mov_b32 v190, v37
  v_mov_b32 v191, v39
  s_waitcnt vmcnt(25)
  s_barrier
  v_bfe_u32 v126, v10, 6, 2
  v_lshl_add_u32 v126, v126, 1, 3
  v_and_b32 v126, 7, v126
  v_lshl_add_u32 v126, v126, 19, v10
  s_lshl_b32 s29, s20, 8
  s_lshl_b32 s30, s21, 17
  s_add_u32 s29, s29, s30
  s_add_u32 s29, s29, 0
  s_lshl_b32 s30, s21, 12
  s_add_u32 m0, s30, 49152
  s_nop 0
  buffer_load_dwordx4 v126, s[56:59], s29 offen lds
  v_bfe_u32 v127, v11, 6, 2
  v_lshl_add_u32 v127, v127, 1, 3
  v_and_b32 v127, 7, v127
  v_lshl_add_u32 v127, v127, 19, v11
  s_lshl_b32 s29, s20, 8
  s_lshl_b32 s30, s21, 17
  s_add_u32 s29, s29, s30
  s_add_u32 s29, s29, 32768
  s_lshl_b32 s30, s21, 12
  s_add_u32 m0, s30, 50176
  s_nop 0
  buffer_load_dwordx4 v127, s[56:59], s29 offen lds
  s_lshl_b32 s29, s20, 8
  s_lshl_b32 s30, s21, 17
  s_add_u32 s29, s29, s30
  s_add_u32 s29, s29, 65536
  s_lshl_b32 s30, s21, 12
  s_add_u32 m0, s30, 51200
  s_nop 0
  buffer_load_dwordx4 v126, s[56:59], s29 offen lds
  s_lshl_b32 s29, s20, 8
  s_lshl_b32 s30, s21, 17
  s_add_u32 s29, s29, s30
  s_add_u32 s29, s29, 98304
  s_lshl_b32 s30, s21, 12
  s_add_u32 m0, s30, 52224
  s_nop 0
  buffer_load_dwordx4 v127, s[56:59], s29 offen lds
  s_waitcnt lgkmcnt(0)
  ds_read_b64_tr_b16 v[24:25], v18 offset:0
  ds_read_b64_tr_b16 v[26:27], v18 offset:2048
  ds_read_b64_tr_b16 v[28:29], v18 offset:8192
  ds_read_b64_tr_b16 v[30:31], v18 offset:10240
  ds_read_b64_tr_b16 v[32:33], v19 offset:0
  ds_read_b64_tr_b16 v[34:35], v19 offset:2048
  ds_read_b64_tr_b16 v[36:37], v19 offset:8192
  ds_read_b64_tr_b16 v[38:39], v19 offset:10240
  s_waitcnt lgkmcnt(0)
  v_mov_b32 v192, v24
  v_mov_b32 v193, v26
  v_mov_b32 v194, v25
  v_mov_b32 v195, v27
  v_mov_b32 v196, v28
  v_mov_b32 v197, v30
  v_mov_b32 v198, v29
  v_mov_b32 v199, v31
  v_mov_b32 v200, v32
  v_mov_b32 v201, v34
  v_mov_b32 v202, v33
  v_mov_b32 v203, v35
  v_mov_b32 v204, v36
  v_mov_b32 v205, v38
  v_mov_b32 v206, v37
  v_mov_b32 v207, v39
  s_waitcnt vmcnt(25)
  s_barrier
  v_bfe_u32 v126, v10, 6, 2
  v_lshl_add_u32 v126, v126, 1, 4
  v_and_b32 v126, 7, v126
  v_lshl_add_u32 v126, v126, 19, v10
  s_lshl_b32 s29, s20, 8
  s_lshl_b32 s30, s21, 17
  s_add_u32 s29, s29, s30
  s_add_u32 s29, s29, 0
  s_lshl_b32 s30, s21, 12
  s_add_u32 m0, s30, 65536
  s_nop 0
  buffer_load_dwordx4 v126, s[56:59], s29 offen lds
  v_bfe_u32 v127, v11, 6, 2
  v_lshl_add_u32 v127, v127, 1, 4
  v_and_b32 v127, 7, v127
  v_lshl_add_u32 v127, v127, 19, v11
  s_lshl_b32 s29, s20, 8
  s_lshl_b32 s30, s21, 17
  s_add_u32 s29, s29, s30
  s_add_u32 s29, s29, 32768
  s_lshl_b32 s30, s21, 12
  s_add_u32 m0, s30, 66560
  s_nop 0
  buffer_load_dwordx4 v127, s[56:59], s29 offen lds
  s_lshl_b32 s29, s20, 8
  s_lshl_b32 s30, s21, 17
  s_add_u32 s29, s29, s30
  s_add_u32 s29, s29, 65536
  s_lshl_b32 s30, s21, 12
  s_add_u32 m0, s30, 67584
  s_nop 0
  buffer_load_dwordx4 v126, s[56:59], s29 offen lds
  s_lshl_b32 s29, s20, 8
  s_lshl_b32 s30, s21, 17
  s_add_u32 s29, s29, s30
  s_add_u32 s29, s29, 98304
  s_lshl_b32 s30, s21, 12
  s_add_u32 m0, s30, 68608
  s_nop 0
  buffer_load_dwordx4 v127, s[56:59], s29 offen lds
  s_waitcnt lgkmcnt(0)
  ds_read_b64_tr_b16 v[24:25], v18 offset:16384
  ds_read_b64_tr_b16 v[26:27], v18 offset:18432
  ds_read_b64_tr_b16 v[28:29], v18 offset:24576
  ds_read_b64_tr_b16 v[30:31], v18 offset:26624
  ds_read_b64_tr_b16 v[32:33], v19 offset:16384
  ds_read_b64_tr_b16 v[34:35], v19 offset:18432
  ds_read_b64_tr_b16 v[36:37], v19 offset:24576
  ds_read_b64_tr_b16 v[38:39], v19 offset:26624
  s_waitcnt lgkmcnt(0)
  v_mov_b32 v208, v24
  v_mov_b32 v209, v26
  v_mov_b32 v210, v25
  v_mov_b32 v211, v27
  v_mov_b32 v212, v28
  v_mov_b32 v213, v30
  v_mov_b32 v214, v29
  v_mov_b32 v215, v31
  v_mov_b32 v216, v32
  v_mov_b32 v217, v34
  v_mov_b32 v218, v33
  v_mov_b32 v219, v35
  v_mov_b32 v220, v36
  v_mov_b32 v221, v38
  v_mov_b32 v222, v37
  v_mov_b32 v223, v39
  s_waitcnt vmcnt(25)
  s_barrier
  v_bfe_u32 v126, v10, 6, 2
  v_lshl_add_u32 v126, v126, 1, 5
  v_and_b32 v126, 7, v126
  v_lshl_add_u32 v126, v126, 19, v10
  s_lshl_b32 s29, s20, 8
  s_lshl_b32 s30, s21, 17
  s_add_u32 s29, s29, s30
  s_add_u32 s29, s29, 0
  s_lshl_b32 s30, s21, 12
  s_add_u32 m0, s30, 81920
  s_nop 0
  buffer_load_dwordx4 v126, s[56:59], s29 offen lds
  v_bfe_u32 v127, v11, 6, 2
  v_lshl_add_u32 v127, v127, 1, 5
  v_and_b32 v127, 7, v127
  v_lshl_add_u32 v127, v127, 19, v11
  s_lshl_b32 s29, s20, 8
  s_lshl_b32 s30, s21, 17
  s_add_u32 s29, s29, s30
  s_add_u32 s29, s29, 32768
  s_lshl_b32 s30, s21, 12
  s_add_u32 m0, s30, 82944
  s_nop 0
  buffer_load_dwordx4 v127, s[56:59], s29 offen lds
  s_lshl_b32 s29, s20, 8
  s_lshl_b32 s30, s21, 17
  s_add_u32 s29, s29, s30
  s_add_u32 s29, s29, 65536
  s_lshl_b32 s30, s21, 12
  s_add_u32 m0, s30, 83968
  s_nop 0
  buffer_load_dwordx4 v126, s[56:59], s29 offen lds
  s_lshl_b32 s29, s20, 8
  s_lshl_b32 s30, s21, 17
  s_add_u32 s29, s29, s30
  s_add_u32 s29, s29, 98304
  s_lshl_b32 s30, s21, 12
  s_add_u32 m0, s30, 84992
  s_nop 0
  buffer_load_dwordx4 v127, s[56:59], s29 offen lds
  s_waitcnt lgkmcnt(0)
  ds_read_b64_tr_b16 v[24:25], v18 offset:32768
  ds_read_b64_tr_b16 v[26:27], v18 offset:34816
  ds_read_b64_tr_b16 v[28:29], v18 offset:40960
  ds_read_b64_tr_b16 v[30:31], v18 offset:43008
  ds_read_b64_tr_b16 v[32:33], v19 offset:32768
  ds_read_b64_tr_b16 v[34:35], v19 offset:34816
  ds_read_b64_tr_b16 v[36:37], v19 offset:40960
  ds_read_b64_tr_b16 v[38:39], v19 offset:43008
  s_waitcnt lgkmcnt(0)
  v_mov_b32 v224, v24
  v_mov_b32 v225, v26
  v_mov_b32 v226, v25
  v_mov_b32 v227, v27
  v_mov_b32 v228, v28
  v_mov_b32 v229, v30
  v_mov_b32 v230, v29
  v_mov_b32 v231, v31
  v_mov_b32 v232, v32
  v_mov_b32 v233, v34
  v_mov_b32 v234, v33
  v_mov_b32 v235, v35
  v_mov_b32 v236, v36
  v_mov_b32 v237, v38
  v_mov_b32 v238, v37
  v_mov_b32 v239, v39
  s_waitcnt vmcnt(25)
  s_barrier
  v_bfe_u32 v126, v10, 6, 2
  v_lshl_add_u32 v126, v126, 1, 6
  v_and_b32 v126, 7, v126
  v_lshl_add_u32 v126, v126, 19, v10
  s_lshl_b32 s29, s20, 8
  s_lshl_b32 s30, s21, 17
  s_add_u32 s29, s29, s30
  s_add_u32 s29, s29, 0
  s_lshl_b32 s30, s21, 12
  s_add_u32 m0, s30, 98304
  s_nop 0
  buffer_load_dwordx4 v126, s[56:59], s29 offen lds
  v_bfe_u32 v127, v11, 6, 2
  v_lshl_add_u32 v127, v127, 1, 6
  v_and_b32 v127, 7, v127
  v_lshl_add_u32 v127, v127, 19, v11
  s_lshl_b32 s29, s20, 8
  s_lshl_b32 s30, s21, 17
  s_add_u32 s29, s29, s30
  s_add_u32 s29, s29, 32768
  s_lshl_b32 s30, s21, 12
  s_add_u32 m0, s30, 99328
  s_nop 0
  buffer_load_dwordx4 v127, s[56:59], s29 offen lds
  s_lshl_b32 s29, s20, 8
  s_lshl_b32 s30, s21, 17
  s_add_u32 s29, s29, s30
  s_add_u32 s29, s29, 65536
  s_lshl_b32 s30, s21, 12
  s_add_u32 m0, s30, 100352
  s_nop 0
  buffer_load_dwordx4 v126, s[56:59], s29 offen lds
  s_lshl_b32 s29, s20, 8
  s_lshl_b32 s30, s21, 17
  s_add_u32 s29, s29, s30
  s_add_u32 s29, s29, 98304
  s_lshl_b32 s30, s21, 12
  s_add_u32 m0, s30, 101376
  s_nop 0
  buffer_load_dwordx4 v127, s[56:59], s29 offen lds
  s_waitcnt lgkmcnt(0)
  ds_read_b64_tr_b16 v[24:25], v18 offset:49152
  ds_read_b64_tr_b16 v[26:27], v18 offset:51200
  ds_read_b64_tr_b16 v[28:29], v18 offset:57344
  ds_read_b64_tr_b16 v[30:31], v18 offset:59392
  ds_read_b64_tr_b16 v[32:33], v19 offset:49152
  ds_read_b64_tr_b16 v[34:35], v19 offset:51200
  ds_read_b64_tr_b16 v[36:37], v19 offset:57344
  ds_read_b64_tr_b16 v[38:39], v19 offset:59392
  s_waitcnt lgkmcnt(0)
  v_mov_b32 v240, v24
  v_mov_b32 v241, v26
  v_mov_b32 v242, v25
  v_mov_b32 v243, v27
  v_mov_b32 v244, v28
  v_mov_b32 v245, v30
  v_mov_b32 v246, v29
  v_mov_b32 v247, v31
  v_mov_b32 v248, v32
  v_mov_b32 v249, v34
  v_mov_b32 v250, v33
  v_mov_b32 v251, v35
  v_mov_b32 v252, v36
  v_mov_b32 v253, v38
  v_mov_b32 v254, v37
  v_mov_b32 v255, v39
  s_waitcnt vmcnt(24)
  s_barrier
  v_bfe_u32 v126, v10, 6, 2
  v_lshl_add_u32 v126, v126, 1, 7
  v_and_b32 v126, 7, v126
  v_lshl_add_u32 v126, v126, 19, v10
  s_lshl_b32 s29, s20, 8
  s_lshl_b32 s30, s21, 17
  s_add_u32 s29, s29, s30
  s_add_u32 s29, s29, 0
  s_lshl_b32 s30, s21, 12
  s_add_u32 m0, s30, 114688
  s_nop 0
  buffer_load_dwordx4 v126, s[56:59], s29 offen lds
  v_bfe_u32 v127, v11, 6, 2
  v_lshl_add_u32 v127, v127, 1, 7
  v_and_b32 v127, 7, v127
  v_lshl_add_u32 v127, v127, 19, v11
  s_lshl_b32 s29, s20, 8
  s_lshl_b32 s30, s21, 17
  s_add_u32 s29, s29, s30
  s_add_u32 s29, s29, 32768
  s_lshl_b32 s30, s21, 12
  s_add_u32 m0, s30, 115712
  s_nop 0
  buffer_load_dwordx4 v127, s[56:59], s29 offen lds
  s_lshl_b32 s29, s20, 8
  s_lshl_b32 s30, s21, 17
  s_add_u32 s29, s29, s30
  s_add_u32 s29, s29, 65536
  s_lshl_b32 s30, s21, 12
  s_add_u32 m0, s30, 116736
  s_nop 0
  buffer_load_dwordx4 v126, s[56:59], s29 offen lds
  s_lshl_b32 s29, s20, 8
  s_lshl_b32 s30, s21, 17
  s_add_u32 s29, s29, s30
  s_add_u32 s29, s29, 98304
  s_lshl_b32 s30, s21, 12
  s_add_u32 m0, s30, 117760
  s_nop 0
  buffer_load_dwordx4 v127, s[56:59], s29 offen lds
  s_waitcnt lgkmcnt(0)
  ds_read_b64_tr_b16 v[24:25], v16 offset:0
  ds_read_b64_tr_b16 v[26:27], v16 offset:2048
  ds_read_b64_tr_b16 v[28:29], v16 offset:8192
  ds_read_b64_tr_b16 v[30:31], v16 offset:10240
  ds_read_b64_tr_b16 v[32:33], v17 offset:0
  ds_read_b64_tr_b16 v[34:35], v17 offset:2048
  ds_read_b64_tr_b16 v[36:37], v17 offset:8192
  ds_read_b64_tr_b16 v[38:39], v17 offset:10240
  s_waitcnt lgkmcnt(0)
  v_mov_b32 v40, v24
  v_mov_b32 v41, v26
  v_mov_b32 v42, v25
  v_mov_b32 v43, v27
  v_mov_b32 v44, v28
  v_mov_b32 v45, v30
  v_mov_b32 v46, v29
  v_mov_b32 v47, v31
  v_mov_b32 v48, v32
  v_mov_b32 v49, v34
  v_mov_b32 v50, v33
  v_mov_b32 v51, v35
  v_mov_b32 v52, v36
  v_mov_b32 v53, v38
  v_mov_b32 v54, v37
  v_mov_b32 v55, v39
  s_waitcnt vmcnt(24)
  s_barrier
  ds_write_b128 v114, v[40:43] offset:0
  ds_write_b128 v114, v[44:47] offset:1024
  ds_write_b128 v114, v[48:51] offset:2048
  ds_write_b128 v114, v[52:55] offset:3072
  s_waitcnt lgkmcnt(0)
  ds_read_b64_tr_b16 v[24:25], v16 offset:16384
  ds_read_b64_tr_b16 v[26:27], v16 offset:18432
  ds_read_b64_tr_b16 v[28:29], v16 offset:24576
  ds_read_b64_tr_b16 v[30:31], v16 offset:26624
  ds_read_b64_tr_b16 v[32:33], v17 offset:16384
  ds_read_b64_tr_b16 v[34:35], v17 offset:18432
  ds_read_b64_tr_b16 v[36:37], v17 offset:24576
  ds_read_b64_tr_b16 v[38:39], v17 offset:26624
  s_waitcnt lgkmcnt(0)
  v_mov_b32 v40, v24
  v_mov_b32 v41, v26
  v_mov_b32 v42, v25
  v_mov_b32 v43, v27
  v_mov_b32 v44, v28
  v_mov_b32 v45, v30
  v_mov_b32 v46, v29
  v_mov_b32 v47, v31
  v_mov_b32 v48, v32
  v_mov_b32 v49, v34
  v_mov_b32 v50, v33
  v_mov_b32 v51, v35
  v_mov_b32 v52, v36
  v_mov_b32 v53, v38
  v_mov_b32 v54, v37
  v_mov_b32 v55, v39
  s_waitcnt vmcnt(20)
  s_barrier
  ds_write_b128 v114, v[40:43] offset:16384
  ds_write_b128 v114, v[44:47] offset:17408
  ds_write_b128 v114, v[48:51] offset:18432
  ds_write_b128 v114, v[52:55] offset:19456
  s_waitcnt lgkmcnt(0)
  ds_read_b64_tr_b16 v[24:25], v16 offset:32768
  ds_read_b64_tr_b16 v[26:27], v16 offset:34816
  ds_read_b64_tr_b16 v[28:29], v16 offset:40960
  ds_read_b64_tr_b16 v[30:31], v16 offset:43008
  ds_read_b64_tr_b16 v[32:33], v17 offset:32768
  ds_read_b64_tr_b16 v[34:35], v17 offset:34816
  ds_read_b64_tr_b16 v[36:37], v17 offset:40960
  ds_read_b64_tr_b16 v[38:39], v17 offset:43008
  s_waitcnt lgkmcnt(0)
  v_mov_b32 v40, v24
  v_mov_b32 v41, v26
  v_mov_b32 v42, v25
  v_mov_b32 v43, v27
  v_mov_b32 v44, v28
  v_mov_b32 v45, v30
  v_mov_b32 v46, v29
  v_mov_b32 v47, v31
  v_mov_b32 v48, v32
  v_mov_b32 v49, v34
  v_mov_b32 v50, v33
  v_mov_b32 v51, v35
  v_mov_b32 v52, v36
  v_mov_b32 v53, v38
  v_mov_b32 v54, v37
  v_mov_b32 v55, v39
  s_waitcnt vmcnt(16)
  s_barrier
  ds_write_b128 v114, v[40:43] offset:32768
  ds_write_b128 v114, v[44:47] offset:33792
  ds_write_b128 v114, v[48:51] offset:34816
  ds_write_b128 v114, v[52:55] offset:35840
  s_waitcnt lgkmcnt(0)
  ds_read_b64_tr_b16 v[24:25], v16 offset:49152
  ds_read_b64_tr_b16 v[26:27], v16 offset:51200
  ds_read_b64_tr_b16 v[28:29], v16 offset:57344
  ds_read_b64_tr_b16 v[30:31], v16 offset:59392
  ds_read_b64_tr_b16 v[32:33], v17 offset:49152
  ds_read_b64_tr_b16 v[34:35], v17 offset:51200
  ds_read_b64_tr_b16 v[36:37], v17 offset:57344
  ds_read_b64_tr_b16 v[38:39], v17 offset:59392
  s_waitcnt lgkmcnt(0)
  v_mov_b32 v40, v24
  v_mov_b32 v41, v26
  v_mov_b32 v42, v25
  v_mov_b32 v43, v27
  v_mov_b32 v44, v28
  v_mov_b32 v45, v30
  v_mov_b32 v46, v29
  v_mov_b32 v47, v31
  v_accvgpr_write_b32 a128, v32
  v_accvgpr_write_b32 a129, v34
  v_accvgpr_write_b32 a130, v33
  v_accvgpr_write_b32 a131, v35
  v_accvgpr_write_b32 a132, v36
  v_accvgpr_write_b32 a133, v38
  v_accvgpr_write_b32 a134, v37
  v_accvgpr_write_b32 a135, v39
  s_waitcnt vmcnt(12)
  s_barrier
  ds_write_b128 v114, v[40:43] offset:49152
  ds_write_b128 v114, v[44:47] offset:50176
  ds_write_b128 v114, v[56:59] offset:51200
  ds_write_b128 v114, v[60:63] offset:52224
  s_waitcnt lgkmcnt(0)
  ds_read_b64_tr_b16 v[24:25], v18 offset:0
  ds_read_b64_tr_b16 v[26:27], v18 offset:2048
  ds_read_b64_tr_b16 v[28:29], v18 offset:8192
  ds_read_b64_tr_b16 v[30:31], v18 offset:10240
  ds_read_b64_tr_b16 v[32:33], v19 offset:0
  ds_read_b64_tr_b16 v[34:35], v19 offset:2048
  ds_read_b64_tr_b16 v[36:37], v19 offset:8192
  ds_read_b64_tr_b16 v[38:39], v19 offset:10240
  s_waitcnt lgkmcnt(0)
  v_accvgpr_write_b32 a136, v24
  v_accvgpr_write_b32 a137, v26
  v_accvgpr_write_b32 a138, v25
  v_accvgpr_write_b32 a139, v27
  v_accvgpr_write_b32 a140, v28
  v_accvgpr_write_b32 a141, v30
  v_accvgpr_write_b32 a142, v29
  v_accvgpr_write_b32 a143, v31
  v_accvgpr_write_b32 a144, v32
  v_accvgpr_write_b32 a145, v34
  v_accvgpr_write_b32 a146, v33
  v_accvgpr_write_b32 a147, v35
  v_accvgpr_write_b32 a148, v36
  v_accvgpr_write_b32 a149, v38
  v_accvgpr_write_b32 a150, v37
  v_accvgpr_write_b32 a151, v39
  s_waitcnt vmcnt(8)
  s_barrier
  ds_write_b128 v115, v[64:67] offset:0
  ds_write_b128 v115, v[68:71] offset:1024
  ds_write_b128 v115, v[72:75] offset:2048
  ds_write_b128 v115, v[76:79] offset:3072
  s_waitcnt lgkmcnt(0)
  ds_read_b64_tr_b16 v[24:25], v18 offset:16384
  ds_read_b64_tr_b16 v[26:27], v18 offset:18432
  ds_read_b64_tr_b16 v[28:29], v18 offset:24576
  ds_read_b64_tr_b16 v[30:31], v18 offset:26624
  ds_read_b64_tr_b16 v[32:33], v19 offset:16384
  ds_read_b64_tr_b16 v[34:35], v19 offset:18432
  ds_read_b64_tr_b16 v[36:37], v19 offset:24576
  ds_read_b64_tr_b16 v[38:39], v19 offset:26624
  s_waitcnt lgkmcnt(0)
  v_accvgpr_write_b32 a152, v24
  v_accvgpr_write_b32 a153, v26
  v_accvgpr_write_b32 a154, v25
  v_accvgpr_write_b32 a155, v27
  v_accvgpr_write_b32 a156, v28
  v_accvgpr_write_b32 a157, v30
  v_accvgpr_write_b32 a158, v29
  v_accvgpr_write_b32 a159, v31
  v_accvgpr_write_b32 a160, v32
  v_accvgpr_write_b32 a161, v34
  v_accvgpr_write_b32 a162, v33
  v_accvgpr_write_b32 a163, v35
  v_accvgpr_write_b32 a164, v36
  v_accvgpr_write_b32 a165, v38
  v_accvgpr_write_b32 a166, v37
  v_accvgpr_write_b32 a167, v39
  s_waitcnt vmcnt(4)
  s_barrier
  ds_write_b128 v115, v[80:83] offset:16384
  ds_write_b128 v115, v[84:87] offset:17408
  ds_write_b128 v115, v[88:91] offset:18432
  ds_write_b128 v115, v[92:95] offset:19456
  s_waitcnt lgkmcnt(0)
  ds_read_b64_tr_b16 v[24:25], v18 offset:32768
  ds_read_b64_tr_b16 v[26:27], v18 offset:34816
  ds_read_b64_tr_b16 v[28:29], v18 offset:40960
  ds_read_b64_tr_b16 v[30:31], v18 offset:43008
  ds_read_b64_tr_b16 v[32:33], v19 offset:32768
  ds_read_b64_tr_b16 v[34:35], v19 offset:34816
  ds_read_b64_tr_b16 v[36:37], v19 offset:40960
  ds_read_b64_tr_b16 v[38:39], v19 offset:43008
  s_waitcnt lgkmcnt(0)
  v_mov_b32 v40, v24
  v_mov_b32 v41, v26
  v_mov_b32 v42, v25
  v_mov_b32 v43, v27
  v_mov_b32 v44, v28
  v_mov_b32 v45, v30
  v_mov_b32 v46, v29
  v_mov_b32 v47, v31
  v_mov_b32 v48, v32
  v_mov_b32 v49, v34
  v_mov_b32 v50, v33
  v_mov_b32 v51, v35
  v_mov_b32 v52, v36
  v_mov_b32 v53, v38
  v_mov_b32 v54, v37
  v_mov_b32 v55, v39
  s_waitcnt vmcnt(0)
  s_barrier
  ds_write_b128 v115, v[40:43] offset:32768
  ds_write_b128 v115, v[44:47] offset:33792
  ds_write_b128 v115, v[48:51] offset:34816
  ds_write_b128 v115, v[52:55] offset:35840
  s_waitcnt lgkmcnt(0)
  ds_read_b64_tr_b16 v[24:25], v18 offset:49152
  ds_read_b64_tr_b16 v[26:27], v18 offset:51200
  ds_read_b64_tr_b16 v[28:29], v18 offset:57344
  ds_read_b64_tr_b16 v[30:31], v18 offset:59392
  ds_read_b64_tr_b16 v[32:33], v19 offset:49152
  ds_read_b64_tr_b16 v[34:35], v19 offset:51200
  ds_read_b64_tr_b16 v[36:37], v19 offset:57344
  ds_read_b64_tr_b16 v[38:39], v19 offset:59392
  s_waitcnt lgkmcnt(0)
  v_mov_b32 v40, v24
  v_mov_b32 v41, v26
  v_mov_b32 v42, v25
  v_mov_b32 v43, v27
  v_mov_b32 v44, v28
  v_mov_b32 v45, v30
  v_mov_b32 v46, v29
  v_mov_b32 v47, v31
  v_mov_b32 v48, v32
  v_mov_b32 v49, v34
  v_mov_b32 v50, v33
  v_mov_b32 v51, v35
  v_mov_b32 v52, v36
  v_mov_b32 v53, v38
  v_mov_b32 v54, v37
  v_mov_b32 v55, v39
  s_barrier
  ds_write_b128 v115, v[40:43] offset:49152
  ds_write_b128 v115, v[44:47] offset:50176
  ds_write_b128 v115, v[48:51] offset:51200
  ds_write_b128 v115, v[52:55] offset:52224
  s_waitcnt lgkmcnt(0)
  s_mov_b32 s12, s92
  s_and_b32 s13, s93, 0xffff
  s_mov_b32 s14, 256
  s_mov_b32 s15, 0x20000
  s_mov_b32 s26, 0
Lwi_202:
  buffer_load_dword v127, off, s[12:15], 0 offset:12 sc1
  s_waitcnt vmcnt(0)
  v_readfirstlane_b32 s29, v127
  s_nop 0
  s_cmp_ge_u32 s29, 4
  s_nop 1
  s_cbranch_scc1 Lwi_203
  s_sleep 2
  s_add_u32 s26, s26, 1
  s_cmp_lt_u32 s26, 0x40000
  s_cbranch_scc1 Lwi_202
  s_branch Labort_187
Lwi_203:
  s_barrier
  s_mov_b32 s8, s92
  s_and_b32 s9, s93, 0xffff
  s_mov_b32 s10, 256
  s_mov_b32 s11, 0x20000
Lrv_191:
  s_mov_b32 s26, 0
Lrv_189:
  buffer_load_dword v127, off, s[8:11], 0 offset:4 sc1
  s_waitcnt vmcnt(0)
  v_readfirstlane_b32 s29, v127
  s_nop 0
  s_cmp_ge_u32 s29, 32
  s_nop 1
  s_cbranch_scc1 Lrv_190
  s_add_u32 s26, s26, 1
  s_and_b32 s29, s26, 255
  s_cmp_lg_u32 s29, 0
  s_cbranch_scc1 Lrv_189
  buffer_wbl2 sc1
  s_waitcnt vmcnt(0)
  s_cmp_lt_u32 s26, 0x40000
  s_cbranch_scc1 Lrv_189
  s_branch Labort_187
Lrv_190:
  s_mov_b32 s24, 0
  s_mov_b32 s33, 0
  s_mov_b32 s19, 0
  s_mov_b32 s27, 0
  s_mov_b32 s28, 0
  s_mov_b32 s34, 0
  s_mov_b32 s23, 1048576
  s_mov_b32 s25, 0
  s_lshl_b32 s35, s20, 7
  s_add_u32 s35, s35, 56960
  s_mov_b32 s26, 0
Lpk_204:
  buffer_load_dword v127, off, s[4:7], s35 sc1
  s_waitcnt vmcnt(0)
  v_readfirstlane_b32 s29, v127
  s_nop 0
  s_cmp_ge_u32 s29, 4
  s_nop 1
  s_cbranch_scc1 Lpk_205
  s_add_u32 s26, s26, 1
  s_and_b32 s29, s26, 4095
  s_cmp_lg_u32 s29, 0
  s_cbranch_scc1 Lpk_204
  buffer_wbl2 sc1
  s_waitcnt vmcnt(0)
  s_cmp_lt_u32 s26, 0x40000
  s_cbranch_scc1 Lpk_204
  s_branch Labort_187
Lpk_205:
  s_add_u32 s29, s20, s21
  s_and_b32 s29, s29, 15
  s_lshl_b32 s29, s29, 8
  s_and_b32 s30, s21, 1
  s_lshl_b32 s30, s30, 7
  s_add_u32 s16, s29, s30
  s_lshl_b32 s11, s20, 13
  s_add_u32 s11, s11, s16
  s_add_u32 s11, s11, 65536
  s_mov_b32 s8, 0x00ff00ff
  s_mov_b32 s9, 0x00ff00ff
  s_mov_b32 s18, s3
  s_mov_b32 s51, 0
  s_mov_b32 s52, 0
  s_mov_b32 s53, 0
  s_cmp_eq_u32 s21, 1
  s_cbranch_scc1 Lwv_207
  s_cmp_eq_u32 s21, 2
  s_cbranch_scc1 Lwv_208
  s_cmp_eq_u32 s21, 3
  s_cbranch_scc1 Lwv_209
Lwv_206:
Llay_210:
  s_mov_b32 s22, 0
  v_add_u32 v126, s43, v117
  v_xor_b32 v127, 16, v126
  ds_read_b64_tr_b16 v[100:101], v126
  ds_read_b64_tr_b16 v[102:103], v127 offset:256
  v_subrev_u32 v126, s18, v124
  s_mov_b32 exec_lo, 0xcccccccc
  s_mov_b32 exec_hi, 0xcccccccc
  ds_read_b128 v[100:103], v126
  s_mov_b64 exec, -1
  ds_read_b128 v[56:59], v114 offset:0
  ds_read_b128 v[60:63], v114 offset:1024
  ds_read_b128 v[64:67], v114 offset:2048
  ds_read_b128 v[68:71], v114 offset:3072
  ds_read_b128 v[72:75], v114 offset:16384
  ds_read_b128 v[76:79], v114 offset:17408
  ds_read_b128 v[80:83], v114 offset:18432
  ds_read_b128 v[84:87], v114 offset:19456
  ds_read_b128 v[88:91], v114 offset:32768
  ds_read_b128 v[92:95], v114 offset:33792
  ds_read_b128 v[48:51], v114 offset:34816
  ds_read_b128 v[52:55], v114 offset:35840
  s_waitcnt lgkmcnt(0)
  v_add_u32 v126, 131072, v112
  buffer_load_dwordx4 v[0:3], v112, s[4:7], s23 offen offset:0 sc1
  buffer_load_dwordx4 v[4:7], v112, s[4:7], s23 offen offset:1024 sc1
  s_nop 15
  s_nop 15
  s_nop 1
  buffer_load_dwordx4 v[24:27], v112, s[4:7], s23 offen offset:0 sc1
  buffer_load_dwordx4 v[28:31], v112, s[4:7], s23 offen offset:1024 sc1
  s_mov_b32 s26, 0
  v_add_u32 v126, 139264, v112
  v_bfe_u32 v127, v113, 4, 1
  v_mul_u32_u24 v127, 2097152, v127
  v_lshlrev_b32 v127, 4, v127
  s_lshl_b32 s29, s21, 11
  v_add_u32 v127, s29, v127
  s_nop 1
Ldp_214:
  buffer_load_dword v125, v127, s[4:7], s37 offen offset:1024 sc1
  s_add_u32 s26, s26, 1
  s_cmp_gt_u32 s26, 8192
  s_cbranch_scc1 Ldp_215
  s_waitcnt vmcnt(0)
  v_cmp_eq_u32 vcc, -1, v125
  s_cbranch_vccnz Ldp_214
  s_mov_b32 m0, s39
  s_add_u32 s34, s34, 1
  buffer_load_dwordx4 v112, s[4:7], s37 offen sc1 lds
  buffer_load_dwordx4 v112, s[4:7], s37 offen offset:1024 sc1 lds
  s_add_u32 s37, s37, 0x40000
  s_mov_b32 m0, s40
  s_nop 0
  buffer_load_dwordx4 v112, s[4:7], s38 offen sc1 lds
  buffer_load_dwordx4 v112, s[4:7], s38 offen offset:1024 sc1 lds
  s_add_u32 s38, s38, 0x40000
  s_waitcnt vmcnt(0)
  ds_read_b128 v[32:35], v126 offset:0
  ds_read_b128 v[36:39], v126 offset:1024
  ds_read_b128 v[40:43], v126 offset:8192
  ds_read_b128 v[44:47], v126 offset:9216
  s_waitcnt lgkmcnt(0)
  v_max3_u32 v32, v32, v33, v34
  v_max3_u32 v32, v32, v35, v36
  v_max3_u32 v32, v32, v37, v38
  v_max3_u32 v32, v32, v39, v40
  v_max3_u32 v32, v32, v41, v42
  v_max3_u32 v32, v32, v43, v44
  v_max3_u32 v32, v32, v45, v46
  v_max_u32 v32, v32, v47
  v_cmp_eq_u32 vcc, -1, v32
  s_cbranch_vccz Ldp_216
  s_sub_u32 s34, s34, 1
  s_sub_u32 s37, s37, 0x40000
  s_sub_u32 s38, s38, 0x40000
  s_branch Ldp_214
Ldp_215:
  s_lshl_b32 s35, s34, 1
  s_or_b32 s35, s35, 3
  s_bitcmp1_b32 s34, 0
  s_cselect_b32 s30, s28, s27
  s_cmp_le_u32 s30, s35
  s_cbranch_scc1 Lkvs_218
Lkv_217:
  s_mov_b32 m0, s39
  s_add_u32 s34, s34, 1
  buffer_load_dwordx4 v112, s[4:7], s37 offen sc1 lds
  buffer_load_dwordx4 v112, s[4:7], s37 offen offset:1024 sc1 lds
  s_add_u32 s37, s37, 0x40000
  s_mov_b32 m0, s40
  s_nop 0
  buffer_load_dwordx4 v112, s[4:7], s38 offen sc1 lds
  buffer_load_dwordx4 v112, s[4:7], s38 offen offset:1024 sc1 lds
  s_add_u32 s38, s38, 0x40000
  s_waitcnt vmcnt(0)
Ldp_216:
  v_mov_b64 v[32:33], 0
  v_mov_b64 v[34:35], 0
  v_mov_b64 v[36:37], 0
  v_mov_b64 v[38:39], 0
  v_mov_b64 v[40:41], 0
  v_mov_b64 v[42:43], 0
  v_mov_b64 v[44:45], 0
  v_mov_b64 v[46:47], 0
  v_add_u32 v126, 131072, v112
  s_nop 0
  s_branch Lstep_211
.p2align 6
Lb4_212:
  ds_read_b128 v[56:59], v114 offset:0
  ds_read_b128 v[60:63], v114 offset:1024
  ds_read_b128 v[64:67], v114 offset:2048
  ds_read_b128 v[68:71], v114 offset:3072
  ds_read_b128 v[72:75], v114 offset:16384
  ds_read_b128 v[76:79], v114 offset:17408
  ds_read_b128 v[80:83], v114 offset:18432
  ds_read_b128 v[84:87], v114 offset:19456
  ds_read_b128 v[88:91], v114 offset:32768
  ds_read_b128 v[92:95], v114 offset:33792
  ds_read_b128 v[48:51], v114 offset:34816
  ds_read_b128 v[52:55], v114 offset:35840
  s_nop 15
  s_nop 15
  s_nop 15
  buffer_load_dwordx4 v[0:3], v110, s[4:7], 0 offen offset:0 sc1
  buffer_load_dwordx4 v[4:7], v110, s[4:7], 0 offen offset:2048 sc1
  buffer_load_dwordx4 v[8:11], v110, s[4:7], s32 offen offset:0 sc1
  buffer_load_dwordx4 v[12:15], v110, s[4:7], s32 offen offset:2048 sc1
  s_nop 15
  s_nop 15
  s_nop 1
  buffer_load_dwordx4 v[16:19], v110, s[4:7], 0 offen offset:0 sc1
  buffer_load_dwordx4 v[20:23], v110, s[4:7], 0 offen offset:2048 sc1
  buffer_load_dwordx4 v[24:27], v110, s[4:7], s32 offen offset:0 sc1
  buffer_load_dwordx4 v[28:31], v110, s[4:7], s32 offen offset:2048 sc1
  s_waitcnt vmcnt(7)
  v_mfma_f32_16x16x32_bf16 v[100:103], v[0:3], v[96:99], 0
  v_xor_b32 v126, s24, v0
  s_waitcnt vmcnt(6)
  v_mfma_f32_16x16x32_bf16 v[100:103], v[4:7], v[96:99], v[100:103]
  v_bitop3_b32 v126, v126, v4, s24 bitop3:0xf6
  s_waitcnt vmcnt(5)
  v_mfma_f32_16x16x32_bf16 v[100:103], v[8:11], v[96:99], v[100:103]
  v_bitop3_b32 v126, v126, v8, s24 bitop3:0xf6
  s_waitcnt vmcnt(4)
  v_mfma_f32_16x16x32_bf16 v[100:103], v[12:15], v[96:99], v[100:103]
  v_bitop3_b32 v126, v126, v12, s24 bitop3:0xf6
  v_and_b32 v126, 1, v126
  v_cmp_ne_u32 vcc, 0, v126
  s_nop 3
  s_cbranch_vccnz Lh1s_220
Lh1_219:
  v_permlane32_swap_b32 v100, v102
  v_permlane32_swap_b32 v101, v103
  v_pk_add_f32 v[100:101], v[100:101], v[102:103]
  v_cvt_pk_bf16_f32 v127, v100, v101
  buffer_store_dword v127, v111, s[4:7], s23 offen
  s_barrier
  v_add_u32 v126, s43, v117
  v_xor_b32 v127, 16, v126
  ds_read_b64_tr_b16 v[100:101], v126
  ds_read_b64_tr_b16 v[102:103], v127 offset:256
  v_subrev_u32 v126, s18, v124
  s_mov_b32 exec_lo, 0xcccccccc
  s_mov_b32 exec_hi, 0xcccccccc
  ds_read_b128 v[100:103], v126
  s_mov_b64 exec, -1
  v_mov_b64 v[32:33], 0
  v_mov_b64 v[34:35], 0
  v_mov_b64 v[36:37], 0
  v_mov_b64 v[38:39], 0
  v_mov_b64 v[40:41], 0
  v_mov_b64 v[42:43], 0
  v_mov_b64 v[44:45], 0
  v_mov_b64 v[46:47], 0
  s_xor_b32 s24, s24, 1
  s_waitcnt lgkmcnt(0)
  v_add_u32 v126, 131072, v112
  s_nop 15
  s_nop 11
  buffer_load_dwordx4 v[0:3], v112, s[4:7], s23 offen offset:0 sc1
  buffer_load_dwordx4 v[4:7], v112, s[4:7], s23 offen offset:1024 sc1
  s_nop 15
  s_nop 15
  s_nop 1
  buffer_load_dwordx4 v[24:27], v112, s[4:7], s23 offen offset:0 sc1
  buffer_load_dwordx4 v[28:31], v112, s[4:7], s23 offen offset:1024 sc1
  s_cmp_eq_u32 s22, 63
  s_cbranch_scc1 Llast_213
Lstep_211:
  s_waitcnt vmcnt(3)
  ds_write_b128 v126, v[0:3] offset:0
  s_waitcnt vmcnt(2)
  ds_write_b128 v126, v[4:7] offset:1024
  v_max3_u32 v127, v0, v1, v2
  v_max3_u32 v127, v127, v3, v4
  v_max3_u32 v127, v127, v5, v6
  v_max_u32 v127, v127, v7
  v_cmp_eq_u32 vcc, -1, v127
  s_cbranch_vccnz Lh2s_223
Lh2_222:
  v_smfmac_f32_16x16x64_bf16 v[32:35], v[0:3], v[56:63], v108
  v_smfmac_f32_16x16x64_bf16 v[36:39], v[0:3], v[64:71], v108
  s_waitcnt lgkmcnt(0)
  s_barrier
  ds_read_b128 v[8:11], v113 offset:2048
  ds_read_b128 v[12:15], v113 offset:3072
  v_smfmac_f32_16x16x64_bf16 v[32:35], v[4:7], v[72:79], v108
  ds_read_b128 v[16:19], v113 offset:4096
  v_smfmac_f32_16x16x64_bf16 v[36:39], v[4:7], v[80:87], v108
  ds_read_b128 v[20:23], v113 offset:5120
  v_smfmac_f32_16x16x64_bf16 v[40:43], v[0:3], a[0:7], v108
  s_waitcnt vmcnt(0)
  ds_read_b128 v[24:27], v113 offset:6144
  v_xor_b32 v127, 0x80, v119
  v_smfmac_f32_16x16x64_bf16 v[44:47], v[0:3], a[8:15], v108
  ds_read_b128 v[28:31], v113 offset:7168
  v_add_u32 v126, -2048, v122
  v_smfmac_f32_16x16x64_bf16 v[40:43], v[4:7], a[16:23], v108
  ds_read_b128 v[56:59], v114 offset:49152
  buffer_store_dwordx4 v[100:103], v124, s[4:7], s25 offen sc1
  s_add_u32 s25, s25, 65536
  buffer_load_dword v125, v123, s[4:7], s41 offen sc1
  v_smfmac_f32_16x16x64_bf16 v[44:47], v[4:7], a[24:31], v108
  ds_read_b128 v[60:63], v114 offset:50176
  s_waitcnt lgkmcnt(7)
  v_smfmac_f32_16x16x64_bf16 v[32:35], v[8:11], v[88:95], v108
  ds_read_b128 v[64:67], v115 offset:32768
  v_smfmac_f32_16x16x64_bf16 v[36:39], v[8:11], v[48:55], v108
  ds_read_b128 v[68:71], v115 offset:33792
  s_waitcnt lgkmcnt(8)
  v_smfmac_f32_16x16x64_bf16 v[36:39], v[12:15], a[128:135], v108
  ds_read_b128 v[72:75], v115 offset:34816
  s_waitcnt lgkmcnt(8)
  v_smfmac_f32_16x16x64_bf16 v[32:35], v[16:19], a[136:143], v108
  ds_read_b128 v[76:79], v115 offset:35840
  v_smfmac_f32_16x16x64_bf16 v[36:39], v[16:19], a[144:151], v108
  ds_read_b128 v[80:83], v115 offset:49152
  s_waitcnt lgkmcnt(9)
  v_smfmac_f32_16x16x64_bf16 v[32:35], v[20:23], a[152:159], v108
  ds_read_b128 v[84:87], v115 offset:50176
  v_smfmac_f32_16x16x64_bf16 v[36:39], v[20:23], a[160:167], v108
  ds_read_b128 v[88:91], v115 offset:51200
  s_waitcnt lgkmcnt(7)
  v_smfmac_f32_16x16x64_bf16 v[32:35], v[12:15], v[56:63], v108
  ds_read_b128 v[92:95], v115 offset:52224
  s_waitcnt lgkmcnt(6)
  v_smfmac_f32_16x16x64_bf16 v[32:35], v[24:27], v[64:71], v108
  ds_read_b128 v[56:59], v119 offset:0
  s_waitcnt lgkmcnt(5)
  v_smfmac_f32_16x16x64_bf16 v[36:39], v[24:27], v[72:79], v108
  ds_read_b128 v[60:63], v127 offset:0
  s_waitcnt lgkmcnt(4)
  v_smfmac_f32_16x16x64_bf16 v[32:35], v[28:31], v[80:87], v108
  ds_read_b128 v[64:67], v119 offset:2048
  s_waitcnt lgkmcnt(3)
  v_smfmac_f32_16x16x64_bf16 v[36:39], v[28:31], v[88:95], v108
  ds_read_b128 v[68:71], v127 offset:2048
  v_smfmac_f32_16x16x64_bf16 v[40:43], v[8:11], a[32:39], v108
  ds_read_b128 v[72:75], v119 offset:4096
  ds_read_b128 v[76:79], v127 offset:4096
  v_smfmac_f32_16x16x64_bf16 v[44:47], v[8:11], a[40:47], v108
  ds_read_b128 v[80:83], v119 offset:6144
  ds_read_b128 v[84:87], v127 offset:6144
  v_smfmac_f32_16x16x64_bf16 v[44:47], v[12:15], a[56:63], v108
  v_add_f32 v32, v32, v34
  v_add_f32 v33, v33, v35
  v_smfmac_f32_16x16x64_bf16 v[40:43], v[16:19], a[64:71], v108
  v_add_f32 v36, v36, v38
  v_add_f32 v37, v37, v39
  v_smfmac_f32_16x16x64_bf16 v[44:47], v[16:19], a[72:79], v108
  v_cvt_pk_bf16_f32 v34, v32, v33
  v_cvt_pk_bf16_f32 v35, v36, v37
  ds_write2_b32 v126, v34, v35 offset0:0 offset1:64
  v_smfmac_f32_16x16x64_bf16 v[40:43], v[20:23], a[80:87], v108
  v_smfmac_f32_16x16x64_bf16 v[44:47], v[20:23], a[88:95], v108
  v_smfmac_f32_16x16x64_bf16 v[40:43], v[12:15], a[48:55], v108
  v_smfmac_f32_16x16x64_bf16 v[40:43], v[24:27], a[96:103], v108
  s_waitcnt lgkmcnt(0)
  s_barrier
  ds_read_b64_tr_b16 v[32:33], v118 offset:0
  ds_read_b64_tr_b16 v[34:35], v118 offset:128
  v_smfmac_f32_16x16x64_bf16 v[44:47], v[24:27], a[104:111], v108
  ds_read_b64_tr_b16 v[36:37], v118 offset:512
  ds_read_b64_tr_b16 v[38:39], v118 offset:640
  v_smfmac_f32_16x16x64_bf16 v[40:43], v[28:31], a[112:119], v108
  ds_read_b64_tr_b16 v[48:49], v118 offset:1024
  ds_read_b64_tr_b16 v[50:51], v118 offset:1152
  v_smfmac_f32_16x16x64_bf16 v[44:47], v[28:31], a[120:127], v108
  ds_read_b64_tr_b16 v[52:53], v118 offset:1536
  ds_read_b64_tr_b16 v[54:55], v118 offset:1664
  v_xor_b32 v127, 16, v117
  s_waitcnt lgkmcnt(6)
  v_mfma_f32_16x16x32_bf16 v[88:91], v[56:59], v[32:35], 0
  v_mfma_f32_16x16x32_bf16 v[92:95], v[60:63], v[32:35], 0
  v_mov_b64 v[56:57], 0
  v_mov_b64 v[58:59], 0
  s_waitcnt lgkmcnt(4)
  v_mfma_f32_16x16x32_bf16 v[88:91], v[64:67], v[36:39], v[88:91]
  v_add_f32 v40, v40, v42
  v_add_f32 v41, v41, v43
  v_mfma_f32_16x16x32_bf16 v[92:95], v[68:71], v[36:39], v[92:95]
  v_add_f32 v44, v44, v46
  v_add_f32 v45, v45, v47
  s_waitcnt lgkmcnt(2)
  v_mfma_f32_16x16x32_bf16 v[88:91], v[72:75], v[48:51], v[88:91]
  v_mul_f32 v40, s44, v40
  v_mul_f32 v41, s44, v41
  v_mfma_f32_16x16x32_bf16 v[92:95], v[76:79], v[48:51], v[92:95]
  v_mul_f32 v44, s44, v44
  v_mul_f32 v45, s44, v45
  s_waitcnt lgkmcnt(0)
  v_mfma_f32_16x16x32_bf16 v[88:91], v[80:83], v[52:55], v[88:91]
  v_cvt_pk_bf16_f32 v42, v40, v41
  v_cvt_pk_bf16_f32 v43, v44, v45
  ds_write2_b32 v116, v42, v43 offset0:0 offset1:128
  v_mfma_f32_16x16x32_bf16 v[92:95], v[84:87], v[52:55], v[92:95]
  v_mov_b64 v[60:61], 0
  v_mov_b64 v[62:63], 0
  v_smfmac_f32_16x16x64_bf16 v[56:59], v[0:3], v[128:135], v108
  v_mov_b64 v[46:47], 0
  v_smfmac_f32_16x16x64_bf16 v[60:63], v[0:3], v[136:143], v108
  v_mov_b32 v45, 0
  v_smfmac_f32_16x16x64_bf16 v[56:59], v[4:7], v[144:151], v108
  v_max3_f32 v126, abs(v88), abs(v89), abs(v90)
  s_waitcnt lgkmcnt(0)
  s_barrier
  ds_read_b64_tr_b16 v[64:65], v117 offset:0
  ds_read_b64_tr_b16 v[66:67], v127 offset:256
  ds_read_b64_tr_b16 v[68:69], v117 offset:1024
  ds_read_b64_tr_b16 v[70:71], v127 offset:1280
  v_smfmac_f32_16x16x64_bf16 v[60:63], v[4:7], v[152:159], v108
  ds_read_b64_tr_b16 v[72:73], v117 offset:2048
  ds_read_b64_tr_b16 v[74:75], v127 offset:2304
  v_max3_f32 v126, v126, abs(v91), abs(v92)
  v_smfmac_f32_16x16x64_bf16 v[56:59], v[8:11], v[160:167], v108
  ds_read_b64_tr_b16 v[76:77], v117 offset:3072
  ds_read_b64_tr_b16 v[78:79], v127 offset:3328
  v_max3_f32 v126, v126, abs(v93), abs(v94)
  s_waitcnt lgkmcnt(6)
  v_mfma_f32_16x16x32_bf16 v[100:103], v[64:67], v[32:35], 0
  v_exp_f32 v80, v88
  s_waitcnt lgkmcnt(4)
  v_mfma_f32_16x16x32_bf16 v[100:103], v[68:71], v[36:39], v[100:103]
  v_exp_f32 v81, v89
  s_waitcnt lgkmcnt(2)
  v_mfma_f32_16x16x32_bf16 v[100:103], v[72:75], v[48:51], v[100:103]
  v_exp_f32 v82, v90
  s_waitcnt lgkmcnt(0)
  v_mfma_f32_16x16x32_bf16 v[100:103], v[76:79], v[52:55], v[100:103]
  v_exp_f32 v83, v91
  ds_read_b128 v[64:67], v120 offset:0
  ds_read_b128 v[68:71], v120 offset:256
  v_smfmac_f32_16x16x64_bf16 v[60:63], v[8:11], v[168:175], v108
  v_max_f32_e64 v126, v126, abs(v95)
  v_smfmac_f32_16x16x64_bf16 v[56:59], v[12:15], v[176:183], v108
  v_cvt_pk_bf16_f32 v40, v80, v81
  v_smfmac_f32_16x16x64_bf16 v[60:63], v[12:15], v[184:191], v108
  v_cvt_pk_bf16_f32 v41, v82, v83
  v_smfmac_f32_16x16x64_bf16 v[56:59], v[16:19], v[192:199], v108
  v_exp_f32 v84, v92
  v_smfmac_f32_16x16x64_bf16 v[60:63], v[16:19], v[200:207], v108
  v_exp_f32 v85, v93
  v_smfmac_f32_16x16x64_bf16 v[56:59], v[20:23], v[208:215], v108
  v_exp_f32 v86, v94
  v_smfmac_f32_16x16x64_bf16 v[60:63], v[20:23], v[216:223], v108
  v_exp_f32 v87, v95
  v_smfmac_f32_16x16x64_bf16 v[56:59], v[24:27], v[224:231], v108
  v_cvt_pk_bf16_f32 v42, v84, v85
  v_smfmac_f32_16x16x64_bf16 v[60:63], v[24:27], v[232:239], v108
  v_max3_f32 v126, v126, v100, v101
  v_smfmac_f32_16x16x64_bf16 v[56:59], v[28:31], v[240:247], v108
  v_cvt_pk_bf16_f32 v43, v86, v87
  v_smfmac_f32_16x16x64_bf16 v[60:63], v[28:31], v[248:255], v108
  v_cmp_nge_f32 vcc, 0x42700000, v126
  s_waitcnt lgkmcnt(0)
  v_mfma_f32_16x16x32_bf16 v[48:51], v[104:107], v[40:43], 0
  v_exp_f32 v80, v100
  v_mfma_f32_16x16x32_bf16 v[32:35], v[64:67], v[40:43], 0
  v_exp_f32 v81, v101
  v_mfma_f32_16x16x32_bf16 v[36:39], v[68:71], v[40:43], 0
  v_cvt_pk_bf16_f32 v44, v80, v81
  s_cbranch_vccnz Lfb_226
Lok_227:
  v_add_f32 v56, v56, v58
  v_add_f32 v57, v57, v59
  v_mfma_f32_16x16x32_bf16 v[48:51], v[104:107], v[44:47], v[48:51]
  v_add_f32 v60, v60, v62
  v_add_f32 v61, v61, v63
  v_cvt_pk_bf16_f32 v72, v56, v57
  v_cvt_pk_bf16_f32 v76, v60, v61
  s_nop 0
  v_mfma_f32_16x16x32_bf16 v[32:35], v[72:75], v[44:47], v[32:35]
  ds_write2_b32 v122, v72, v76 offset0:0 offset1:64
  v_mov_b64 v[0:1], 0
  v_mfma_f32_16x16x32_bf16 v[36:39], v[76:79], v[44:47], v[36:39]
  v_rcp_f32 v126, v48
  v_mov_b64 v[2:3], 0
  v_mov_b64 v[4:5], 0
  v_mov_b64 v[6:7], 0
  v_mov_b64 v[8:9], 0
  v_mov_b64 v[10:11], 0
  v_mov_b64 v[12:13], 0
  v_mov_b64 v[14:15], 0
  v_pk_mul_f32 v[32:33], v[32:33], v[126:127] op_sel_hi:[1,0]
  v_pk_mul_f32 v[34:35], v[34:35], v[126:127] op_sel_hi:[1,0]
  v_cvt_pk_bf16_f32 v40, v32, v33
  v_cvt_pk_bf16_f32 v41, v34, v35
  ds_write_b64 v121, v[40:41] offset:0
  v_pk_mul_f32 v[36:37], v[36:37], v[126:127] op_sel_hi:[1,0]
  v_pk_mul_f32 v[38:39], v[38:39], v[126:127] op_sel_hi:[1,0]
  v_cvt_pk_bf16_f32 v42, v36, v37
  v_cvt_pk_bf16_f32 v43, v38, v39
  ds_write_b64 v121, v[42:43] offset:256
  v_mov_b64 v[16:17], 0
  v_mov_b64 v[18:19], 0
  v_mov_b64 v[20:21], 0
  v_mov_b64 v[22:23], 0
  v_mov_b64 v[24:25], 0
  v_mov_b64 v[26:27], 0
  v_mov_b64 v[28:29], 0
  v_mov_b64 v[30:31], 0
  s_waitcnt lgkmcnt(0)
  s_barrier
  ds_read_b128 v[48:51], v113 offset:28672
  ds_read_b128 v[52:55], v113 offset:29696
  s_mov_b32 m0, s39
  s_add_u32 s34, s34, 1
  buffer_load_dwordx4 v112, s[4:7], s37 offen sc1 lds
  s_waitcnt lgkmcnt(1)
  v_smfmac_f32_16x16x64_bf16 v[0:3], v[48:51], a[168:175], v108
  ds_read_b128 v[88:91], v114 offset:51200
  buffer_load_dwordx4 v112, s[4:7], s37 offen offset:1024 sc1 lds
  s_add_u32 s37, s37, 0x40000
  s_waitcnt lgkmcnt(1)
  v_smfmac_f32_16x16x64_bf16 v[0:3], v[52:55], a[176:183], v108
  ds_read_b128 v[92:95], v114 offset:52224
  s_mov_b32 m0, s40
  s_nop 0
  buffer_load_dwordx4 v112, s[4:7], s38 offen sc1 lds
  v_smfmac_f32_16x16x64_bf16 v[4:7], v[48:51], a[184:191], v108
  ds_read_b128 v[80:83], v115 offset:0
  buffer_load_dwordx4 v112, s[4:7], s38 offen offset:1024 sc1 lds
  s_add_u32 s38, s38, 0x40000
  v_smfmac_f32_16x16x64_bf16 v[4:7], v[52:55], a[192:199], v108
  ds_read_b128 v[84:87], v115 offset:1024
  v_smfmac_f32_16x16x64_bf16 v[8:11], v[48:51], a[200:207], v108
  ds_read_b128 v[72:75], v115 offset:2048
  v_add_f32 v0, v0, v2
  v_smfmac_f32_16x16x64_bf16 v[8:11], v[52:55], a[208:215], v108
  ds_read_b128 v[76:79], v115 offset:3072
  v_add_f32 v1, v1, v3
  v_smfmac_f32_16x16x64_bf16 v[12:15], v[48:51], a[216:223], v108
  ds_read_b128 v[56:59], v115 offset:16384
  v_cvt_pk_bf16_f32 v32, v0, v1
  v_smfmac_f32_16x16x64_bf16 v[12:15], v[52:55], a[224:231], v108
  ds_read_b128 v[60:63], v115 offset:17408
  v_and_or_b32 v32, v32, -2, s24
  v_add_f32 v4, v4, v6
  v_smfmac_f32_16x16x64_bf16 v[16:19], v[48:51], a[232:239], v108
  ds_read_b128 v[64:67], v115 offset:18432
  v_add_f32 v5, v5, v7
  v_smfmac_f32_16x16x64_bf16 v[16:19], v[52:55], a[240:247], v108
  ds_read_b128 v[68:71], v115 offset:19456
  v_cvt_pk_bf16_f32 v33, v4, v5
  v_add_f32 v8, v8, v10
  v_smfmac_f32_16x16x64_bf16 v[20:23], v[48:51], a[248:255], v108
  v_add_f32 v9, v9, v11
  s_waitcnt lgkmcnt(8)
  v_smfmac_f32_16x16x64_bf16 v[20:23], v[52:55], v[88:95], v108
  v_cvt_pk_bf16_f32 v34, v8, v9
  v_add_f32 v12, v12, v14
  s_waitcnt lgkmcnt(6)
  v_smfmac_f32_16x16x64_bf16 v[24:27], v[48:51], v[80:87], v108
  v_add_f32 v13, v13, v15
  v_cvt_pk_bf16_f32 v35, v12, v13
  s_waitcnt lgkmcnt(4)
  v_smfmac_f32_16x16x64_bf16 v[24:27], v[52:55], v[72:79], v108
  buffer_store_dwordx4 v[32:35], v109, s[4:7], 0 offen
  v_add_f32 v16, v16, v18
  s_waitcnt lgkmcnt(2)
  v_smfmac_f32_16x16x64_bf16 v[28:31], v[48:51], v[56:63], v108
  v_add_f32 v17, v17, v19
  v_cvt_pk_bf16_f32 v36, v16, v17
  s_waitcnt lgkmcnt(0)
  v_smfmac_f32_16x16x64_bf16 v[28:31], v[52:55], v[64:71], v108
  v_and_or_b32 v36, v36, -2, s24
  v_add_f32 v20, v20, v22
  v_add_f32 v21, v21, v23
  v_cvt_pk_bf16_f32 v37, v20, v21
  v_add_f32 v24, v24, v26
  v_add_f32 v25, v25, v27
  v_cvt_pk_bf16_f32 v38, v24, v25
  s_nop 0
  v_add_f32 v28, v28, v30
  v_add_f32 v29, v29, v31
  v_cvt_pk_bf16_f32 v39, v28, v29
  buffer_store_dwordx4 v[36:39], v109, s[4:7], s31 offen
  s_add_u32 s23, s23, 8192
  s_add_u32 s22, s22, 1
  s_mov_b32 s26, 0
  s_add_u32 s41, s41, s42
  s_branch Lb4_212
Llast_213:
  s_waitcnt vmcnt(3)
  ds_write_b128 v126, v[0:3] offset:0
  s_waitcnt vmcnt(2)
  ds_write_b128 v126, v[4:7] offset:1024
  v_max3_u32 v127, v0, v1, v2
  v_max3_u32 v127, v127, v3, v4
  v_max3_u32 v127, v127, v5, v6
  v_max_u32 v127, v127, v7
  v_cmp_eq_u32 vcc, -1, v127
  s_cbranch_vccnz Lh2s_229
Lh2_228:
Llast_213x:
  v_smfmac_f32_16x16x64_bf16 v[40:43], v[0:3], a[0:7], v108
  v_smfmac_f32_16x16x64_bf16 v[44:47], v[0:3], a[8:15], v108
  s_waitcnt lgkmcnt(0)
  s_barrier
  buffer_store_dwordx4 v[100:103], v124, s[4:7], s25 offen sc1
  s_add_u32 s25, s25, 65536
  buffer_load_dword v125, v123, s[4:7], s41 offen sc1
  ds_read_b128 v[8:11], v113 offset:2048
  ds_read_b128 v[12:15], v113 offset:3072
  ds_read_b128 v[16:19], v113 offset:4096
  ds_read_b128 v[20:23], v113 offset:5120
  s_waitcnt vmcnt(2)
  ds_read_b128 v[24:27], v113 offset:6144
  ds_read_b128 v[28:31], v113 offset:7168
  v_smfmac_f32_16x16x64_bf16 v[40:43], v[4:7], a[16:23], v108
  v_smfmac_f32_16x16x64_bf16 v[44:47], v[4:7], a[24:31], v108
  s_waitcnt lgkmcnt(5)
  v_smfmac_f32_16x16x64_bf16 v[40:43], v[8:11], a[32:39], v108
  v_smfmac_f32_16x16x64_bf16 v[44:47], v[8:11], a[40:47], v108
  s_waitcnt lgkmcnt(4)
  v_smfmac_f32_16x16x64_bf16 v[44:47], v[12:15], a[56:63], v108
  s_waitcnt lgkmcnt(3)
  v_smfmac_f32_16x16x64_bf16 v[40:43], v[16:19], a[64:71], v108
  v_smfmac_f32_16x16x64_bf16 v[44:47], v[16:19], a[72:79], v108
  s_waitcnt lgkmcnt(2)
  v_smfmac_f32_16x16x64_bf16 v[40:43], v[20:23], a[80:87], v108
  v_smfmac_f32_16x16x64_bf16 v[44:47], v[20:23], a[88:95], v108
  v_smfmac_f32_16x16x64_bf16 v[40:43], v[12:15], a[48:55], v108
  s_waitcnt lgkmcnt(1)
  v_smfmac_f32_16x16x64_bf16 v[40:43], v[24:27], a[96:103], v108
  v_smfmac_f32_16x16x64_bf16 v[44:47], v[24:27], a[104:111], v108
  s_waitcnt lgkmcnt(0)
  v_smfmac_f32_16x16x64_bf16 v[40:43], v[28:31], a[112:119], v108
  v_smfmac_f32_16x16x64_bf16 v[44:47], v[28:31], a[120:127], v108
  v_mov_b64 v[56:57], 0
  v_mov_b64 v[58:59], 0
  v_mov_b64 v[60:61], 0
  v_mov_b64 v[62:63], 0
  v_smfmac_f32_16x16x64_bf16 v[56:59], v[0:3], v[128:135], v108
  s_nop 0
  v_smfmac_f32_16x16x64_bf16 v[60:63], v[0:3], v[136:143], v108
  v_add_f32 v40, v40, v42
  v_add_f32 v41, v41, v43
  v_add_f32 v44, v44, v46
  v_add_f32 v45, v45, v47
  v_mul_f32 v40, s44, v40
  v_mul_f32 v41, s44, v41
  v_mul_f32 v44, s44, v44
  v_mul_f32 v45, s44, v45
  v_cvt_pk_bf16_f32 v42, v40, v41
  v_cvt_pk_bf16_f32 v43, v44, v45
  ds_write2_b32 v116, v42, v43 offset0:0 offset1:128
  v_smfmac_f32_16x16x64_bf16 v[56:59], v[4:7], v[144:151], v108
  v_smfmac_f32_16x16x64_bf16 v[60:63], v[4:7], v[152:159], v108
  v_smfmac_f32_16x16x64_bf16 v[56:59], v[8:11], v[160:167], v108
  v_smfmac_f32_16x16x64_bf16 v[60:63], v[8:11], v[168:175], v108
  v_smfmac_f32_16x16x64_bf16 v[56:59], v[12:15], v[176:183], v108
  v_smfmac_f32_16x16x64_bf16 v[60:63], v[12:15], v[184:191], v108
  v_smfmac_f32_16x16x64_bf16 v[56:59], v[16:19], v[192:199], v108
  v_smfmac_f32_16x16x64_bf16 v[60:63], v[16:19], v[200:207], v108
  v_smfmac_f32_16x16x64_bf16 v[56:59], v[20:23], v[208:215], v108
  v_smfmac_f32_16x16x64_bf16 v[60:63], v[20:23], v[216:223], v108
  v_smfmac_f32_16x16x64_bf16 v[56:59], v[24:27], v[224:231], v108
  v_smfmac_f32_16x16x64_bf16 v[60:63], v[24:27], v[232:239], v108
  v_smfmac_f32_16x16x64_bf16 v[56:59], v[28:31], v[240:247], v108
  v_smfmac_f32_16x16x64_bf16 v[60:63], v[28:31], v[248:255], v108
  s_nop 6
  v_add_f32 v56, v56, v58
  v_add_f32 v57, v57, v59
  v_add_f32 v60, v60, v62
  v_add_f32 v61, v61, v63
  v_cvt_pk_bf16_f32 v72, v56, v57
  v_cvt_pk_bf16_f32 v76, v60, v61
  ds_write2_b32 v122, v72, v76 offset0:0 offset1:64
  s_waitcnt lgkmcnt(0)
  s_add_u32 s23, s23, 8192
  s_add_u32 s22, s22, 1
  s_mov_b32 s26, 0
  s_add_u32 s41, s41, s42
  v_add_u32 v126, s43, v117
  v_xor_b32 v127, 16, v126
  ds_read_b64_tr_b16 v[100:101], v126
  ds_read_b64_tr_b16 v[102:103], v127 offset:256
  v_subrev_u32 v126, s18, v124
  s_mov_b32 exec_lo, 0xcccccccc
  s_mov_b32 exec_hi, 0xcccccccc
  ds_read_b128 v[100:103], v126
  s_mov_b64 exec, -1
  s_waitcnt lgkmcnt(0)
  buffer_store_dwordx4 v[100:103], v124, s[4:7], s25 offen sc1
  s_add_u32 s25, s25, 65536
  s_sub_u32 s25, s25, 65536
  s_waitcnt vmcnt(0)
  s_barrier
  s_cmp_lt_u32 s23, 2097152
  s_cbranch_scc1 Llay_210
  s_branch Lfin_188
Lwv_207:
Llay_232:
  s_mov_b32 s22, 0
  v_add_u32 v126, s43, v117
  v_xor_b32 v127, 16, v126
  ds_read_b64_tr_b16 v[100:101], v126
  ds_read_b64_tr_b16 v[102:103], v127 offset:256
  v_subrev_u32 v126, s18, v124
  s_mov_b32 exec_lo, 0xcccccccc
  s_mov_b32 exec_hi, 0xcccccccc
  ds_read_b128 v[100:103], v126
  s_mov_b64 exec, -1
  ds_read_b128 v[56:59], v114 offset:0
  ds_read_b128 v[60:63], v114 offset:1024
  ds_read_b128 v[64:67], v114 offset:2048
  ds_read_b128 v[68:71], v114 offset:3072
  ds_read_b128 v[72:75], v114 offset:16384
  ds_read_b128 v[76:79], v114 offset:17408
  ds_read_b128 v[80:83], v114 offset:18432
  ds_read_b128 v[84:87], v114 offset:19456
  ds_read_b128 v[88:91], v114 offset:32768
  ds_read_b128 v[92:95], v114 offset:33792
  ds_read_b128 v[48:51], v114 offset:34816
  ds_read_b128 v[52:55], v114 offset:35840
  s_waitcnt lgkmcnt(0)
  v_add_u32 v126, 131072, v112
  buffer_load_dwordx4 v[8:11], v112, s[4:7], s23 offen offset:0 sc1
  buffer_load_dwordx4 v[12:15], v112, s[4:7], s23 offen offset:1024 sc1
  s_nop 15
  s_nop 15
  s_nop 1
  buffer_load_dwordx4 v[0:3], v112, s[4:7], s23 offen offset:0 sc1
  buffer_load_dwordx4 v[4:7], v112, s[4:7], s23 offen offset:1024 sc1
  s_mov_b32 s26, 0
  v_add_u32 v126, 139264, v112
  v_bfe_u32 v127, v113, 4, 1
  v_mul_u32_u24 v127, 2097152, v127
  v_lshlrev_b32 v127, 4, v127
  s_lshl_b32 s29, s21, 11
  v_add_u32 v127, s29, v127
  s_nop 1
Ldp_236:
  buffer_load_dword v125, v127, s[4:7], s37 offen offset:1024 sc1
  s_add_u32 s26, s26, 1
  s_cmp_gt_u32 s26, 8192
  s_cbranch_scc1 Ldp_237
  s_waitcnt vmcnt(0)
  v_cmp_eq_u32 vcc, -1, v125
  s_cbranch_vccnz Ldp_236
  s_mov_b32 m0, s39
  s_add_u32 s34, s34, 1
  buffer_load_dwordx4 v112, s[4:7], s37 offen sc1 lds
  buffer_load_dwordx4 v112, s[4:7], s37 offen offset:1024 sc1 lds
  s_add_u32 s37, s37, 0x40000
  s_mov_b32 m0, s40
  s_nop 0
  buffer_load_dwordx4 v112, s[4:7], s38 offen sc1 lds
  buffer_load_dwordx4 v112, s[4:7], s38 offen offset:1024 sc1 lds
  s_add_u32 s38, s38, 0x40000
  s_waitcnt vmcnt(0)
  ds_read_b128 v[32:35], v126 offset:0
  ds_read_b128 v[36:39], v126 offset:1024
  ds_read_b128 v[40:43], v126 offset:8192
  ds_read_b128 v[44:47], v126 offset:9216
  s_waitcnt lgkmcnt(0)
  v_max3_u32 v32, v32, v33, v34
  v_max3_u32 v32, v32, v35, v36
  v_max3_u32 v32, v32, v37, v38
  v_max3_u32 v32, v32, v39, v40
  v_max3_u32 v32, v32, v41, v42
  v_max3_u32 v32, v32, v43, v44
  v_max3_u32 v32, v32, v45, v46
  v_max_u32 v32, v32, v47
  v_cmp_eq_u32 vcc, -1, v32
  s_cbranch_vccz Ldp_238
  s_sub_u32 s34, s34, 1
  s_sub_u32 s37, s37, 0x40000
  s_sub_u32 s38, s38, 0x40000
  s_branch Ldp_236
Ldp_237:
  s_lshl_b32 s35, s34, 1
  s_or_b32 s35, s35, 3
  s_bitcmp1_b32 s34, 0
  s_cselect_b32 s30, s28, s27
  s_cmp_le_u32 s30, s35
  s_cbranch_scc1 Lkvs_240
Lkv_239:
  s_mov_b32 m0, s39
  s_add_u32 s34, s34, 1
  buffer_load_dwordx4 v112, s[4:7], s37 offen sc1 lds
  buffer_load_dwordx4 v112, s[4:7], s37 offen offset:1024 sc1 lds
  s_add_u32 s37, s37, 0x40000
  s_mov_b32 m0, s40
  s_nop 0
  buffer_load_dwordx4 v112, s[4:7], s38 offen sc1 lds
  buffer_load_dwordx4 v112, s[4:7], s38 offen offset:1024 sc1 lds
  s_add_u32 s38, s38, 0x40000
  s_waitcnt vmcnt(0)
Ldp_238:
  v_mov_b64 v[32:33], 0
  v_mov_b64 v[34:35], 0
  v_mov_b64 v[36:37], 0
  v_mov_b64 v[38:39], 0
  v_mov_b64 v[40:41], 0
  v_mov_b64 v[42:43], 0
  v_mov_b64 v[44:45], 0
  v_mov_b64 v[46:47], 0
  v_add_u32 v126, 131072, v112
  s_nop 0
  s_branch Lstep_233
.p2align 6
Lb4_234:
  ds_read_b128 v[56:59], v114 offset:0
  ds_read_b128 v[60:63], v114 offset:1024
  ds_read_b128 v[64:67], v114 offset:2048
  ds_read_b128 v[68:71], v114 offset:3072
  ds_read_b128 v[72:75], v114 offset:16384
  ds_read_b128 v[76:79], v114 offset:17408
  ds_read_b128 v[80:83], v114 offset:18432
  ds_read_b128 v[84:87], v114 offset:19456
  ds_read_b128 v[88:91], v114 offset:32768
  ds_read_b128 v[92:95], v114 offset:33792
  ds_read_b128 v[48:51], v114 offset:34816
  ds_read_b128 v[52:55], v114 offset:35840
  s_nop 15
  s_nop 15
  s_nop 15
  buffer_load_dwordx4 v[0:3], v110, s[4:7], 0 offen offset:0 sc1
  buffer_load_dwordx4 v[4:7], v110, s[4:7], 0 offen offset:2048 sc1
  buffer_load_dwordx4 v[8:11], v110, s[4:7], s32 offen offset:0 sc1
  buffer_load_dwordx4 v[12:15], v110, s[4:7], s32 offen offset:2048 sc1
  s_nop 15
  s_nop 15
  s_nop 1
  buffer_load_dwordx4 v[16:19], v110, s[4:7], 0 offen offset:0 sc1
  buffer_load_dwordx4 v[20:23], v110, s[4:7], 0 offen offset:2048 sc1
  buffer_load_dwordx4 v[24:27], v110, s[4:7], s32 offen offset:0 sc1
  buffer_load_dwordx4 v[28:31], v110, s[4:7], s32 offen offset:2048 sc1
  s_waitcnt vmcnt(7)
  v_mfma_f32_16x16x32_bf16 v[100:103], v[0:3], v[96:99], 0
  v_xor_b32 v126, s24, v0
  s_waitcnt vmcnt(6)
  v_mfma_f32_16x16x32_bf16 v[100:103], v[4:7], v[96:99], v[100:103]
  v_bitop3_b32 v126, v126, v4, s24 bitop3:0xf6
  s_waitcnt vmcnt(5)
  v_mfma_f32_16x16x32_bf16 v[100:103], v[8:11], v[96:99], v[100:103]
  v_bitop3_b32 v126, v126, v8, s24 bitop3:0xf6
  s_waitcnt vmcnt(4)
  v_mfma_f32_16x16x32_bf16 v[100:103], v[12:15], v[96:99], v[100:103]
  v_bitop3_b32 v126, v126, v12, s24 bitop3:0xf6
  v_and_b32 v126, 1, v126
  v_cmp_ne_u32 vcc, 0, v126
  s_nop 3
  s_cbranch_vccnz Lh1s_242
Lh1_241:
  v_permlane32_swap_b32 v100, v102
  v_permlane32_swap_b32 v101, v103
  v_pk_add_f32 v[100:101], v[100:101], v[102:103]
  v_cvt_pk_bf16_f32 v127, v100, v101
  buffer_store_dword v127, v111, s[4:7], s23 offen
  s_barrier
  v_add_u32 v126, s43, v117
  v_xor_b32 v127, 16, v126
  ds_read_b64_tr_b16 v[100:101], v126
  ds_read_b64_tr_b16 v[102:103], v127 offset:256
  v_subrev_u32 v126, s18, v124
  s_mov_b32 exec_lo, 0xcccccccc
  s_mov_b32 exec_hi, 0xcccccccc
  ds_read_b128 v[100:103], v126
  s_mov_b64 exec, -1
  v_mov_b64 v[32:33], 0
  v_mov_b64 v[34:35], 0
  v_mov_b64 v[36:37], 0
  v_mov_b64 v[38:39], 0
  v_mov_b64 v[40:41], 0
  v_mov_b64 v[42:43], 0
  v_mov_b64 v[44:45], 0
  v_mov_b64 v[46:47], 0
  s_xor_b32 s24, s24, 1
  s_waitcnt lgkmcnt(0)
  v_add_u32 v126, 131072, v112
  s_nop 15
  s_nop 11
  buffer_load_dwordx4 v[8:11], v112, s[4:7], s23 offen offset:0 sc1
  buffer_load_dwordx4 v[12:15], v112, s[4:7], s23 offen offset:1024 sc1
  s_nop 15
  s_nop 15
  s_nop 1
  buffer_load_dwordx4 v[0:3], v112, s[4:7], s23 offen offset:0 sc1
  buffer_load_dwordx4 v[4:7], v112, s[4:7], s23 offen offset:1024 sc1
  s_cmp_eq_u32 s22, 63
  s_cbranch_scc1 Llast_235
Lstep_233:
  s_waitcnt vmcnt(3)
  ds_write_b128 v126, v[8:11] offset:0
  s_waitcnt vmcnt(2)
  ds_write_b128 v126, v[12:15] offset:1024
  v_max3_u32 v127, v8, v9, v10
  v_max3_u32 v127, v127, v11, v12
  v_max3_u32 v127, v127, v13, v14
  v_max_u32 v127, v127, v15
  v_cmp_eq_u32 vcc, -1, v127
  s_cbranch_vccnz Lh2s_245
Lh2_244:
  v_smfmac_f32_16x16x64_bf16 v[32:35], v[8:11], v[56:63], v108
  v_smfmac_f32_16x16x64_bf16 v[36:39], v[8:11], v[64:71], v108
  s_waitcnt lgkmcnt(0)
  s_barrier
  ds_read_b128 v[16:19], v113 offset:4096
  ds_read_b128 v[20:23], v113 offset:5120
  v_smfmac_f32_16x16x64_bf16 v[32:35], v[12:15], v[72:79], v108
  ds_read_b128 v[24:27], v113 offset:6144
  v_smfmac_f32_16x16x64_bf16 v[36:39], v[12:15], v[80:87], v108
  ds_read_b128 v[28:31], v113 offset:7168
  v_smfmac_f32_16x16x64_bf16 v[40:43], v[8:11], a[32:39], v108
  s_waitcnt vmcnt(0)
  ds_read_b128 v[0:3], v113 offset:0
  v_xor_b32 v127, 0x80, v119
  v_smfmac_f32_16x16x64_bf16 v[44:47], v[8:11], a[40:47], v108
  ds_read_b128 v[4:7], v113 offset:1024
  v_add_u32 v126, -2048, v122
  v_smfmac_f32_16x16x64_bf16 v[40:43], v[12:15], a[48:55], v108
  ds_read_b128 v[56:59], v114 offset:49152
  buffer_store_dwordx4 v[100:103], v124, s[4:7], s25 offen sc1
  s_add_u32 s25, s25, 65536
  buffer_load_dword v125, v123, s[4:7], s41 offen sc1
  v_smfmac_f32_16x16x64_bf16 v[44:47], v[12:15], a[56:63], v108
  ds_read_b128 v[60:63], v114 offset:50176
  s_waitcnt lgkmcnt(7)
  v_smfmac_f32_16x16x64_bf16 v[32:35], v[16:19], v[88:95], v108
  ds_read_b128 v[64:67], v115 offset:32768
  v_smfmac_f32_16x16x64_bf16 v[36:39], v[16:19], v[48:55], v108
  ds_read_b128 v[68:71], v115 offset:33792
  s_waitcnt lgkmcnt(8)
  v_smfmac_f32_16x16x64_bf16 v[36:39], v[20:23], a[128:135], v108
  ds_read_b128 v[72:75], v115 offset:34816
  s_waitcnt lgkmcnt(8)
  v_smfmac_f32_16x16x64_bf16 v[32:35], v[24:27], a[136:143], v108
  ds_read_b128 v[76:79], v115 offset:35840
  v_smfmac_f32_16x16x64_bf16 v[36:39], v[24:27], a[144:151], v108
  ds_read_b128 v[80:83], v115 offset:49152
  s_waitcnt lgkmcnt(9)
  v_smfmac_f32_16x16x64_bf16 v[32:35], v[28:31], a[152:159], v108
  ds_read_b128 v[84:87], v115 offset:50176
  v_smfmac_f32_16x16x64_bf16 v[36:39], v[28:31], a[160:167], v108
  ds_read_b128 v[88:91], v115 offset:51200
  s_waitcnt lgkmcnt(7)
  v_smfmac_f32_16x16x64_bf16 v[32:35], v[20:23], v[56:63], v108
  ds_read_b128 v[92:95], v115 offset:52224
  s_waitcnt lgkmcnt(6)
  v_smfmac_f32_16x16x64_bf16 v[32:35], v[0:3], v[64:71], v108
  ds_read_b128 v[56:59], v119 offset:0
  s_waitcnt lgkmcnt(5)
  v_smfmac_f32_16x16x64_bf16 v[36:39], v[0:3], v[72:79], v108
  ds_read_b128 v[60:63], v127 offset:0
  s_waitcnt lgkmcnt(4)
  v_smfmac_f32_16x16x64_bf16 v[32:35], v[4:7], v[80:87], v108
  ds_read_b128 v[64:67], v119 offset:2048
  s_waitcnt lgkmcnt(3)
  v_smfmac_f32_16x16x64_bf16 v[36:39], v[4:7], v[88:95], v108
  ds_read_b128 v[68:71], v127 offset:2048
  v_smfmac_f32_16x16x64_bf16 v[40:43], v[16:19], a[64:71], v108
  ds_read_b128 v[72:75], v119 offset:4096
  ds_read_b128 v[76:79], v127 offset:4096
  v_smfmac_f32_16x16x64_bf16 v[44:47], v[16:19], a[72:79], v108
  ds_read_b128 v[80:83], v119 offset:6144
  ds_read_b128 v[84:87], v127 offset:6144
  v_smfmac_f32_16x16x64_bf16 v[44:47], v[20:23], a[88:95], v108
  v_add_f32 v32, v32, v34
  v_add_f32 v33, v33, v35
  v_smfmac_f32_16x16x64_bf16 v[40:43], v[24:27], a[96:103], v108
  v_add_f32 v36, v36, v38
  v_add_f32 v37, v37, v39
  v_smfmac_f32_16x16x64_bf16 v[44:47], v[24:27], a[104:111], v108
  v_cvt_pk_bf16_f32 v34, v32, v33
  v_cvt_pk_bf16_f32 v35, v36, v37
  ds_write2_b32 v126, v34, v35 offset0:0 offset1:64
  v_smfmac_f32_16x16x64_bf16 v[40:43], v[28:31], a[112:119], v108
  v_smfmac_f32_16x16x64_bf16 v[44:47], v[28:31], a[120:127], v108
  v_smfmac_f32_16x16x64_bf16 v[40:43], v[20:23], a[80:87], v108
  v_smfmac_f32_16x16x64_bf16 v[40:43], v[0:3], a[0:7], v108
  s_waitcnt lgkmcnt(0)
  s_barrier
  ds_read_b64_tr_b16 v[32:33], v118 offset:0
  ds_read_b64_tr_b16 v[34:35], v118 offset:128
  v_smfmac_f32_16x16x64_bf16 v[44:47], v[0:3], a[8:15], v108
  ds_read_b64_tr_b16 v[36:37], v118 offset:512
  ds_read_b64_tr_b16 v[38:39], v118 offset:640
  v_smfmac_f32_16x16x64_bf16 v[40:43], v[4:7], a[16:23], v108
  ds_read_b64_tr_b16 v[48:49], v118 offset:1024
  ds_read_b64_tr_b16 v[50:51], v118 offset:1152
  v_smfmac_f32_16x16x64_bf16 v[44:47], v[4:7], a[24:31], v108
  ds_read_b64_tr_b16 v[52:53], v118 offset:1536
  ds_read_b64_tr_b16 v[54:55], v118 offset:1664
  v_xor_b32 v127, 16, v117
  s_waitcnt lgkmcnt(6)
  v_mfma_f32_16x16x32_bf16 v[88:91], v[56:59], v[32:35], 0
  v_mfma_f32_16x16x32_bf16 v[92:95], v[60:63], v[32:35], 0
  v_mov_b64 v[56:57], 0
  v_mov_b64 v[58:59], 0
  s_waitcnt lgkmcnt(4)
  v_mfma_f32_16x16x32_bf16 v[88:91], v[64:67], v[36:39], v[88:91]
  v_add_f32 v40, v40, v42
  v_add_f32 v41, v41, v43
  v_mfma_f32_16x16x32_bf16 v[92:95], v[68:71], v[36:39], v[92:95]
  v_add_f32 v44, v44, v46
  v_add_f32 v45, v45, v47
  s_waitcnt lgkmcnt(2)
  v_mfma_f32_16x16x32_bf16 v[88:91], v[72:75], v[48:51], v[88:91]
  v_mul_f32 v40, s44, v40
  v_mul_f32 v41, s44, v41
  v_mfma_f32_16x16x32_bf16 v[92:95], v[76:79], v[48:51], v[92:95]
  v_mul_f32 v44, s44, v44
  v_mul_f32 v45, s44, v45
  s_waitcnt lgkmcnt(0)
  v_mfma_f32_16x16x32_bf16 v[88:91], v[80:83], v[52:55], v[88:91]
  v_cvt_pk_bf16_f32 v42, v40, v41
  v_cvt_pk_bf16_f32 v43, v44, v45
  ds_write2_b32 v116, v42, v43 offset0:0 offset1:128
  v_mfma_f32_16x16x32_bf16 v[92:95], v[84:87], v[52:55], v[92:95]
  v_mov_b64 v[60:61], 0
  v_mov_b64 v[62:63], 0
  v_smfmac_f32_16x16x64_bf16 v[56:59], v[0:3], v[128:135], v108
  v_mov_b64 v[46:47], 0
  v_smfmac_f32_16x16x64_bf16 v[60:63], v[0:3], v[136:143], v108
  v_mov_b32 v45, 0
  v_smfmac_f32_16x16x64_bf16 v[56:59], v[4:7], v[144:151], v108
  v_max3_f32 v126, abs(v88), abs(v89), abs(v90)
  s_waitcnt lgkmcnt(0)
  s_barrier
  ds_read_b64_tr_b16 v[64:65], v117 offset:0
  ds_read_b64_tr_b16 v[66:67], v127 offset:256
  ds_read_b64_tr_b16 v[68:69], v117 offset:1024
  ds_read_b64_tr_b16 v[70:71], v127 offset:1280
  v_smfmac_f32_16x16x64_bf16 v[60:63], v[4:7], v[152:159], v108
  ds_read_b64_tr_b16 v[72:73], v117 offset:2048
  ds_read_b64_tr_b16 v[74:75], v127 offset:2304
  v_max3_f32 v126, v126, abs(v91), abs(v92)
  v_smfmac_f32_16x16x64_bf16 v[56:59], v[8:11], v[160:167], v108
  ds_read_b64_tr_b16 v[76:77], v117 offset:3072
  ds_read_b64_tr_b16 v[78:79], v127 offset:3328
  v_max3_f32 v126, v126, abs(v93), abs(v94)
  s_waitcnt lgkmcnt(6)
  v_mfma_f32_16x16x32_bf16 v[100:103], v[64:67], v[32:35], 0
  v_exp_f32 v80, v88
  s_waitcnt lgkmcnt(4)
  v_mfma_f32_16x16x32_bf16 v[100:103], v[68:71], v[36:39], v[100:103]
  v_exp_f32 v81, v89
  s_waitcnt lgkmcnt(2)
  v_mfma_f32_16x16x32_bf16 v[100:103], v[72:75], v[48:51], v[100:103]
  v_exp_f32 v82, v90
  s_waitcnt lgkmcnt(0)
  v_mfma_f32_16x16x32_bf16 v[100:103], v[76:79], v[52:55], v[100:103]
  v_exp_f32 v83, v91
  ds_read_b128 v[64:67], v120 offset:0
  ds_read_b128 v[68:71], v120 offset:256
  v_smfmac_f32_16x16x64_bf16 v[60:63], v[8:11], v[168:175], v108
  v_max_f32_e64 v126, v126, abs(v95)
  v_smfmac_f32_16x16x64_bf16 v[56:59], v[12:15], v[176:183], v108
  v_cvt_pk_bf16_f32 v40, v80, v81
  v_smfmac_f32_16x16x64_bf16 v[60:63], v[12:15], v[184:191], v108
  v_cvt_pk_bf16_f32 v41, v82, v83
  v_smfmac_f32_16x16x64_bf16 v[56:59], v[16:19], v[192:199], v108
  v_exp_f32 v84, v92
  v_smfmac_f32_16x16x64_bf16 v[60:63], v[16:19], v[200:207], v108
  v_exp_f32 v85, v93
  v_smfmac_f32_16x16x64_bf16 v[56:59], v[20:23], v[208:215], v108
  v_exp_f32 v86, v94
  v_smfmac_f32_16x16x64_bf16 v[60:63], v[20:23], v[216:223], v108
  v_exp_f32 v87, v95
  v_smfmac_f32_16x16x64_bf16 v[56:59], v[24:27], v[224:231], v108
  v_cvt_pk_bf16_f32 v42, v84, v85
  v_smfmac_f32_16x16x64_bf16 v[60:63], v[24:27], v[232:239], v108
  v_max3_f32 v126, v126, v100, v101
  v_smfmac_f32_16x16x64_bf16 v[56:59], v[28:31], v[240:247], v108
  v_cvt_pk_bf16_f32 v43, v86, v87
  v_smfmac_f32_16x16x64_bf16 v[60:63], v[28:31], v[248:255], v108
  v_cmp_nge_f32 vcc, 0x42700000, v126
  s_waitcnt lgkmcnt(0)
  v_mfma_f32_16x16x32_bf16 v[48:51], v[104:107], v[40:43], 0
  v_exp_f32 v80, v100
  v_mfma_f32_16x16x32_bf16 v[32:35], v[64:67], v[40:43], 0
  v_exp_f32 v81, v101
  v_mfma_f32_16x16x32_bf16 v[36:39], v[68:71], v[40:43], 0
  v_cvt_pk_bf16_f32 v44, v80, v81
  s_cbranch_vccnz Lfb_248
Lok_249:
  v_add_f32 v56, v56, v58
  v_add_f32 v57, v57, v59
  v_mfma_f32_16x16x32_bf16 v[48:51], v[104:107], v[44:47], v[48:51]
  v_add_f32 v60, v60, v62
  v_add_f32 v61, v61, v63
  v_cvt_pk_bf16_f32 v72, v56, v57
  v_cvt_pk_bf16_f32 v76, v60, v61
  s_nop 0
  v_mfma_f32_16x16x32_bf16 v[32:35], v[72:75], v[44:47], v[32:35]
  ds_write2_b32 v122, v72, v76 offset0:0 offset1:64
  v_mov_b64 v[0:1], 0
  v_mfma_f32_16x16x32_bf16 v[36:39], v[76:79], v[44:47], v[36:39]
  v_rcp_f32 v126, v48
  v_mov_b64 v[2:3], 0
  v_mov_b64 v[4:5], 0
  v_mov_b64 v[6:7], 0
  v_mov_b64 v[8:9], 0
  v_mov_b64 v[10:11], 0
  v_mov_b64 v[12:13], 0
  v_mov_b64 v[14:15], 0
  v_pk_mul_f32 v[32:33], v[32:33], v[126:127] op_sel_hi:[1,0]
  v_pk_mul_f32 v[34:35], v[34:35], v[126:127] op_sel_hi:[1,0]
  v_cvt_pk_bf16_f32 v40, v32, v33
  v_cvt_pk_bf16_f32 v41, v34, v35
  ds_write_b64 v121, v[40:41] offset:0
  v_pk_mul_f32 v[36:37], v[36:37], v[126:127] op_sel_hi:[1,0]
  v_pk_mul_f32 v[38:39], v[38:39], v[126:127] op_sel_hi:[1,0]
  v_cvt_pk_bf16_f32 v42, v36, v37
  v_cvt_pk_bf16_f32 v43, v38, v39
  ds_write_b64 v121, v[42:43] offset:256
  v_mov_b64 v[16:17], 0
  v_mov_b64 v[18:19], 0
  v_mov_b64 v[20:21], 0
  v_mov_b64 v[22:23], 0
  v_mov_b64 v[24:25], 0
  v_mov_b64 v[26:27], 0
  v_mov_b64 v[28:29], 0
  v_mov_b64 v[30:31], 0
  s_waitcnt lgkmcnt(0)
  s_barrier
  ds_read_b128 v[48:51], v113 offset:28672
  ds_read_b128 v[52:55], v113 offset:29696
  s_mov_b32 m0, s39
  s_add_u32 s34, s34, 1
  buffer_load_dwordx4 v112, s[4:7], s37 offen sc1 lds
  s_waitcnt lgkmcnt(1)
  v_smfmac_f32_16x16x64_bf16 v[0:3], v[48:51], a[168:175], v108
  ds_read_b128 v[88:91], v114 offset:51200
  buffer_load_dwordx4 v112, s[4:7], s37 offen offset:1024 sc1 lds
  s_add_u32 s37, s37, 0x40000
  s_waitcnt lgkmcnt(1)
  v_smfmac_f32_16x16x64_bf16 v[0:3], v[52:55], a[176:183], v108
  ds_read_b128 v[92:95], v114 offset:52224
  s_mov_b32 m0, s40
  s_nop 0
  buffer_load_dwordx4 v112, s[4:7], s38 offen sc1 lds
  v_smfmac_f32_16x16x64_bf16 v[4:7], v[48:51], a[184:191], v108
  ds_read_b128 v[80:83], v115 offset:0
  buffer_load_dwordx4 v112, s[4:7], s38 offen offset:1024 sc1 lds
  s_add_u32 s38, s38, 0x40000
  v_smfmac_f32_16x16x64_bf16 v[4:7], v[52:55], a[192:199], v108
  ds_read_b128 v[84:87], v115 offset:1024
  v_smfmac_f32_16x16x64_bf16 v[8:11], v[48:51], a[200:207], v108
  ds_read_b128 v[72:75], v115 offset:2048
  v_add_f32 v0, v0, v2
  v_smfmac_f32_16x16x64_bf16 v[8:11], v[52:55], a[208:215], v108
  ds_read_b128 v[76:79], v115 offset:3072
  v_add_f32 v1, v1, v3
  v_smfmac_f32_16x16x64_bf16 v[12:15], v[48:51], a[216:223], v108
  ds_read_b128 v[56:59], v115 offset:16384
  v_cvt_pk_bf16_f32 v32, v0, v1
  v_smfmac_f32_16x16x64_bf16 v[12:15], v[52:55], a[224:231], v108
  ds_read_b128 v[60:63], v115 offset:17408
  v_and_or_b32 v32, v32, -2, s24
  v_add_f32 v4, v4, v6
  v_smfmac_f32_16x16x64_bf16 v[16:19], v[48:51], a[232:239], v108
  ds_read_b128 v[64:67], v115 offset:18432
  v_add_f32 v5, v5, v7
  v_smfmac_f32_16x16x64_bf16 v[16:19], v[52:55], a[240:247], v108
  ds_read_b128 v[68:71], v115 offset:19456
  v_cvt_pk_bf16_f32 v33, v4, v5
  v_add_f32 v8, v8, v10
  v_smfmac_f32_16x16x64_bf16 v[20:23], v[48:51], a[248:255], v108
  v_add_f32 v9, v9, v11
  s_waitcnt lgkmcnt(8)
  v_smfmac_f32_16x16x64_bf16 v[20:23], v[52:55], v[88:95], v108
  v_cvt_pk_bf16_f32 v34, v8, v9
  v_add_f32 v12, v12, v14
  s_waitcnt lgkmcnt(6)
  v_smfmac_f32_16x16x64_bf16 v[24:27], v[48:51], v[80:87], v108
  v_add_f32 v13, v13, v15
  v_cvt_pk_bf16_f32 v35, v12, v13
  s_waitcnt lgkmcnt(4)
  v_smfmac_f32_16x16x64_bf16 v[24:27], v[52:55], v[72:79], v108
  buffer_store_dwordx4 v[32:35], v109, s[4:7], 0 offen
  v_add_f32 v16, v16, v18
  s_waitcnt lgkmcnt(2)
  v_smfmac_f32_16x16x64_bf16 v[28:31], v[48:51], v[56:63], v108
  v_add_f32 v17, v17, v19
  v_cvt_pk_bf16_f32 v36, v16, v17
  s_waitcnt lgkmcnt(0)
  v_smfmac_f32_16x16x64_bf16 v[28:31], v[52:55], v[64:71], v108
  v_and_or_b32 v36, v36, -2, s24
  v_add_f32 v20, v20, v22
  v_add_f32 v21, v21, v23
  v_cvt_pk_bf16_f32 v37, v20, v21
  v_add_f32 v24, v24, v26
  v_add_f32 v25, v25, v27
  v_cvt_pk_bf16_f32 v38, v24, v25
  s_nop 0
  v_add_f32 v28, v28, v30
  v_add_f32 v29, v29, v31
  v_cvt_pk_bf16_f32 v39, v28, v29
  buffer_store_dwordx4 v[36:39], v109, s[4:7], s31 offen
  s_add_u32 s23, s23, 8192
  s_add_u32 s22, s22, 1
  s_mov_b32 s26, 0
  s_add_u32 s41, s41, s42
  s_branch Lb4_234
Llast_235:
  s_waitcnt vmcnt(3)
  ds_write_b128 v126, v[8:11] offset:0
  s_waitcnt vmcnt(2)
  ds_write_b128 v126, v[12:15] offset:1024
  v_max3_u32 v127, v8, v9, v10
  v_max3_u32 v127, v127, v11, v12
  v_max3_u32 v127, v127, v13, v14
  v_max_u32 v127, v127, v15
  v_cmp_eq_u32 vcc, -1, v127
  s_cbranch_vccnz Lh2s_251
Lh2_250:
Llast_235x:
  v_smfmac_f32_16x16x64_bf16 v[40:43], v[8:11], a[32:39], v108
  v_smfmac_f32_16x16x64_bf16 v[44:47], v[8:11], a[40:47], v108
  s_waitcnt lgkmcnt(0)
  s_barrier
  buffer_store_dwordx4 v[100:103], v124, s[4:7], s25 offen sc1
  s_add_u32 s25, s25, 65536
  buffer_load_dword v125, v123, s[4:7], s41 offen sc1
  ds_read_b128 v[16:19], v113 offset:4096
  ds_read_b128 v[20:23], v113 offset:5120
  ds_read_b128 v[24:27], v113 offset:6144
  ds_read_b128 v[28:31], v113 offset:7168
  s_waitcnt vmcnt(2)
  ds_read_b128 v[0:3], v113 offset:0
  ds_read_b128 v[4:7], v113 offset:1024
  v_smfmac_f32_16x16x64_bf16 v[40:43], v[12:15], a[48:55], v108
  v_smfmac_f32_16x16x64_bf16 v[44:47], v[12:15], a[56:63], v108
  s_waitcnt lgkmcnt(5)
  v_smfmac_f32_16x16x64_bf16 v[40:43], v[16:19], a[64:71], v108
  v_smfmac_f32_16x16x64_bf16 v[44:47], v[16:19], a[72:79], v108
  s_waitcnt lgkmcnt(4)
  v_smfmac_f32_16x16x64_bf16 v[44:47], v[20:23], a[88:95], v108
  s_waitcnt lgkmcnt(3)
  v_smfmac_f32_16x16x64_bf16 v[40:43], v[24:27], a[96:103], v108
  v_smfmac_f32_16x16x64_bf16 v[44:47], v[24:27], a[104:111], v108
  s_waitcnt lgkmcnt(2)
  v_smfmac_f32_16x16x64_bf16 v[40:43], v[28:31], a[112:119], v108
  v_smfmac_f32_16x16x64_bf16 v[44:47], v[28:31], a[120:127], v108
  v_smfmac_f32_16x16x64_bf16 v[40:43], v[20:23], a[80:87], v108
  s_waitcnt lgkmcnt(1)
  v_smfmac_f32_16x16x64_bf16 v[40:43], v[0:3], a[0:7], v108
  v_smfmac_f32_16x16x64_bf16 v[44:47], v[0:3], a[8:15], v108
  s_waitcnt lgkmcnt(0)
  v_smfmac_f32_16x16x64_bf16 v[40:43], v[4:7], a[16:23], v108
  v_smfmac_f32_16x16x64_bf16 v[44:47], v[4:7], a[24:31], v108
  v_mov_b64 v[56:57], 0
  v_mov_b64 v[58:59], 0
  v_mov_b64 v[60:61], 0
  v_mov_b64 v[62:63], 0
  v_smfmac_f32_16x16x64_bf16 v[56:59], v[0:3], v[128:135], v108
  s_nop 0
  v_smfmac_f32_16x16x64_bf16 v[60:63], v[0:3], v[136:143], v108
  v_add_f32 v40, v40, v42
  v_add_f32 v41, v41, v43
  v_add_f32 v44, v44, v46
  v_add_f32 v45, v45, v47
  v_mul_f32 v40, s44, v40
  v_mul_f32 v41, s44, v41
  v_mul_f32 v44, s44, v44
  v_mul_f32 v45, s44, v45
  v_cvt_pk_bf16_f32 v42, v40, v41
  v_cvt_pk_bf16_f32 v43, v44, v45
  ds_write2_b32 v116, v42, v43 offset0:0 offset1:128
  v_smfmac_f32_16x16x64_bf16 v[56:59], v[4:7], v[144:151], v108
  v_smfmac_f32_16x16x64_bf16 v[60:63], v[4:7], v[152:159], v108
  v_smfmac_f32_16x16x64_bf16 v[56:59], v[8:11], v[160:167], v108
  v_smfmac_f32_16x16x64_bf16 v[60:63], v[8:11], v[168:175], v108
  v_smfmac_f32_16x16x64_bf16 v[56:59], v[12:15], v[176:183], v108
  v_smfmac_f32_16x16x64_bf16 v[60:63], v[12:15], v[184:191], v108
  v_smfmac_f32_16x16x64_bf16 v[56:59], v[16:19], v[192:199], v108
  v_smfmac_f32_16x16x64_bf16 v[60:63], v[16:19], v[200:207], v108
  v_smfmac_f32_16x16x64_bf16 v[56:59], v[20:23], v[208:215], v108
  v_smfmac_f32_16x16x64_bf16 v[60:63], v[20:23], v[216:223], v108
  v_smfmac_f32_16x16x64_bf16 v[56:59], v[24:27], v[224:231], v108
  v_smfmac_f32_16x16x64_bf16 v[60:63], v[24:27], v[232:239], v108
  v_smfmac_f32_16x16x64_bf16 v[56:59], v[28:31], v[240:247], v108
  v_smfmac_f32_16x16x64_bf16 v[60:63], v[28:31], v[248:255], v108
  s_nop 6
  v_add_f32 v56, v56, v58
  v_add_f32 v57, v57, v59
  v_add_f32 v60, v60, v62
  v_add_f32 v61, v61, v63
  v_cvt_pk_bf16_f32 v72, v56, v57
  v_cvt_pk_bf16_f32 v76, v60, v61
  ds_write2_b32 v122, v72, v76 offset0:0 offset1:64
  s_waitcnt lgkmcnt(0)
  s_add_u32 s23, s23, 8192
  s_add_u32 s22, s22, 1
  s_mov_b32 s26, 0
  s_add_u32 s41, s41, s42
  v_add_u32 v126, s43, v117
  v_xor_b32 v127, 16, v126
  ds_read_b64_tr_b16 v[100:101], v126
  ds_read_b64_tr_b16 v[102:103], v127 offset:256
  v_subrev_u32 v126, s18, v124
  s_mov_b32 exec_lo, 0xcccccccc
  s_mov_b32 exec_hi, 0xcccccccc
  ds_read_b128 v[100:103], v126
  s_mov_b64 exec, -1
  s_waitcnt lgkmcnt(0)
  buffer_store_dwordx4 v[100:103], v124, s[4:7], s25 offen sc1
  s_add_u32 s25, s25, 65536
  s_sub_u32 s25, s25, 65536
  s_waitcnt vmcnt(0)
  s_barrier
  s_cmp_lt_u32 s23, 2097152
  s_cbranch_scc1 Llay_232
  s_branch Lfin_188
Lwv_208:
Llay_254:
  s_mov_b32 s22, 0
  v_add_u32 v126, s43, v117
  v_xor_b32 v127, 16, v126
  ds_read_b64_tr_b16 v[100:101], v126
  ds_read_b64_tr_b16 v[102:103], v127 offset:256
  v_subrev_u32 v126, s18, v124
  s_mov_b32 exec_lo, 0xcccccccc
  s_mov_b32 exec_hi, 0xcccccccc
  ds_read_b128 v[100:103], v126
  s_mov_b64 exec, -1
  ds_read_b128 v[56:59], v114 offset:0
  ds_read_b128 v[60:63], v114 offset:1024
  ds_read_b128 v[64:67], v114 offset:2048
  ds_read_b128 v[68:71], v114 offset:3072
  ds_read_b128 v[72:75], v114 offset:16384
  ds_read_b128 v[76:79], v114 offset:17408
  ds_read_b128 v[80:83], v114 offset:18432
  ds_read_b128 v[84:87], v114 offset:19456
  ds_read_b128 v[88:91], v114 offset:32768
  ds_read_b128 v[92:95], v114 offset:33792
  ds_read_b128 v[48:51], v114 offset:34816
  ds_read_b128 v[52:55], v114 offset:35840
  s_waitcnt lgkmcnt(0)
  v_add_u32 v126, 131072, v112
  buffer_load_dwordx4 v[16:19], v112, s[4:7], s23 offen offset:0 sc1
  buffer_load_dwordx4 v[20:23], v112, s[4:7], s23 offen offset:1024 sc1
  s_nop 15
  s_nop 15
  s_nop 1
  buffer_load_dwordx4 v[8:11], v112, s[4:7], s23 offen offset:0 sc1
  buffer_load_dwordx4 v[12:15], v112, s[4:7], s23 offen offset:1024 sc1
  s_mov_b32 s26, 0
  v_add_u32 v126, 139264, v112
  v_bfe_u32 v127, v113, 4, 1
  v_mul_u32_u24 v127, 2097152, v127
  v_lshlrev_b32 v127, 4, v127
  s_lshl_b32 s29, s21, 11
  v_add_u32 v127, s29, v127
  s_nop 1
Ldp_258:
  buffer_load_dword v125, v127, s[4:7], s37 offen offset:1024 sc1
  s_add_u32 s26, s26, 1
  s_cmp_gt_u32 s26, 8192
  s_cbranch_scc1 Ldp_259
  s_waitcnt vmcnt(0)
  v_cmp_eq_u32 vcc, -1, v125
  s_cbranch_vccnz Ldp_258
  s_mov_b32 m0, s39
  s_add_u32 s34, s34, 1
  buffer_load_dwordx4 v112, s[4:7], s37 offen sc1 lds
  buffer_load_dwordx4 v112, s[4:7], s37 offen offset:1024 sc1 lds
  s_add_u32 s37, s37, 0x40000
  s_mov_b32 m0, s40
  s_nop 0
  buffer_load_dwordx4 v112, s[4:7], s38 offen sc1 lds
  buffer_load_dwordx4 v112, s[4:7], s38 offen offset:1024 sc1 lds
  s_add_u32 s38, s38, 0x40000
  s_waitcnt vmcnt(0)
  ds_read_b128 v[32:35], v126 offset:0
  ds_read_b128 v[36:39], v126 offset:1024
  ds_read_b128 v[40:43], v126 offset:8192
  ds_read_b128 v[44:47], v126 offset:9216
  s_waitcnt lgkmcnt(0)
  v_max3_u32 v32, v32, v33, v34
  v_max3_u32 v32, v32, v35, v36
  v_max3_u32 v32, v32, v37, v38
  v_max3_u32 v32, v32, v39, v40
  v_max3_u32 v32, v32, v41, v42
  v_max3_u32 v32, v32, v43, v44
  v_max3_u32 v32, v32, v45, v46
  v_max_u32 v32, v32, v47
  v_cmp_eq_u32 vcc, -1, v32
  s_cbranch_vccz Ldp_260
  s_sub_u32 s34, s34, 1
  s_sub_u32 s37, s37, 0x40000
  s_sub_u32 s38, s38, 0x40000
  s_branch Ldp_258
Ldp_259:
  s_lshl_b32 s35, s34, 1
  s_or_b32 s35, s35, 3
  s_bitcmp1_b32 s34, 0
  s_cselect_b32 s30, s28, s27
  s_cmp_le_u32 s30, s35
  s_cbranch_scc1 Lkvs_262
Lkv_261:
  s_mov_b32 m0, s39
  s_add_u32 s34, s34, 1
  buffer_load_dwordx4 v112, s[4:7], s37 offen sc1 lds
  buffer_load_dwordx4 v112, s[4:7], s37 offen offset:1024 sc1 lds
  s_add_u32 s37, s37, 0x40000
  s_mov_b32 m0, s40
  s_nop 0
  buffer_load_dwordx4 v112, s[4:7], s38 offen sc1 lds
  buffer_load_dwordx4 v112, s[4:7], s38 offen offset:1024 sc1 lds
  s_add_u32 s38, s38, 0x40000
  s_waitcnt vmcnt(0)
Ldp_260:
  v_mov_b64 v[32:33], 0
  v_mov_b64 v[34:35], 0
  v_mov_b64 v[36:37], 0
  v_mov_b64 v[38:39], 0
  v_mov_b64 v[40:41], 0
  v_mov_b64 v[42:43], 0
  v_mov_b64 v[44:45], 0
  v_mov_b64 v[46:47], 0
  v_add_u32 v126, 131072, v112
  s_nop 0
  s_branch Lstep_255
.p2align 6
Lb4_256:
  v_add_u32 v126, s43, v117
  v_xor_b32 v127, 16, v126
  ds_read_b64_tr_b16 v[100:101], v126
  ds_read_b64_tr_b16 v[102:103], v127 offset:256
  v_subrev_u32 v126, s18, v124
  s_mov_b32 exec_lo, 0xcccccccc
  s_mov_b32 exec_hi, 0xcccccccc
  ds_read_b128 v[100:103], v126
  s_mov_b64 exec, -1
  ds_read_b128 v[56:59], v114 offset:0
  ds_read_b128 v[60:63], v114 offset:1024
  ds_read_b128 v[64:67], v114 offset:2048
  ds_read_b128 v[68:71], v114 offset:3072
  ds_read_b128 v[72:75], v114 offset:16384
  ds_read_b128 v[76:79], v114 offset:17408
  ds_read_b128 v[80:83], v114 offset:18432
  ds_read_b128 v[84:87], v114 offset:19456
  ds_read_b128 v[88:91], v114 offset:32768
  ds_read_b128 v[92:95], v114 offset:33792
  ds_read_b128 v[48:51], v114 offset:34816
  ds_read_b128 v[52:55], v114 offset:35840
  v_mov_b64 v[32:33], 0
  v_mov_b64 v[34:35], 0
  v_mov_b64 v[36:37], 0
  v_mov_b64 v[38:39], 0
  v_mov_b64 v[40:41], 0
  v_mov_b64 v[42:43], 0
  v_mov_b64 v[44:45], 0
  v_mov_b64 v[46:47], 0
  s_barrier
  s_xor_b32 s24, s24, 1
  s_waitcnt lgkmcnt(0)
  v_add_u32 v126, 131072, v112
  s_nop 15
  s_nop 15
  s_nop 9
  buffer_load_dwordx4 v[16:19], v112, s[4:7], s23 offen offset:0 sc1
  buffer_load_dwordx4 v[20:23], v112, s[4:7], s23 offen offset:1024 sc1
  s_nop 15
  s_nop 15
  s_nop 1
  buffer_load_dwordx4 v[8:11], v112, s[4:7], s23 offen offset:0 sc1
  buffer_load_dwordx4 v[12:15], v112, s[4:7], s23 offen offset:1024 sc1
  s_cmp_eq_u32 s22, 63
  s_cbranch_scc1 Llast_257
Lstep_255:
  s_waitcnt vmcnt(3)
  ds_write_b128 v126, v[16:19] offset:0
  s_waitcnt vmcnt(2)
  ds_write_b128 v126, v[20:23] offset:1024
  v_max3_u32 v127, v16, v17, v18
  v_max3_u32 v127, v127, v19, v20
  v_max3_u32 v127, v127, v21, v22
  v_max_u32 v127, v127, v23
  v_cmp_eq_u32 vcc, -1, v127
  s_cbranch_vccnz Lh2s_264
Lh2_263:
  v_smfmac_f32_16x16x64_bf16 v[32:35], v[16:19], v[56:63], v108
  v_smfmac_f32_16x16x64_bf16 v[36:39], v[16:19], v[64:71], v108
  s_waitcnt lgkmcnt(0)
  s_barrier
  ds_read_b128 v[24:27], v113 offset:6144
  ds_read_b128 v[28:31], v113 offset:7168
  v_smfmac_f32_16x16x64_bf16 v[32:35], v[20:23], v[72:79], v108
  ds_read_b128 v[0:3], v113 offset:0
  v_smfmac_f32_16x16x64_bf16 v[36:39], v[20:23], v[80:87], v108
  ds_read_b128 v[4:7], v113 offset:1024
  v_smfmac_f32_16x16x64_bf16 v[40:43], v[16:19], a[64:71], v108
  s_waitcnt vmcnt(0)
  ds_read_b128 v[8:11], v113 offset:2048
  v_xor_b32 v127, 0x80, v119
  v_smfmac_f32_16x16x64_bf16 v[44:47], v[16:19], a[72:79], v108
  ds_read_b128 v[12:15], v113 offset:3072
  v_add_u32 v126, -2048, v122
  v_smfmac_f32_16x16x64_bf16 v[40:43], v[20:23], a[80:87], v108
  ds_read_b128 v[56:59], v114 offset:49152
  buffer_store_dwordx4 v[100:103], v124, s[4:7], s25 offen sc1
  s_add_u32 s25, s25, 65536
  buffer_load_dword v125, v123, s[4:7], s41 offen sc1
  v_smfmac_f32_16x16x64_bf16 v[44:47], v[20:23], a[88:95], v108
  ds_read_b128 v[60:63], v114 offset:50176
  s_waitcnt lgkmcnt(7)
  v_smfmac_f32_16x16x64_bf16 v[32:35], v[24:27], v[88:95], v108
  ds_read_b128 v[64:67], v115 offset:32768
  v_smfmac_f32_16x16x64_bf16 v[36:39], v[24:27], v[48:55], v108
  ds_read_b128 v[68:71], v115 offset:33792
  s_waitcnt lgkmcnt(8)
  v_smfmac_f32_16x16x64_bf16 v[36:39], v[28:31], a[128:135], v108
  ds_read_b128 v[72:75], v115 offset:34816
  s_waitcnt lgkmcnt(8)
  v_smfmac_f32_16x16x64_bf16 v[32:35], v[0:3], a[136:143], v108
  ds_read_b128 v[76:79], v115 offset:35840
  v_smfmac_f32_16x16x64_bf16 v[36:39], v[0:3], a[144:151], v108
  ds_read_b128 v[80:83], v115 offset:49152
  s_waitcnt lgkmcnt(9)
  v_smfmac_f32_16x16x64_bf16 v[32:35], v[4:7], a[152:159], v108
  ds_read_b128 v[84:87], v115 offset:50176
  v_smfmac_f32_16x16x64_bf16 v[36:39], v[4:7], a[160:167], v108
  ds_read_b128 v[88:91], v115 offset:51200
  s_waitcnt lgkmcnt(7)
  v_smfmac_f32_16x16x64_bf16 v[32:35], v[28:31], v[56:63], v108
  ds_read_b128 v[92:95], v115 offset:52224
  s_waitcnt lgkmcnt(6)
  v_smfmac_f32_16x16x64_bf16 v[32:35], v[8:11], v[64:71], v108
  ds_read_b128 v[56:59], v119 offset:0
  s_waitcnt lgkmcnt(5)
  v_smfmac_f32_16x16x64_bf16 v[36:39], v[8:11], v[72:79], v108
  ds_read_b128 v[60:63], v127 offset:0
  s_waitcnt lgkmcnt(4)
  v_smfmac_f32_16x16x64_bf16 v[32:35], v[12:15], v[80:87], v108
  ds_read_b128 v[64:67], v119 offset:2048
  s_waitcnt lgkmcnt(3)
  v_smfmac_f32_16x16x64_bf16 v[36:39], v[12:15], v[88:95], v108
  ds_read_b128 v[68:71], v127 offset:2048
  v_smfmac_f32_16x16x64_bf16 v[40:43], v[24:27], a[96:103], v108
  ds_read_b128 v[72:75], v119 offset:4096
  ds_read_b128 v[76:79], v127 offset:4096
  v_smfmac_f32_16x16x64_bf16 v[44:47], v[24:27], a[104:111], v108
  ds_read_b128 v[80:83], v119 offset:6144
  ds_read_b128 v[84:87], v127 offset:6144
  v_smfmac_f32_16x16x64_bf16 v[44:47], v[28:31], a[120:127], v108
  v_add_f32 v32, v32, v34
  v_add_f32 v33, v33, v35
  v_smfmac_f32_16x16x64_bf16 v[40:43], v[0:3], a[0:7], v108
  v_add_f32 v36, v36, v38
  v_add_f32 v37, v37, v39
  v_smfmac_f32_16x16x64_bf16 v[44:47], v[0:3], a[8:15], v108
  v_cvt_pk_bf16_f32 v34, v32, v33
  v_cvt_pk_bf16_f32 v35, v36, v37
  ds_write2_b32 v126, v34, v35 offset0:0 offset1:64
  v_smfmac_f32_16x16x64_bf16 v[40:43], v[4:7], a[16:23], v108
  v_smfmac_f32_16x16x64_bf16 v[44:47], v[4:7], a[24:31], v108
  v_smfmac_f32_16x16x64_bf16 v[40:43], v[28:31], a[112:119], v108
  v_smfmac_f32_16x16x64_bf16 v[40:43], v[8:11], a[32:39], v108
  s_waitcnt lgkmcnt(0)
  s_barrier
  ds_read_b64_tr_b16 v[32:33], v118 offset:0
  ds_read_b64_tr_b16 v[34:35], v118 offset:128
  v_smfmac_f32_16x16x64_bf16 v[44:47], v[8:11], a[40:47], v108
  ds_read_b64_tr_b16 v[36:37], v118 offset:512
  ds_read_b64_tr_b16 v[38:39], v118 offset:640
  v_smfmac_f32_16x16x64_bf16 v[40:43], v[12:15], a[48:55], v108
  ds_read_b64_tr_b16 v[48:49], v118 offset:1024
  ds_read_b64_tr_b16 v[50:51], v118 offset:1152
  v_smfmac_f32_16x16x64_bf16 v[44:47], v[12:15], a[56:63], v108
  ds_read_b64_tr_b16 v[52:53], v118 offset:1536
  ds_read_b64_tr_b16 v[54:55], v118 offset:1664
  v_xor_b32 v127, 16, v117
  s_waitcnt lgkmcnt(6)
  v_mfma_f32_16x16x32_bf16 v[88:91], v[56:59], v[32:35], 0
  v_mfma_f32_16x16x32_bf16 v[92:95], v[60:63], v[32:35], 0
  v_mov_b64 v[56:57], 0
  v_mov_b64 v[58:59], 0
  s_waitcnt lgkmcnt(4)
  v_mfma_f32_16x16x32_bf16 v[88:91], v[64:67], v[36:39], v[88:91]
  v_add_f32 v40, v40, v42
  v_add_f32 v41, v41, v43
  v_mfma_f32_16x16x32_bf16 v[92:95], v[68:71], v[36:39], v[92:95]
  v_add_f32 v44, v44, v46
  v_add_f32 v45, v45, v47
  s_waitcnt lgkmcnt(2)
  v_mfma_f32_16x16x32_bf16 v[88:91], v[72:75], v[48:51], v[88:91]
  v_mul_f32 v40, s44, v40
  v_mul_f32 v41, s44, v41
  v_mfma_f32_16x16x32_bf16 v[92:95], v[76:79], v[48:51], v[92:95]
  v_mul_f32 v44, s44, v44
  v_mul_f32 v45, s44, v45
  s_waitcnt lgkmcnt(0)
  v_mfma_f32_16x16x32_bf16 v[88:91], v[80:83], v[52:55], v[88:91]
  v_cvt_pk_bf16_f32 v42, v40, v41
  v_cvt_pk_bf16_f32 v43, v44, v45
  ds_write2_b32 v116, v42, v43 offset0:0 offset1:128
  v_mfma_f32_16x16x32_bf16 v[92:95], v[84:87], v[52:55], v[92:95]
  v_mov_b64 v[60:61], 0
  v_mov_b64 v[62:63], 0
  v_smfmac_f32_16x16x64_bf16 v[56:59], v[0:3], v[128:135], v108
  v_mov_b64 v[46:47], 0
  v_smfmac_f32_16x16x64_bf16 v[60:63], v[0:3], v[136:143], v108
  v_mov_b32 v45, 0
  v_smfmac_f32_16x16x64_bf16 v[56:59], v[4:7], v[144:151], v108
  v_max3_f32 v126, abs(v88), abs(v89), abs(v90)
  s_waitcnt lgkmcnt(0)
  s_barrier
  ds_read_b64_tr_b16 v[64:65], v117 offset:0
  ds_read_b64_tr_b16 v[66:67], v127 offset:256
  ds_read_b64_tr_b16 v[68:69], v117 offset:1024
  ds_read_b64_tr_b16 v[70:71], v127 offset:1280
  v_smfmac_f32_16x16x64_bf16 v[60:63], v[4:7], v[152:159], v108
  ds_read_b64_tr_b16 v[72:73], v117 offset:2048
  ds_read_b64_tr_b16 v[74:75], v127 offset:2304
  v_max3_f32 v126, v126, abs(v91), abs(v92)
  v_smfmac_f32_16x16x64_bf16 v[56:59], v[8:11], v[160:167], v108
  ds_read_b64_tr_b16 v[76:77], v117 offset:3072
  ds_read_b64_tr_b16 v[78:79], v127 offset:3328
  v_max3_f32 v126, v126, abs(v93), abs(v94)
  s_waitcnt lgkmcnt(6)
  v_mfma_f32_16x16x32_bf16 v[100:103], v[64:67], v[32:35], 0
  v_exp_f32 v80, v88
  s_waitcnt lgkmcnt(4)
  v_mfma_f32_16x16x32_bf16 v[100:103], v[68:71], v[36:39], v[100:103]
  v_exp_f32 v81, v89
  s_waitcnt lgkmcnt(2)
  v_mfma_f32_16x16x32_bf16 v[100:103], v[72:75], v[48:51], v[100:103]
  v_exp_f32 v82, v90
  s_waitcnt lgkmcnt(0)
  v_mfma_f32_16x16x32_bf16 v[100:103], v[76:79], v[52:55], v[100:103]
  v_exp_f32 v83, v91
  ds_read_b128 v[64:67], v120 offset:0
  ds_read_b128 v[68:71], v120 offset:256
  v_smfmac_f32_16x16x64_bf16 v[60:63], v[8:11], v[168:175], v108
  v_max_f32_e64 v126, v126, abs(v95)
  v_smfmac_f32_16x16x64_bf16 v[56:59], v[12:15], v[176:183], v108
  v_cvt_pk_bf16_f32 v40, v80, v81
  v_smfmac_f32_16x16x64_bf16 v[60:63], v[12:15], v[184:191], v108
  v_cvt_pk_bf16_f32 v41, v82, v83
  v_smfmac_f32_16x16x64_bf16 v[56:59], v[16:19], v[192:199], v108
  v_exp_f32 v84, v92
  v_smfmac_f32_16x16x64_bf16 v[60:63], v[16:19], v[200:207], v108
  v_exp_f32 v85, v93
  v_smfmac_f32_16x16x64_bf16 v[56:59], v[20:23], v[208:215], v108
  v_exp_f32 v86, v94
  v_smfmac_f32_16x16x64_bf16 v[60:63], v[20:23], v[216:223], v108
  v_exp_f32 v87, v95
  v_smfmac_f32_16x16x64_bf16 v[56:59], v[24:27], v[224:231], v108
  v_cvt_pk_bf16_f32 v42, v84, v85
  v_smfmac_f32_16x16x64_bf16 v[60:63], v[24:27], v[232:239], v108
  v_max3_f32 v126, v126, v100, v101
  v_smfmac_f32_16x16x64_bf16 v[56:59], v[28:31], v[240:247], v108
  v_cvt_pk_bf16_f32 v43, v86, v87
  v_smfmac_f32_16x16x64_bf16 v[60:63], v[28:31], v[248:255], v108
  v_cmp_nge_f32 vcc, 0x42700000, v126
  s_waitcnt lgkmcnt(0)
  v_mfma_f32_16x16x32_bf16 v[48:51], v[104:107], v[40:43], 0
  v_exp_f32 v80, v100
  v_mfma_f32_16x16x32_bf16 v[32:35], v[64:67], v[40:43], 0
  v_exp_f32 v81, v101
  v_mfma_f32_16x16x32_bf16 v[36:39], v[68:71], v[40:43], 0
  v_cvt_pk_bf16_f32 v44, v80, v81
  s_cbranch_vccnz Lfb_267
Lok_268:
  v_add_f32 v56, v56, v58
  v_add_f32 v57, v57, v59
  v_mfma_f32_16x16x32_bf16 v[48:51], v[104:107], v[44:47], v[48:51]
  v_add_f32 v60, v60, v62
  v_add_f32 v61, v61, v63
  v_cvt_pk_bf16_f32 v72, v56, v57
  v_cvt_pk_bf16_f32 v76, v60, v61
  s_nop 0
  v_mfma_f32_16x16x32_bf16 v[32:35], v[72:75], v[44:47], v[32:35]
  ds_write2_b32 v122, v72, v76 offset0:0 offset1:64
  v_mov_b64 v[0:1], 0
  v_mfma_f32_16x16x32_bf16 v[36:39], v[76:79], v[44:47], v[36:39]
  v_rcp_f32 v126, v48
  v_mov_b64 v[2:3], 0
  v_mov_b64 v[4:5], 0
  v_mov_b64 v[6:7], 0
  v_mov_b64 v[8:9], 0
  v_mov_b64 v[10:11], 0
  v_mov_b64 v[12:13], 0
  v_mov_b64 v[14:15], 0
  v_pk_mul_f32 v[32:33], v[32:33], v[126:127] op_sel_hi:[1,0]
  v_pk_mul_f32 v[34:35], v[34:35], v[126:127] op_sel_hi:[1,0]
  v_cvt_pk_bf16_f32 v40, v32, v33
  v_cvt_pk_bf16_f32 v41, v34, v35
  ds_write_b64 v121, v[40:41] offset:0
  v_pk_mul_f32 v[36:37], v[36:37], v[126:127] op_sel_hi:[1,0]
  v_pk_mul_f32 v[38:39], v[38:39], v[126:127] op_sel_hi:[1,0]
  v_cvt_pk_bf16_f32 v42, v36, v37
  v_cvt_pk_bf16_f32 v43, v38, v39
  ds_write_b64 v121, v[42:43] offset:256
  v_mov_b64 v[16:17], 0
  v_mov_b64 v[18:19], 0
  v_mov_b64 v[20:21], 0
  v_mov_b64 v[22:23], 0
  v_mov_b64 v[24:25], 0
  v_mov_b64 v[26:27], 0
  v_mov_b64 v[28:29], 0
  v_mov_b64 v[30:31], 0
  s_waitcnt lgkmcnt(0)
  s_barrier
  ds_read_b128 v[48:51], v113 offset:28672
  ds_read_b128 v[52:55], v113 offset:29696
  s_mov_b32 m0, s39
  s_add_u32 s34, s34, 1
  buffer_load_dwordx4 v112, s[4:7], s37 offen sc1 lds
  s_waitcnt lgkmcnt(1)
  v_smfmac_f32_16x16x64_bf16 v[0:3], v[48:51], a[168:175], v108
  ds_read_b128 v[88:91], v114 offset:51200
  buffer_load_dwordx4 v112, s[4:7], s37 offen offset:1024 sc1 lds
  s_add_u32 s37, s37, 0x40000
  s_waitcnt lgkmcnt(1)
  v_smfmac_f32_16x16x64_bf16 v[0:3], v[52:55], a[176:183], v108
  ds_read_b128 v[92:95], v114 offset:52224
  s_mov_b32 m0, s40
  s_nop 0
  buffer_load_dwordx4 v112, s[4:7], s38 offen sc1 lds
  v_smfmac_f32_16x16x64_bf16 v[4:7], v[48:51], a[184:191], v108
  ds_read_b128 v[80:83], v115 offset:0
  buffer_load_dwordx4 v112, s[4:7], s38 offen offset:1024 sc1 lds
  s_add_u32 s38, s38, 0x40000
  v_smfmac_f32_16x16x64_bf16 v[4:7], v[52:55], a[192:199], v108
  ds_read_b128 v[84:87], v115 offset:1024
  v_smfmac_f32_16x16x64_bf16 v[8:11], v[48:51], a[200:207], v108
  ds_read_b128 v[72:75], v115 offset:2048
  v_add_f32 v0, v0, v2
  v_smfmac_f32_16x16x64_bf16 v[8:11], v[52:55], a[208:215], v108
  ds_read_b128 v[76:79], v115 offset:3072
  v_add_f32 v1, v1, v3
  v_smfmac_f32_16x16x64_bf16 v[12:15], v[48:51], a[216:223], v108
  ds_read_b128 v[56:59], v115 offset:16384
  v_cvt_pk_bf16_f32 v32, v0, v1
  v_smfmac_f32_16x16x64_bf16 v[12:15], v[52:55], a[224:231], v108
  ds_read_b128 v[60:63], v115 offset:17408
  v_and_or_b32 v32, v32, -2, s24
  v_add_f32 v4, v4, v6
  v_smfmac_f32_16x16x64_bf16 v[16:19], v[48:51], a[232:239], v108
  ds_read_b128 v[64:67], v115 offset:18432
  v_add_f32 v5, v5, v7
  v_smfmac_f32_16x16x64_bf16 v[16:19], v[52:55], a[240:247], v108
  ds_read_b128 v[68:71], v115 offset:19456
  v_cvt_pk_bf16_f32 v33, v4, v5
  v_add_f32 v8, v8, v10
  v_smfmac_f32_16x16x64_bf16 v[20:23], v[48:51], a[248:255], v108
  v_add_f32 v9, v9, v11
  s_waitcnt lgkmcnt(8)
  v_smfmac_f32_16x16x64_bf16 v[20:23], v[52:55], v[88:95], v108
  v_cvt_pk_bf16_f32 v34, v8, v9
  v_add_f32 v12, v12, v14
  s_waitcnt lgkmcnt(6)
  v_smfmac_f32_16x16x64_bf16 v[24:27], v[48:51], v[80:87], v108
  v_add_f32 v13, v13, v15
  v_cvt_pk_bf16_f32 v35, v12, v13
  s_waitcnt lgkmcnt(4)
  v_smfmac_f32_16x16x64_bf16 v[24:27], v[52:55], v[72:79], v108
  buffer_store_dwordx4 v[32:35], v109, s[4:7], 0 offen
  v_add_f32 v16, v16, v18
  s_waitcnt lgkmcnt(2)
  v_smfmac_f32_16x16x64_bf16 v[28:31], v[48:51], v[56:63], v108
  v_add_f32 v17, v17, v19
  v_cvt_pk_bf16_f32 v36, v16, v17
  s_waitcnt lgkmcnt(0)
  v_smfmac_f32_16x16x64_bf16 v[28:31], v[52:55], v[64:71], v108
  v_and_or_b32 v36, v36, -2, s24
  v_add_f32 v20, v20, v22
  v_add_f32 v21, v21, v23
  v_cvt_pk_bf16_f32 v37, v20, v21
  v_add_f32 v24, v24, v26
  v_add_f32 v25, v25, v27
  v_cvt_pk_bf16_f32 v38, v24, v25
  s_nop 0
  v_add_f32 v28, v28, v30
  v_add_f32 v29, v29, v31
  v_cvt_pk_bf16_f32 v39, v28, v29
  buffer_store_dwordx4 v[36:39], v109, s[4:7], s31 offen
  s_add_u32 s23, s23, 8192
  s_add_u32 s22, s22, 1
  s_mov_b32 s26, 0
  s_add_u32 s41, s41, s42
  s_branch Lb4_256
Llast_257:
  s_waitcnt vmcnt(3)
  ds_write_b128 v126, v[16:19] offset:0
  s_waitcnt vmcnt(2)
  ds_write_b128 v126, v[20:23] offset:1024
  v_max3_u32 v127, v16, v17, v18
  v_max3_u32 v127, v127, v19, v20
  v_max3_u32 v127, v127, v21, v22
  v_max_u32 v127, v127, v23
  v_cmp_eq_u32 vcc, -1, v127
  s_cbranch_vccnz Lh2s_270
Lh2_269:
Llast_257x:
  v_smfmac_f32_16x16x64_bf16 v[40:43], v[16:19], a[64:71], v108
  v_smfmac_f32_16x16x64_bf16 v[44:47], v[16:19], a[72:79], v108
  s_waitcnt lgkmcnt(0)
  s_barrier
  buffer_store_dwordx4 v[100:103], v124, s[4:7], s25 offen sc1
  s_add_u32 s25, s25, 65536
  buffer_load_dword v125, v123, s[4:7], s41 offen sc1
  ds_read_b128 v[24:27], v113 offset:6144
  ds_read_b128 v[28:31], v113 offset:7168
  ds_read_b128 v[0:3], v113 offset:0
  ds_read_b128 v[4:7], v113 offset:1024
  s_waitcnt vmcnt(2)
  ds_read_b128 v[8:11], v113 offset:2048
  ds_read_b128 v[12:15], v113 offset:3072
  v_smfmac_f32_16x16x64_bf16 v[40:43], v[20:23], a[80:87], v108
  v_smfmac_f32_16x16x64_bf16 v[44:47], v[20:23], a[88:95], v108
  s_waitcnt lgkmcnt(5)
  v_smfmac_f32_16x16x64_bf16 v[40:43], v[24:27], a[96:103], v108
  v_smfmac_f32_16x16x64_bf16 v[44:47], v[24:27], a[104:111], v108
  s_waitcnt lgkmcnt(4)
  v_smfmac_f32_16x16x64_bf16 v[44:47], v[28:31], a[120:127], v108
  s_waitcnt lgkmcnt(3)
  v_smfmac_f32_16x16x64_bf16 v[40:43], v[0:3], a[0:7], v108
  v_smfmac_f32_16x16x64_bf16 v[44:47], v[0:3], a[8:15], v108
  s_waitcnt lgkmcnt(2)
  v_smfmac_f32_16x16x64_bf16 v[40:43], v[4:7], a[16:23], v108
  v_smfmac_f32_16x16x64_bf16 v[44:47], v[4:7], a[24:31], v108
  v_smfmac_f32_16x16x64_bf16 v[40:43], v[28:31], a[112:119], v108
  s_waitcnt lgkmcnt(1)
  v_smfmac_f32_16x16x64_bf16 v[40:43], v[8:11], a[32:39], v108
  v_smfmac_f32_16x16x64_bf16 v[44:47], v[8:11], a[40:47], v108
  s_waitcnt lgkmcnt(0)
  v_smfmac_f32_16x16x64_bf16 v[40:43], v[12:15], a[48:55], v108
  v_smfmac_f32_16x16x64_bf16 v[44:47], v[12:15], a[56:63], v108
  v_mov_b64 v[56:57], 0
  v_mov_b64 v[58:59], 0
  v_mov_b64 v[60:61], 0
  v_mov_b64 v[62:63], 0
  v_smfmac_f32_16x16x64_bf16 v[56:59], v[0:3], v[128:135], v108
  s_nop 0
  v_smfmac_f32_16x16x64_bf16 v[60:63], v[0:3], v[136:143], v108
  v_add_f32 v40, v40, v42
  v_add_f32 v41, v41, v43
  v_add_f32 v44, v44, v46
  v_add_f32 v45, v45, v47
  v_mul_f32 v40, s44, v40
  v_mul_f32 v41, s44, v41
  v_mul_f32 v44, s44, v44
  v_mul_f32 v45, s44, v45
  v_cvt_pk_bf16_f32 v42, v40, v41
  v_cvt_pk_bf16_f32 v43, v44, v45
  ds_write2_b32 v116, v42, v43 offset0:0 offset1:128
  v_smfmac_f32_16x16x64_bf16 v[56:59], v[4:7], v[144:151], v108
  v_smfmac_f32_16x16x64_bf16 v[60:63], v[4:7], v[152:159], v108
  v_smfmac_f32_16x16x64_bf16 v[56:59], v[8:11], v[160:167], v108
  v_smfmac_f32_16x16x64_bf16 v[60:63], v[8:11], v[168:175], v108
  v_smfmac_f32_16x16x64_bf16 v[56:59], v[12:15], v[176:183], v108
  v_smfmac_f32_16x16x64_bf16 v[60:63], v[12:15], v[184:191], v108
  v_smfmac_f32_16x16x64_bf16 v[56:59], v[16:19], v[192:199], v108
  v_smfmac_f32_16x16x64_bf16 v[60:63], v[16:19], v[200:207], v108
  v_smfmac_f32_16x16x64_bf16 v[56:59], v[20:23], v[208:215], v108
  v_smfmac_f32_16x16x64_bf16 v[60:63], v[20:23], v[216:223], v108
  v_smfmac_f32_16x16x64_bf16 v[56:59], v[24:27], v[224:231], v108
  v_smfmac_f32_16x16x64_bf16 v[60:63], v[24:27], v[232:239], v108
  v_smfmac_f32_16x16x64_bf16 v[56:59], v[28:31], v[240:247], v108
  v_smfmac_f32_16x16x64_bf16 v[60:63], v[28:31], v[248:255], v108
  s_nop 6
  v_add_f32 v56, v56, v58
  v_add_f32 v57, v57, v59
  v_add_f32 v60, v60, v62
  v_add_f32 v61, v61, v63
  v_cvt_pk_bf16_f32 v72, v56, v57
  v_cvt_pk_bf16_f32 v76, v60, v61
  ds_write2_b32 v122, v72, v76 offset0:0 offset1:64
  s_waitcnt lgkmcnt(0)
  s_add_u32 s23, s23, 8192
  s_add_u32 s22, s22, 1
  s_mov_b32 s26, 0
  s_add_u32 s41, s41, s42
  v_add_u32 v126, s43, v117
  v_xor_b32 v127, 16, v126
  ds_read_b64_tr_b16 v[100:101], v126
  ds_read_b64_tr_b16 v[102:103], v127 offset:256
  v_subrev_u32 v126, s18, v124
  s_mov_b32 exec_lo, 0xcccccccc
  s_mov_b32 exec_hi, 0xcccccccc
  ds_read_b128 v[100:103], v126
  s_mov_b64 exec, -1
  s_waitcnt lgkmcnt(0)
  buffer_store_dwordx4 v[100:103], v124, s[4:7], s25 offen sc1
  s_add_u32 s25, s25, 65536
  s_sub_u32 s25, s25, 65536
  s_waitcnt vmcnt(0)
  s_barrier
  s_cmp_lt_u32 s23, 2097152
  s_cbranch_scc1 Llay_254
  s_branch Lfin_188
Lwv_209:
  s_lshl_b32 s29, s20, 8
  s_add_u32 s29, s29, 4096
  v_bfe_u32 v97, v113, 4, 1
  v_lshlrev_b32 v97, 7, v97
  v_add_u32 v97, s29, v97
  v_mov_b32 v96, 0
  s_nop 1
Llay_273:
  s_mov_b32 s22, 0
  v_add_u32 v126, s43, v117
  v_xor_b32 v127, 16, v126
  ds_read_b64_tr_b16 v[100:101], v126
  ds_read_b64_tr_b16 v[102:103], v127 offset:256
  v_subrev_u32 v126, s18, v124
  s_mov_b32 exec_lo, 0xcccccccc
  s_mov_b32 exec_hi, 0xcccccccc
  ds_read_b128 v[100:103], v126
  s_mov_b64 exec, -1
  ds_read_b128 v[56:59], v114 offset:0
  ds_read_b128 v[60:63], v114 offset:1024
  ds_read_b128 v[64:67], v114 offset:2048
  ds_read_b128 v[68:71], v114 offset:3072
  ds_read_b128 v[72:75], v114 offset:16384
  ds_read_b128 v[76:79], v114 offset:17408
  ds_read_b128 v[80:83], v114 offset:18432
  ds_read_b128 v[84:87], v114 offset:19456
  ds_read_b128 v[88:91], v114 offset:32768
  ds_read_b128 v[92:95], v114 offset:33792
  ds_read_b128 v[48:51], v114 offset:34816
  ds_read_b128 v[52:55], v114 offset:35840
  s_waitcnt lgkmcnt(0)
  v_add_u32 v126, 131072, v112
  buffer_load_dwordx4 v[24:27], v112, s[4:7], s23 offen offset:0 sc1
  buffer_load_dwordx4 v[28:31], v112, s[4:7], s23 offen offset:1024 sc1
  s_nop 15
  s_nop 15
  s_nop 1
  buffer_load_dwordx4 v[16:19], v112, s[4:7], s23 offen offset:0 sc1
  buffer_load_dwordx4 v[20:23], v112, s[4:7], s23 offen offset:1024 sc1
  s_mov_b32 s26, 0
  v_add_u32 v126, 139264, v112
  v_bfe_u32 v127, v113, 4, 1
  v_mul_u32_u24 v127, 2097152, v127
  v_lshlrev_b32 v127, 4, v127
  s_lshl_b32 s29, s21, 11
  v_add_u32 v127, s29, v127
  s_nop 1
Ldp_277:
  buffer_load_dword v125, v127, s[4:7], s37 offen offset:1024 sc1
  s_add_u32 s26, s26, 1
  s_cmp_gt_u32 s26, 8192
  s_cbranch_scc1 Ldp_278
  s_waitcnt vmcnt(0)
  v_cmp_eq_u32 vcc, -1, v125
  s_cbranch_vccnz Ldp_277
  s_mov_b32 m0, s39
  s_add_u32 s34, s34, 1
  buffer_load_dwordx4 v112, s[4:7], s37 offen sc1 lds
  buffer_load_dwordx4 v112, s[4:7], s37 offen offset:1024 sc1 lds
  s_add_u32 s37, s37, 0x40000
  s_mov_b32 m0, s40
  s_nop 0
  buffer_load_dwordx4 v112, s[4:7], s38 offen sc1 lds
  buffer_load_dwordx4 v112, s[4:7], s38 offen offset:1024 sc1 lds
  s_add_u32 s38, s38, 0x40000
  s_waitcnt vmcnt(0)
  ds_read_b128 v[32:35], v126 offset:0
  ds_read_b128 v[36:39], v126 offset:1024
  ds_read_b128 v[40:43], v126 offset:8192
  ds_read_b128 v[44:47], v126 offset:9216
  s_waitcnt lgkmcnt(0)
  v_max3_u32 v32, v32, v33, v34
  v_max3_u32 v32, v32, v35, v36
  v_max3_u32 v32, v32, v37, v38
  v_max3_u32 v32, v32, v39, v40
  v_max3_u32 v32, v32, v41, v42
  v_max3_u32 v32, v32, v43, v44
  v_max3_u32 v32, v32, v45, v46
  v_max_u32 v32, v32, v47
  v_cmp_eq_u32 vcc, -1, v32
  s_cbranch_vccz Ldp_279
  s_sub_u32 s34, s34, 1
  s_sub_u32 s37, s37, 0x40000
  s_sub_u32 s38, s38, 0x40000
  s_branch Ldp_277
Ldp_278:
  s_lshl_b32 s35, s34, 1
  s_or_b32 s35, s35, 3
  s_bitcmp1_b32 s34, 0
  s_cselect_b32 s30, s28, s27
  s_cmp_le_u32 s30, s35
  s_cbranch_scc1 Lkvs_281
Lkv_280:
  s_mov_b32 m0, s39
  s_add_u32 s34, s34, 1
  buffer_load_dwordx4 v112, s[4:7], s37 offen sc1 lds
  buffer_load_dwordx4 v112, s[4:7], s37 offen offset:1024 sc1 lds
  s_add_u32 s37, s37, 0x40000
  s_mov_b32 m0, s40
  s_nop 0
  buffer_load_dwordx4 v112, s[4:7], s38 offen sc1 lds
  buffer_load_dwordx4 v112, s[4:7], s38 offen offset:1024 sc1 lds
  s_add_u32 s38, s38, 0x40000
  s_waitcnt vmcnt(0)
Ldp_279:
  v_mov_b64 v[32:33], 0
  v_mov_b64 v[34:35], 0
  v_mov_b64 v[36:37], 0
  v_mov_b64 v[38:39], 0
  v_mov_b64 v[40:41], 0
  v_mov_b64 v[42:43], 0
  v_mov_b64 v[44:45], 0
  v_mov_b64 v[46:47], 0
  v_add_u32 v126, 131072, v112
  s_nop 0
  s_branch Lstep_274
.p2align 6
Lb4_275:
  v_add_u32 v126, s43, v117
  v_xor_b32 v127, 16, v126
  ds_read_b64_tr_b16 v[100:101], v126
  ds_read_b64_tr_b16 v[102:103], v127 offset:256
  v_subrev_u32 v126, s18, v124
  s_mov_b32 exec_lo, 0xcccccccc
  s_mov_b32 exec_hi, 0xcccccccc
  ds_read_b128 v[100:103], v126
  s_mov_b64 exec, -1
  ds_read_b128 v[56:59], v114 offset:0
  ds_read_b128 v[60:63], v114 offset:1024
  ds_read_b128 v[64:67], v114 offset:2048
  ds_read_b128 v[68:71], v114 offset:3072
  ds_read_b128 v[72:75], v114 offset:16384
  ds_read_b128 v[76:79], v114 offset:17408
  ds_read_b128 v[80:83], v114 offset:18432
  ds_read_b128 v[84:87], v114 offset:19456
  ds_read_b128 v[88:91], v114 offset:32768
  ds_read_b128 v[92:95], v114 offset:33792
  ds_read_b128 v[48:51], v114 offset:34816
  ds_read_b128 v[52:55], v114 offset:35840
  v_mov_b64 v[32:33], 0
  v_mov_b64 v[34:35], 0
  v_mov_b64 v[36:37], 0
  v_mov_b64 v[38:39], 0
  v_mov_b64 v[40:41], 0
  v_mov_b64 v[42:43], 0
  v_mov_b64 v[44:45], 0
  v_mov_b64 v[46:47], 0
  s_barrier
  s_xor_b32 s24, s24, 1
  s_waitcnt lgkmcnt(0)
  v_add_u32 v126, 131072, v112
  s_nop 15
  s_nop 15
  s_nop 9
  buffer_load_dwordx4 v[24:27], v112, s[4:7], s23 offen offset:0 sc1
  buffer_load_dwordx4 v[28:31], v112, s[4:7], s23 offen offset:1024 sc1
  s_nop 15
  s_nop 15
  s_nop 1
  buffer_load_dwordx4 v[16:19], v112, s[4:7], s23 offen offset:0 sc1
  buffer_load_dwordx4 v[20:23], v112, s[4:7], s23 offen offset:1024 sc1
  s_cmp_eq_u32 s22, 63
  s_cbranch_scc1 Llast_276
Lstep_274:
  s_waitcnt vmcnt(3)
  ds_write_b128 v126, v[24:27] offset:0
  s_waitcnt vmcnt(2)
  ds_write_b128 v126, v[28:31] offset:1024
  v_max3_u32 v127, v24, v25, v26
  v_max3_u32 v127, v127, v27, v28
  v_max3_u32 v127, v127, v29, v30
  v_max_u32 v127, v127, v31
  v_cmp_eq_u32 vcc, -1, v127
  s_cbranch_vccnz Lh2s_283
Lh2_282:
  v_smfmac_f32_16x16x64_bf16 v[32:35], v[24:27], v[56:63], v108
  v_smfmac_f32_16x16x64_bf16 v[36:39], v[24:27], v[64:71], v108
  s_waitcnt lgkmcnt(0)
  s_barrier
  ds_read_b128 v[0:3], v113 offset:0
  ds_read_b128 v[4:7], v113 offset:1024
  v_smfmac_f32_16x16x64_bf16 v[32:35], v[28:31], v[72:79], v108
  ds_read_b128 v[8:11], v113 offset:2048
  v_smfmac_f32_16x16x64_bf16 v[36:39], v[28:31], v[80:87], v108
  ds_read_b128 v[12:15], v113 offset:3072
  v_smfmac_f32_16x16x64_bf16 v[40:43], v[24:27], a[96:103], v108
  s_waitcnt vmcnt(0)
  ds_read_b128 v[16:19], v113 offset:4096
  v_xor_b32 v127, 0x80, v119
  v_smfmac_f32_16x16x64_bf16 v[44:47], v[24:27], a[104:111], v108
  ds_read_b128 v[20:23], v113 offset:5120
  v_add_u32 v126, -2048, v122
  v_smfmac_f32_16x16x64_bf16 v[40:43], v[28:31], a[112:119], v108
  ds_read_b128 v[56:59], v114 offset:49152
  v_readlane_b32 s27, v96, 0
  v_readlane_b32 s28, v96, 1
  buffer_load_dword v96, v97, s[4:7], 0 offen sc1
  buffer_store_dwordx4 v[100:103], v124, s[4:7], s25 offen sc1
  s_add_u32 s25, s25, 65536
  s_sub_u32 s29, s33, 1
  s_max_i32 s19, s19, s29
  v_mov_b32 v123, s19
  s_add_u32 s33, s33, 1
  buffer_store_dword v123, off, s[4:7], s36 sc1
  v_smfmac_f32_16x16x64_bf16 v[44:47], v[28:31], a[120:127], v108
  ds_read_b128 v[60:63], v114 offset:50176
  s_waitcnt lgkmcnt(7)
  v_smfmac_f32_16x16x64_bf16 v[32:35], v[0:3], v[88:95], v108
  ds_read_b128 v[64:67], v115 offset:32768
  v_smfmac_f32_16x16x64_bf16 v[36:39], v[0:3], v[48:55], v108
  ds_read_b128 v[68:71], v115 offset:33792
  s_waitcnt lgkmcnt(8)
  v_smfmac_f32_16x16x64_bf16 v[36:39], v[4:7], a[128:135], v108
  ds_read_b128 v[72:75], v115 offset:34816
  s_waitcnt lgkmcnt(8)
  v_smfmac_f32_16x16x64_bf16 v[32:35], v[8:11], a[136:143], v108
  ds_read_b128 v[76:79], v115 offset:35840
  v_smfmac_f32_16x16x64_bf16 v[36:39], v[8:11], a[144:151], v108
  ds_read_b128 v[80:83], v115 offset:49152
  s_waitcnt lgkmcnt(9)
  v_smfmac_f32_16x16x64_bf16 v[32:35], v[12:15], a[152:159], v108
  ds_read_b128 v[84:87], v115 offset:50176
  v_smfmac_f32_16x16x64_bf16 v[36:39], v[12:15], a[160:167], v108
  ds_read_b128 v[88:91], v115 offset:51200
  s_waitcnt lgkmcnt(7)
  v_smfmac_f32_16x16x64_bf16 v[32:35], v[4:7], v[56:63], v108
  ds_read_b128 v[92:95], v115 offset:52224
  s_waitcnt lgkmcnt(6)
  v_smfmac_f32_16x16x64_bf16 v[32:35], v[16:19], v[64:71], v108
  ds_read_b128 v[56:59], v119 offset:0
  s_waitcnt lgkmcnt(5)
  v_smfmac_f32_16x16x64_bf16 v[36:39], v[16:19], v[72:79], v108
  ds_read_b128 v[60:63], v127 offset:0
  s_waitcnt lgkmcnt(4)
  v_smfmac_f32_16x16x64_bf16 v[32:35], v[20:23], v[80:87], v108
  ds_read_b128 v[64:67], v119 offset:2048
  s_waitcnt lgkmcnt(3)
  v_smfmac_f32_16x16x64_bf16 v[36:39], v[20:23], v[88:95], v108
  ds_read_b128 v[68:71], v127 offset:2048
  v_smfmac_f32_16x16x64_bf16 v[40:43], v[0:3], a[0:7], v108
  ds_read_b128 v[72:75], v119 offset:4096
  ds_read_b128 v[76:79], v127 offset:4096
  v_smfmac_f32_16x16x64_bf16 v[44:47], v[0:3], a[8:15], v108
  ds_read_b128 v[80:83], v119 offset:6144
  ds_read_b128 v[84:87], v127 offset:6144
  v_smfmac_f32_16x16x64_bf16 v[44:47], v[4:7], a[24:31], v108
  v_add_f32 v32, v32, v34
  v_add_f32 v33, v33, v35
  v_smfmac_f32_16x16x64_bf16 v[40:43], v[8:11], a[32:39], v108
  v_add_f32 v36, v36, v38
  v_add_f32 v37, v37, v39
  v_smfmac_f32_16x16x64_bf16 v[44:47], v[8:11], a[40:47], v108
  v_cvt_pk_bf16_f32 v34, v32, v33
  v_cvt_pk_bf16_f32 v35, v36, v37
  ds_write2_b32 v126, v34, v35 offset0:0 offset1:64
  v_smfmac_f32_16x16x64_bf16 v[40:43], v[12:15], a[48:55], v108
  v_smfmac_f32_16x16x64_bf16 v[44:47], v[12:15], a[56:63], v108
  v_smfmac_f32_16x16x64_bf16 v[40:43], v[4:7], a[16:23], v108
  v_smfmac_f32_16x16x64_bf16 v[40:43], v[16:19], a[64:71], v108
  s_waitcnt lgkmcnt(0)
  s_barrier
  ds_read_b64_tr_b16 v[32:33], v118 offset:0
  ds_read_b64_tr_b16 v[34:35], v118 offset:128
  v_smfmac_f32_16x16x64_bf16 v[44:47], v[16:19], a[72:79], v108
  ds_read_b64_tr_b16 v[36:37], v118 offset:512
  ds_read_b64_tr_b16 v[38:39], v118 offset:640
  v_smfmac_f32_16x16x64_bf16 v[40:43], v[20:23], a[80:87], v108
  ds_read_b64_tr_b16 v[48:49], v118 offset:1024
  ds_read_b64_tr_b16 v[50:51], v118 offset:1152
  v_smfmac_f32_16x16x64_bf16 v[44:47], v[20:23], a[88:95], v108
  ds_read_b64_tr_b16 v[52:53], v118 offset:1536
  ds_read_b64_tr_b16 v[54:55], v118 offset:1664
  v_xor_b32 v127, 16, v117
  s_waitcnt lgkmcnt(6)
  v_mfma_f32_16x16x32_bf16 v[88:91], v[56:59], v[32:35], 0
  v_mfma_f32_16x16x32_bf16 v[92:95], v[60:63], v[32:35], 0
  v_mov_b64 v[56:57], 0
  v_mov_b64 v[58:59], 0
  s_waitcnt lgkmcnt(4)
  v_mfma_f32_16x16x32_bf16 v[88:91], v[64:67], v[36:39], v[88:91]
  v_add_f32 v40, v40, v42
  v_add_f32 v41, v41, v43
  v_mfma_f32_16x16x32_bf16 v[92:95], v[68:71], v[36:39], v[92:95]
  v_add_f32 v44, v44, v46
  v_add_f32 v45, v45, v47
  s_waitcnt lgkmcnt(2)
  v_mfma_f32_16x16x32_bf16 v[88:91], v[72:75], v[48:51], v[88:91]
  v_mul_f32 v40, s44, v40
  v_mul_f32 v41, s44, v41
  v_mfma_f32_16x16x32_bf16 v[92:95], v[76:79], v[48:51], v[92:95]
  v_mul_f32 v44, s44, v44
  v_mul_f32 v45, s44, v45
  s_waitcnt lgkmcnt(0)
  v_mfma_f32_16x16x32_bf16 v[88:91], v[80:83], v[52:55], v[88:91]
  v_cvt_pk_bf16_f32 v42, v40, v41
  v_cvt_pk_bf16_f32 v43, v44, v45
  ds_write2_b32 v116, v42, v43 offset0:0 offset1:128
  v_mfma_f32_16x16x32_bf16 v[92:95], v[84:87], v[52:55], v[92:95]
  v_mov_b64 v[60:61], 0
  v_mov_b64 v[62:63], 0
  v_smfmac_f32_16x16x64_bf16 v[56:59], v[0:3], v[128:135], v108
  v_mov_b64 v[46:47], 0
  v_smfmac_f32_16x16x64_bf16 v[60:63], v[0:3], v[136:143], v108
  v_mov_b32 v45, 0
  v_smfmac_f32_16x16x64_bf16 v[56:59], v[4:7], v[144:151], v108
  v_max3_f32 v126, abs(v88), abs(v89), abs(v90)
  s_waitcnt lgkmcnt(0)
  s_barrier
  ds_read_b64_tr_b16 v[64:65], v117 offset:0
  ds_read_b64_tr_b16 v[66:67], v127 offset:256
  ds_read_b64_tr_b16 v[68:69], v117 offset:1024
  ds_read_b64_tr_b16 v[70:71], v127 offset:1280
  v_smfmac_f32_16x16x64_bf16 v[60:63], v[4:7], v[152:159], v108
  ds_read_b64_tr_b16 v[72:73], v117 offset:2048
  ds_read_b64_tr_b16 v[74:75], v127 offset:2304
  v_max3_f32 v126, v126, abs(v91), abs(v92)
  v_smfmac_f32_16x16x64_bf16 v[56:59], v[8:11], v[160:167], v108
  ds_read_b64_tr_b16 v[76:77], v117 offset:3072
  ds_read_b64_tr_b16 v[78:79], v127 offset:3328
  v_max3_f32 v126, v126, abs(v93), abs(v94)
  s_waitcnt lgkmcnt(6)
  v_mfma_f32_16x16x32_bf16 v[100:103], v[64:67], v[32:35], 0
  v_exp_f32 v80, v88
  s_waitcnt lgkmcnt(4)
  v_mfma_f32_16x16x32_bf16 v[100:103], v[68:71], v[36:39], v[100:103]
  v_exp_f32 v81, v89
  s_waitcnt lgkmcnt(2)
  v_mfma_f32_16x16x32_bf16 v[100:103], v[72:75], v[48:51], v[100:103]
  v_exp_f32 v82, v90
  s_waitcnt lgkmcnt(0)
  v_mfma_f32_16x16x32_bf16 v[100:103], v[76:79], v[52:55], v[100:103]
  v_exp_f32 v83, v91
  ds_read_b128 v[64:67], v120 offset:0
  ds_read_b128 v[68:71], v120 offset:256
  v_smfmac_f32_16x16x64_bf16 v[60:63], v[8:11], v[168:175], v108
  v_max_f32_e64 v126, v126, abs(v95)
  v_smfmac_f32_16x16x64_bf16 v[56:59], v[12:15], v[176:183], v108
  v_cvt_pk_bf16_f32 v40, v80, v81
  v_smfmac_f32_16x16x64_bf16 v[60:63], v[12:15], v[184:191], v108
  v_cvt_pk_bf16_f32 v41, v82, v83
  v_smfmac_f32_16x16x64_bf16 v[56:59], v[16:19], v[192:199], v108
  v_exp_f32 v84, v92
  v_smfmac_f32_16x16x64_bf16 v[60:63], v[16:19], v[200:207], v108
  v_exp_f32 v85, v93
  v_smfmac_f32_16x16x64_bf16 v[56:59], v[20:23], v[208:215], v108
  v_exp_f32 v86, v94
  v_smfmac_f32_16x16x64_bf16 v[60:63], v[20:23], v[216:223], v108
  v_exp_f32 v87, v95
  v_smfmac_f32_16x16x64_bf16 v[56:59], v[24:27], v[224:231], v108
  v_cvt_pk_bf16_f32 v42, v84, v85
  v_smfmac_f32_16x16x64_bf16 v[60:63], v[24:27], v[232:239], v108
  v_max3_f32 v126, v126, v100, v101
  v_smfmac_f32_16x16x64_bf16 v[56:59], v[28:31], v[240:247], v108
  v_cvt_pk_bf16_f32 v43, v86, v87
  v_smfmac_f32_16x16x64_bf16 v[60:63], v[28:31], v[248:255], v108
  v_cmp_nge_f32 vcc, 0x42700000, v126
  s_waitcnt lgkmcnt(0)
  v_mfma_f32_16x16x32_bf16 v[48:51], v[104:107], v[40:43], 0
  v_exp_f32 v80, v100
  v_mfma_f32_16x16x32_bf16 v[32:35], v[64:67], v[40:43], 0
  v_exp_f32 v81, v101
  v_mfma_f32_16x16x32_bf16 v[36:39], v[68:71], v[40:43], 0
  v_cvt_pk_bf16_f32 v44, v80, v81
  s_cbranch_vccnz Lfb_286
Lok_287:
  v_add_f32 v56, v56, v58
  v_add_f32 v57, v57, v59
  v_mfma_f32_16x16x32_bf16 v[48:51], v[104:107], v[44:47], v[48:51]
  v_add_f32 v60, v60, v62
  v_add_f32 v61, v61, v63
  v_cvt_pk_bf16_f32 v72, v56, v57
  v_cvt_pk_bf16_f32 v76, v60, v61
  s_nop 0
  v_mfma_f32_16x16x32_bf16 v[32:35], v[72:75], v[44:47], v[32:35]
  ds_write2_b32 v122, v72, v76 offset0:0 offset1:64
  v_mov_b64 v[0:1], 0
  v_mfma_f32_16x16x32_bf16 v[36:39], v[76:79], v[44:47], v[36:39]
  v_rcp_f32 v126, v48
  v_mov_b64 v[2:3], 0
  v_mov_b64 v[4:5], 0
  v_mov_b64 v[6:7], 0
  v_mov_b64 v[8:9], 0
  v_mov_b64 v[10:11], 0
  v_mov_b64 v[12:13], 0
  v_mov_b64 v[14:15], 0
  v_pk_mul_f32 v[32:33], v[32:33], v[126:127] op_sel_hi:[1,0]
  v_pk_mul_f32 v[34:35], v[34:35], v[126:127] op_sel_hi:[1,0]
  v_cvt_pk_bf16_f32 v40, v32, v33
  v_cvt_pk_bf16_f32 v41, v34, v35
  ds_write_b64 v121, v[40:41] offset:0
  v_pk_mul_f32 v[36:37], v[36:37], v[126:127] op_sel_hi:[1,0]
  v_pk_mul_f32 v[38:39], v[38:39], v[126:127] op_sel_hi:[1,0]
  v_cvt_pk_bf16_f32 v42, v36, v37
  v_cvt_pk_bf16_f32 v43, v38, v39
  ds_write_b64 v121, v[42:43] offset:256
  s_lshl_b32 s35, s34, 1
  s_or_b32 s35, s35, 3
  s_bitcmp1_b32 s34, 0
  s_cselect_b32 s30, s28, s27
  s_cmp_le_u32 s30, s35
  s_cbranch_scc1 Lkvs_289
Lkv_288:
  v_mov_b64 v[16:17], 0
  v_mov_b64 v[18:19], 0
  v_mov_b64 v[20:21], 0
  v_mov_b64 v[22:23], 0
  v_mov_b64 v[24:25], 0
  v_mov_b64 v[26:27], 0
  v_mov_b64 v[28:29], 0
  v_mov_b64 v[30:31], 0
  s_waitcnt lgkmcnt(0)
  s_barrier
  ds_read_b128 v[48:51], v113 offset:28672
  ds_read_b128 v[52:55], v113 offset:29696
  s_mov_b32 m0, s39
  s_add_u32 s34, s34, 1
  buffer_load_dwordx4 v112, s[4:7], s37 offen sc1 lds
  s_waitcnt lgkmcnt(1)
  v_smfmac_f32_16x16x64_bf16 v[0:3], v[48:51], a[168:175], v108
  ds_read_b128 v[88:91], v114 offset:51200
  buffer_load_dwordx4 v112, s[4:7], s37 offen offset:1024 sc1 lds
  s_add_u32 s37, s37, 0x40000
  s_waitcnt lgkmcnt(1)
  v_smfmac_f32_16x16x64_bf16 v[0:3], v[52:55], a[176:183], v108
  ds_read_b128 v[92:95], v114 offset:52224
  s_mov_b32 m0, s40
  s_nop 0
  buffer_load_dwordx4 v112, s[4:7], s38 offen sc1 lds
  v_smfmac_f32_16x16x64_bf16 v[4:7], v[48:51], a[184:191], v108
  ds_read_b128 v[80:83], v115 offset:0
  buffer_load_dwordx4 v112, s[4:7], s38 offen offset:1024 sc1 lds
  s_add_u32 s38, s38, 0x40000
  v_smfmac_f32_16x16x64_bf16 v[4:7], v[52:55], a[192:199], v108
  ds_read_b128 v[84:87], v115 offset:1024
  v_smfmac_f32_16x16x64_bf16 v[8:11], v[48:51], a[200:207], v108
  ds_read_b128 v[72:75], v115 offset:2048
  v_add_f32 v0, v0, v2
  v_smfmac_f32_16x16x64_bf16 v[8:11], v[52:55], a[208:215], v108
  ds_read_b128 v[76:79], v115 offset:3072
  v_add_f32 v1, v1, v3
  v_smfmac_f32_16x16x64_bf16 v[12:15], v[48:51], a[216:223], v108
  ds_read_b128 v[56:59], v115 offset:16384
  v_cvt_pk_bf16_f32 v32, v0, v1
  v_smfmac_f32_16x16x64_bf16 v[12:15], v[52:55], a[224:231], v108
  ds_read_b128 v[60:63], v115 offset:17408
  v_and_or_b32 v32, v32, -2, s24
  v_add_f32 v4, v4, v6
  v_smfmac_f32_16x16x64_bf16 v[16:19], v[48:51], a[232:239], v108
  ds_read_b128 v[64:67], v115 offset:18432
  v_add_f32 v5, v5, v7
  v_smfmac_f32_16x16x64_bf16 v[16:19], v[52:55], a[240:247], v108
  ds_read_b128 v[68:71], v115 offset:19456
  v_cvt_pk_bf16_f32 v33, v4, v5
  v_add_f32 v8, v8, v10
  v_smfmac_f32_16x16x64_bf16 v[20:23], v[48:51], a[248:255], v108
  v_add_f32 v9, v9, v11
  s_waitcnt lgkmcnt(8)
  v_smfmac_f32_16x16x64_bf16 v[20:23], v[52:55], v[88:95], v108
  v_cvt_pk_bf16_f32 v34, v8, v9
  v_add_f32 v12, v12, v14
  s_waitcnt lgkmcnt(6)
  v_smfmac_f32_16x16x64_bf16 v[24:27], v[48:51], v[80:87], v108
  v_add_f32 v13, v13, v15
  v_cvt_pk_bf16_f32 v35, v12, v13
  s_waitcnt lgkmcnt(4)
  v_smfmac_f32_16x16x64_bf16 v[24:27], v[52:55], v[72:79], v108
  buffer_store_dwordx4 v[32:35], v109, s[4:7], 0 offen
  v_add_f32 v16, v16, v18
  s_waitcnt lgkmcnt(2)
  v_smfmac_f32_16x16x64_bf16 v[28:31], v[48:51], v[56:63], v108
  v_add_f32 v17, v17, v19
  v_cvt_pk_bf16_f32 v36, v16, v17
  s_waitcnt lgkmcnt(0)
  v_smfmac_f32_16x16x64_bf16 v[28:31], v[52:55], v[64:71], v108
  v_and_or_b32 v36, v36, -2, s24
  v_add_f32 v20, v20, v22
  v_add_f32 v21, v21, v23
  v_cvt_pk_bf16_f32 v37, v20, v21
  v_add_f32 v24, v24, v26
  v_add_f32 v25, v25, v27
  v_cvt_pk_bf16_f32 v38, v24, v25
  s_nop 0
  v_add_f32 v28, v28, v30
  v_add_f32 v29, v29, v31
  v_cvt_pk_bf16_f32 v39, v28, v29
  buffer_store_dwordx4 v[36:39], v109, s[4:7], s31 offen
  s_add_u32 s23, s23, 8192
  s_add_u32 s22, s22, 1
  s_mov_b32 s26, 0
  s_add_u32 s41, s41, s42
  s_branch Lb4_275
Llast_276:
  s_waitcnt vmcnt(3)
  ds_write_b128 v126, v[24:27] offset:0
  s_waitcnt vmcnt(2)
  ds_write_b128 v126, v[28:31] offset:1024
  v_max3_u32 v127, v24, v25, v26
  v_max3_u32 v127, v127, v27, v28
  v_max3_u32 v127, v127, v29, v30
  v_max_u32 v127, v127, v31
  v_cmp_eq_u32 vcc, -1, v127
  s_cbranch_vccnz Lh2s_291
Lh2_290:
Llast_276x:
  v_smfmac_f32_16x16x64_bf16 v[40:43], v[24:27], a[96:103], v108
  v_smfmac_f32_16x16x64_bf16 v[44:47], v[24:27], a[104:111], v108
  s_waitcnt lgkmcnt(0)
  s_barrier
  buffer_store_dwordx4 v[100:103], v124, s[4:7], s25 offen sc1
  s_add_u32 s25, s25, 65536
  s_sub_u32 s29, s33, 1
  s_max_i32 s19, s19, s29
  v_mov_b32 v123, s19
  s_add_u32 s33, s33, 1
  buffer_store_dword v123, off, s[4:7], s36 sc1
  ds_read_b128 v[0:3], v113 offset:0
  ds_read_b128 v[4:7], v113 offset:1024
  ds_read_b128 v[8:11], v113 offset:2048
  ds_read_b128 v[12:15], v113 offset:3072
  s_waitcnt vmcnt(2)
  ds_read_b128 v[16:19], v113 offset:4096
  ds_read_b128 v[20:23], v113 offset:5120
  v_smfmac_f32_16x16x64_bf16 v[40:43], v[28:31], a[112:119], v108
  v_smfmac_f32_16x16x64_bf16 v[44:47], v[28:31], a[120:127], v108
  s_waitcnt lgkmcnt(5)
  v_smfmac_f32_16x16x64_bf16 v[40:43], v[0:3], a[0:7], v108
  v_smfmac_f32_16x16x64_bf16 v[44:47], v[0:3], a[8:15], v108
  s_waitcnt lgkmcnt(4)
  v_smfmac_f32_16x16x64_bf16 v[44:47], v[4:7], a[24:31], v108
  s_waitcnt lgkmcnt(3)
  v_smfmac_f32_16x16x64_bf16 v[40:43], v[8:11], a[32:39], v108
  v_smfmac_f32_16x16x64_bf16 v[44:47], v[8:11], a[40:47], v108
  s_waitcnt lgkmcnt(2)
  v_smfmac_f32_16x16x64_bf16 v[40:43], v[12:15], a[48:55], v108
  v_smfmac_f32_16x16x64_bf16 v[44:47], v[12:15], a[56:63], v108
  v_smfmac_f32_16x16x64_bf16 v[40:43], v[4:7], a[16:23], v108
  s_waitcnt lgkmcnt(1)
  v_smfmac_f32_16x16x64_bf16 v[40:43], v[16:19], a[64:71], v108
  v_smfmac_f32_16x16x64_bf16 v[44:47], v[16:19], a[72:79], v108
  s_waitcnt lgkmcnt(0)
  v_smfmac_f32_16x16x64_bf16 v[40:43], v[20:23], a[80:87], v108
  v_smfmac_f32_16x16x64_bf16 v[44:47], v[20:23], a[88:95], v108
  v_mov_b64 v[56:57], 0
  v_mov_b64 v[58:59], 0
  v_mov_b64 v[60:61], 0
  v_mov_b64 v[62:63], 0
  v_smfmac_f32_16x16x64_bf16 v[56:59], v[0:3], v[128:135], v108
  s_nop 0
  v_smfmac_f32_16x16x64_bf16 v[60:63], v[0:3], v[136:143], v108
  v_add_f32 v40, v40, v42
  v_add_f32 v41, v41, v43
  v_add_f32 v44, v44, v46
  v_add_f32 v45, v45, v47
  v_mul_f32 v40, s44, v40
  v_mul_f32 v41, s44, v41
  v_mul_f32 v44, s44, v44
  v_mul_f32 v45, s44, v45
  v_cvt_pk_bf16_f32 v42, v40, v41
  v_cvt_pk_bf16_f32 v43, v44, v45
  ds_write2_b32 v116, v42, v43 offset0:0 offset1:128
  v_smfmac_f32_16x16x64_bf16 v[56:59], v[4:7], v[144:151], v108
  v_smfmac_f32_16x16x64_bf16 v[60:63], v[4:7], v[152:159], v108
  v_smfmac_f32_16x16x64_bf16 v[56:59], v[8:11], v[160:167], v108
  v_smfmac_f32_16x16x64_bf16 v[60:63], v[8:11], v[168:175], v108
  v_smfmac_f32_16x16x64_bf16 v[56:59], v[12:15], v[176:183], v108
  v_smfmac_f32_16x16x64_bf16 v[60:63], v[12:15], v[184:191], v108
  v_smfmac_f32_16x16x64_bf16 v[56:59], v[16:19], v[192:199], v108
  v_smfmac_f32_16x16x64_bf16 v[60:63], v[16:19], v[200:207], v108
  v_smfmac_f32_16x16x64_bf16 v[56:59], v[20:23], v[208:215], v108
  v_smfmac_f32_16x16x64_bf16 v[60:63], v[20:23], v[216:223], v108
  v_smfmac_f32_16x16x64_bf16 v[56:59], v[24:27], v[224:231], v108
  v_smfmac_f32_16x16x64_bf16 v[60:63], v[24:27], v[232:239], v108
  v_smfmac_f32_16x16x64_bf16 v[56:59], v[28:31], v[240:247], v108
  v_smfmac_f32_16x16x64_bf16 v[60:63], v[28:31], v[248:255], v108
  s_nop 6
  v_add_f32 v56, v56, v58
  v_add_f32 v57, v57, v59
  v_add_f32 v60, v60, v62
  v_add_f32 v61, v61, v63
  v_cvt_pk_bf16_f32 v72, v56, v57
  v_cvt_pk_bf16_f32 v76, v60, v61
  ds_write2_b32 v122, v72, v76 offset0:0 offset1:64
  s_waitcnt lgkmcnt(0)
  s_add_u32 s23, s23, 8192
  s_add_u32 s22, s22, 1
  s_mov_b32 s26, 0
  s_add_u32 s41, s41, s42
  v_add_u32 v126, s43, v117
  v_xor_b32 v127, 16, v126
  ds_read_b64_tr_b16 v[100:101], v126
  ds_read_b64_tr_b16 v[102:103], v127 offset:256
  v_subrev_u32 v126, s18, v124
  s_mov_b32 exec_lo, 0xcccccccc
  s_mov_b32 exec_hi, 0xcccccccc
  ds_read_b128 v[100:103], v126
  s_mov_b64 exec, -1
  s_waitcnt lgkmcnt(0)
  buffer_store_dwordx4 v[100:103], v124, s[4:7], s25 offen sc1
  s_add_u32 s25, s25, 65536
  s_sub_u32 s25, s25, 65536
  s_waitcnt vmcnt(0)
  s_barrier
  v_mov_b32 v123, s33
  s_mov_b32 s19, s33
  buffer_store_dword v123, off, s[4:7], s36 sc1
  s_cmp_lt_u32 s23, 2097152
  s_cbranch_scc1 Llay_273
  s_waitcnt vmcnt(0)
  s_branch Labort_187
  s_branch Lfin_188
Lkvs_218:
  s_mov_b32 s26, 0
Lkvt_294:
  s_and_b32 s29, s34, 1
  s_lshl_b32 s30, s20, 1
  s_add_u32 s29, s29, s30
  s_lshl_b32 s29, s29, 7
  s_add_u32 s29, s29, 4096
  s_sub_u32 s30, s41, 262144
  buffer_load_dword v125, v123, s[4:7], s30 offen sc1
  buffer_load_dword v125, off, s[4:7], s29 sc1
  s_waitcnt vmcnt(0)
  v_readfirstlane_b32 s30, v125
  s_bitcmp1_b32 s34, 0
  s_cselect_b32 s27, s27, s30
  s_cselect_b32 s28, s30, s28
  s_cmp_gt_u32 s30, s35
  s_cbranch_scc1 Lkv_217
  s_add_u32 s26, s26, 1
  s_and_b32 s29, s26, 4095
  s_cmp_lg_u32 s29, 0
  s_cbranch_scc1 Lkvt_294
  buffer_wbl2 sc1
  s_waitcnt vmcnt(0)
  s_cmp_lt_u32 s26, 0x40000
  s_cbranch_scc1 Lkvt_294
  s_branch Labort_187
Lh1s_220:
  s_add_u32 s53, s53, 1
  s_mov_b32 s26, 0
Lh1t_221:
  s_waitcnt vmcnt(3)
  v_mfma_f32_16x16x32_bf16 v[100:103], v[16:19], v[96:99], 0
  v_xor_b32 v126, s24, v16
  s_waitcnt vmcnt(2)
  v_mfma_f32_16x16x32_bf16 v[100:103], v[20:23], v[96:99], v[100:103]
  v_bitop3_b32 v126, v126, v20, s24 bitop3:0xf6
  s_waitcnt vmcnt(1)
  v_mfma_f32_16x16x32_bf16 v[100:103], v[24:27], v[96:99], v[100:103]
  v_bitop3_b32 v126, v126, v24, s24 bitop3:0xf6
  s_waitcnt vmcnt(0)
  v_mfma_f32_16x16x32_bf16 v[100:103], v[28:31], v[96:99], v[100:103]
  v_bitop3_b32 v126, v126, v28, s24 bitop3:0xf6
  v_and_b32 v126, 1, v126
  v_cmp_ne_u32 vcc, 0, v126
  s_nop 3
  s_cbranch_vccz Lh1_219
  buffer_load_dwordx4 v[16:19], v110, s[4:7], 0 offen offset:0 sc1
  buffer_load_dwordx4 v[20:23], v110, s[4:7], 0 offen offset:2048 sc1
  buffer_load_dwordx4 v[24:27], v110, s[4:7], s32 offen offset:0 sc1
  buffer_load_dwordx4 v[28:31], v110, s[4:7], s32 offen offset:2048 sc1
  s_add_u32 s26, s26, 1
  s_and_b32 s29, s26, 63
  s_cmp_lg_u32 s29, 0
  s_cbranch_scc1 Lh1t_221
  buffer_wbl2 sc1
  s_waitcnt vmcnt(0)
  s_cmp_lt_u32 s26, 0x40000
  s_cbranch_scc1 Lh1t_221
  s_branch Labort_187
Lh2s_223:
  s_add_u32 s52, s52, 1
  s_mov_b32 s26, 0
Lh2t_224:
  s_waitcnt vmcnt(1)
  ds_write_b128 v126, v[24:27] offset:0
  s_waitcnt vmcnt(0)
  ds_write_b128 v126, v[28:31] offset:1024
  v_max3_u32 v127, v24, v25, v26
  v_max3_u32 v127, v127, v27, v28
  v_max3_u32 v127, v127, v29, v30
  v_max_u32 v127, v127, v31
  v_cmp_eq_u32 vcc, -1, v127
  s_cbranch_vccz Lh2g_225
  s_waitcnt lgkmcnt(0)
  buffer_load_dwordx4 v[24:27], v112, s[4:7], s23 offen offset:0 sc1
  buffer_load_dwordx4 v[28:31], v112, s[4:7], s23 offen offset:1024 sc1
  s_add_u32 s26, s26, 1
  s_and_b32 s29, s26, 63
  s_cmp_lg_u32 s29, 0
  s_cbranch_scc1 Lh2t_224
  buffer_wbl2 sc1
  s_waitcnt vmcnt(0)
  s_cmp_lt_u32 s26, 0x40000
  s_cbranch_scc1 Lh2t_224
  s_branch Labort_187
Lh2g_225:
  v_mov_b64 v[0:1], v[24:25]
  v_mov_b64 v[2:3], v[26:27]
  v_mov_b64 v[4:5], v[28:29]
  v_mov_b64 v[6:7], v[30:31]
  s_nop 0
  s_branch Lh2_222
Lfb_226:
  s_nop 7
  v_max3_f32 v126, v88, v89, v90
  v_max3_f32 v127, v92, v93, v94
  v_max3_f32 v126, v126, v91, v95
  v_max3_f32 v127, v127, v100, v101
  v_max_f32 v126, v126, v127
  v_mov_b32 v127, v126
  s_nop 1
  v_permlane32_swap_b32 v126, v127
  v_max_f32 v126, v126, v127
  v_mov_b32 v127, v126
  s_nop 1
  v_permlane16_swap_b32 v126, v127
  v_max_f32 v126, v126, v127
  v_sub_f32 v88, v88, v126
  v_sub_f32 v89, v89, v126
  v_sub_f32 v90, v90, v126
  v_sub_f32 v91, v91, v126
  v_sub_f32 v92, v92, v126
  v_sub_f32 v93, v93, v126
  v_sub_f32 v94, v94, v126
  v_sub_f32 v95, v95, v126
  v_sub_f32 v100, v100, v126
  v_sub_f32 v101, v101, v126
  v_exp_f32 v80, v88
  v_exp_f32 v81, v89
  v_exp_f32 v82, v90
  v_exp_f32 v83, v91
  v_exp_f32 v84, v92
  v_exp_f32 v85, v93
  v_exp_f32 v86, v94
  v_exp_f32 v87, v95
  v_cvt_pk_bf16_f32 v40, v80, v81
  v_cvt_pk_bf16_f32 v41, v82, v83
  v_cvt_pk_bf16_f32 v42, v84, v85
  v_cvt_pk_bf16_f32 v43, v86, v87
  s_nop 1
  v_mfma_f32_16x16x32_bf16 v[48:51], v[104:107], v[40:43], 0
  v_exp_f32 v80, v100
  v_mfma_f32_16x16x32_bf16 v[32:35], v[64:67], v[40:43], 0
  v_exp_f32 v81, v101
  v_mfma_f32_16x16x32_bf16 v[36:39], v[68:71], v[40:43], 0
  v_cvt_pk_bf16_f32 v44, v80, v81
  s_nop 5
  s_branch Lok_227
Lh2s_229:
  s_add_u32 s52, s52, 1
  s_mov_b32 s26, 0
Lh2t_230:
  s_waitcnt vmcnt(1)
  ds_write_b128 v126, v[24:27] offset:0
  s_waitcnt vmcnt(0)
  ds_write_b128 v126, v[28:31] offset:1024
  v_max3_u32 v127, v24, v25, v26
  v_max3_u32 v127, v127, v27, v28
  v_max3_u32 v127, v127, v29, v30
  v_max_u32 v127, v127, v31
  v_cmp_eq_u32 vcc, -1, v127
  s_cbranch_vccz Lh2g_231
  s_waitcnt lgkmcnt(0)
  buffer_load_dwordx4 v[24:27], v112, s[4:7], s23 offen offset:0 sc1
  buffer_load_dwordx4 v[28:31], v112, s[4:7], s23 offen offset:1024 sc1
  s_add_u32 s26, s26, 1
  s_and_b32 s29, s26, 63
  s_cmp_lg_u32 s29, 0
  s_cbranch_scc1 Lh2t_230
  buffer_wbl2 sc1
  s_waitcnt vmcnt(0)
  s_cmp_lt_u32 s26, 0x40000
  s_cbranch_scc1 Lh2t_230
  s_branch Labort_187
Lh2g_231:
  v_mov_b64 v[0:1], v[24:25]
  v_mov_b64 v[2:3], v[26:27]
  v_mov_b64 v[4:5], v[28:29]
  v_mov_b64 v[6:7], v[30:31]
  s_nop 0
  s_branch Lh2_228
Lkvs_240:
  s_mov_b32 s26, 0
Lkvt_295:
  s_and_b32 s29, s34, 1
  s_lshl_b32 s30, s20, 1
  s_add_u32 s29, s29, s30
  s_lshl_b32 s29, s29, 7
  s_add_u32 s29, s29, 4096
  s_sub_u32 s30, s41, 262144
  buffer_load_dword v125, v123, s[4:7], s30 offen sc1
  buffer_load_dword v125, off, s[4:7], s29 sc1
  s_waitcnt vmcnt(0)
  v_readfirstlane_b32 s30, v125
  s_bitcmp1_b32 s34, 0
  s_cselect_b32 s27, s27, s30
  s_cselect_b32 s28, s30, s28
  s_cmp_gt_u32 s30, s35
  s_cbranch_scc1 Lkv_239
  s_add_u32 s26, s26, 1
  s_and_b32 s29, s26, 4095
  s_cmp_lg_u32 s29, 0
  s_cbranch_scc1 Lkvt_295
  buffer_wbl2 sc1
  s_waitcnt vmcnt(0)
  s_cmp_lt_u32 s26, 0x40000
  s_cbranch_scc1 Lkvt_295
  s_branch Labort_187
Lh1s_242:
  s_add_u32 s53, s53, 1
  s_mov_b32 s26, 0
Lh1t_243:
  s_waitcnt vmcnt(3)
  v_mfma_f32_16x16x32_bf16 v[100:103], v[16:19], v[96:99], 0
  v_xor_b32 v126, s24, v16
  s_waitcnt vmcnt(2)
  v_mfma_f32_16x16x32_bf16 v[100:103], v[20:23], v[96:99], v[100:103]
  v_bitop3_b32 v126, v126, v20, s24 bitop3:0xf6
  s_waitcnt vmcnt(1)
  v_mfma_f32_16x16x32_bf16 v[100:103], v[24:27], v[96:99], v[100:103]
  v_bitop3_b32 v126, v126, v24, s24 bitop3:0xf6
  s_waitcnt vmcnt(0)
  v_mfma_f32_16x16x32_bf16 v[100:103], v[28:31], v[96:99], v[100:103]
  v_bitop3_b32 v126, v126, v28, s24 bitop3:0xf6
  v_and_b32 v126, 1, v126
  v_cmp_ne_u32 vcc, 0, v126
  s_nop 3
  s_cbranch_vccz Lh1_241
  buffer_load_dwordx4 v[16:19], v110, s[4:7], 0 offen offset:0 sc1
  buffer_load_dwordx4 v[20:23], v110, s[4:7], 0 offen offset:2048 sc1
  buffer_load_dwordx4 v[24:27], v110, s[4:7], s32 offen offset:0 sc1
  buffer_load_dwordx4 v[28:31], v110, s[4:7], s32 offen offset:2048 sc1
  s_add_u32 s26, s26, 1
  s_and_b32 s29, s26, 63
  s_cmp_lg_u32 s29, 0
  s_cbranch_scc1 Lh1t_243
  buffer_wbl2 sc1
  s_waitcnt vmcnt(0)
  s_cmp_lt_u32 s26, 0x40000
  s_cbranch_scc1 Lh1t_243
  s_branch Labort_187
Lh2s_245:
  s_add_u32 s52, s52, 1
  s_mov_b32 s26, 0
Lh2t_246:
  s_waitcnt vmcnt(1)
  ds_write_b128 v126, v[0:3] offset:0
  s_waitcnt vmcnt(0)
  ds_write_b128 v126, v[4:7] offset:1024
  v_max3_u32 v127, v0, v1, v2
  v_max3_u32 v127, v127, v3, v4
  v_max3_u32 v127, v127, v5, v6
  v_max_u32 v127, v127, v7
  v_cmp_eq_u32 vcc, -1, v127
  s_cbranch_vccz Lh2g_247
  s_waitcnt lgkmcnt(0)
  buffer_load_dwordx4 v[0:3], v112, s[4:7], s23 offen offset:0 sc1
  buffer_load_dwordx4 v[4:7], v112, s[4:7], s23 offen offset:1024 sc1
  s_add_u32 s26, s26, 1
  s_and_b32 s29, s26, 63
  s_cmp_lg_u32 s29, 0
  s_cbranch_scc1 Lh2t_246
  buffer_wbl2 sc1
  s_waitcnt vmcnt(0)
  s_cmp_lt_u32 s26, 0x40000
  s_cbranch_scc1 Lh2t_246
  s_branch Labort_187
Lh2g_247:
  v_mov_b64 v[8:9], v[0:1]
  v_mov_b64 v[10:11], v[2:3]
  v_mov_b64 v[12:13], v[4:5]
  v_mov_b64 v[14:15], v[6:7]
  s_nop 0
  s_branch Lh2_244
Lfb_248:
  s_nop 7
  v_max3_f32 v126, v88, v89, v90
  v_max3_f32 v127, v92, v93, v94
  v_max3_f32 v126, v126, v91, v95
  v_max3_f32 v127, v127, v100, v101
  v_max_f32 v126, v126, v127
  v_mov_b32 v127, v126
  s_nop 1
  v_permlane32_swap_b32 v126, v127
  v_max_f32 v126, v126, v127
  v_mov_b32 v127, v126
  s_nop 1
  v_permlane16_swap_b32 v126, v127
  v_max_f32 v126, v126, v127
  v_sub_f32 v88, v88, v126
  v_sub_f32 v89, v89, v126
  v_sub_f32 v90, v90, v126
  v_sub_f32 v91, v91, v126
  v_sub_f32 v92, v92, v126
  v_sub_f32 v93, v93, v126
  v_sub_f32 v94, v94, v126
  v_sub_f32 v95, v95, v126
  v_sub_f32 v100, v100, v126
  v_sub_f32 v101, v101, v126
  v_exp_f32 v80, v88
  v_exp_f32 v81, v89
  v_exp_f32 v82, v90
  v_exp_f32 v83, v91
  v_exp_f32 v84, v92
  v_exp_f32 v85, v93
  v_exp_f32 v86, v94
  v_exp_f32 v87, v95
  v_cvt_pk_bf16_f32 v40, v80, v81
  v_cvt_pk_bf16_f32 v41, v82, v83
  v_cvt_pk_bf16_f32 v42, v84, v85
  v_cvt_pk_bf16_f32 v43, v86, v87
  s_nop 1
  v_mfma_f32_16x16x32_bf16 v[48:51], v[104:107], v[40:43], 0
  v_exp_f32 v80, v100
  v_mfma_f32_16x16x32_bf16 v[32:35], v[64:67], v[40:43], 0
  v_exp_f32 v81, v101
  v_mfma_f32_16x16x32_bf16 v[36:39], v[68:71], v[40:43], 0
  v_cvt_pk_bf16_f32 v44, v80, v81
  s_nop 5
  s_branch Lok_249
Lh2s_251:
  s_add_u32 s52, s52, 1
  s_mov_b32 s26, 0
Lh2t_252:
  s_waitcnt vmcnt(1)
  ds_write_b128 v126, v[0:3] offset:0
  s_waitcnt vmcnt(0)
  ds_write_b128 v126, v[4:7] offset:1024
  v_max3_u32 v127, v0, v1, v2
  v_max3_u32 v127, v127, v3, v4
  v_max3_u32 v127, v127, v5, v6
  v_max_u32 v127, v127, v7
  v_cmp_eq_u32 vcc, -1, v127
  s_cbranch_vccz Lh2g_253
  s_waitcnt lgkmcnt(0)
  buffer_load_dwordx4 v[0:3], v112, s[4:7], s23 offen offset:0 sc1
  buffer_load_dwordx4 v[4:7], v112, s[4:7], s23 offen offset:1024 sc1
  s_add_u32 s26, s26, 1
  s_and_b32 s29, s26, 63
  s_cmp_lg_u32 s29, 0
  s_cbranch_scc1 Lh2t_252
  buffer_wbl2 sc1
  s_waitcnt vmcnt(0)
  s_cmp_lt_u32 s26, 0x40000
  s_cbranch_scc1 Lh2t_252
  s_branch Labort_187
Lh2g_253:
  v_mov_b64 v[8:9], v[0:1]
  v_mov_b64 v[10:11], v[2:3]
  v_mov_b64 v[12:13], v[4:5]
  v_mov_b64 v[14:15], v[6:7]
  s_nop 0
  s_branch Lh2_250
Lkvs_262:
  s_mov_b32 s26, 0
Lkvt_296:
  s_and_b32 s29, s34, 1
  s_lshl_b32 s30, s20, 1
  s_add_u32 s29, s29, s30
  s_lshl_b32 s29, s29, 7
  s_add_u32 s29, s29, 4096
  buffer_load_dword v125, off, s[4:7], s29 sc1
  s_waitcnt vmcnt(0)
  v_readfirstlane_b32 s30, v125
  s_bitcmp1_b32 s34, 0
  s_cselect_b32 s27, s27, s30
  s_cselect_b32 s28, s30, s28
  s_cmp_gt_u32 s30, s35
  s_cbranch_scc1 Lkv_261
  s_add_u32 s26, s26, 1
  s_and_b32 s29, s26, 4095
  s_cmp_lg_u32 s29, 0
  s_cbranch_scc1 Lkvt_296
  buffer_wbl2 sc1
  s_waitcnt vmcnt(0)
  s_cmp_lt_u32 s26, 0x40000
  s_cbranch_scc1 Lkvt_296
  s_branch Labort_187
Lh2s_264:
  s_add_u32 s52, s52, 1
  s_mov_b32 s26, 0
Lh2t_265:
  s_waitcnt vmcnt(1)
  ds_write_b128 v126, v[8:11] offset:0
  s_waitcnt vmcnt(0)
  ds_write_b128 v126, v[12:15] offset:1024
  v_max3_u32 v127, v8, v9, v10
  v_max3_u32 v127, v127, v11, v12
  v_max3_u32 v127, v127, v13, v14
  v_max_u32 v127, v127, v15
  v_cmp_eq_u32 vcc, -1, v127
  s_cbranch_vccz Lh2g_266
  s_waitcnt lgkmcnt(0)
  buffer_load_dwordx4 v[8:11], v112, s[4:7], s23 offen offset:0 sc1
  buffer_load_dwordx4 v[12:15], v112, s[4:7], s23 offen offset:1024 sc1
  s_add_u32 s26, s26, 1
  s_and_b32 s29, s26, 63
  s_cmp_lg_u32 s29, 0
  s_cbranch_scc1 Lh2t_265
  buffer_wbl2 sc1
  s_waitcnt vmcnt(0)
  s_cmp_lt_u32 s26, 0x40000
  s_cbranch_scc1 Lh2t_265
  s_branch Labort_187
Lh2g_266:
  v_mov_b64 v[16:17], v[8:9]
  v_mov_b64 v[18:19], v[10:11]
  v_mov_b64 v[20:21], v[12:13]
  v_mov_b64 v[22:23], v[14:15]
  s_nop 0
  s_branch Lh2_263
Lfb_267:
  s_nop 7
  v_max3_f32 v126, v88, v89, v90
  v_max3_f32 v127, v92, v93, v94
  v_max3_f32 v126, v126, v91, v95
  v_max3_f32 v127, v127, v100, v101
  v_max_f32 v126, v126, v127
  v_mov_b32 v127, v126
  s_nop 1
  v_permlane32_swap_b32 v126, v127
  v_max_f32 v126, v126, v127
  v_mov_b32 v127, v126
  s_nop 1
  v_permlane16_swap_b32 v126, v127
  v_max_f32 v126, v126, v127
  v_sub_f32 v88, v88, v126
  v_sub_f32 v89, v89, v126
  v_sub_f32 v90, v90, v126
  v_sub_f32 v91, v91, v126
  v_sub_f32 v92, v92, v126
  v_sub_f32 v93, v93, v126
  v_sub_f32 v94, v94, v126
  v_sub_f32 v95, v95, v126
  v_sub_f32 v100, v100, v126
  v_sub_f32 v101, v101, v126
  v_exp_f32 v80, v88
  v_exp_f32 v81, v89
  v_exp_f32 v82, v90
  v_exp_f32 v83, v91
  v_exp_f32 v84, v92
  v_exp_f32 v85, v93
  v_exp_f32 v86, v94
  v_exp_f32 v87, v95
  v_cvt_pk_bf16_f32 v40, v80, v81
  v_cvt_pk_bf16_f32 v41, v82, v83
  v_cvt_pk_bf16_f32 v42, v84, v85
  v_cvt_pk_bf16_f32 v43, v86, v87
  s_nop 1
  v_mfma_f32_16x16x32_bf16 v[48:51], v[104:107], v[40:43], 0
  v_exp_f32 v80, v100
  v_mfma_f32_16x16x32_bf16 v[32:35], v[64:67], v[40:43], 0
  v_exp_f32 v81, v101
  v_mfma_f32_16x16x32_bf16 v[36:39], v[68:71], v[40:43], 0
  v_cvt_pk_bf16_f32 v44, v80, v81
  s_nop 5
  s_branch Lok_268
Lh2s_270:
  s_add_u32 s52, s52, 1
  s_mov_b32 s26, 0
Lh2t_271:
  s_waitcnt vmcnt(1)
  ds_write_b128 v126, v[8:11] offset:0
  s_waitcnt vmcnt(0)
  ds_write_b128 v126, v[12:15] offset:1024
  v_max3_u32 v127, v8, v9, v10
  v_max3_u32 v127, v127, v11, v12
  v_max3_u32 v127, v127, v13, v14
  v_max_u32 v127, v127, v15
  v_cmp_eq_u32 vcc, -1, v127
  s_cbranch_vccz Lh2g_272
  s_waitcnt lgkmcnt(0)
  buffer_load_dwordx4 v[8:11], v112, s[4:7], s23 offen offset:0 sc1
  buffer_load_dwordx4 v[12:15], v112, s[4:7], s23 offen offset:1024 sc1
  s_add_u32 s26, s26, 1
  s_and_b32 s29, s26, 63
  s_cmp_lg_u32 s29, 0
  s_cbranch_scc1 Lh2t_271
  buffer_wbl2 sc1
  s_waitcnt vmcnt(0)
  s_cmp_lt_u32 s26, 0x40000
  s_cbranch_scc1 Lh2t_271
  s_branch Labort_187
Lh2g_272:
  v_mov_b64 v[16:17], v[8:9]
  v_mov_b64 v[18:19], v[10:11]
  v_mov_b64 v[20:21], v[12:13]
  v_mov_b64 v[22:23], v[14:15]
  s_nop 0
  s_branch Lh2_269
Lkvs_281:
  s_mov_b32 s26, 0
Lkvt_297:
  s_and_b32 s29, s34, 1
  s_lshl_b32 s30, s20, 1
  s_add_u32 s29, s29, s30
  s_lshl_b32 s29, s29, 7
  s_add_u32 s29, s29, 4096
  buffer_load_dword v125, off, s[4:7], s29 sc1
  s_waitcnt vmcnt(0)
  v_readfirstlane_b32 s30, v125
  s_bitcmp1_b32 s34, 0
  s_cselect_b32 s27, s27, s30
  s_cselect_b32 s28, s30, s28
  s_cmp_gt_u32 s30, s35
  s_cbranch_scc1 Lkv_280
  s_add_u32 s26, s26, 1
  s_and_b32 s29, s26, 4095
  s_cmp_lg_u32 s29, 0
  s_cbranch_scc1 Lkvt_297
  buffer_wbl2 sc1
  s_waitcnt vmcnt(0)
  s_cmp_lt_u32 s26, 0x40000
  s_cbranch_scc1 Lkvt_297
  s_branch Labort_187
Lh2s_283:
  s_add_u32 s52, s52, 1
  s_mov_b32 s26, 0
Lh2t_284:
  s_waitcnt vmcnt(1)
  ds_write_b128 v126, v[16:19] offset:0
  s_waitcnt vmcnt(0)
  ds_write_b128 v126, v[20:23] offset:1024
  v_max3_u32 v127, v16, v17, v18
  v_max3_u32 v127, v127, v19, v20
  v_max3_u32 v127, v127, v21, v22
  v_max_u32 v127, v127, v23
  v_cmp_eq_u32 vcc, -1, v127
  s_cbranch_vccz Lh2g_285
  s_waitcnt lgkmcnt(0)
  buffer_load_dwordx4 v[16:19], v112, s[4:7], s23 offen offset:0 sc1
  buffer_load_dwordx4 v[20:23], v112, s[4:7], s23 offen offset:1024 sc1
  s_add_u32 s26, s26, 1
  s_and_b32 s29, s26, 63
  s_cmp_lg_u32 s29, 0
  s_cbranch_scc1 Lh2t_284
  buffer_wbl2 sc1
  s_waitcnt vmcnt(0)
  s_cmp_lt_u32 s26, 0x40000
  s_cbranch_scc1 Lh2t_284
  s_branch Labort_187
Lh2g_285:
  v_mov_b64 v[24:25], v[16:17]
  v_mov_b64 v[26:27], v[18:19]
  v_mov_b64 v[28:29], v[20:21]
  v_mov_b64 v[30:31], v[22:23]
  s_nop 0
  s_branch Lh2_282
Lkvs_289:
  s_mov_b32 s26, 0
Lkvt_298:
  s_and_b32 s29, s34, 1
  s_lshl_b32 s30, s20, 1
  s_add_u32 s29, s29, s30
  s_lshl_b32 s29, s29, 7
  s_add_u32 s29, s29, 4096
  buffer_load_dword v125, off, s[4:7], s29 sc1
  s_waitcnt vmcnt(0)
  v_readfirstlane_b32 s30, v125
  s_bitcmp1_b32 s34, 0
  s_cselect_b32 s27, s27, s30
  s_cselect_b32 s28, s30, s28
  s_cmp_gt_u32 s30, s35
  s_cbranch_scc1 Lkv_288
  s_add_u32 s26, s26, 1
  s_and_b32 s29, s26, 4095
  s_cmp_lg_u32 s29, 0
  s_cbranch_scc1 Lkvt_298
  buffer_wbl2 sc1
  s_waitcnt vmcnt(0)
  s_cmp_lt_u32 s26, 0x40000
  s_cbranch_scc1 Lkvt_298
  s_branch Labort_187
Lfb_286:
  s_nop 7
  v_max3_f32 v126, v88, v89, v90
  v_max3_f32 v127, v92, v93, v94
  v_max3_f32 v126, v126, v91, v95
  v_max3_f32 v127, v127, v100, v101
  v_max_f32 v126, v126, v127
  v_mov_b32 v127, v126
  s_nop 1
  v_permlane32_swap_b32 v126, v127
  v_max_f32 v126, v126, v127
  v_mov_b32 v127, v126
  s_nop 1
  v_permlane16_swap_b32 v126, v127
  v_max_f32 v126, v126, v127
  v_sub_f32 v88, v88, v126
  v_sub_f32 v89, v89, v126
  v_sub_f32 v90, v90, v126
  v_sub_f32 v91, v91, v126
  v_sub_f32 v92, v92, v126
  v_sub_f32 v93, v93, v126
  v_sub_f32 v94, v94, v126
  v_sub_f32 v95, v95, v126
  v_sub_f32 v100, v100, v126
  v_sub_f32 v101, v101, v126
  v_exp_f32 v80, v88
  v_exp_f32 v81, v89
  v_exp_f32 v82, v90
  v_exp_f32 v83, v91
  v_exp_f32 v84, v92
  v_exp_f32 v85, v93
  v_exp_f32 v86, v94
  v_exp_f32 v87, v95
  v_cvt_pk_bf16_f32 v40, v80, v81
  v_cvt_pk_bf16_f32 v41, v82, v83
  v_cvt_pk_bf16_f32 v42, v84, v85
  v_cvt_pk_bf16_f32 v43, v86, v87
  s_nop 1
  v_mfma_f32_16x16x32_bf16 v[48:51], v[104:107], v[40:43], 0
  v_exp_f32 v80, v100
  v_mfma_f32_16x16x32_bf16 v[32:35], v[64:67], v[40:43], 0
  v_exp_f32 v81, v101
  v_mfma_f32_16x16x32_bf16 v[36:39], v[68:71], v[40:43], 0
  v_cvt_pk_bf16_f32 v44, v80, v81
  s_nop 5
  s_branch Lok_287
Lh2s_291:
  s_add_u32 s52, s52, 1
  s_mov_b32 s26, 0
Lh2t_292:
  s_waitcnt vmcnt(1)
  ds_write_b128 v126, v[16:19] offset:0
  s_waitcnt vmcnt(0)
  ds_write_b128 v126, v[20:23] offset:1024
  v_max3_u32 v127, v16, v17, v18
  v_max3_u32 v127, v127, v19, v20
  v_max3_u32 v127, v127, v21, v22
  v_max_u32 v127, v127, v23
  v_cmp_eq_u32 vcc, -1, v127
  s_cbranch_vccz Lh2g_293
  s_waitcnt lgkmcnt(0)
  buffer_load_dwordx4 v[16:19], v112, s[4:7], s23 offen offset:0 sc1
  buffer_load_dwordx4 v[20:23], v112, s[4:7], s23 offen offset:1024 sc1
  s_add_u32 s26, s26, 1
  s_and_b32 s29, s26, 63
  s_cmp_lg_u32 s29, 0
  s_cbranch_scc1 Lh2t_292
  buffer_wbl2 sc1
  s_waitcnt vmcnt(0)
  s_cmp_lt_u32 s26, 0x40000
  s_cbranch_scc1 Lh2t_292
  s_branch Labort_187
Lh2g_293:
  v_mov_b64 v[24:25], v[16:17]
  v_mov_b64 v[26:27], v[18:19]
  v_mov_b64 v[28:29], v[20:21]
  v_mov_b64 v[30:31], v[22:23]
  s_nop 0
  s_branch Lh2_290
Labort_187:
  buffer_wbl2 sc1
  s_waitcnt vmcnt(0)
Lfin_188:
L_end:
L_last:
  s_endpgm
.section .rodata,"a"
.p2align 6
.amdhsa_kernel interleave_layers__linear_attn_block__memory_aug_recurrent_mem_tr__prompt_kernel
  .amdhsa_next_free_vgpr 512
  .amdhsa_next_free_sgpr 102
  .amdhsa_accum_offset 256
  .amdhsa_group_segment_fixed_size 0
  .amdhsa_kernarg_size 104
  .amdhsa_user_sgpr_count 2
  .amdhsa_user_sgpr_kernarg_segment_ptr 1
  .amdhsa_system_sgpr_workgroup_id_x 1
.end_amdhsa_kernel
```
